```python
import torch

def _softmax(x, axis=-1):
    return torch.softmax(x, dim=axis)
def _gelu(x):
    return torch.nn.functional.gelu(x, approximate="tanh")
def _silu(x):
    return torch.nn.functional.silu(x)
def _sigmoid(x):
    return torch.sigmoid(x)
def _layernorm(x, axis=-1, eps=1e-5):
    m = x.mean(dim=axis, keepdim=True)
    v = x.var(dim=axis, keepdim=True, unbiased=False)
    return (x - m) / torch.sqrt(v + eps)
def _scatter_add(tgt, idx, src, axis=0):
    return tgt.clone().index_add_(axis, idx, src)
def _segment_sum(src, seg, n):
    out = torch.zeros((n,) + src.shape[1:], dtype=src.dtype)
    return out.index_add_(0, seg, src)
def _pad(x, pw):
    flat = tuple(v for pair in reversed(pw) for v in pair)
    return torch.nn.functional.pad(x, flat)

kernel_name = 'interleave_layers__sliding_local_dilated__glu_gated_bilinear__prompt'

def setup_inputs():

    _w = (lambda a: (lambda t: t.to(torch.bfloat16) if t.is_floating_point() else t)(torch.as_tensor(a)))
    def _A_setup():
        B, S, D = 1, 2048, 640
        return {
            "x": _w((lambda *s: torch.randn(*s, dtype=torch.bfloat16) * 0.05)(B, S, D)),
            "wqkv": _w((lambda *s: torch.randn(*s, dtype=torch.bfloat16) * 0.05)(D, 3 * D)),
            "wo": _w((lambda *s: torch.randn(*s, dtype=torch.bfloat16) * 0.05)(D, D)),
        }
    _A_in = _A_setup()

    def _B_setup():
        B, S, D, F = 1, 2048, 640, 1728
        return {
            "x": _w((lambda *s: torch.randn(*s, dtype=torch.bfloat16) * 0.05)(B, S, D)),
            "w_gate": _w((lambda *s: torch.randn(*s, dtype=torch.bfloat16) * 0.8)(D, F) * (D ** -0.5)),
            "w_up": _w((lambda *s: torch.randn(*s, dtype=torch.bfloat16) * 0.8)(D, F) * (D ** -0.5)),
            "w_down": _w((lambda *s: torch.randn(*s, dtype=torch.bfloat16) * 0.8)(F, D) * (F ** -0.5)),
        }
    _B_in = _B_setup()

    return {
        "A_x": _A_in["x"],
        "A_wqkv": _A_in["wqkv"],
        "A_wo": _A_in["wo"],
        "B_x": _B_in["x"],
        "B_w_gate": _B_in["w_gate"],
        "B_w_up": _B_in["w_up"],
        "B_w_down": _B_in["w_down"],
    }

def reference(A_x, A_wqkv, A_wo, B_x, B_w_gate, B_w_up, B_w_down):
    def _A_ref(x, wqkv, wo):
        B, S, D = x.shape
        H = 32; Dh = D // H
        W, dil = 8, 2
        qkv = (lambda x, *d: x.permute(*d))((x @ wqkv).reshape(B, S, 3, H, Dh), 2, 0, 3, 1, 4)
        q, k, v = qkv[0], qkv[1], qkv[2]
        scale = Dh ** -0.5
        pos = torch.arange(S)
        off = torch.arange(W) * dil
        idx = pos[:, None] - off[None, :]
        mask = idx >= 0
        idx_c = torch.where(mask, idx, 0).reshape(-1)
        kg = k[:, :, idx_c, :].reshape(B, H, S, W, Dh)
        vg = v[:, :, idx_c, :].reshape(B, H, S, W, Dh)
        logits = torch.einsum("bhsd,bhswd->bhsw", q, kg) * scale
        logits = torch.where(mask[None, None, :, :], logits, -1e9)
        attn = _softmax(logits, axis=-1)
        o = torch.einsum("bhsw,bhswd->bhsd", attn, vg)
        return (lambda x, *d: x.permute(*d))(o, 0, 2, 1, 3).reshape(B, S, D) @ wo

    def _B_ref(x, w_gate, w_up, w_down):
        g = torch.einsum("bsd,df->bsf", x, w_gate)
        u = torch.einsum("bsd,df->bsf", x, w_up)
        h = g * u
        return torch.einsum("bsf,fd->bsd", h, w_down)

    x = A_x
    x = x + _A_ref(_layernorm(x, axis=-1), A_wqkv, A_wo)
    x = x + _B_ref(_layernorm(x, axis=-1), B_w_gate, B_w_up, B_w_down)
    x = x + _A_ref(_layernorm(x, axis=-1), A_wqkv, A_wo)
    x = x + _B_ref(_layernorm(x, axis=-1), B_w_gate, B_w_up, B_w_down)
    return x
```

```asm
; @launch grid=(256,1,1) block=(256,1,1) lds=147456
.amdgcn_target "amdgcn-amd-amdhsa--gfx950"
.text
.globl interleave_layers__sliding_local_dilated__glu_gated_bilinear__prompt_kernel
.p2align 8
.type interleave_layers__sliding_local_dilated__glu_gated_bilinear__prompt_kernel,@function
interleave_layers__sliding_local_dilated__glu_gated_bilinear__prompt_kernel:
s_cmp_ge_u32 s2, 256
s_cbranch_scc1 L_END
s_load_dwordx16 s[16:31], s[0:1], 0
s_load_dwordx4 s[32:35], s[0:1], 64
v_lshrrev_b32 v12, 6, v0
v_and_b32 v2, 63, v0
v_readfirstlane_b32 s3, v12
v_lshlrev_b32 v1, 4, v2
v_and_b32 v3, 15, v0
v_lshrrev_b32 v4, 4, v2
v_mov_b32 v8, 0
v_mov_b32 v10, 0
v_mov_b32 v9, 0
v_mov_b32 v13, 0x7ff00000
v_cmp_gt_u32 vcc, 40, v2
s_nop 1
v_cndmask_b32 v11, v13, v1, vcc
s_and_b32 s4, s2, 7
s_lshr_b32 s5, s2, 3
s_mov_b32 s76, 0x3acccccd
s_mov_b32 s77, 0x3727c5ac
s_mov_b32 s78, 0x3ea52b5c
s_getreg_b32 s7, hwreg(HW_REG_XCC_ID, 0, 4)
s_and_b32 s7, s7, 7
s_and_b32 s8, s7, 3
s_lshl_b32 s8, s8, 3
s_lshl_b32 s69, 1, s8
s_lshl_b32 s13, s69, 5
s_and_b32 s7, s7, 4
s_lshl_b32 s8, s4, 5
s_add_u32 s8, s8, s7
v_mov_b32 v12, s8
v_cmp_eq_u32 vcc, 0, v0
s_nop 1
v_cndmask_b32 v14, v13, v12, vcc
v_mov_b32 v15, s69
s_waitcnt lgkmcnt(0)
s_cmp_eq_u32 s7, 0
s_cselect_b32 s22, s13, 0
s_cselect_b32 s23, 0, s13
s_mov_b32 s52, s32
s_mov_b32 s53, s33
s_mov_b32 s54, 0x100
s_mov_b32 s55, 0x20000
s_mov_b32 s36, s34
s_mov_b32 s37, s35
s_mov_b32 s38, 0x4000000
s_mov_b32 s39, 0x20000
s_mov_b32 s40, s34
s_mov_b32 s41, s35
s_mov_b32 s42, 0x4000000
s_mov_b32 s43, 0x20000
s_mov_b32 s44, s34
s_mov_b32 s45, s35
s_mov_b32 s46, 0x0
s_mov_b32 s47, 0x20000
s_mov_b32 s60, s34
s_mov_b32 s61, s35
s_mov_b32 s62, 0x0
s_mov_b32 s63, 0x20000
s_mov_b32 s56, s16
s_mov_b32 s57, s17
s_mov_b32 s58, 0x280000
s_mov_b32 s59, 0x20000
s_mov_b32 s48, s18
s_mov_b32 s49, s19
s_mov_b32 s50, 0x258000
s_mov_b32 s51, 0x20000
v_mov_b32 v254, v15
v_mov_b32 v255, v14
s_mov_b32 s64, 0
s_mov_b32 s0, 0
s_mov_b32 s1, 0
s_mov_b32 s79, 1
s_mov_b32 s14, 0
s_mov_b32 s67, 0
s_mov_b32 s68, 0
s_mov_b32 s101, 0
s_mov_b32 s74, 0x4000000
s_mul_i32 s9, s4, 17
s_cmp_lt_u32 s5, 8
s_cbranch_scc1 K1_START
s_cmp_lt_u32 s5, 15
s_cbranch_scc1 K4_START
s_cmp_lt_u32 s5, 18
s_cbranch_scc1 K2_START
s_branch K3_START
K1_START:
s_sub_u32 s6, s5, 0
s_lshl_b32 s71, s6, 2
s_add_u32 s71, s71, s3
s_mov_b32 s73, s71
s_mul_i32 s69, s3, 5
s_lshl_b32 s7, s4, 15
s_lshl_b32 s8, s73, 7
s_add_u32 s8, s8, s7
s_add_u32 s8, s8, 0
v_mov_b32 v12, s8
v_mov_b32 v13, 0x7ff00000
v_cmp_eq_u32 vcc, 0, v2
s_nop 1
v_cndmask_b32 v7, v13, v12, vcc
s_add_u32 s7, s7, 24576
v_min_u32 v5, 4, v2
buffer_store_dword v8, v7, s[36:39], 0 offen sc1
v_add_u32 v5, s69, v5
v_lshl_add_u32 v5, v5, 7, s7
s_lshl_b32 s7, s4, 15
s_add_u32 s7, s7, 11648
v_min_u32 v12, 7, v2
v_lshl_add_u32 v12, v12, 7, s7
v_cmp_lt_u32 vcc, 4, v2
s_nop 1
v_cndmask_b32 v5, v5, v12, vcc
v_lshlrev_b32 v12, 2, v4
v_xor_b32 v12, v12, v3
s_lshr_b32 s7, s3, 1
s_and_b32 s8, s3, 1
v_mov_b32 v15, 0x7ff00000
s_mul_i32 s7, s6, 160
s_and_b32 s75, s7, 127
s_andn2_b32 s7, s7, 127
v_lshl_add_u32 v14, v12, 4, s7
s_mul_i32 s15, s3, 30720
v_cmp_gt_u32 vcc, 3840, v14
s_nop 1
v_cndmask_b32 v14, v15, v14, vcc
v_mul_u32_u24 v13, 3840, v4
v_add_u32 v88, v13, v14
s_lshl_b32 s70, s3, 11
s_add_u32 s13, s15, 2457600
s_mul_i32 s7, s4, 5
s_lshr_b32 s7, s7, 1
s_mul_i32 s7, s7, 122880
s_add_u32 s15, s15, s7
s_add_u32 m0, s70, 0
s_add_u32 s7, s15, 0
buffer_load_dwordx4 v88, s[48:51], s7 offen lds
s_add_u32 m0, s70, 8192
s_add_u32 s7, s15, 1280
buffer_load_dwordx4 v88, s[48:51], s7 offen lds
s_add_u32 m0, s70, 16384
s_add_u32 s7, s15, 2560
buffer_load_dwordx4 v88, s[48:51], s7 offen lds
s_add_u32 m0, s70, 1024
s_add_u32 s7, s15, 15360
buffer_load_dwordx4 v88, s[48:51], s7 offen lds
s_add_u32 m0, s70, 9216
s_add_u32 s7, s15, 16640
buffer_load_dwordx4 v88, s[48:51], s7 offen lds
s_add_u32 m0, s70, 17408
s_add_u32 s7, s15, 17920
buffer_load_dwordx4 v88, s[48:51], s7 offen lds
s_add_u32 s15, s15, 122880
s_cmp_ge_u32 s15, s13
s_cselect_b32 s7, 2457600, 0
s_sub_u32 s15, s15, s7
s_add_u32 m0, s70, 24576
s_add_u32 s7, s15, 0
buffer_load_dwordx4 v88, s[48:51], s7 offen lds
s_add_u32 m0, s70, 32768
s_add_u32 s7, s15, 1280
buffer_load_dwordx4 v88, s[48:51], s7 offen lds
s_add_u32 m0, s70, 40960
s_add_u32 s7, s15, 2560
buffer_load_dwordx4 v88, s[48:51], s7 offen lds
s_add_u32 m0, s70, 25600
s_add_u32 s7, s15, 15360
buffer_load_dwordx4 v88, s[48:51], s7 offen lds
s_add_u32 m0, s70, 33792
s_add_u32 s7, s15, 16640
buffer_load_dwordx4 v88, s[48:51], s7 offen lds
s_add_u32 m0, s70, 41984
s_add_u32 s7, s15, 17920
buffer_load_dwordx4 v88, s[48:51], s7 offen lds
s_add_u32 s15, s15, 122880
s_cmp_ge_u32 s15, s13
s_cselect_b32 s7, 2457600, 0
s_sub_u32 s15, s15, s7
s_add_u32 m0, s70, 49152
s_add_u32 s7, s15, 0
buffer_load_dwordx4 v88, s[48:51], s7 offen lds
s_add_u32 m0, s70, 57344
s_add_u32 s7, s15, 1280
buffer_load_dwordx4 v88, s[48:51], s7 offen lds
s_add_u32 m0, s70, 65536
s_add_u32 s7, s15, 2560
buffer_load_dwordx4 v88, s[48:51], s7 offen lds
s_add_u32 m0, s70, 50176
s_add_u32 s7, s15, 15360
buffer_load_dwordx4 v88, s[48:51], s7 offen lds
s_add_u32 m0, s70, 58368
s_add_u32 s7, s15, 16640
buffer_load_dwordx4 v88, s[48:51], s7 offen lds
s_add_u32 m0, s70, 66560
s_add_u32 s7, s15, 17920
buffer_load_dwordx4 v88, s[48:51], s7 offen lds
s_add_u32 s15, s15, 122880
s_cmp_ge_u32 s15, s13
s_cselect_b32 s7, 2457600, 0
s_sub_u32 s15, s15, s7
s_add_u32 m0, s70, 73728
s_add_u32 s7, s15, 0
buffer_load_dwordx4 v88, s[48:51], s7 offen lds
s_add_u32 m0, s70, 81920
s_add_u32 s7, s15, 1280
buffer_load_dwordx4 v88, s[48:51], s7 offen lds
s_add_u32 m0, s70, 90112
s_add_u32 s7, s15, 2560
buffer_load_dwordx4 v88, s[48:51], s7 offen lds
s_add_u32 m0, s70, 74752
s_add_u32 s7, s15, 15360
buffer_load_dwordx4 v88, s[48:51], s7 offen lds
s_add_u32 m0, s70, 82944
s_add_u32 s7, s15, 16640
buffer_load_dwordx4 v88, s[48:51], s7 offen lds
s_add_u32 m0, s70, 91136
s_add_u32 s7, s15, 17920
buffer_load_dwordx4 v88, s[48:51], s7 offen lds
s_add_u32 s15, s15, 122880
s_cmp_ge_u32 s15, s13
s_cselect_b32 s7, 2457600, 0
s_sub_u32 s15, s15, s7
v_lshrrev_b32 v12, 2, v3
v_and_b32 v13, 3, v3
v_lshl_add_u32 v14, v4, 3, v12
v_lshlrev_b32 v14, 8, v14
v_lshlrev_b32 v12, 2, v12
s_mul_i32 s7, s3, 40
s_add_u32 s7, s7, s75
s_add_u32 s7, s7, 0
v_lshl_add_u32 v15, v13, 3, s7
v_bfe_u32 v84, v15, 4, 4
v_xor_b32 v84, v84, v12
v_lshl_add_u32 v80, v84, 4, v14
v_lshrrev_b32 v84, 8, v15
v_lshl_add_u32 v80, v84, 13, v80
v_and_b32 v84, 8, v15
v_add_u32 v80, v80, v84
s_mul_i32 s7, s3, 40
s_add_u32 s7, s7, s75
s_add_u32 s7, s7, 256
v_lshl_add_u32 v15, v13, 3, s7
v_bfe_u32 v84, v15, 4, 4
v_xor_b32 v84, v84, v12
v_lshl_add_u32 v81, v84, 4, v14
v_lshrrev_b32 v84, 8, v15
v_lshl_add_u32 v81, v84, 13, v81
v_and_b32 v84, 8, v15
v_add_u32 v81, v81, v84
s_mul_i32 s7, s3, 40
s_add_u32 s7, s7, s75
v_mov_b32 v15, 288
v_mov_b32 v84, 520
v_cmp_eq_u32 vcc, 1, v13
s_nop 1
v_cndmask_b32 v15, v15, v84, vcc
v_mov_b32 v84, 528
v_cmp_eq_u32 vcc, 2, v13
s_nop 1
v_cndmask_b32 v15, v15, v84, vcc
v_mov_b32 v84, 536
v_cmp_eq_u32 vcc, 3, v13
s_nop 1
v_cndmask_b32 v15, v15, v84, vcc
v_add_u32 v15, s7, v15
v_bfe_u32 v84, v15, 4, 4
v_xor_b32 v84, v84, v12
v_lshl_add_u32 v82, v84, 4, v14
v_lshrrev_b32 v84, 8, v15
v_lshl_add_u32 v82, v84, 13, v82
v_and_b32 v84, 8, v15
v_add_u32 v82, v82, v84
s_mul_i32 s7, s3, 40
s_add_u32 s7, s7, s75
v_mov_b32 v15, 32
v_mov_b32 v84, 512
v_cmp_eq_u32 vcc, 1, v13
s_nop 1
v_cndmask_b32 v15, v15, v84, vcc
v_mov_b32 v84, 544
v_cmp_eq_u32 vcc, 2, v13
s_nop 1
v_cndmask_b32 v15, v15, v84, vcc
v_mov_b32 v84, 544
v_cmp_eq_u32 vcc, 3, v13
s_nop 1
v_cndmask_b32 v15, v15, v84, vcc
v_add_u32 v15, s7, v15
v_bfe_u32 v84, v15, 4, 4
v_xor_b32 v84, v84, v12
v_lshl_add_u32 v83, v84, 4, v14
v_lshrrev_b32 v84, 8, v15
v_lshl_add_u32 v83, v84, 13, v83
v_and_b32 v84, 8, v15
v_add_u32 v83, v83, v84
v_lshrrev_b32 v15, 2, v3
v_lshl_add_u32 v15, v13, 2, v15
v_lshl_add_u32 v15, v4, 4, v15
v_lshlrev_b32 v89, 2, v15
v_mov_b32 v84, 0x3f803f80
v_mov_b32 v85, 0x3f803f80
v_mov_b32 v86, 0x3f803f80
v_mov_b32 v87, 0x3f803f80
s_mul_i32 s10, s9, 24576
s_add_u32 s12, s10, 327680
s_mul_i32 s7, s3, 6144
s_add_u32 s10, s10, s7
s_add_u32 s10, s10, 327680
s_mov_b32 s66, s10
s_add_u32 s72, s7, 98304
s_mul_i32 s11, s9, 24576
s_add_u32 s11, s11, 7012352
s_mov_b32 s100, 24576
v_mov_b32 v48, 0
v_mov_b32 v49, 0
v_mov_b32 v50, 0
v_mov_b32 v51, 0
v_mov_b32 v52, 0
v_mov_b32 v53, 0
v_mov_b32 v54, 0
v_mov_b32 v55, 0
v_mov_b32 v56, 0
v_mov_b32 v57, 0
v_mov_b32 v58, 0
v_mov_b32 v59, 0
v_mov_b32 v60, 0
v_mov_b32 v61, 0
v_mov_b32 v62, 0
v_mov_b32 v63, 0
v_mov_b32 v64, 0
v_mov_b32 v65, 0
v_mov_b32 v66, 0
v_mov_b32 v67, 0
v_mov_b32 v68, 0
v_mov_b32 v69, 0
v_mov_b32 v70, 0
v_mov_b32 v71, 0
v_mov_b32 v72, 0
v_mov_b32 v73, 0
v_mov_b32 v74, 0
v_mov_b32 v75, 0
v_mov_b32 v76, 0
v_mov_b32 v77, 0
v_mov_b32 v78, 0
v_mov_b32 v79, 0
v_add_u32 v96, 98304, v1
v_mul_u32_u24 v12, 6144, v4
v_lshl_add_u32 v12, v3, 3, v12
v_add_u32 v99, 103424, v12
v_mov_b32 v126, 0
v_mov_b32 v127, 0
v_mov_b32 v128, 0
v_mov_b32 v129, 0
v_mov_b32 v130, 0
v_mov_b32 v131, 0
s_lshr_b32 s8, s71, 3
s_lshl_b32 s8, s8, 1
s_add_u32 s7, s71, s8
s_lshl_b32 s7, s7, 9
v_lshl_add_u32 v97, v2, 3, s7
s_lshl_b32 s8, s8, 2
s_add_u32 s7, s6, s8
s_add_u32 s7, s7, 8
s_lshl_b32 s7, s7, 9
s_lshl_b32 s8, s3, 7
s_add_u32 s7, s7, s8
v_lshl_add_u32 v12, v3, 3, s7
v_lshl_add_u32 v98, v4, 1, v12
s_lshr_b32 s7, s4, 1
s_cmp_eq_u32 s7, 0
s_cselect_b32 s73, 1, 99
v_lshlrev_b32 v12, 2, v4
v_sub_u32 v12, v3, v12
v_mov_b32 v14, 0xf149f2ca
v_mov_b32 v116, 0
v_mov_b32 v117, 0
v_mov_b32 v132, 0
v_mov_b32 v133, 0
v_mov_b32 v134, 0
v_mov_b32 v135, 0
v_mov_b32 v136, 0
v_mov_b32 v137, 0
v_mov_b32 v138, 0
v_mov_b32 v139, 0
v_mov_b32 v156, 0
v_mov_b32 v157, 0
v_mov_b32 v158, 0
v_mov_b32 v159, 0
v_mov_b32 v160, 0
v_mov_b32 v161, 0
v_mov_b32 v162, 0
v_mov_b32 v163, 0
v_mov_b32 v172, 0
v_mov_b32 v173, 0
v_mov_b32 v174, 0
v_mov_b32 v175, 0
v_mov_b32 v176, 0
v_mov_b32 v177, 0
v_mov_b32 v178, 0
v_mov_b32 v179, 0
v_mov_b32 v184, 0
v_mov_b32 v185, 0
v_mov_b32 v186, 0
v_mov_b32 v187, 0
v_mov_b32 v188, 0
v_mov_b32 v189, 0
v_mov_b32 v190, 0
v_mov_b32 v191, 0
v_subrev_u32 v13, 0, v12
v_cmp_gt_u32 vcc, 8, v13
s_nop 1
v_cndmask_b32 v168, v14, 0, vcc
v_cmp_gt_i32 s[88:89], -8, v13
s_nop 1
v_cndmask_b32 v164, v14, 0, s[88:89]
v_cmp_le_i32 s[80:81], 0, v13
v_mov_b32 v15, 0xffff
s_nop 0
v_cndmask_b32 v15, 0, v15, s[80:81]
v_or_b32 v116, v116, v15
v_cmp_eq_u32 vcc, 0, v13
v_mov_b32 v15, 0x3f80
s_nop 0
v_cndmask_b32 v15, 0, v15, vcc
v_or_b32 v172, v172, v15
v_mov_b32 v15, 0x3f80
v_cmp_eq_u32 vcc, 16, v2
s_nop 1
v_cndmask_b32 v13, 0, v15, vcc
v_or_b32 v174, v174, v13
v_cmp_eq_u32 vcc, 32, v2
s_nop 1
v_cndmask_b32 v13, 0, v15, vcc
v_or_b32 v178, v178, v13
v_subrev_u32 v13, 1, v12
v_cmp_gt_u32 vcc, 8, v13
s_nop 1
v_cndmask_b32 v169, v14, 0, vcc
v_cmp_gt_i32 s[90:91], -8, v13
s_nop 1
v_cndmask_b32 v165, v14, 0, s[90:91]
v_cmp_le_i32 s[82:83], 0, v13
v_mov_b32 v15, 0xffff0000
s_nop 0
v_cndmask_b32 v15, 0, v15, s[82:83]
v_or_b32 v116, v116, v15
v_cmp_eq_u32 vcc, 0, v13
v_mov_b32 v15, 0x3f800000
s_nop 0
v_cndmask_b32 v15, 0, v15, vcc
v_or_b32 v172, v172, v15
v_mov_b32 v15, 0x3f800000
v_cmp_eq_u32 vcc, 17, v2
s_nop 1
v_cndmask_b32 v13, 0, v15, vcc
v_or_b32 v174, v174, v13
v_cmp_eq_u32 vcc, 36, v2
s_nop 1
v_cndmask_b32 v13, 0, v15, vcc
v_or_b32 v178, v178, v13
v_subrev_u32 v13, 2, v12
v_cmp_gt_u32 vcc, 8, v13
s_nop 1
v_cndmask_b32 v170, v14, 0, vcc
v_cmp_gt_i32 s[92:93], -8, v13
s_nop 1
v_cndmask_b32 v166, v14, 0, s[92:93]
v_cmp_le_i32 s[84:85], 0, v13
v_mov_b32 v15, 0xffff
s_nop 0
v_cndmask_b32 v15, 0, v15, s[84:85]
v_or_b32 v117, v117, v15
v_cmp_eq_u32 vcc, 0, v13
v_mov_b32 v15, 0x3f80
s_nop 0
v_cndmask_b32 v15, 0, v15, vcc
v_or_b32 v173, v173, v15
v_mov_b32 v15, 0x3f80
v_cmp_eq_u32 vcc, 18, v2
s_nop 1
v_cndmask_b32 v13, 0, v15, vcc
v_or_b32 v175, v175, v13
v_cmp_eq_u32 vcc, 40, v2
s_nop 1
v_cndmask_b32 v13, 0, v15, vcc
v_or_b32 v179, v179, v13
v_subrev_u32 v13, 3, v12
v_cmp_gt_u32 vcc, 8, v13
s_nop 1
v_cndmask_b32 v171, v14, 0, vcc
v_cmp_gt_i32 s[94:95], -8, v13
s_nop 1
v_cndmask_b32 v167, v14, 0, s[94:95]
v_cmp_le_i32 s[86:87], 0, v13
v_mov_b32 v15, 0xffff0000
s_nop 0
v_cndmask_b32 v15, 0, v15, s[86:87]
v_or_b32 v117, v117, v15
v_cmp_eq_u32 vcc, 0, v13
v_mov_b32 v15, 0x3f800000
s_nop 0
v_cndmask_b32 v15, 0, v15, vcc
v_or_b32 v173, v173, v15
v_mov_b32 v15, 0x3f800000
v_cmp_eq_u32 vcc, 19, v2
s_nop 1
v_cndmask_b32 v13, 0, v15, vcc
v_or_b32 v175, v175, v13
v_cmp_eq_u32 vcc, 44, v2
s_nop 1
v_cndmask_b32 v13, 0, v15, vcc
v_or_b32 v179, v179, v13
s_mov_b32 s56, 0xffff
s_mov_b32 s57, 0
v_cndmask_b32 v172, v172, 0, s[56:57]
v_cndmask_b32 v173, v173, 0, s[56:57]
v_and_b32 v13, 3, v3
v_cmp_eq_u32 vcc, 1, v13
s_nop 1
v_cndmask_b32 v180, 0, 1.0, vcc
v_cndmask_b32 v181, 0, 1.0, vcc
v_cndmask_b32 v182, 0, 1.0, vcc
v_cndmask_b32 v183, 0, 1.0, vcc
s_mov_b32 s60, s12
v_and_b32 v12, 1, v2
v_cmp_eq_u32 vcc, 1, v12
s_nop 1
v_cndmask_b32 v13, v97, v98, vcc
v_add_u32 v13, 6684672, v13
s_and_b32 s7, s71, 7
s_mul_i32 s7, s7, 6
v_add_u32 v14, s7, v3
v_min_u32 v14, 44, v14
s_lshr_b32 s7, s71, 3
s_mul_i32 s7, s7, 6144
s_add_u32 s7, s7, 24576
v_lshl_add_u32 v14, v14, 7, s7
v_cmp_gt_u32 vcc, 6, v2
s_nop 1
v_cndmask_b32 v4, v13, v14, vcc
v_mov_b32 v12, v116
v_mov_b32 v13, v117
s_mov_b32 s65, 2
s_waitcnt vmcnt(18)
s_barrier
buffer_atomic_add v254, v255, s[52:55], 0 offen sc1
s_add_u32 m0, s70, 122880
s_add_u32 s7, s15, 0
buffer_load_dwordx4 v88, s[48:51], s7 offen lds
ds_read_b64_tr_b16 a[0:1], v80 offset:0
ds_read_b64_tr_b16 a[2:3], v80 offset:1024
s_add_u32 m0, s70, 131072
s_add_u32 s7, s15, 1280
buffer_load_dwordx4 v88, s[48:51], s7 offen lds
ds_read_b64_tr_b16 a[4:5], v81 offset:0
ds_read_b64_tr_b16 a[6:7], v81 offset:1024
s_add_u32 m0, s70, 139264
s_add_u32 s7, s15, 2560
buffer_load_dwordx4 v88, s[48:51], s7 offen lds
ds_read_b64_tr_b16 a[8:9], v82 offset:0
ds_read_b64_tr_b16 a[10:11], v82 offset:1024
s_add_u32 m0, s70, 123904
s_add_u32 s7, s15, 15360
buffer_load_dwordx4 v88, s[48:51], s7 offen lds
ds_read_b64_tr_b16 a[12:13], v83 offset:0
ds_read_b64_tr_b16 a[14:15], v83 offset:1024
s_add_u32 m0, s70, 132096
s_add_u32 s7, s15, 16640
buffer_load_dwordx4 v88, s[48:51], s7 offen lds
s_add_u32 m0, s70, 140288
s_add_u32 s7, s15, 17920
buffer_load_dwordx4 v88, s[48:51], s7 offen lds
s_add_u32 s15, s15, 122880
s_cmp_ge_u32 s15, s13
s_cselect_b32 s7, 2457600, 0
s_sub_u32 s15, s15, s7
s_waitcnt lgkmcnt(0)
s_waitcnt vmcnt(19)
s_barrier
s_add_u32 m0, s70, 0
s_add_u32 s7, s15, 0
buffer_load_dwordx4 v88, s[48:51], s7 offen lds
ds_read_b64_tr_b16 a[16:17], v80 offset:24576
ds_read_b64_tr_b16 a[18:19], v80 offset:25600
s_add_u32 m0, s70, 8192
s_add_u32 s7, s15, 1280
buffer_load_dwordx4 v88, s[48:51], s7 offen lds
ds_read_b64_tr_b16 a[20:21], v81 offset:24576
ds_read_b64_tr_b16 a[22:23], v81 offset:25600
s_add_u32 m0, s70, 16384
s_add_u32 s7, s15, 2560
buffer_load_dwordx4 v88, s[48:51], s7 offen lds
ds_read_b64_tr_b16 a[24:25], v82 offset:24576
ds_read_b64_tr_b16 a[26:27], v82 offset:25600
s_add_u32 m0, s70, 1024
s_add_u32 s7, s15, 15360
buffer_load_dwordx4 v88, s[48:51], s7 offen lds
ds_read_b64_tr_b16 a[28:29], v83 offset:24576
ds_read_b64_tr_b16 a[30:31], v83 offset:25600
s_add_u32 m0, s70, 9216
s_add_u32 s7, s15, 16640
buffer_load_dwordx4 v88, s[48:51], s7 offen lds
s_add_u32 m0, s70, 17408
s_add_u32 s7, s15, 17920
buffer_load_dwordx4 v88, s[48:51], s7 offen lds
s_add_u32 s15, s15, 122880
s_cmp_ge_u32 s15, s13
s_cselect_b32 s7, 2457600, 0
s_sub_u32 s15, s15, s7
v_mfma_f32_16x16x32_bf16 v[100:103], a[0:3], v[84:87], 0
v_mfma_f32_16x16x32_bf16 v[104:107], a[4:7], v[84:87], 0
v_mfma_f32_16x16x32_bf16 v[108:111], a[8:11], v[84:87], 0
v_mfma_f32_16x16x32_bf16 v[112:115], a[12:15], v[84:87], 0
s_waitcnt lgkmcnt(0)
s_waitcnt vmcnt(19)
s_barrier
s_add_u32 m0, s70, 24576
s_add_u32 s7, s15, 0
buffer_load_dwordx4 v88, s[48:51], s7 offen lds
ds_read_b64_tr_b16 a[32:33], v80 offset:49152
ds_read_b64_tr_b16 a[34:35], v80 offset:50176
s_add_u32 m0, s70, 32768
s_add_u32 s7, s15, 1280
buffer_load_dwordx4 v88, s[48:51], s7 offen lds
ds_read_b64_tr_b16 a[36:37], v81 offset:49152
ds_read_b64_tr_b16 a[38:39], v81 offset:50176
s_add_u32 m0, s70, 40960
s_add_u32 s7, s15, 2560
buffer_load_dwordx4 v88, s[48:51], s7 offen lds
ds_read_b64_tr_b16 a[40:41], v82 offset:49152
ds_read_b64_tr_b16 a[42:43], v82 offset:50176
s_add_u32 m0, s70, 25600
s_add_u32 s7, s15, 15360
buffer_load_dwordx4 v88, s[48:51], s7 offen lds
ds_read_b64_tr_b16 a[44:45], v83 offset:49152
ds_read_b64_tr_b16 a[46:47], v83 offset:50176
s_add_u32 m0, s70, 33792
s_add_u32 s7, s15, 16640
buffer_load_dwordx4 v88, s[48:51], s7 offen lds
s_add_u32 m0, s70, 41984
s_add_u32 s7, s15, 17920
buffer_load_dwordx4 v88, s[48:51], s7 offen lds
s_add_u32 s15, s15, 122880
s_cmp_ge_u32 s15, s13
s_cselect_b32 s7, 2457600, 0
s_sub_u32 s15, s15, s7
v_mfma_f32_16x16x32_bf16 v[100:103], a[16:19], v[84:87], v[100:103]
v_mfma_f32_16x16x32_bf16 v[104:107], a[20:23], v[84:87], v[104:107]
v_mfma_f32_16x16x32_bf16 v[108:111], a[24:27], v[84:87], v[108:111]
v_mfma_f32_16x16x32_bf16 v[112:115], a[28:31], v[84:87], v[112:115]
s_waitcnt lgkmcnt(0)
s_waitcnt vmcnt(19)
s_barrier
v_add_u32 v80, 0x12000, v80
v_add_u32 v81, 0x12000, v81
v_add_u32 v82, 0x12000, v82
v_add_u32 v83, 0x12000, v83
s_add_u32 m0, s70, 49152
s_add_u32 s7, s15, 0
buffer_load_dwordx4 v88, s[48:51], s7 offen lds
ds_read_b64_tr_b16 a[48:49], v80 offset:0
ds_read_b64_tr_b16 a[50:51], v80 offset:1024
s_add_u32 m0, s70, 57344
s_add_u32 s7, s15, 1280
buffer_load_dwordx4 v88, s[48:51], s7 offen lds
ds_read_b64_tr_b16 a[52:53], v81 offset:0
ds_read_b64_tr_b16 a[54:55], v81 offset:1024
s_add_u32 m0, s70, 65536
s_add_u32 s7, s15, 2560
buffer_load_dwordx4 v88, s[48:51], s7 offen lds
ds_read_b64_tr_b16 a[56:57], v82 offset:0
ds_read_b64_tr_b16 a[58:59], v82 offset:1024
s_add_u32 m0, s70, 50176
s_add_u32 s7, s15, 15360
buffer_load_dwordx4 v88, s[48:51], s7 offen lds
ds_read_b64_tr_b16 a[60:61], v83 offset:0
ds_read_b64_tr_b16 a[62:63], v83 offset:1024
s_add_u32 m0, s70, 58368
s_add_u32 s7, s15, 16640
buffer_load_dwordx4 v88, s[48:51], s7 offen lds
s_add_u32 m0, s70, 66560
s_add_u32 s7, s15, 17920
buffer_load_dwordx4 v88, s[48:51], s7 offen lds
s_add_u32 s15, s15, 122880
s_cmp_ge_u32 s15, s13
s_cselect_b32 s7, 2457600, 0
s_sub_u32 s15, s15, s7
v_mfma_f32_16x16x32_bf16 v[100:103], a[32:35], v[84:87], v[100:103]
v_mfma_f32_16x16x32_bf16 v[104:107], a[36:39], v[84:87], v[104:107]
v_mfma_f32_16x16x32_bf16 v[108:111], a[40:43], v[84:87], v[108:111]
v_mfma_f32_16x16x32_bf16 v[112:115], a[44:47], v[84:87], v[112:115]
s_waitcnt lgkmcnt(0)
s_waitcnt vmcnt(18)
s_barrier
s_add_u32 m0, s70, 73728
s_add_u32 s7, s15, 0
buffer_load_dwordx4 v88, s[48:51], s7 offen lds
ds_read_b64_tr_b16 a[64:65], v80 offset:49152
ds_read_b64_tr_b16 a[66:67], v80 offset:50176
s_add_u32 m0, s70, 81920
s_add_u32 s7, s15, 1280
buffer_load_dwordx4 v88, s[48:51], s7 offen lds
ds_read_b64_tr_b16 a[68:69], v81 offset:49152
ds_read_b64_tr_b16 a[70:71], v81 offset:50176
s_add_u32 m0, s70, 90112
s_add_u32 s7, s15, 2560
buffer_load_dwordx4 v88, s[48:51], s7 offen lds
ds_read_b64_tr_b16 a[72:73], v82 offset:49152
ds_read_b64_tr_b16 a[74:75], v82 offset:50176
s_add_u32 m0, s70, 74752
s_add_u32 s7, s15, 15360
buffer_load_dwordx4 v88, s[48:51], s7 offen lds
ds_read_b64_tr_b16 a[76:77], v83 offset:49152
ds_read_b64_tr_b16 a[78:79], v83 offset:50176
s_add_u32 m0, s70, 82944
s_add_u32 s7, s15, 16640
buffer_load_dwordx4 v88, s[48:51], s7 offen lds
s_add_u32 m0, s70, 91136
s_add_u32 s7, s15, 17920
buffer_load_dwordx4 v88, s[48:51], s7 offen lds
s_add_u32 s15, s15, 122880
s_cmp_ge_u32 s15, s13
s_cselect_b32 s7, 2457600, 0
s_sub_u32 s15, s15, s7
v_mfma_f32_16x16x32_bf16 v[100:103], a[48:51], v[84:87], v[100:103]
v_mfma_f32_16x16x32_bf16 v[104:107], a[52:55], v[84:87], v[104:107]
v_mfma_f32_16x16x32_bf16 v[108:111], a[56:59], v[84:87], v[108:111]
v_mfma_f32_16x16x32_bf16 v[112:115], a[60:63], v[84:87], v[112:115]
s_waitcnt lgkmcnt(0)
s_waitcnt vmcnt(18)
s_barrier
v_add_u32 v80, 0xfffee000, v80
v_add_u32 v81, 0xfffee000, v81
v_add_u32 v82, 0xfffee000, v82
v_add_u32 v83, 0xfffee000, v83
s_add_u32 m0, s70, 122880
s_add_u32 s7, s15, 0
buffer_load_dwordx4 v88, s[48:51], s7 offen lds
ds_read_b64_tr_b16 a[80:81], v80 offset:0
ds_read_b64_tr_b16 a[82:83], v80 offset:1024
s_add_u32 m0, s70, 131072
s_add_u32 s7, s15, 1280
buffer_load_dwordx4 v88, s[48:51], s7 offen lds
ds_read_b64_tr_b16 a[84:85], v81 offset:0
ds_read_b64_tr_b16 a[86:87], v81 offset:1024
s_add_u32 m0, s70, 139264
s_add_u32 s7, s15, 2560
buffer_load_dwordx4 v88, s[48:51], s7 offen lds
ds_read_b64_tr_b16 a[88:89], v82 offset:0
ds_read_b64_tr_b16 a[90:91], v82 offset:1024
s_add_u32 m0, s70, 123904
s_add_u32 s7, s15, 15360
buffer_load_dwordx4 v88, s[48:51], s7 offen lds
ds_read_b64_tr_b16 a[92:93], v83 offset:0
ds_read_b64_tr_b16 a[94:95], v83 offset:1024
s_add_u32 m0, s70, 132096
s_add_u32 s7, s15, 16640
buffer_load_dwordx4 v88, s[48:51], s7 offen lds
s_add_u32 m0, s70, 140288
s_add_u32 s7, s15, 17920
buffer_load_dwordx4 v88, s[48:51], s7 offen lds
s_add_u32 s15, s15, 122880
s_cmp_ge_u32 s15, s13
s_cselect_b32 s7, 2457600, 0
s_sub_u32 s15, s15, s7
v_mfma_f32_16x16x32_bf16 v[100:103], a[64:67], v[84:87], v[100:103]
v_mfma_f32_16x16x32_bf16 v[104:107], a[68:71], v[84:87], v[104:107]
v_mfma_f32_16x16x32_bf16 v[108:111], a[72:75], v[84:87], v[108:111]
v_mfma_f32_16x16x32_bf16 v[112:115], a[76:79], v[84:87], v[112:115]
s_waitcnt lgkmcnt(0)
s_waitcnt vmcnt(18)
s_barrier
s_add_u32 m0, s70, 0
s_add_u32 s7, s15, 0
buffer_load_dwordx4 v88, s[48:51], s7 offen lds
ds_read_b64_tr_b16 a[96:97], v80 offset:24576
ds_read_b64_tr_b16 a[98:99], v80 offset:25600
s_add_u32 m0, s70, 8192
s_add_u32 s7, s15, 1280
buffer_load_dwordx4 v88, s[48:51], s7 offen lds
ds_read_b64_tr_b16 a[100:101], v81 offset:24576
ds_read_b64_tr_b16 a[102:103], v81 offset:25600
s_add_u32 m0, s70, 16384
s_add_u32 s7, s15, 2560
buffer_load_dwordx4 v88, s[48:51], s7 offen lds
ds_read_b64_tr_b16 a[104:105], v82 offset:24576
ds_read_b64_tr_b16 a[106:107], v82 offset:25600
s_add_u32 m0, s70, 1024
s_add_u32 s7, s15, 15360
buffer_load_dwordx4 v88, s[48:51], s7 offen lds
ds_read_b64_tr_b16 a[108:109], v83 offset:24576
ds_read_b64_tr_b16 a[110:111], v83 offset:25600
s_add_u32 m0, s70, 9216
s_add_u32 s7, s15, 16640
buffer_load_dwordx4 v88, s[48:51], s7 offen lds
s_add_u32 m0, s70, 17408
s_add_u32 s7, s15, 17920
buffer_load_dwordx4 v88, s[48:51], s7 offen lds
s_add_u32 s15, s15, 122880
s_cmp_ge_u32 s15, s13
s_cselect_b32 s7, 2457600, 0
s_sub_u32 s15, s15, s7
v_mfma_f32_16x16x32_bf16 v[100:103], a[80:83], v[84:87], v[100:103]
v_mfma_f32_16x16x32_bf16 v[104:107], a[84:87], v[84:87], v[104:107]
v_mfma_f32_16x16x32_bf16 v[108:111], a[88:91], v[84:87], v[108:111]
v_mfma_f32_16x16x32_bf16 v[112:115], a[92:95], v[84:87], v[112:115]
s_waitcnt lgkmcnt(0)
s_waitcnt vmcnt(18)
s_barrier
s_add_u32 m0, s70, 24576
s_add_u32 s7, s15, 0
buffer_load_dwordx4 v88, s[48:51], s7 offen lds
ds_read_b64_tr_b16 a[112:113], v80 offset:49152
ds_read_b64_tr_b16 a[114:115], v80 offset:50176
s_add_u32 m0, s70, 32768
s_add_u32 s7, s15, 1280
buffer_load_dwordx4 v88, s[48:51], s7 offen lds
ds_read_b64_tr_b16 a[116:117], v81 offset:49152
ds_read_b64_tr_b16 a[118:119], v81 offset:50176
s_add_u32 m0, s70, 40960
s_add_u32 s7, s15, 2560
buffer_load_dwordx4 v88, s[48:51], s7 offen lds
ds_read_b64_tr_b16 a[120:121], v82 offset:49152
ds_read_b64_tr_b16 a[122:123], v82 offset:50176
s_add_u32 m0, s70, 25600
s_add_u32 s7, s15, 15360
buffer_load_dwordx4 v88, s[48:51], s7 offen lds
ds_read_b64_tr_b16 a[124:125], v83 offset:49152
ds_read_b64_tr_b16 a[126:127], v83 offset:50176
s_add_u32 m0, s70, 33792
s_add_u32 s7, s15, 16640
buffer_load_dwordx4 v88, s[48:51], s7 offen lds
s_add_u32 m0, s70, 41984
s_add_u32 s7, s15, 17920
buffer_load_dwordx4 v88, s[48:51], s7 offen lds
s_add_u32 s15, s15, 122880
s_cmp_ge_u32 s15, s13
s_cselect_b32 s7, 2457600, 0
s_sub_u32 s15, s15, s7
v_mfma_f32_16x16x32_bf16 v[100:103], a[96:99], v[84:87], v[100:103]
v_mfma_f32_16x16x32_bf16 v[104:107], a[100:103], v[84:87], v[104:107]
v_mfma_f32_16x16x32_bf16 v[108:111], a[104:107], v[84:87], v[108:111]
v_mfma_f32_16x16x32_bf16 v[112:115], a[108:111], v[84:87], v[112:115]
s_waitcnt lgkmcnt(0)
s_waitcnt vmcnt(18)
s_barrier
v_add_u32 v80, 0x12000, v80
v_add_u32 v81, 0x12000, v81
v_add_u32 v82, 0x12000, v82
v_add_u32 v83, 0x12000, v83
s_add_u32 m0, s70, 49152
s_add_u32 s7, s15, 0
buffer_load_dwordx4 v88, s[48:51], s7 offen lds
ds_read_b64_tr_b16 a[128:129], v80 offset:0
ds_read_b64_tr_b16 a[130:131], v80 offset:1024
s_add_u32 m0, s70, 57344
s_add_u32 s7, s15, 1280
buffer_load_dwordx4 v88, s[48:51], s7 offen lds
ds_read_b64_tr_b16 a[132:133], v81 offset:0
ds_read_b64_tr_b16 a[134:135], v81 offset:1024
s_add_u32 m0, s70, 65536
s_add_u32 s7, s15, 2560
buffer_load_dwordx4 v88, s[48:51], s7 offen lds
ds_read_b64_tr_b16 a[136:137], v82 offset:0
ds_read_b64_tr_b16 a[138:139], v82 offset:1024
s_add_u32 m0, s70, 50176
s_add_u32 s7, s15, 15360
buffer_load_dwordx4 v88, s[48:51], s7 offen lds
ds_read_b64_tr_b16 a[140:141], v83 offset:0
ds_read_b64_tr_b16 a[142:143], v83 offset:1024
s_add_u32 m0, s70, 58368
s_add_u32 s7, s15, 16640
buffer_load_dwordx4 v88, s[48:51], s7 offen lds
s_add_u32 m0, s70, 66560
s_add_u32 s7, s15, 17920
buffer_load_dwordx4 v88, s[48:51], s7 offen lds
s_add_u32 s15, s15, 122880
s_cmp_ge_u32 s15, s13
s_cselect_b32 s7, 2457600, 0
s_sub_u32 s15, s15, s7
v_mfma_f32_16x16x32_bf16 v[100:103], a[112:115], v[84:87], v[100:103]
v_mfma_f32_16x16x32_bf16 v[104:107], a[116:119], v[84:87], v[104:107]
v_mfma_f32_16x16x32_bf16 v[108:111], a[120:123], v[84:87], v[108:111]
v_mfma_f32_16x16x32_bf16 v[112:115], a[124:127], v[84:87], v[112:115]
s_waitcnt lgkmcnt(0)
s_waitcnt vmcnt(18)
s_barrier
s_add_u32 m0, s70, 73728
s_add_u32 s7, s15, 0
buffer_load_dwordx4 v88, s[48:51], s7 offen lds
ds_read_b64_tr_b16 a[144:145], v80 offset:49152
ds_read_b64_tr_b16 a[146:147], v80 offset:50176
s_add_u32 m0, s70, 81920
s_add_u32 s7, s15, 1280
buffer_load_dwordx4 v88, s[48:51], s7 offen lds
ds_read_b64_tr_b16 a[148:149], v81 offset:49152
ds_read_b64_tr_b16 a[150:151], v81 offset:50176
s_add_u32 m0, s70, 90112
s_add_u32 s7, s15, 2560
buffer_load_dwordx4 v88, s[48:51], s7 offen lds
ds_read_b64_tr_b16 a[152:153], v82 offset:49152
ds_read_b64_tr_b16 a[154:155], v82 offset:50176
s_add_u32 m0, s70, 74752
s_add_u32 s7, s15, 15360
buffer_load_dwordx4 v88, s[48:51], s7 offen lds
ds_read_b64_tr_b16 a[156:157], v83 offset:49152
ds_read_b64_tr_b16 a[158:159], v83 offset:50176
s_add_u32 m0, s70, 82944
s_add_u32 s7, s15, 16640
buffer_load_dwordx4 v88, s[48:51], s7 offen lds
s_add_u32 m0, s70, 91136
s_add_u32 s7, s15, 17920
buffer_load_dwordx4 v88, s[48:51], s7 offen lds
s_add_u32 s15, s15, 122880
s_cmp_ge_u32 s15, s13
s_cselect_b32 s7, 2457600, 0
s_sub_u32 s15, s15, s7
v_mfma_f32_16x16x32_bf16 v[100:103], a[128:131], v[84:87], v[100:103]
v_mfma_f32_16x16x32_bf16 v[104:107], a[132:135], v[84:87], v[104:107]
v_mfma_f32_16x16x32_bf16 v[108:111], a[136:139], v[84:87], v[108:111]
v_mfma_f32_16x16x32_bf16 v[112:115], a[140:143], v[84:87], v[112:115]
s_waitcnt lgkmcnt(0)
s_waitcnt vmcnt(18)
s_barrier
v_add_u32 v80, 0xfffee000, v80
v_add_u32 v81, 0xfffee000, v81
v_add_u32 v82, 0xfffee000, v82
v_add_u32 v83, 0xfffee000, v83
s_add_u32 m0, s70, 122880
s_add_u32 s7, s15, 0
buffer_load_dwordx4 v88, s[48:51], s7 offen lds
ds_read_b64_tr_b16 a[160:161], v80 offset:0
ds_read_b64_tr_b16 a[162:163], v80 offset:1024
s_add_u32 m0, s70, 131072
s_add_u32 s7, s15, 1280
buffer_load_dwordx4 v88, s[48:51], s7 offen lds
ds_read_b64_tr_b16 a[164:165], v81 offset:0
ds_read_b64_tr_b16 a[166:167], v81 offset:1024
s_add_u32 m0, s70, 139264
s_add_u32 s7, s15, 2560
buffer_load_dwordx4 v88, s[48:51], s7 offen lds
ds_read_b64_tr_b16 a[168:169], v82 offset:0
ds_read_b64_tr_b16 a[170:171], v82 offset:1024
s_add_u32 m0, s70, 123904
s_add_u32 s7, s15, 15360
buffer_load_dwordx4 v88, s[48:51], s7 offen lds
ds_read_b64_tr_b16 a[172:173], v83 offset:0
ds_read_b64_tr_b16 a[174:175], v83 offset:1024
s_add_u32 m0, s70, 132096
s_add_u32 s7, s15, 16640
buffer_load_dwordx4 v88, s[48:51], s7 offen lds
s_add_u32 m0, s70, 140288
s_add_u32 s7, s15, 17920
buffer_load_dwordx4 v88, s[48:51], s7 offen lds
s_add_u32 s15, s15, 122880
s_cmp_ge_u32 s15, s13
s_cselect_b32 s7, 2457600, 0
s_sub_u32 s15, s15, s7
s_lshl_b32 s7, s4, 5
v_mov_b32 v14, s7
buffer_load_dwordx2 v[14:15], v14, s[52:55], 0 offen sc1
v_mfma_f32_16x16x32_bf16 v[100:103], a[144:147], v[84:87], v[100:103]
v_mfma_f32_16x16x32_bf16 v[104:107], a[148:151], v[84:87], v[104:107]
v_mfma_f32_16x16x32_bf16 v[108:111], a[152:155], v[84:87], v[108:111]
v_mfma_f32_16x16x32_bf16 v[112:115], a[156:159], v[84:87], v[112:115]
s_waitcnt lgkmcnt(0)
s_waitcnt vmcnt(19)
s_barrier
s_add_u32 m0, s70, 0
s_add_u32 s7, s15, 0
buffer_load_dwordx4 v88, s[48:51], s7 offen lds
ds_read_b64_tr_b16 a[176:177], v80 offset:24576
ds_read_b64_tr_b16 a[178:179], v80 offset:25600
s_add_u32 m0, s70, 8192
s_add_u32 s7, s15, 1280
buffer_load_dwordx4 v88, s[48:51], s7 offen lds
ds_read_b64_tr_b16 a[180:181], v81 offset:24576
ds_read_b64_tr_b16 a[182:183], v81 offset:25600
s_add_u32 m0, s70, 16384
s_add_u32 s7, s15, 2560
buffer_load_dwordx4 v88, s[48:51], s7 offen lds
ds_read_b64_tr_b16 a[184:185], v82 offset:24576
ds_read_b64_tr_b16 a[186:187], v82 offset:25600
s_add_u32 m0, s70, 1024
s_add_u32 s7, s15, 15360
buffer_load_dwordx4 v88, s[48:51], s7 offen lds
ds_read_b64_tr_b16 a[188:189], v83 offset:24576
ds_read_b64_tr_b16 a[190:191], v83 offset:25600
s_add_u32 m0, s70, 9216
s_add_u32 s7, s15, 16640
buffer_load_dwordx4 v88, s[48:51], s7 offen lds
s_add_u32 m0, s70, 17408
s_add_u32 s7, s15, 17920
buffer_load_dwordx4 v88, s[48:51], s7 offen lds
s_add_u32 s15, s15, 122880
s_cmp_ge_u32 s15, s13
s_cselect_b32 s7, 2457600, 0
s_sub_u32 s15, s15, s7
v_mfma_f32_16x16x32_bf16 v[100:103], a[160:163], v[84:87], v[100:103]
v_mfma_f32_16x16x32_bf16 v[104:107], a[164:167], v[84:87], v[104:107]
v_mfma_f32_16x16x32_bf16 v[108:111], a[168:171], v[84:87], v[108:111]
v_mfma_f32_16x16x32_bf16 v[112:115], a[172:175], v[84:87], v[112:115]
s_waitcnt lgkmcnt(0)
s_waitcnt vmcnt(19)
s_barrier
s_add_u32 m0, s70, 24576
s_add_u32 s7, s15, 0
buffer_load_dwordx4 v88, s[48:51], s7 offen lds
ds_read_b64_tr_b16 a[192:193], v80 offset:49152
ds_read_b64_tr_b16 a[194:195], v80 offset:50176
s_add_u32 m0, s70, 32768
s_add_u32 s7, s15, 1280
buffer_load_dwordx4 v88, s[48:51], s7 offen lds
ds_read_b64_tr_b16 a[196:197], v81 offset:49152
ds_read_b64_tr_b16 a[198:199], v81 offset:50176
s_add_u32 m0, s70, 40960
s_add_u32 s7, s15, 2560
buffer_load_dwordx4 v88, s[48:51], s7 offen lds
ds_read_b64_tr_b16 a[200:201], v82 offset:49152
ds_read_b64_tr_b16 a[202:203], v82 offset:50176
s_add_u32 m0, s70, 25600
s_add_u32 s7, s15, 15360
buffer_load_dwordx4 v88, s[48:51], s7 offen lds
ds_read_b64_tr_b16 a[204:205], v83 offset:49152
ds_read_b64_tr_b16 a[206:207], v83 offset:50176
s_add_u32 m0, s70, 33792
s_add_u32 s7, s15, 16640
buffer_load_dwordx4 v88, s[48:51], s7 offen lds
s_add_u32 m0, s70, 41984
s_add_u32 s7, s15, 17920
buffer_load_dwordx4 v88, s[48:51], s7 offen lds
s_add_u32 s15, s15, 122880
s_cmp_ge_u32 s15, s13
s_cselect_b32 s7, 2457600, 0
s_sub_u32 s15, s15, s7
v_mfma_f32_16x16x32_bf16 v[100:103], a[176:179], v[84:87], v[100:103]
v_mfma_f32_16x16x32_bf16 v[104:107], a[180:183], v[84:87], v[104:107]
v_mfma_f32_16x16x32_bf16 v[108:111], a[184:187], v[84:87], v[108:111]
v_mfma_f32_16x16x32_bf16 v[112:115], a[188:191], v[84:87], v[112:115]
s_waitcnt lgkmcnt(0)
s_waitcnt vmcnt(19)
s_barrier
v_add_u32 v80, 0x12000, v80
v_add_u32 v81, 0x12000, v81
v_add_u32 v82, 0x12000, v82
v_add_u32 v83, 0x12000, v83
s_add_u32 m0, s70, 49152
s_add_u32 s7, s15, 0
buffer_load_dwordx4 v88, s[48:51], s7 offen lds
ds_read_b64_tr_b16 a[208:209], v80 offset:0
ds_read_b64_tr_b16 a[210:211], v80 offset:1024
s_add_u32 m0, s70, 57344
s_add_u32 s7, s15, 1280
buffer_load_dwordx4 v88, s[48:51], s7 offen lds
ds_read_b64_tr_b16 a[212:213], v81 offset:0
ds_read_b64_tr_b16 a[214:215], v81 offset:1024
s_add_u32 m0, s70, 65536
s_add_u32 s7, s15, 2560
buffer_load_dwordx4 v88, s[48:51], s7 offen lds
ds_read_b64_tr_b16 a[216:217], v82 offset:0
ds_read_b64_tr_b16 a[218:219], v82 offset:1024
s_add_u32 m0, s70, 50176
s_add_u32 s7, s15, 15360
buffer_load_dwordx4 v88, s[48:51], s7 offen lds
ds_read_b64_tr_b16 a[220:221], v83 offset:0
ds_read_b64_tr_b16 a[222:223], v83 offset:1024
s_add_u32 m0, s70, 58368
s_add_u32 s7, s15, 16640
buffer_load_dwordx4 v88, s[48:51], s7 offen lds
s_add_u32 m0, s70, 66560
s_add_u32 s7, s15, 17920
buffer_load_dwordx4 v88, s[48:51], s7 offen lds
s_add_u32 s15, s15, 122880
s_cmp_ge_u32 s15, s13
s_cselect_b32 s7, 2457600, 0
s_sub_u32 s15, s15, s7
v_mfma_f32_16x16x32_bf16 v[100:103], a[192:195], v[84:87], v[100:103]
v_mfma_f32_16x16x32_bf16 v[104:107], a[196:199], v[84:87], v[104:107]
v_mfma_f32_16x16x32_bf16 v[108:111], a[200:203], v[84:87], v[108:111]
v_mfma_f32_16x16x32_bf16 v[112:115], a[204:207], v[84:87], v[112:115]
s_waitcnt lgkmcnt(0)
s_waitcnt vmcnt(19)
s_barrier
s_add_u32 m0, s70, 73728
s_add_u32 s7, s15, 0
buffer_load_dwordx4 v88, s[48:51], s7 offen lds
ds_read_b64_tr_b16 a[224:225], v80 offset:49152
ds_read_b64_tr_b16 a[226:227], v80 offset:50176
s_add_u32 m0, s70, 81920
s_add_u32 s7, s15, 1280
buffer_load_dwordx4 v88, s[48:51], s7 offen lds
ds_read_b64_tr_b16 a[228:229], v81 offset:49152
ds_read_b64_tr_b16 a[230:231], v81 offset:50176
s_add_u32 m0, s70, 90112
s_add_u32 s7, s15, 2560
buffer_load_dwordx4 v88, s[48:51], s7 offen lds
ds_read_b64_tr_b16 a[232:233], v82 offset:49152
ds_read_b64_tr_b16 a[234:235], v82 offset:50176
s_add_u32 m0, s70, 74752
s_add_u32 s7, s15, 15360
buffer_load_dwordx4 v88, s[48:51], s7 offen lds
ds_read_b64_tr_b16 a[236:237], v83 offset:49152
ds_read_b64_tr_b16 a[238:239], v83 offset:50176
s_add_u32 m0, s70, 82944
s_add_u32 s7, s15, 16640
buffer_load_dwordx4 v88, s[48:51], s7 offen lds
s_add_u32 m0, s70, 91136
s_add_u32 s7, s15, 17920
buffer_load_dwordx4 v88, s[48:51], s7 offen lds
s_add_u32 s15, s15, 122880
s_cmp_ge_u32 s15, s13
s_cselect_b32 s7, 2457600, 0
s_sub_u32 s15, s15, s7
s_waitcnt vmcnt(24)
v_readfirstlane_b32 s7, v14
v_readfirstlane_b32 s8, v15
s_xor_b32 s101, s7, s22
s_xor_b32 s69, s8, s23
s_or_b32 s69, s69, s101
s_cmp_eq_u32 s69, 0
s_cselect_b32 s101, 1, 0
s_add_u32 s7, s7, s8
s_mul_i32 s7, s7, 0x01010101
s_lshr_b32 s7, s7, 24
s_cmp_eq_u32 s7, 32
s_cselect_b32 s75, 1, 0
buffer_load_dword v6, v5, s[36:39], 0 offen sc1
v_mfma_f32_16x16x32_bf16 v[100:103], a[208:211], v[84:87], v[100:103]
v_mfma_f32_16x16x32_bf16 v[104:107], a[212:215], v[84:87], v[104:107]
v_mfma_f32_16x16x32_bf16 v[108:111], a[216:219], v[84:87], v[108:111]
v_mfma_f32_16x16x32_bf16 v[112:115], a[220:223], v[84:87], v[112:115]
s_waitcnt lgkmcnt(0)
s_waitcnt vmcnt(19)
s_barrier
v_add_u32 v80, 0xfffee000, v80
v_add_u32 v81, 0xfffee000, v81
v_add_u32 v82, 0xfffee000, v82
v_add_u32 v83, 0xfffee000, v83
s_add_u32 m0, s70, 122880
s_add_u32 s7, s15, 0
buffer_load_dwordx4 v88, s[48:51], s7 offen lds
ds_read_b64_tr_b16 a[240:241], v80 offset:0
ds_read_b64_tr_b16 a[242:243], v80 offset:1024
s_add_u32 m0, s70, 131072
s_add_u32 s7, s15, 1280
buffer_load_dwordx4 v88, s[48:51], s7 offen lds
ds_read_b64_tr_b16 a[244:245], v81 offset:0
ds_read_b64_tr_b16 a[246:247], v81 offset:1024
s_add_u32 m0, s70, 139264
s_add_u32 s7, s15, 2560
buffer_load_dwordx4 v88, s[48:51], s7 offen lds
ds_read_b64_tr_b16 a[248:249], v82 offset:0
ds_read_b64_tr_b16 a[250:251], v82 offset:1024
s_add_u32 m0, s70, 123904
s_add_u32 s7, s15, 15360
buffer_load_dwordx4 v88, s[48:51], s7 offen lds
ds_read_b64_tr_b16 a[252:253], v83 offset:0
ds_read_b64_tr_b16 a[254:255], v83 offset:1024
s_add_u32 m0, s70, 132096
s_add_u32 s7, s15, 16640
buffer_load_dwordx4 v88, s[48:51], s7 offen lds
s_add_u32 m0, s70, 140288
s_add_u32 s7, s15, 17920
buffer_load_dwordx4 v88, s[48:51], s7 offen lds
s_add_u32 s15, s15, 122880
s_cmp_ge_u32 s15, s13
s_cselect_b32 s7, 2457600, 0
s_sub_u32 s15, s15, s7
v_mov_b32 v8, 1
buffer_store_dword v8, v7, s[36:39], 0 offen
v_mfma_f32_16x16x32_bf16 v[100:103], a[224:227], v[84:87], v[100:103]
v_mfma_f32_16x16x32_bf16 v[104:107], a[228:231], v[84:87], v[104:107]
v_mfma_f32_16x16x32_bf16 v[108:111], a[232:235], v[84:87], v[108:111]
v_mfma_f32_16x16x32_bf16 v[112:115], a[236:239], v[84:87], v[112:115]
s_waitcnt lgkmcnt(0)
s_waitcnt vmcnt(20)
s_barrier
ds_read_b64_tr_b16 v[192:193], v80 offset:24576
ds_read_b64_tr_b16 v[194:195], v80 offset:25600
ds_read_b64_tr_b16 v[196:197], v81 offset:24576
ds_read_b64_tr_b16 v[198:199], v81 offset:25600
ds_read_b64_tr_b16 v[200:201], v82 offset:24576
ds_read_b64_tr_b16 v[202:203], v82 offset:25600
ds_read_b64_tr_b16 v[204:205], v83 offset:24576
ds_read_b64_tr_b16 v[206:207], v83 offset:25600
v_mfma_f32_16x16x32_bf16 v[100:103], a[240:243], v[84:87], v[100:103]
v_mfma_f32_16x16x32_bf16 v[104:107], a[244:247], v[84:87], v[104:107]
v_mfma_f32_16x16x32_bf16 v[108:111], a[248:251], v[84:87], v[108:111]
v_mfma_f32_16x16x32_bf16 v[112:115], a[252:255], v[84:87], v[112:115]
s_waitcnt lgkmcnt(0)
s_waitcnt vmcnt(14)
s_barrier
ds_read_b64_tr_b16 v[208:209], v80 offset:49152
ds_read_b64_tr_b16 v[210:211], v80 offset:50176
ds_read_b64_tr_b16 v[212:213], v81 offset:49152
ds_read_b64_tr_b16 v[214:215], v81 offset:50176
ds_read_b64_tr_b16 v[216:217], v82 offset:49152
ds_read_b64_tr_b16 v[218:219], v82 offset:50176
ds_read_b64_tr_b16 v[220:221], v83 offset:49152
ds_read_b64_tr_b16 v[222:223], v83 offset:50176
v_mfma_f32_16x16x32_bf16 v[100:103], v[192:195], v[84:87], v[100:103]
v_mfma_f32_16x16x32_bf16 v[104:107], v[196:199], v[84:87], v[104:107]
v_mfma_f32_16x16x32_bf16 v[108:111], v[200:203], v[84:87], v[108:111]
v_mfma_f32_16x16x32_bf16 v[112:115], v[204:207], v[84:87], v[112:115]
s_waitcnt lgkmcnt(0)
s_waitcnt vmcnt(8)
s_barrier
v_add_u32 v80, 0x12000, v80
v_add_u32 v81, 0x12000, v81
v_add_u32 v82, 0x12000, v82
v_add_u32 v83, 0x12000, v83
ds_read_b64_tr_b16 v[224:225], v80 offset:0
ds_read_b64_tr_b16 v[226:227], v80 offset:1024
ds_read_b64_tr_b16 v[228:229], v81 offset:0
ds_read_b64_tr_b16 v[230:231], v81 offset:1024
ds_read_b64_tr_b16 v[232:233], v82 offset:0
ds_read_b64_tr_b16 v[234:235], v82 offset:1024
ds_read_b64_tr_b16 v[236:237], v83 offset:0
ds_read_b64_tr_b16 v[238:239], v83 offset:1024
s_waitcnt vmcnt(7)
v_cmp_le_u32 vcc, s65, v6
s_nop 0
s_cmp_eq_u64 vcc, -1
s_cselect_b32 s68, 1, 0
s_and_b32 s68, s68, s75
s_cselect_b32 s42, 0x4000000, 0
s_add_u32 s69, s66, 4096
s_add_u32 m0, s72, 4096
s_nop 0
buffer_load_dwordx4 v11, s[40:43], s69 offen offset:1024 sc1 lds
buffer_load_dwordx4 v1, s[40:43], s69 offen offset:0 sc1 lds
s_add_u32 m0, s72, 0
s_nop 0
buffer_load_dwordx4 v1, s[40:43], s66 offen offset:0 sc1 lds
buffer_load_dwordx4 v1, s[40:43], s66 offen offset:1024 sc1 lds
buffer_load_dwordx4 v1, s[40:43], s66 offen offset:2048 sc1 lds
buffer_load_dwordx4 v1, s[40:43], s66 offen offset:3072 sc1 lds
v_mfma_f32_16x16x32_bf16 v[100:103], v[208:211], v[84:87], v[100:103]
v_mfma_f32_16x16x32_bf16 v[104:107], v[212:215], v[84:87], v[104:107]
v_mfma_f32_16x16x32_bf16 v[108:111], v[216:219], v[84:87], v[108:111]
v_mfma_f32_16x16x32_bf16 v[112:115], v[220:223], v[84:87], v[112:115]
s_waitcnt lgkmcnt(0)
s_waitcnt vmcnt(7)
s_barrier
ds_read_b64_tr_b16 v[240:241], v80 offset:49152
ds_read_b64_tr_b16 v[242:243], v80 offset:50176
ds_read_b64_tr_b16 v[244:245], v81 offset:49152
ds_read_b64_tr_b16 v[246:247], v81 offset:50176
ds_read_b64_tr_b16 v[248:249], v82 offset:49152
ds_read_b64_tr_b16 v[250:251], v82 offset:50176
ds_read_b64_tr_b16 v[252:253], v83 offset:49152
ds_read_b64_tr_b16 v[254:255], v83 offset:50176
v_mfma_f32_16x16x32_bf16 v[100:103], v[224:227], v[84:87], v[100:103]
v_mfma_f32_16x16x32_bf16 v[104:107], v[228:231], v[84:87], v[104:107]
v_mfma_f32_16x16x32_bf16 v[108:111], v[232:235], v[84:87], v[108:111]
v_mfma_f32_16x16x32_bf16 v[112:115], v[236:239], v[84:87], v[112:115]
s_waitcnt lgkmcnt(0)
v_mfma_f32_16x16x32_bf16 v[100:103], v[240:243], v[84:87], v[100:103]
v_mfma_f32_16x16x32_bf16 v[104:107], v[244:247], v[84:87], v[104:107]
v_mfma_f32_16x16x32_bf16 v[108:111], v[248:251], v[84:87], v[108:111]
v_mfma_f32_16x16x32_bf16 v[112:115], v[252:255], v[84:87], v[112:115]
s_cmp_eq_u32 s68, 0
s_cbranch_scc1 K1_LATE
s_waitcnt vmcnt(0)
s_cmp_eq_u32 s101, 1
s_cbranch_scc1 K1_GO1f
s_branch K1_GO1s
K1_LATE:
s_cmp_eq_u32 s75, 1
s_cbranch_scc1 K1_IOK
s_mov_b32 s75, 0
K1_IW:
s_lshl_b32 s7, s4, 5
v_mov_b32 v14, s7
buffer_load_dwordx2 v[14:15], v14, s[52:55], 0 offen sc1
s_add_u32 s75, s75, 1
s_cmp_gt_u32 s75, 0x8000
s_cbranch_scc1 L_TIMEOUT
s_waitcnt vmcnt(0)
v_readfirstlane_b32 s7, v14
v_readfirstlane_b32 s8, v15
s_xor_b32 s101, s7, s22
s_xor_b32 s69, s8, s23
s_or_b32 s69, s69, s101
s_cmp_eq_u32 s69, 0
s_cselect_b32 s101, 1, 0
s_add_u32 s7, s7, s8
s_mul_i32 s7, s7, 0x01010101
s_lshr_b32 s7, s7, 24
s_cmp_eq_u32 s7, 32
s_cbranch_scc0 K1_IW
K1_IOK:
s_cmp_eq_u32 s101, 1
s_cbranch_scc1 K1_SW1f
s_branch K1_SW1s
.p2align 6
K1_U0f:
v_mfma_f32_16x16x32_bf16 v[64:67], v[224:227], v[40:43], v[64:67]
s_barrier

v_mfma_f32_16x16x32_bf16 v[64:67], v[240:243], v[44:47], v[64:67]
s_and_b32 s67, s64, 7
ds_read_b128 v[16:19], v96 offset:0
s_mul_i32 s67, s67, s100
v_mfma_f32_16x16x32_bf16 v[68:71], v[196:199], v[32:35], v[68:71]
s_add_u32 s67, s67, s11
ds_read_b128 v[20:23], v96 offset:1024
s_mov_b32 s46, s74
v_mfma_f32_16x16x32_bf16 v[68:71], v[212:215], v[36:39], v[68:71]
s_add_u32 s79, s64, 2
ds_read_b128 v[24:27], v96 offset:2048
v_fma_f32 v80, -v127, v100, v64
v_mfma_f32_16x16x32_bf16 v[68:71], v[228:231], v[40:43], v[68:71]
s_mov_b32 s64, s13
ds_read_b128 v[28:31], v96 offset:3072
v_fma_f32 v81, -v127, v101, v65
v_mfma_f32_16x16x32_bf16 v[68:71], v[244:247], v[44:47], v[68:71]
s_mov_b32 s0, s1
ds_read_b64 v[116:117], v99 offset:0
v_fma_f32 v82, -v127, v102, v66
v_mfma_f32_16x16x32_bf16 v[72:75], v[200:203], v[32:35], v[72:75]
s_add_u32 s13, s64, 1
ds_read_b64 v[118:119], v99 offset:128
v_fma_f32 v83, -v127, v103, v67
v_mfma_f32_16x16x32_bf16 v[72:75], v[216:219], v[36:39], v[72:75]
s_sub_u32 s1, s13, 17
ds_read_b64 v[120:121], v99 offset:256
v_fma_f32 v84, -v127, v104, v68
v_mfma_f32_16x16x32_bf16 v[72:75], v[232:235], v[40:43], v[72:75]
s_cselect_b32 s1, s13, s1
ds_read_b64 v[122:123], v99 offset:384
v_fma_f32 v85, -v127, v105, v69
v_mfma_f32_16x16x32_bf16 v[72:75], v[248:251], v[44:47], v[72:75]
s_mul_i32 s66, s1, 24576
ds_read_b64 v[124:125], v99 offset:512
v_fma_f32 v86, -v127, v106, v70
v_mfma_f32_16x16x32_bf16 v[76:79], v[204:207], v[32:35], v[76:79]
s_add_u32 s66, s66, s10
v_fma_f32 v87, -v127, v107, v71
s_add_u32 s65, s13, 2
v_mfma_f32_16x16x32_bf16 v[76:79], v[220:223], v[36:39], v[76:79]
s_waitcnt vmcnt(2)
v_cmp_le_u32 vcc, s65, v6
v_fma_f32 v88, -v127, v108, v72
v_mfma_f32_16x16x32_bf16 v[76:79], v[236:239], v[40:43], v[76:79]
s_cmp_eq_u64 vcc, -1
v_fma_f32 v89, -v127, v109, v73
v_fma_f32 v90, -v127, v110, v74
v_mfma_f32_16x16x32_bf16 v[76:79], v[252:255], v[44:47], v[76:79]
s_waitcnt lgkmcnt(5)
v_fma_f32 v91, -v127, v111, v75
s_waitcnt vmcnt(0)
K1_F0f:
v_mfma_f32_16x16x32_bf16 v[48:51], a[0:3], v[16:19], 0
ds_read_b128 v[32:35], v96 offset:4096
v_mfma_f32_16x16x32_bf16 v[48:51], a[16:19], v[20:23], v[48:51]
s_cbranch_scc0 K1_W0f
K1_W0fR:
s_cselect_b32 s68, 1, 0
v_mfma_f32_16x16x32_bf16 v[48:51], a[32:35], v[24:27], v[48:51]
s_cselect_b32 s42, 0x4000000, 0
ds_read_b128 v[36:39], v96 offset:6144
s_add_u32 s69, s66, 4096
v_mfma_f32_16x16x32_bf16 v[48:51], a[48:51], v[28:31], v[48:51]
buffer_store_dword v8, v7, s[36:39], 0 offen
v_mfma_f32_16x16x32_bf16 v[52:55], a[4:7], v[16:19], 0
s_add_u32 m0, s72, 28672
ds_read_b128 v[40:43], v96 offset:7168
v_mov_b32 v8, s79
v_mfma_f32_16x16x32_bf16 v[52:55], a[20:23], v[20:23], v[52:55]
buffer_load_dwordx4 v11, s[40:43], s69 offen offset:1024 sc1 lds
v_mfma_f32_16x16x32_bf16 v[52:55], a[36:39], v[24:27], v[52:55]
s_waitcnt lgkmcnt(3)
ds_read_b128 v[44:47], v96 offset:8192
v_fma_f32 v92, -v127, v112, v76
v_mfma_f32_16x16x32_bf16 v[52:55], a[52:55], v[28:31], v[52:55]
v_fma_f32 v93, -v127, v113, v77
v_fma_f32 v94, -v127, v114, v78
v_mfma_f32_16x16x32_bf16 v[56:59], a[8:11], v[16:19], 0
buffer_load_dwordx4 v1, s[40:43], s69 offen offset:0 sc1 lds
v_mfma_f32_16x16x32_bf16 v[56:59], a[24:27], v[20:23], v[56:59]
s_add_u32 m0, s72, 24576
v_fma_f32 v95, -v127, v115, v79
v_mul_f32 v84, v84, v129
v_mfma_f32_16x16x32_bf16 v[56:59], a[40:43], v[24:27], v[56:59]
v_mul_f32 v85, v85, v129
v_mul_f32 v86, v86, v129
v_mfma_f32_16x16x32_bf16 v[56:59], a[56:59], v[28:31], v[56:59]
v_mul_f32 v87, v87, v129
v_mul_f32 v88, v88, v129
v_mfma_f32_16x16x32_bf16 v[60:63], a[12:15], v[16:19], 0
buffer_load_dwordx4 v1, s[40:43], s66 offen offset:0 sc1 lds
v_mfma_f32_16x16x32_bf16 v[60:63], a[28:31], v[20:23], v[60:63]
v_mul_f32 v89, v89, v129
v_mul_f32 v90, v90, v129
v_mfma_f32_16x16x32_bf16 v[60:63], a[44:47], v[24:27], v[60:63]
v_mul_f32 v91, v91, v129
v_cvt_pk_bf16_f32 v132, v80, v81
v_mfma_f32_16x16x32_bf16 v[60:63], a[60:63], v[28:31], v[60:63]
s_waitcnt lgkmcnt(0)
v_cvt_pk_bf16_f32 v133, v82, v83
v_cvt_pk_bf16_f32 v134, v92, v93
v_mfma_f32_16x16x32_bf16 v[48:51], a[64:67], v[32:35], v[48:51]
ds_read_b128 v[16:19], v96 offset:9216
v_cvt_pk_bf16_f32 v135, v94, v95
v_mfma_f32_16x16x32_bf16 v[48:51], a[80:83], v[36:39], v[48:51]
buffer_load_dwordx4 v1, s[40:43], s66 offen offset:1024 sc1 lds
v_mfma_f32_16x16x32_bf16 v[48:51], a[96:99], v[40:43], v[48:51]
ds_read_b128 v[20:23], v96 offset:10240
v_cvt_pk_bf16_f32 v136, v88, v89
v_mfma_f32_16x16x32_bf16 v[48:51], a[112:115], v[44:47], v[48:51]
v_cvt_pk_bf16_f32 v137, v90, v91
v_cvt_pk_bf16_f32 v188, v84, v85
v_mfma_f32_16x16x32_bf16 v[52:55], a[68:71], v[32:35], v[52:55]
ds_read_b128 v[24:27], v96 offset:12288
v_cvt_pk_bf16_f32 v189, v86, v87
v_mfma_f32_16x16x32_bf16 v[52:55], a[84:87], v[36:39], v[52:55]
buffer_load_dwordx4 v1, s[40:43], s66 offen offset:2048 sc1 lds
v_mfma_f32_16x16x32_bf16 v[52:55], a[100:103], v[40:43], v[52:55]
ds_read_b128 v[28:31], v96 offset:13312
v_cndmask_b32 v190, 0, v136, s[56:57]
v_mfma_f32_16x16x32_bf16 v[52:55], a[116:119], v[44:47], v[52:55]
v_cndmask_b32 v191, 0, v137, s[56:57]
v_mul_f32 v92, v92, v129
v_mfma_f32_16x16x32_bf16 v[144:147], v[184:187], v[132:135], v[164:167]
v_mul_f32 v93, v93, v129
v_mul_f32 v94, v94, v129
v_mfma_f32_16x16x32_bf16 v[140:143], v[188:191], v[132:135], v[168:171]
v_mul_f32 v95, v95, v129
v_cvt_pk_bf16_f32 v138, v92, v93
v_mfma_f32_16x16x32_bf16 v[56:59], a[72:75], v[32:35], v[56:59]
buffer_load_dwordx4 v1, s[40:43], s66 offen offset:3072 sc1 lds
v_mfma_f32_16x16x32_bf16 v[56:59], a[88:91], v[36:39], v[56:59]
v_cvt_pk_bf16_f32 v139, v94, v95
v_add_f32 v116, v116, v118
v_mfma_f32_16x16x32_bf16 v[56:59], a[104:107], v[40:43], v[56:59]
v_max_f32 v140, v144, v140
v_max_f32 v141, v145, v141
v_mfma_f32_16x16x32_bf16 v[148:151], v[136:139], v[172:175], 0
v_max_f32 v142, v146, v142
v_max_f32 v143, v147, v143
v_mfma_f32_16x16x32_bf16 v[152:155], v[136:139], v[176:179], v[180:183]
v_max3_f32 v144, v140, v141, v142
v_max_f32 v145, v144, v143
v_mfma_f32_16x16x32_bf16 v[56:59], a[120:123], v[44:47], v[56:59]
v_max_f32 v144, v144, v143
v_add_f32 v117, v117, v119
v_mfma_f32_16x16x32_bf16 v[60:63], a[76:79], v[32:35], v[60:63]
v_permlane32_swap_b32 v144, v145
v_mfma_f32_16x16x32_bf16 v[60:63], a[92:95], v[36:39], v[60:63]
v_max_f32 v146, v144, v145
v_max_f32 v147, v144, v145
v_mfma_f32_16x16x32_bf16 v[60:63], a[108:111], v[40:43], v[60:63]
v_cvt_pk_bf16_f32 v158, v148, v149
v_cvt_pk_bf16_f32 v159, v150, v151
v_mfma_f32_16x16x32_bf16 v[60:63], a[124:127], v[44:47], v[60:63]
s_waitcnt lgkmcnt(0)
v_permlane16_swap_b32 v146, v147
v_mfma_f32_16x16x32_bf16 v[48:51], a[128:131], v[16:19], v[48:51]
ds_read_b128 v[32:35], v96 offset:14336
v_max_f32 v144, v146, v147
v_mfma_f32_16x16x32_bf16 v[48:51], a[144:147], v[20:23], v[48:51]
v_mul_f32 v144, v144, v131
v_fma_f32 v140, v140, v131, -v144
v_mfma_f32_16x16x32_bf16 v[48:51], a[160:163], v[24:27], v[48:51]
ds_read_b128 v[36:39], v96 offset:15360
v_fma_f32 v141, v141, v131, -v144
v_mfma_f32_16x16x32_bf16 v[48:51], a[176:179], v[28:31], v[48:51]
v_fma_f32 v142, v142, v131, -v144
v_fma_f32 v143, v143, v131, -v144
v_mfma_f32_16x16x32_bf16 v[52:55], a[132:135], v[16:19], v[52:55]
ds_read_b128 v[40:43], v96 offset:16384
v_cvt_pk_bf16_f32 v162, v152, v153
v_mfma_f32_16x16x32_bf16 v[52:55], a[148:151], v[20:23], v[52:55]
v_exp_f32 v140, v140
v_mfma_f32_16x16x32_bf16 v[52:55], a[164:167], v[24:27], v[52:55]
ds_read_b128 v[44:47], v96 offset:18432
v_cvt_pk_bf16_f32 v163, v154, v155
v_mfma_f32_16x16x32_bf16 v[52:55], a[180:183], v[28:31], v[52:55]
v_exp_f32 v141, v141
v_mfma_f32_16x16x32_bf16 v[56:59], a[136:139], v[16:19], v[56:59]
v_exp_f32 v142, v142
v_mfma_f32_16x16x32_bf16 v[56:59], a[152:155], v[20:23], v[56:59]
v_exp_f32 v143, v143
v_mfma_f32_16x16x32_bf16 v[56:59], a[168:171], v[24:27], v[56:59]
buffer_load_dword v6, v5, s[36:39], 0 offen sc1
v_mfma_f32_16x16x32_bf16 v[56:59], a[184:187], v[28:31], v[56:59]
s_sub_u32 s69, s0, s73
v_cvt_pk_bf16_f32 v144, v140, v141
v_cvt_pk_bf16_f32 v145, v142, v143
v_mfma_f32_16x16x32_bf16 v[60:63], a[140:143], v[16:19], v[60:63]
s_cmp_lt_u32 s69, 2
v_and_b32 v134, v12, v144
v_and_b32 v135, v13, v145
v_mfma_f32_16x16x32_bf16 v[60:63], a[156:159], v[20:23], v[60:63]
s_cselect_b32 s69, 0, s68
v_bfi_b32 v132, v12, 0, v144
v_bfi_b32 v133, v13, 0, v145
v_mfma_f32_16x16x32_bf16 v[60:63], a[172:175], v[24:27], v[60:63]
s_cmp_eq_u32 s69, 0
v_add_f32 v120, v120, v122
v_add_f32 v121, v121, v123
v_mfma_f32_16x16x32_bf16 v[152:155], v[160:163], v[132:135], 0
v_add_f32 v116, v116, v124
v_add_f32 v117, v117, v125
v_mfma_f32_16x16x32_bf16 v[148:151], v[156:159], v[132:135], 0
v_add_f32 v116, v116, v120
v_add_f32 v117, v117, v121
v_mfma_f32_16x16x32_bf16 v[60:63], a[188:191], v[28:31], v[60:63]
s_waitcnt lgkmcnt(0)
v_permlane32_swap_b32 v116, v117
v_mfma_f32_16x16x32_bf16 v[48:51], a[192:195], v[32:35], v[48:51]
ds_read_b128 v[16:19], v96 offset:19456
v_add_f32 v118, v116, v117
v_mfma_f32_16x16x32_bf16 v[48:51], a[208:211], v[36:39], v[48:51]
v_rcp_f32 v144, v153
v_mfma_f32_16x16x32_bf16 v[48:51], a[224:227], v[40:43], v[48:51]
ds_read_b128 v[20:23], v96 offset:20480
v_mul_f32 v148, v148, v144
v_mfma_f32_16x16x32_bf16 v[48:51], a[240:243], v[44:47], v[48:51]
v_mul_f32 v149, v149, v144
v_mul_f32 v150, v150, v144
v_mfma_f32_16x16x32_bf16 v[52:55], a[196:199], v[32:35], v[52:55]
ds_read_b128 v[24:27], v96 offset:21504
v_mul_f32 v151, v151, v144
v_mfma_f32_16x16x32_bf16 v[52:55], a[212:215], v[36:39], v[52:55]
v_mul_f32 v152, v152, v144
v_cvt_pk_bf16_f32 v140, v148, v149
v_mfma_f32_16x16x32_bf16 v[52:55], a[228:231], v[40:43], v[52:55]
ds_read_b128 v[28:31], v96 offset:22528
v_cvt_pk_bf16_f32 v141, v150, v151
v_mfma_f32_16x16x32_bf16 v[52:55], a[244:247], v[44:47], v[52:55]
v_cvt_pk_bf16_f32 v142, v152, v152
v_add_f32 v119, v116, v117
v_mfma_f32_16x16x32_bf16 v[56:59], a[200:203], v[32:35], v[56:59]
buffer_store_dwordx2 v[140:141], v97, s[44:47], s67 offen
v_mfma_f32_16x16x32_bf16 v[56:59], a[216:219], v[36:39], v[56:59]
buffer_store_short v142, v98, s[44:47], s67 offen
v_mfma_f32_16x16x32_bf16 v[56:59], a[232:235], v[40:43], v[56:59]
v_permlane16_swap_b32 v118, v119
v_mfma_f32_16x16x32_bf16 v[56:59], a[248:251], v[44:47], v[56:59]
v_add_f32 v126, v118, v119
v_add_f32 v117, v118, v119
v_mfma_f32_16x16x32_bf16 v[60:63], a[204:207], v[32:35], v[60:63]
v_mfma_f32_16x16x32_bf16 v[60:63], a[220:223], v[36:39], v[60:63]
v_permlane32_swap_b32 v126, v117
v_mfma_f32_16x16x32_bf16 v[60:63], a[236:239], v[40:43], v[60:63]
v_fma_f32 v117, -v126, v126, v117
v_max_f32 v117, s77, v117
v_mfma_f32_16x16x32_bf16 v[60:63], a[252:255], v[44:47], v[60:63]
s_waitcnt lgkmcnt(0)
v_rsq_f32 v128, v117
v_mfma_f32_16x16x32_bf16 v[48:51], v[192:195], v[16:19], v[48:51]
s_waitcnt vmcnt(3) lgkmcnt(0)
v_mul_f32 v130, s78, v128
v_mfma_f32_16x16x32_bf16 v[48:51], v[208:211], v[20:23], v[48:51]
s_cbranch_scc1 K1_X0f
K1_U1f:
v_mfma_f32_16x16x32_bf16 v[48:51], v[224:227], v[24:27], v[48:51]
s_barrier

v_mfma_f32_16x16x32_bf16 v[48:51], v[240:243], v[28:31], v[48:51]
s_and_b32 s67, s64, 7
ds_read_b128 v[32:35], v96 offset:24576
s_mul_i32 s67, s67, s100
v_mfma_f32_16x16x32_bf16 v[52:55], v[196:199], v[16:19], v[52:55]
s_add_u32 s67, s67, s11
ds_read_b128 v[36:39], v96 offset:25600
s_mov_b32 s46, s74
v_mfma_f32_16x16x32_bf16 v[52:55], v[212:215], v[20:23], v[52:55]
s_add_u32 s79, s64, 2
ds_read_b128 v[40:43], v96 offset:26624
v_fma_f32 v80, -v126, v100, v48
v_mfma_f32_16x16x32_bf16 v[52:55], v[228:231], v[24:27], v[52:55]
s_mov_b32 s64, s13
ds_read_b128 v[44:47], v96 offset:27648
v_fma_f32 v81, -v126, v101, v49
v_mfma_f32_16x16x32_bf16 v[52:55], v[244:247], v[28:31], v[52:55]
s_mov_b32 s0, s1
ds_read_b64 v[116:117], v99 offset:24576
v_fma_f32 v82, -v126, v102, v50
v_mfma_f32_16x16x32_bf16 v[56:59], v[200:203], v[16:19], v[56:59]
s_add_u32 s13, s64, 1
ds_read_b64 v[118:119], v99 offset:24704
v_fma_f32 v83, -v126, v103, v51
v_mfma_f32_16x16x32_bf16 v[56:59], v[216:219], v[20:23], v[56:59]
s_sub_u32 s1, s13, 17
ds_read_b64 v[120:121], v99 offset:24832
v_fma_f32 v84, -v126, v104, v52
v_mfma_f32_16x16x32_bf16 v[56:59], v[232:235], v[24:27], v[56:59]
s_cselect_b32 s1, s13, s1
ds_read_b64 v[122:123], v99 offset:24960
v_fma_f32 v85, -v126, v105, v53
v_mfma_f32_16x16x32_bf16 v[56:59], v[248:251], v[28:31], v[56:59]
s_mul_i32 s66, s1, 24576
ds_read_b64 v[124:125], v99 offset:25088
v_fma_f32 v86, -v126, v106, v54
v_mfma_f32_16x16x32_bf16 v[60:63], v[204:207], v[16:19], v[60:63]
s_add_u32 s66, s66, s10
v_fma_f32 v87, -v126, v107, v55
s_add_u32 s65, s13, 2
v_mfma_f32_16x16x32_bf16 v[60:63], v[220:223], v[20:23], v[60:63]
s_waitcnt vmcnt(2)
v_cmp_le_u32 vcc, s65, v6
v_fma_f32 v88, -v126, v108, v56
v_mfma_f32_16x16x32_bf16 v[60:63], v[236:239], v[24:27], v[60:63]
s_cmp_eq_u64 vcc, -1
v_fma_f32 v89, -v126, v109, v57
v_fma_f32 v90, -v126, v110, v58
v_mfma_f32_16x16x32_bf16 v[60:63], v[252:255], v[28:31], v[60:63]
s_waitcnt lgkmcnt(5)
v_fma_f32 v91, -v126, v111, v59
s_waitcnt vmcnt(0)
K1_F1f:
v_mfma_f32_16x16x32_bf16 v[64:67], a[0:3], v[32:35], 0
ds_read_b128 v[16:19], v96 offset:28672
v_mfma_f32_16x16x32_bf16 v[64:67], a[16:19], v[36:39], v[64:67]
s_cbranch_scc0 K1_W1f
K1_W1fR:
s_cselect_b32 s68, 1, 0
v_mfma_f32_16x16x32_bf16 v[64:67], a[32:35], v[40:43], v[64:67]
s_cselect_b32 s42, 0x4000000, 0
ds_read_b128 v[20:23], v96 offset:30720
s_add_u32 s69, s66, 4096
v_mfma_f32_16x16x32_bf16 v[64:67], a[48:51], v[44:47], v[64:67]
buffer_store_dword v8, v7, s[36:39], 0 offen
v_mfma_f32_16x16x32_bf16 v[68:71], a[4:7], v[32:35], 0
s_add_u32 m0, s72, 4096
ds_read_b128 v[24:27], v96 offset:31744
v_mov_b32 v8, s79
v_mfma_f32_16x16x32_bf16 v[68:71], a[20:23], v[36:39], v[68:71]
buffer_load_dwordx4 v11, s[40:43], s69 offen offset:1024 sc1 lds
v_mfma_f32_16x16x32_bf16 v[68:71], a[36:39], v[40:43], v[68:71]
s_waitcnt lgkmcnt(3)
ds_read_b128 v[28:31], v96 offset:32768
v_fma_f32 v92, -v126, v112, v60
v_mfma_f32_16x16x32_bf16 v[68:71], a[52:55], v[44:47], v[68:71]
v_fma_f32 v93, -v126, v113, v61
v_fma_f32 v94, -v126, v114, v62
v_mfma_f32_16x16x32_bf16 v[72:75], a[8:11], v[32:35], 0
buffer_load_dwordx4 v1, s[40:43], s69 offen offset:0 sc1 lds
v_mfma_f32_16x16x32_bf16 v[72:75], a[24:27], v[36:39], v[72:75]
s_add_u32 m0, s72, 0
v_fma_f32 v95, -v126, v115, v63
v_mul_f32 v84, v84, v128
v_mfma_f32_16x16x32_bf16 v[72:75], a[40:43], v[40:43], v[72:75]
v_mul_f32 v85, v85, v128
v_mul_f32 v86, v86, v128
v_mfma_f32_16x16x32_bf16 v[72:75], a[56:59], v[44:47], v[72:75]
v_mul_f32 v87, v87, v128
v_mul_f32 v88, v88, v128
v_mfma_f32_16x16x32_bf16 v[76:79], a[12:15], v[32:35], 0
buffer_load_dwordx4 v1, s[40:43], s66 offen offset:0 sc1 lds
v_mfma_f32_16x16x32_bf16 v[76:79], a[28:31], v[36:39], v[76:79]
v_mul_f32 v89, v89, v128
v_mul_f32 v90, v90, v128
v_mfma_f32_16x16x32_bf16 v[76:79], a[44:47], v[40:43], v[76:79]
v_mul_f32 v91, v91, v128
v_cvt_pk_bf16_f32 v132, v80, v81
v_mfma_f32_16x16x32_bf16 v[76:79], a[60:63], v[44:47], v[76:79]
s_waitcnt lgkmcnt(0)
v_cvt_pk_bf16_f32 v133, v82, v83
v_cvt_pk_bf16_f32 v134, v92, v93
v_mfma_f32_16x16x32_bf16 v[64:67], a[64:67], v[16:19], v[64:67]
ds_read_b128 v[32:35], v96 offset:33792
v_cvt_pk_bf16_f32 v135, v94, v95
v_mfma_f32_16x16x32_bf16 v[64:67], a[80:83], v[20:23], v[64:67]
buffer_load_dwordx4 v1, s[40:43], s66 offen offset:1024 sc1 lds
v_mfma_f32_16x16x32_bf16 v[64:67], a[96:99], v[24:27], v[64:67]
ds_read_b128 v[36:39], v96 offset:34816
v_cvt_pk_bf16_f32 v136, v88, v89
v_mfma_f32_16x16x32_bf16 v[64:67], a[112:115], v[28:31], v[64:67]
v_cvt_pk_bf16_f32 v137, v90, v91
v_cvt_pk_bf16_f32 v184, v84, v85
v_mfma_f32_16x16x32_bf16 v[68:71], a[68:71], v[16:19], v[68:71]
ds_read_b128 v[40:43], v96 offset:36864
v_cvt_pk_bf16_f32 v185, v86, v87
v_mfma_f32_16x16x32_bf16 v[68:71], a[84:87], v[20:23], v[68:71]
buffer_load_dwordx4 v1, s[40:43], s66 offen offset:2048 sc1 lds
v_mfma_f32_16x16x32_bf16 v[68:71], a[100:103], v[24:27], v[68:71]
ds_read_b128 v[44:47], v96 offset:37888
v_cndmask_b32 v186, 0, v136, s[56:57]
v_mfma_f32_16x16x32_bf16 v[68:71], a[116:119], v[28:31], v[68:71]
v_cndmask_b32 v187, 0, v137, s[56:57]
v_mul_f32 v92, v92, v128
v_mfma_f32_16x16x32_bf16 v[144:147], v[188:191], v[132:135], v[164:167]
v_mul_f32 v93, v93, v128
v_mul_f32 v94, v94, v128
v_mfma_f32_16x16x32_bf16 v[140:143], v[184:187], v[132:135], v[168:171]
v_mul_f32 v95, v95, v128
v_cvt_pk_bf16_f32 v138, v92, v93
v_mfma_f32_16x16x32_bf16 v[72:75], a[72:75], v[16:19], v[72:75]
buffer_load_dwordx4 v1, s[40:43], s66 offen offset:3072 sc1 lds
v_mfma_f32_16x16x32_bf16 v[72:75], a[88:91], v[20:23], v[72:75]
v_cvt_pk_bf16_f32 v139, v94, v95
v_add_f32 v116, v116, v118
v_mfma_f32_16x16x32_bf16 v[72:75], a[104:107], v[24:27], v[72:75]
v_max_f32 v140, v144, v140
v_max_f32 v141, v145, v141
v_mfma_f32_16x16x32_bf16 v[148:151], v[136:139], v[172:175], 0
v_max_f32 v142, v146, v142
v_max_f32 v143, v147, v143
v_mfma_f32_16x16x32_bf16 v[152:155], v[136:139], v[176:179], v[180:183]
v_max3_f32 v144, v140, v141, v142
v_max_f32 v145, v144, v143
v_mfma_f32_16x16x32_bf16 v[72:75], a[120:123], v[28:31], v[72:75]
v_max_f32 v144, v144, v143
v_add_f32 v117, v117, v119
v_mfma_f32_16x16x32_bf16 v[76:79], a[76:79], v[16:19], v[76:79]
v_permlane32_swap_b32 v144, v145
v_mfma_f32_16x16x32_bf16 v[76:79], a[92:95], v[20:23], v[76:79]
v_max_f32 v146, v144, v145
v_max_f32 v147, v144, v145
v_mfma_f32_16x16x32_bf16 v[76:79], a[108:111], v[24:27], v[76:79]
v_cvt_pk_bf16_f32 v156, v148, v149
v_cvt_pk_bf16_f32 v157, v150, v151
v_mfma_f32_16x16x32_bf16 v[76:79], a[124:127], v[28:31], v[76:79]
s_waitcnt lgkmcnt(0)
v_permlane16_swap_b32 v146, v147
v_mfma_f32_16x16x32_bf16 v[64:67], a[128:131], v[32:35], v[64:67]
ds_read_b128 v[16:19], v96 offset:38912
v_max_f32 v144, v146, v147
v_mfma_f32_16x16x32_bf16 v[64:67], a[144:147], v[36:39], v[64:67]
v_mul_f32 v144, v144, v130
v_fma_f32 v140, v140, v130, -v144
v_mfma_f32_16x16x32_bf16 v[64:67], a[160:163], v[40:43], v[64:67]
ds_read_b128 v[20:23], v96 offset:39936
v_fma_f32 v141, v141, v130, -v144
v_mfma_f32_16x16x32_bf16 v[64:67], a[176:179], v[44:47], v[64:67]
v_fma_f32 v142, v142, v130, -v144
v_fma_f32 v143, v143, v130, -v144
v_mfma_f32_16x16x32_bf16 v[68:71], a[132:135], v[32:35], v[68:71]
ds_read_b128 v[24:27], v96 offset:40960
v_cvt_pk_bf16_f32 v160, v152, v153
v_mfma_f32_16x16x32_bf16 v[68:71], a[148:151], v[36:39], v[68:71]
v_exp_f32 v140, v140
v_mfma_f32_16x16x32_bf16 v[68:71], a[164:167], v[40:43], v[68:71]
ds_read_b128 v[28:31], v96 offset:43008
v_cvt_pk_bf16_f32 v161, v154, v155
v_mfma_f32_16x16x32_bf16 v[68:71], a[180:183], v[44:47], v[68:71]
v_exp_f32 v141, v141
v_mfma_f32_16x16x32_bf16 v[72:75], a[136:139], v[32:35], v[72:75]
v_exp_f32 v142, v142
v_mfma_f32_16x16x32_bf16 v[72:75], a[152:155], v[36:39], v[72:75]
v_exp_f32 v143, v143
v_mfma_f32_16x16x32_bf16 v[72:75], a[168:171], v[40:43], v[72:75]
buffer_load_dword v6, v5, s[36:39], 0 offen sc1
v_mfma_f32_16x16x32_bf16 v[72:75], a[184:187], v[44:47], v[72:75]
s_sub_u32 s69, s0, s73
v_cvt_pk_bf16_f32 v144, v140, v141
v_cvt_pk_bf16_f32 v145, v142, v143
v_mfma_f32_16x16x32_bf16 v[76:79], a[140:143], v[32:35], v[76:79]
s_cmp_lt_u32 s69, 2
v_and_b32 v132, v12, v144
v_and_b32 v133, v13, v145
v_mfma_f32_16x16x32_bf16 v[76:79], a[156:159], v[36:39], v[76:79]
s_cselect_b32 s69, 0, s68
v_bfi_b32 v134, v12, 0, v144
v_bfi_b32 v135, v13, 0, v145
v_mfma_f32_16x16x32_bf16 v[76:79], a[172:175], v[40:43], v[76:79]
s_cmp_eq_u32 s69, 0
v_add_f32 v120, v120, v122
v_add_f32 v121, v121, v123
v_mfma_f32_16x16x32_bf16 v[152:155], v[160:163], v[132:135], 0
v_add_f32 v116, v116, v124
v_add_f32 v117, v117, v125
v_mfma_f32_16x16x32_bf16 v[148:151], v[156:159], v[132:135], 0
v_add_f32 v116, v116, v120
v_add_f32 v117, v117, v121
v_mfma_f32_16x16x32_bf16 v[76:79], a[188:191], v[44:47], v[76:79]
s_waitcnt lgkmcnt(0)
v_permlane32_swap_b32 v116, v117
v_mfma_f32_16x16x32_bf16 v[64:67], a[192:195], v[16:19], v[64:67]
ds_read_b128 v[32:35], v96 offset:44032
v_add_f32 v118, v116, v117
v_mfma_f32_16x16x32_bf16 v[64:67], a[208:211], v[20:23], v[64:67]
v_rcp_f32 v144, v153
v_mfma_f32_16x16x32_bf16 v[64:67], a[224:227], v[24:27], v[64:67]
ds_read_b128 v[36:39], v96 offset:45056
v_mul_f32 v148, v148, v144
v_mfma_f32_16x16x32_bf16 v[64:67], a[240:243], v[28:31], v[64:67]
v_mul_f32 v149, v149, v144
v_mul_f32 v150, v150, v144
v_mfma_f32_16x16x32_bf16 v[68:71], a[196:199], v[16:19], v[68:71]
ds_read_b128 v[40:43], v96 offset:46080
v_mul_f32 v151, v151, v144
v_mfma_f32_16x16x32_bf16 v[68:71], a[212:215], v[20:23], v[68:71]
v_mul_f32 v152, v152, v144
v_cvt_pk_bf16_f32 v140, v148, v149
v_mfma_f32_16x16x32_bf16 v[68:71], a[228:231], v[24:27], v[68:71]
ds_read_b128 v[44:47], v96 offset:47104
v_cvt_pk_bf16_f32 v141, v150, v151
v_mfma_f32_16x16x32_bf16 v[68:71], a[244:247], v[28:31], v[68:71]
v_cvt_pk_bf16_f32 v142, v152, v152
v_add_f32 v119, v116, v117
v_mfma_f32_16x16x32_bf16 v[72:75], a[200:203], v[16:19], v[72:75]
buffer_store_dwordx2 v[140:141], v97, s[44:47], s67 offen
v_mfma_f32_16x16x32_bf16 v[72:75], a[216:219], v[20:23], v[72:75]
buffer_store_short v142, v98, s[44:47], s67 offen
v_mfma_f32_16x16x32_bf16 v[72:75], a[232:235], v[24:27], v[72:75]
v_permlane16_swap_b32 v118, v119
v_mfma_f32_16x16x32_bf16 v[72:75], a[248:251], v[28:31], v[72:75]
v_add_f32 v127, v118, v119
v_add_f32 v117, v118, v119
v_mfma_f32_16x16x32_bf16 v[76:79], a[204:207], v[16:19], v[76:79]
v_mfma_f32_16x16x32_bf16 v[76:79], a[220:223], v[20:23], v[76:79]
v_permlane32_swap_b32 v127, v117
v_mfma_f32_16x16x32_bf16 v[76:79], a[236:239], v[24:27], v[76:79]
v_fma_f32 v117, -v127, v127, v117
v_max_f32 v117, s77, v117
v_mfma_f32_16x16x32_bf16 v[76:79], a[252:255], v[28:31], v[76:79]
s_waitcnt lgkmcnt(0)
v_rsq_f32 v129, v117
v_mfma_f32_16x16x32_bf16 v[64:67], v[192:195], v[32:35], v[64:67]
s_waitcnt vmcnt(3) lgkmcnt(0)
v_mul_f32 v131, s78, v129
v_mfma_f32_16x16x32_bf16 v[64:67], v[208:211], v[36:39], v[64:67]
s_cbranch_scc0 K1_U0f
K1_X1f:
s_sub_u32 s69, s0, s73
s_cmp_lt_u32 s69, 2
s_cbranch_scc0 K1_XB1f
s_cmp_eq_u32 s69, 0
s_cselect_b64 s[96:97], 0, -1
v_mov_b32 v14, 0xf149f2ca
s_and_b64 vcc, s[88:89], s[96:97]
v_cndmask_b32 v164, v14, 0, vcc
s_and_b64 vcc, s[90:91], s[96:97]
v_cndmask_b32 v165, v14, 0, vcc
s_and_b64 vcc, s[92:93], s[96:97]
v_cndmask_b32 v166, v14, 0, vcc
s_and_b64 vcc, s[94:95], s[96:97]
v_cndmask_b32 v167, v14, 0, vcc
K1_XB1f:
s_cmp_eq_u32 s68, 0
s_cbranch_scc1 K1_NR1f
s_branch K1_U0f
K1_NR1f:
buffer_load_dword v6, v5, s[36:39], 0 offen sc1
v_mfma_f32_16x16x32_bf16 v[64:67], v[224:227], v[40:43], v[64:67]
s_and_b32 s67, s64, 7
s_mul_i32 s67, s67, s100
s_add_u32 s67, s67, s11
v_mfma_f32_16x16x32_bf16 v[64:67], v[240:243], v[44:47], v[64:67]
s_mov_b32 s46, s74
s_add_u32 s79, s64, 2
s_mov_b32 s64, s13
v_mfma_f32_16x16x32_bf16 v[68:71], v[196:199], v[32:35], v[68:71]
s_mov_b32 s0, s1
v_mfma_f32_16x16x32_bf16 v[68:71], v[212:215], v[36:39], v[68:71]
v_mfma_f32_16x16x32_bf16 v[68:71], v[228:231], v[40:43], v[68:71]
v_mfma_f32_16x16x32_bf16 v[68:71], v[244:247], v[44:47], v[68:71]
v_mfma_f32_16x16x32_bf16 v[72:75], v[200:203], v[32:35], v[72:75]
v_mfma_f32_16x16x32_bf16 v[72:75], v[216:219], v[36:39], v[72:75]
v_mfma_f32_16x16x32_bf16 v[72:75], v[232:235], v[40:43], v[72:75]
v_mfma_f32_16x16x32_bf16 v[72:75], v[248:251], v[44:47], v[72:75]
v_mfma_f32_16x16x32_bf16 v[76:79], v[204:207], v[32:35], v[76:79]
v_mfma_f32_16x16x32_bf16 v[76:79], v[220:223], v[36:39], v[76:79]
v_mfma_f32_16x16x32_bf16 v[76:79], v[236:239], v[40:43], v[76:79]
v_mfma_f32_16x16x32_bf16 v[76:79], v[252:255], v[44:47], v[76:79]
s_waitcnt vmcnt(0)
buffer_store_dword v8, v7, s[36:39], 0 offen
s_mov_b32 s68, 2
s_cmp_gt_u32 s64, 33
s_cbranch_scc1 K1_EP1f
v_cmp_le_u32 vcc, s65, v6
s_nop 0
s_cmp_eq_u64 vcc, -1
s_cselect_b32 s68, 1, 0
s_cselect_b32 s42, 0x4000000, 0
s_add_u32 s69, s66, 4096
s_add_u32 m0, s72, 4096
s_nop 0
buffer_load_dwordx4 v11, s[40:43], s69 offen offset:1024 sc1 lds
buffer_load_dwordx4 v1, s[40:43], s69 offen offset:0 sc1 lds
s_add_u32 m0, s72, 0
s_nop 0
buffer_load_dwordx4 v1, s[40:43], s66 offen offset:0 sc1 lds
buffer_load_dwordx4 v1, s[40:43], s66 offen offset:1024 sc1 lds
buffer_load_dwordx4 v1, s[40:43], s66 offen offset:2048 sc1 lds
buffer_load_dwordx4 v1, s[40:43], s66 offen offset:3072 sc1 lds
buffer_load_dword v6, v5, s[36:39], 0 offen sc1
K1_EP1f:
v_fma_f32 v80, -v127, v100, v64
v_fma_f32 v81, -v127, v101, v65
v_fma_f32 v82, -v127, v102, v66
v_fma_f32 v83, -v127, v103, v67
v_fma_f32 v84, -v127, v104, v68
v_fma_f32 v85, -v127, v105, v69
v_fma_f32 v86, -v127, v106, v70
v_fma_f32 v87, -v127, v107, v71
v_fma_f32 v88, -v127, v108, v72
v_fma_f32 v89, -v127, v109, v73
v_fma_f32 v90, -v127, v110, v74
v_fma_f32 v91, -v127, v111, v75
v_fma_f32 v92, -v127, v112, v76
v_fma_f32 v93, -v127, v113, v77
v_fma_f32 v94, -v127, v114, v78
v_fma_f32 v95, -v127, v115, v79
v_mul_f32 v84, v84, v129
v_mul_f32 v85, v85, v129
v_mul_f32 v86, v86, v129
v_mul_f32 v87, v87, v129
v_mul_f32 v88, v88, v129
v_mul_f32 v89, v89, v129
v_mul_f32 v90, v90, v129
v_mul_f32 v91, v91, v129
v_cvt_pk_bf16_f32 v132, v80, v81
v_cvt_pk_bf16_f32 v133, v82, v83
v_cvt_pk_bf16_f32 v134, v92, v93
v_cvt_pk_bf16_f32 v135, v94, v95
v_cvt_pk_bf16_f32 v136, v88, v89
v_cvt_pk_bf16_f32 v137, v90, v91
v_cvt_pk_bf16_f32 v188, v84, v85
v_cvt_pk_bf16_f32 v189, v86, v87
v_cndmask_b32 v190, 0, v136, s[56:57]
v_cndmask_b32 v191, 0, v137, s[56:57]
v_mfma_f32_16x16x32_bf16 v[144:147], v[184:187], v[132:135], v[164:167]
v_mul_f32 v92, v92, v129
v_mfma_f32_16x16x32_bf16 v[140:143], v[188:191], v[132:135], v[168:171]
v_mul_f32 v93, v93, v129
v_mul_f32 v94, v94, v129
v_mul_f32 v95, v95, v129
v_cvt_pk_bf16_f32 v138, v92, v93
v_cvt_pk_bf16_f32 v139, v94, v95
s_nop 1
v_mfma_f32_16x16x32_bf16 v[148:151], v[136:139], v[172:175], 0
v_max_f32 v140, v144, v140
v_max_f32 v141, v145, v141
v_max_f32 v142, v146, v142
v_max_f32 v143, v147, v143
v_max3_f32 v144, v140, v141, v142
v_max_f32 v145, v144, v143
v_max_f32 v144, v144, v143
v_mfma_f32_16x16x32_bf16 v[152:155], v[136:139], v[176:179], v[180:183]
v_cvt_pk_bf16_f32 v158, v148, v149
v_permlane32_swap_b32 v144, v145
v_max_f32 v146, v144, v145
v_max_f32 v147, v144, v145
v_cvt_pk_bf16_f32 v159, v150, v151
s_nop 0
v_permlane16_swap_b32 v146, v147
v_max_f32 v144, v146, v147
v_mul_f32 v144, v144, v131
v_fma_f32 v140, v140, v131, -v144
v_fma_f32 v141, v141, v131, -v144
v_fma_f32 v142, v142, v131, -v144
v_fma_f32 v143, v143, v131, -v144
v_exp_f32 v140, v140
v_exp_f32 v141, v141
v_exp_f32 v142, v142
v_exp_f32 v143, v143
v_cvt_pk_bf16_f32 v144, v140, v141
v_cvt_pk_bf16_f32 v145, v142, v143
v_and_b32 v134, v12, v144
v_and_b32 v135, v13, v145
v_bfi_b32 v132, v12, 0, v144
v_bfi_b32 v133, v13, 0, v145
v_cvt_pk_bf16_f32 v162, v152, v153
v_cvt_pk_bf16_f32 v163, v154, v155
s_nop 1
v_mfma_f32_16x16x32_bf16 v[152:155], v[160:163], v[132:135], 0
v_mfma_f32_16x16x32_bf16 v[148:151], v[156:159], v[132:135], 0
s_nop 6
v_rcp_f32 v144, v153
s_nop 0
v_mul_f32 v148, v148, v144
v_mul_f32 v149, v149, v144
v_mul_f32 v150, v150, v144
v_mul_f32 v151, v151, v144
v_mul_f32 v152, v152, v144
v_cvt_pk_bf16_f32 v140, v148, v149
v_cvt_pk_bf16_f32 v141, v150, v151
v_cvt_pk_bf16_f32 v142, v152, v152
buffer_store_dwordx2 v[140:141], v97, s[44:47], s67 offen
buffer_store_short v142, v98, s[44:47], s67 offen
v_mov_b32 v8, s79
s_mov_b32 s46, 0
s_cmp_eq_u32 s68, 0
s_cbranch_scc1 K1_N21f
s_waitcnt vmcnt(0)
buffer_store_dword v8, v7, s[36:39], 0 offen
s_cmp_eq_u32 s68, 2
s_cbranch_scc1 L_FIN
s_branch K1_GO1f
K1_N21f:
s_waitcnt vmcnt(2)
v_cmp_le_u32 vcc, s65, v6
s_nop 0
s_cmp_eq_u64 vcc, -1
s_cselect_b32 s68, 1, 0
s_cselect_b32 s42, 0x4000000, 0
s_add_u32 s69, s66, 4096
s_add_u32 m0, s72, 4096
s_nop 0
buffer_load_dwordx4 v11, s[40:43], s69 offen offset:1024 sc1 lds
buffer_load_dwordx4 v1, s[40:43], s69 offen offset:0 sc1 lds
s_add_u32 m0, s72, 0
s_nop 0
buffer_load_dwordx4 v1, s[40:43], s66 offen offset:0 sc1 lds
buffer_load_dwordx4 v1, s[40:43], s66 offen offset:1024 sc1 lds
buffer_load_dwordx4 v1, s[40:43], s66 offen offset:2048 sc1 lds
buffer_load_dwordx4 v1, s[40:43], s66 offen offset:3072 sc1 lds
buffer_load_dword v6, v5, s[36:39], 0 offen sc1
s_waitcnt vmcnt(7)
buffer_store_dword v8, v7, s[36:39], 0 offen
s_waitcnt vmcnt(1)
s_cmp_eq_u32 s68, 1
s_cbranch_scc1 K1_GO1f
K1_SW1f:
s_mov_b32 s75, 0
K1_SP1f:
buffer_load_dword v6, v5, s[36:39], 0 offen sc1
s_add_u32 s75, s75, 1
s_cmp_gt_u32 s75, 0x8000
s_cbranch_scc1 L_TIMEOUT
s_waitcnt vmcnt(0)
v_cmp_le_u32 vcc, s65, v6
s_nop 0
s_cmp_eq_u64 vcc, -1
s_cbranch_scc0 K1_SP1f
s_mov_b32 s42, 0x4000000
s_add_u32 s69, s66, 4096
s_add_u32 m0, s72, 4096
s_nop 0
buffer_load_dwordx4 v11, s[40:43], s69 offen offset:1024 sc1 lds
buffer_load_dwordx4 v1, s[40:43], s69 offen offset:0 sc1 lds
s_add_u32 m0, s72, 0
s_nop 0
buffer_load_dwordx4 v1, s[40:43], s66 offen offset:0 sc1 lds
buffer_load_dwordx4 v1, s[40:43], s66 offen offset:1024 sc1 lds
buffer_load_dwordx4 v1, s[40:43], s66 offen offset:2048 sc1 lds
buffer_load_dwordx4 v1, s[40:43], s66 offen offset:3072 sc1 lds
buffer_load_dword v6, v5, s[36:39], 0 offen sc1
s_waitcnt vmcnt(0)
K1_GO1f:
s_barrier

ds_read_b128 v[16:19], v96 offset:0
ds_read_b128 v[20:23], v96 offset:1024
ds_read_b128 v[24:27], v96 offset:2048
v_fma_f32 v80, -v127, v100, v64
ds_read_b128 v[28:31], v96 offset:3072
v_fma_f32 v81, -v127, v101, v65
ds_read_b64 v[116:117], v99 offset:0
v_fma_f32 v82, -v127, v102, v66
s_add_u32 s13, s64, 1
ds_read_b64 v[118:119], v99 offset:128
v_fma_f32 v83, -v127, v103, v67
s_sub_u32 s1, s13, 17
ds_read_b64 v[120:121], v99 offset:256
v_fma_f32 v84, -v127, v104, v68
s_cselect_b32 s1, s13, s1
ds_read_b64 v[122:123], v99 offset:384
v_fma_f32 v85, -v127, v105, v69
s_mul_i32 s66, s1, 24576
ds_read_b64 v[124:125], v99 offset:512
v_fma_f32 v86, -v127, v106, v70
s_add_u32 s66, s66, s10
v_fma_f32 v87, -v127, v107, v71
s_add_u32 s65, s13, 2
s_waitcnt vmcnt(2)
v_cmp_le_u32 vcc, s65, v6
v_fma_f32 v88, -v127, v108, v72
s_cmp_eq_u64 vcc, -1
v_fma_f32 v89, -v127, v109, v73
v_fma_f32 v90, -v127, v110, v74
s_waitcnt lgkmcnt(5)
v_fma_f32 v91, -v127, v111, v75
s_waitcnt vmcnt(0)
s_nop 7
s_branch K1_F0f
K1_W1f:
s_mov_b32 s75, 6
s_cmp_lt_u32 s65, 36
s_cbranch_scc0 K1_W1fR
K1_W1fL:
buffer_load_dword v6, v5, s[36:39], 0 offen sc1
s_waitcnt vmcnt(0)
v_cmp_le_u32 vcc, s65, v6
s_nop 0
s_cmp_eq_u64 vcc, -1
s_cbranch_scc1 K1_W1fR
s_sub_u32 s75, s75, 1
s_cmp_lg_u32 s75, 0
s_cbranch_scc1 K1_W1fL
s_branch K1_W1fR
K1_X0f:
s_sub_u32 s69, s0, s73
s_cmp_lt_u32 s69, 2
s_cbranch_scc0 K1_XB0f
s_cmp_eq_u32 s69, 0
s_cselect_b64 s[96:97], 0, -1
v_mov_b32 v14, 0xf149f2ca
s_and_b64 vcc, s[88:89], s[96:97]
v_cndmask_b32 v164, v14, 0, vcc
s_and_b64 vcc, s[90:91], s[96:97]
v_cndmask_b32 v165, v14, 0, vcc
s_and_b64 vcc, s[92:93], s[96:97]
v_cndmask_b32 v166, v14, 0, vcc
s_and_b64 vcc, s[94:95], s[96:97]
v_cndmask_b32 v167, v14, 0, vcc
K1_XB0f:
s_cmp_eq_u32 s68, 0
s_cbranch_scc1 K1_NR0f
s_branch K1_U1f
K1_NR0f:
buffer_load_dword v6, v5, s[36:39], 0 offen sc1
v_mfma_f32_16x16x32_bf16 v[48:51], v[224:227], v[24:27], v[48:51]
s_and_b32 s67, s64, 7
s_mul_i32 s67, s67, s100
s_add_u32 s67, s67, s11
v_mfma_f32_16x16x32_bf16 v[48:51], v[240:243], v[28:31], v[48:51]
s_mov_b32 s46, s74
s_add_u32 s79, s64, 2
s_mov_b32 s64, s13
v_mfma_f32_16x16x32_bf16 v[52:55], v[196:199], v[16:19], v[52:55]
s_mov_b32 s0, s1
v_mfma_f32_16x16x32_bf16 v[52:55], v[212:215], v[20:23], v[52:55]
v_mfma_f32_16x16x32_bf16 v[52:55], v[228:231], v[24:27], v[52:55]
v_mfma_f32_16x16x32_bf16 v[52:55], v[244:247], v[28:31], v[52:55]
v_mfma_f32_16x16x32_bf16 v[56:59], v[200:203], v[16:19], v[56:59]
v_mfma_f32_16x16x32_bf16 v[56:59], v[216:219], v[20:23], v[56:59]
v_mfma_f32_16x16x32_bf16 v[56:59], v[232:235], v[24:27], v[56:59]
v_mfma_f32_16x16x32_bf16 v[56:59], v[248:251], v[28:31], v[56:59]
v_mfma_f32_16x16x32_bf16 v[60:63], v[204:207], v[16:19], v[60:63]
v_mfma_f32_16x16x32_bf16 v[60:63], v[220:223], v[20:23], v[60:63]
v_mfma_f32_16x16x32_bf16 v[60:63], v[236:239], v[24:27], v[60:63]
v_mfma_f32_16x16x32_bf16 v[60:63], v[252:255], v[28:31], v[60:63]
s_waitcnt vmcnt(0)
buffer_store_dword v8, v7, s[36:39], 0 offen
s_mov_b32 s68, 2
s_cmp_gt_u32 s64, 33
s_cbranch_scc1 K1_EP0f
v_cmp_le_u32 vcc, s65, v6
s_nop 0
s_cmp_eq_u64 vcc, -1
s_cselect_b32 s68, 1, 0
s_cselect_b32 s42, 0x4000000, 0
s_add_u32 s69, s66, 4096
s_add_u32 m0, s72, 28672
s_nop 0
buffer_load_dwordx4 v11, s[40:43], s69 offen offset:1024 sc1 lds
buffer_load_dwordx4 v1, s[40:43], s69 offen offset:0 sc1 lds
s_add_u32 m0, s72, 24576
s_nop 0
buffer_load_dwordx4 v1, s[40:43], s66 offen offset:0 sc1 lds
buffer_load_dwordx4 v1, s[40:43], s66 offen offset:1024 sc1 lds
buffer_load_dwordx4 v1, s[40:43], s66 offen offset:2048 sc1 lds
buffer_load_dwordx4 v1, s[40:43], s66 offen offset:3072 sc1 lds
buffer_load_dword v6, v5, s[36:39], 0 offen sc1
K1_EP0f:
v_fma_f32 v80, -v126, v100, v48
v_fma_f32 v81, -v126, v101, v49
v_fma_f32 v82, -v126, v102, v50
v_fma_f32 v83, -v126, v103, v51
v_fma_f32 v84, -v126, v104, v52
v_fma_f32 v85, -v126, v105, v53
v_fma_f32 v86, -v126, v106, v54
v_fma_f32 v87, -v126, v107, v55
v_fma_f32 v88, -v126, v108, v56
v_fma_f32 v89, -v126, v109, v57
v_fma_f32 v90, -v126, v110, v58
v_fma_f32 v91, -v126, v111, v59
v_fma_f32 v92, -v126, v112, v60
v_fma_f32 v93, -v126, v113, v61
v_fma_f32 v94, -v126, v114, v62
v_fma_f32 v95, -v126, v115, v63
v_mul_f32 v84, v84, v128
v_mul_f32 v85, v85, v128
v_mul_f32 v86, v86, v128
v_mul_f32 v87, v87, v128
v_mul_f32 v88, v88, v128
v_mul_f32 v89, v89, v128
v_mul_f32 v90, v90, v128
v_mul_f32 v91, v91, v128
v_cvt_pk_bf16_f32 v132, v80, v81
v_cvt_pk_bf16_f32 v133, v82, v83
v_cvt_pk_bf16_f32 v134, v92, v93
v_cvt_pk_bf16_f32 v135, v94, v95
v_cvt_pk_bf16_f32 v136, v88, v89
v_cvt_pk_bf16_f32 v137, v90, v91
v_cvt_pk_bf16_f32 v184, v84, v85
v_cvt_pk_bf16_f32 v185, v86, v87
v_cndmask_b32 v186, 0, v136, s[56:57]
v_cndmask_b32 v187, 0, v137, s[56:57]
v_mfma_f32_16x16x32_bf16 v[144:147], v[188:191], v[132:135], v[164:167]
v_mul_f32 v92, v92, v128
v_mfma_f32_16x16x32_bf16 v[140:143], v[184:187], v[132:135], v[168:171]
v_mul_f32 v93, v93, v128
v_mul_f32 v94, v94, v128
v_mul_f32 v95, v95, v128
v_cvt_pk_bf16_f32 v138, v92, v93
v_cvt_pk_bf16_f32 v139, v94, v95
s_nop 1
v_mfma_f32_16x16x32_bf16 v[148:151], v[136:139], v[172:175], 0
v_max_f32 v140, v144, v140
v_max_f32 v141, v145, v141
v_max_f32 v142, v146, v142
v_max_f32 v143, v147, v143
v_max3_f32 v144, v140, v141, v142
v_max_f32 v145, v144, v143
v_max_f32 v144, v144, v143
v_mfma_f32_16x16x32_bf16 v[152:155], v[136:139], v[176:179], v[180:183]
v_cvt_pk_bf16_f32 v156, v148, v149
v_permlane32_swap_b32 v144, v145
v_max_f32 v146, v144, v145
v_max_f32 v147, v144, v145
v_cvt_pk_bf16_f32 v157, v150, v151
s_nop 0
v_permlane16_swap_b32 v146, v147
v_max_f32 v144, v146, v147
v_mul_f32 v144, v144, v130
v_fma_f32 v140, v140, v130, -v144
v_fma_f32 v141, v141, v130, -v144
v_fma_f32 v142, v142, v130, -v144
v_fma_f32 v143, v143, v130, -v144
v_exp_f32 v140, v140
v_exp_f32 v141, v141
v_exp_f32 v142, v142
v_exp_f32 v143, v143
v_cvt_pk_bf16_f32 v144, v140, v141
v_cvt_pk_bf16_f32 v145, v142, v143
v_and_b32 v132, v12, v144
v_and_b32 v133, v13, v145
v_bfi_b32 v134, v12, 0, v144
v_bfi_b32 v135, v13, 0, v145
v_cvt_pk_bf16_f32 v160, v152, v153
v_cvt_pk_bf16_f32 v161, v154, v155
s_nop 1
v_mfma_f32_16x16x32_bf16 v[152:155], v[160:163], v[132:135], 0
v_mfma_f32_16x16x32_bf16 v[148:151], v[156:159], v[132:135], 0
s_nop 6
v_rcp_f32 v144, v153
s_nop 0
v_mul_f32 v148, v148, v144
v_mul_f32 v149, v149, v144
v_mul_f32 v150, v150, v144
v_mul_f32 v151, v151, v144
v_mul_f32 v152, v152, v144
v_cvt_pk_bf16_f32 v140, v148, v149
v_cvt_pk_bf16_f32 v141, v150, v151
v_cvt_pk_bf16_f32 v142, v152, v152
buffer_store_dwordx2 v[140:141], v97, s[44:47], s67 offen
buffer_store_short v142, v98, s[44:47], s67 offen
v_mov_b32 v8, s79
s_mov_b32 s46, 0
s_cmp_eq_u32 s68, 0
s_cbranch_scc1 K1_N20f
s_waitcnt vmcnt(0)
buffer_store_dword v8, v7, s[36:39], 0 offen
s_cmp_eq_u32 s68, 2
s_cbranch_scc1 L_FIN
s_branch K1_GO0f
K1_N20f:
s_waitcnt vmcnt(2)
v_cmp_le_u32 vcc, s65, v6
s_nop 0
s_cmp_eq_u64 vcc, -1
s_cselect_b32 s68, 1, 0
s_cselect_b32 s42, 0x4000000, 0
s_add_u32 s69, s66, 4096
s_add_u32 m0, s72, 28672
s_nop 0
buffer_load_dwordx4 v11, s[40:43], s69 offen offset:1024 sc1 lds
buffer_load_dwordx4 v1, s[40:43], s69 offen offset:0 sc1 lds
s_add_u32 m0, s72, 24576
s_nop 0
buffer_load_dwordx4 v1, s[40:43], s66 offen offset:0 sc1 lds
buffer_load_dwordx4 v1, s[40:43], s66 offen offset:1024 sc1 lds
buffer_load_dwordx4 v1, s[40:43], s66 offen offset:2048 sc1 lds
buffer_load_dwordx4 v1, s[40:43], s66 offen offset:3072 sc1 lds
buffer_load_dword v6, v5, s[36:39], 0 offen sc1
s_waitcnt vmcnt(7)
buffer_store_dword v8, v7, s[36:39], 0 offen
s_waitcnt vmcnt(1)
s_cmp_eq_u32 s68, 1
s_cbranch_scc1 K1_GO0f
K1_SW0f:
s_mov_b32 s75, 0
K1_SP0f:
buffer_load_dword v6, v5, s[36:39], 0 offen sc1
s_add_u32 s75, s75, 1
s_cmp_gt_u32 s75, 0x8000
s_cbranch_scc1 L_TIMEOUT
s_waitcnt vmcnt(0)
v_cmp_le_u32 vcc, s65, v6
s_nop 0
s_cmp_eq_u64 vcc, -1
s_cbranch_scc0 K1_SP0f
s_mov_b32 s42, 0x4000000
s_add_u32 s69, s66, 4096
s_add_u32 m0, s72, 28672
s_nop 0
buffer_load_dwordx4 v11, s[40:43], s69 offen offset:1024 sc1 lds
buffer_load_dwordx4 v1, s[40:43], s69 offen offset:0 sc1 lds
s_add_u32 m0, s72, 24576
s_nop 0
buffer_load_dwordx4 v1, s[40:43], s66 offen offset:0 sc1 lds
buffer_load_dwordx4 v1, s[40:43], s66 offen offset:1024 sc1 lds
buffer_load_dwordx4 v1, s[40:43], s66 offen offset:2048 sc1 lds
buffer_load_dwordx4 v1, s[40:43], s66 offen offset:3072 sc1 lds
buffer_load_dword v6, v5, s[36:39], 0 offen sc1
s_waitcnt vmcnt(0)
K1_GO0f:
s_barrier

ds_read_b128 v[32:35], v96 offset:24576
ds_read_b128 v[36:39], v96 offset:25600
ds_read_b128 v[40:43], v96 offset:26624
v_fma_f32 v80, -v126, v100, v48
ds_read_b128 v[44:47], v96 offset:27648
v_fma_f32 v81, -v126, v101, v49
ds_read_b64 v[116:117], v99 offset:24576
v_fma_f32 v82, -v126, v102, v50
s_add_u32 s13, s64, 1
ds_read_b64 v[118:119], v99 offset:24704
v_fma_f32 v83, -v126, v103, v51
s_sub_u32 s1, s13, 17
ds_read_b64 v[120:121], v99 offset:24832
v_fma_f32 v84, -v126, v104, v52
s_cselect_b32 s1, s13, s1
ds_read_b64 v[122:123], v99 offset:24960
v_fma_f32 v85, -v126, v105, v53
s_mul_i32 s66, s1, 24576
ds_read_b64 v[124:125], v99 offset:25088
v_fma_f32 v86, -v126, v106, v54
s_add_u32 s66, s66, s10
v_fma_f32 v87, -v126, v107, v55
s_add_u32 s65, s13, 2
s_waitcnt vmcnt(2)
v_cmp_le_u32 vcc, s65, v6
v_fma_f32 v88, -v126, v108, v56
s_cmp_eq_u64 vcc, -1
v_fma_f32 v89, -v126, v109, v57
v_fma_f32 v90, -v126, v110, v58
s_waitcnt lgkmcnt(5)
v_fma_f32 v91, -v126, v111, v59
s_waitcnt vmcnt(0)
s_nop 7
s_branch K1_F1f
K1_W0f:
s_mov_b32 s75, 6
s_cmp_lt_u32 s65, 36
s_cbranch_scc0 K1_W0fR
K1_W0fL:
buffer_load_dword v6, v5, s[36:39], 0 offen sc1
s_waitcnt vmcnt(0)
v_cmp_le_u32 vcc, s65, v6
s_nop 0
s_cmp_eq_u64 vcc, -1
s_cbranch_scc1 K1_W0fR
s_sub_u32 s75, s75, 1
s_cmp_lg_u32 s75, 0
s_cbranch_scc1 K1_W0fL
s_branch K1_W0fR
K4_START:
s_sub_u32 s6, s5, 8
s_mul_i32 s73, s6, 3
s_add_u32 s73, s73, s3
s_add_u32 s8, s73, 32
s_cmp_lt_u32 s3, 3
s_cselect_b32 s73, s73, 40
s_cmp_lt_u32 s73, 20
s_cselect_b32 s69, s73, s8
s_mul_i32 s72, s3, 27
s_lshr_b32 s72, s72, 1
s_lshr_b32 s7, s4, 1
s_lshl_b32 s7, s7, 9
s_and_b32 s8, s4, 1
s_add_u32 s7, s7, s8
s_mul_i32 s7, s7, 1280
s_lshl_b32 s8, s73, 6
s_add_u32 s7, s7, s8
s_cmp_lt_u32 s73, 20
s_cselect_b32 s7, s7, 0x7ff00000
v_mul_u32_u24 v12, 2560, v3
v_lshl_add_u32 v12, v4, 4, v12
v_add_u32 v158, s7, v12
v_subrev_u32 v13, 40960, v158
v_mov_b32 v140, v13
s_mov_b32 s68, s73
s_mul_i32 s7, s4, 5
s_lshr_b32 s7, s7, 1
s_sub_u32 s68, s68, s7
s_cselect_b32 s7, 20, 0
s_add_u32 s68, s68, s7
s_cmp_lt_u32 s73, 20
s_cselect_b32 s69, s68, s69
s_lshl_b32 s7, s4, 15
s_lshl_b32 s8, s69, 7
s_add_u32 s8, s8, s7
s_add_u32 s8, s8, 24576
v_mov_b32 v12, s8
v_mov_b32 v13, 0x7ff00000
v_cmp_eq_u32 vcc, 0, v2
s_nop 1
v_cndmask_b32 v7, v13, v12, vcc
s_add_u32 s7, s7, 16384
v_min_u32 v5, 13, v2
s_lshl_b32 s8, s4, 8
s_add_u32 s8, s8, s6
s_lshl_b32 s8, s8, 7
s_add_u32 s8, s8, 31744
s_cmp_eq_u32 s3, 0
s_cselect_b32 s8, s8, 0x7ff00000
v_writelane_b32 v7, s8, 2
v_mov_b32 v11, 0
v_writelane_b32 v11, -9, 2
v_mov_b32 v8, 0
v_writelane_b32 v8, 9, 2
buffer_store_dword v8, v7, s[36:39], 0 offen sc1
v_add_u32 v5, s72, v5
v_lshl_add_u32 v5, v5, 7, s7
v_mov_b32 v13, v140
buffer_load_dwordx4 v[16:19], v13, s[56:59], 0 offen
s_mov_b32 s7, 0
buffer_load_dwordx4 v[20:23], v158, s[56:59], s7 offen
s_mov_b32 s7, 40960
buffer_load_dwordx4 v[24:27], v158, s[56:59], s7 offen
s_mov_b32 s7, 81920
buffer_load_dwordx4 v[28:31], v158, s[56:59], s7 offen
s_mov_b32 s7, 122880
buffer_load_dwordx4 v[32:35], v158, s[56:59], s7 offen
s_mov_b32 s7, 163840
buffer_load_dwordx4 v[36:39], v158, s[56:59], s7 offen
s_mov_b32 s7, 204800
buffer_load_dwordx4 v[40:43], v158, s[56:59], s7 offen
s_mov_b32 s7, 245760
buffer_load_dwordx4 v[44:47], v158, s[56:59], s7 offen
s_mov_b32 s7, 286720
buffer_load_dwordx4 v[48:51], v158, s[56:59], s7 offen
s_mov_b32 s7, 327680
buffer_load_dwordx4 v[52:55], v158, s[56:59], s7 offen
s_mov_b32 s7, 368640
buffer_load_dwordx4 v[56:59], v158, s[56:59], s7 offen
s_mov_b32 s7, 409600
buffer_load_dwordx4 v[60:63], v158, s[56:59], s7 offen
s_mov_b32 s7, 450560
buffer_load_dwordx4 v[64:67], v158, s[56:59], s7 offen
s_mov_b32 s7, 491520
buffer_load_dwordx4 v[68:71], v158, s[56:59], s7 offen
s_mov_b32 s7, 532480
buffer_load_dwordx4 v[72:75], v158, s[56:59], s7 offen
s_mov_b32 s7, 573440
buffer_load_dwordx4 v[76:79], v158, s[56:59], s7 offen
s_mov_b32 s7, 614400
buffer_load_dwordx4 v[80:83], v158, s[56:59], s7 offen
s_mul_i32 s8, s68, 52
s_lshr_b32 s8, s8, 8
s_mul_i32 s8, s8, 1024
s_mul_i32 s7, s68, 1024
s_add_u32 s7, s7, s8
s_add_u32 s7, s7, 0
s_cmp_lt_u32 s73, 20
s_cselect_b32 s7, s7, 0x7ff00000
v_add_u32 v148, s7, v1
v_mov_b32 v150, v148
s_mul_i32 s8, s68, 52
s_lshr_b32 s8, s8, 8
s_mul_i32 s8, s8, 5504
s_mul_i32 s7, s68, 128
s_add_u32 s7, s7, s8
s_add_u32 s7, s7, 5120
s_mov_b32 s68, 0
s_cmp_lt_u32 s73, 20
s_cselect_b32 s7, s7, 0x7ff00000
v_lshrrev_b32 v13, 1, v4
v_lshlrev_b32 v12, 3, v3
v_lshl_add_u32 v12, v13, 2, v12
v_add_u32 v149, s7, v12
s_mul_i32 s11, s9, 24576
s_add_u32 s12, s11, 327680
s_add_u32 s11, s11, 327680
s_mul_i32 s10, s9, 55296
s_and_b32 s8, s3, 1
s_add_u32 s7, s72, s8
s_lshl_b32 s7, s7, 10
s_add_u32 s10, s10, s7
s_mul_i32 s84, s8, -14336
s_add_u32 s10, s10, 10354688
s_mov_b32 s66, s10
s_mov_b32 s100, 24576
s_mov_b32 s81, 0x4000000
s_mov_b32 s48, s28
s_mov_b32 s49, s29
s_mov_b32 s50, 2211840
s_mul_i32 s7, s3, 6144
v_lshl_add_u32 v151, v2, 3, s7
s_mul_i32 s7, s6, 192
v_mov_b32 v15, 0x7ff00000
v_add_u32 v12, 0, v2
v_mul_u32_u24 v13, 0x156, v12
v_lshrrev_b32 v13, 12, v13
v_mul_u32_u24 v14, 12, v13
v_sub_u32 v14, v12, v14
v_lshl_add_u32 v14, v14, 4, s7
v_cmp_gt_u32 vcc, 1280, v14
s_nop 1
v_cndmask_b32 v14, v15, v14, vcc
v_mul_u32_u24 v13, 1280, v13
v_add_u32 v165, v13, v14
v_add_u32 v12, 64, v2
v_mul_u32_u24 v13, 0x156, v12
v_lshrrev_b32 v13, 12, v13
v_mul_u32_u24 v14, 12, v13
v_sub_u32 v14, v12, v14
v_lshl_add_u32 v14, v14, 4, s7
v_cmp_gt_u32 vcc, 1280, v14
s_nop 1
v_cndmask_b32 v14, v15, v14, vcc
v_mul_u32_u24 v13, 1280, v13
v_add_u32 v166, v13, v14
v_add_u32 v12, 128, v2
v_mul_u32_u24 v13, 0x156, v12
v_lshrrev_b32 v13, 12, v13
v_mul_u32_u24 v14, 12, v13
v_sub_u32 v14, v12, v14
v_lshl_add_u32 v14, v14, 4, s7
v_cmp_gt_u32 vcc, 1280, v14
s_nop 1
v_cndmask_b32 v14, v15, v14, vcc
v_mul_u32_u24 v13, 1280, v13
v_add_u32 v167, v13, v14
s_mul_i32 s15, s4, 7
s_lshr_b32 s15, s15, 2
s_add_u32 s15, s15, s72
s_mul_i32 s85, s15, 40960
s_and_b32 s8, s3, 1
s_add_u32 s15, s15, s8
s_mul_i32 s15, s15, 40960
s_mul_i32 s70, s3, 36864
v_lshrrev_b32 v12, 2, v3
v_lshl_add_u32 v12, v4, 3, v12
v_mul_u32_u24 v12, 192, v12
v_and_b32 v13, 3, v3
v_lshl_add_u32 v12, v13, 4, v12
v_add_u32 v12, s70, v12
s_mov_b32 s69, 0x208c128
s_cmp_eq_u32 s3, 1
s_cselect_b32 s69, 0x12884420, s69
s_cmp_eq_u32 s3, 2
s_cselect_b32 s69, 0x2304a020, s69
s_cmp_eq_u32 s3, 3
s_cselect_b32 s69, 0x2042630, s69
s_bfe_u32 s7, s69, 0x50000
s_lshl_b32 s7, s7, 3
v_add_u32 v159, s7, v12
s_bfe_u32 s7, s69, 0x50005
s_lshl_b32 s7, s7, 3
v_add_u32 v160, s7, v12
s_bfe_u32 s7, s69, 0x5000a
s_lshl_b32 s7, s7, 3
v_add_u32 v161, s7, v12
s_bfe_u32 s7, s69, 0x5000f
s_lshl_b32 s7, s7, 3
v_add_u32 v162, s7, v12
s_bfe_u32 s7, s69, 0x50014
s_lshl_b32 s7, s7, 3
v_add_u32 v163, s7, v12
s_bfe_u32 s7, s69, 0x50019
s_lshl_b32 s7, s7, 3
v_add_u32 v164, s7, v12
s_mov_b32 s69, 0x2f66b0e6
s_cmp_eq_u32 s3, 1
s_cselect_b32 s69, 0x2957b820, s69
s_cmp_eq_u32 s3, 2
s_cselect_b32 s69, 0x27242462, s69
s_cmp_eq_u32 s3, 3
s_cselect_b32 s69, 0x1ac398a4, s69
s_bfe_u32 s7, s69, 0x50000
s_lshl_b32 s7, s7, 10
v_lshl_add_u32 v152, v2, 3, s7
s_bfe_u32 s7, s69, 0x50005
s_lshl_b32 s7, s7, 10
v_lshl_add_u32 v153, v2, 3, s7
s_bfe_u32 s7, s69, 0x5000a
s_lshl_b32 s7, s7, 10
v_lshl_add_u32 v154, v2, 3, s7
s_bfe_u32 s7, s69, 0x5000f
s_lshl_b32 s7, s7, 10
v_lshl_add_u32 v155, v2, 3, s7
s_bfe_u32 s7, s69, 0x50014
s_lshl_b32 s7, s7, 10
v_lshl_add_u32 v156, v2, 3, s7
s_bfe_u32 s7, s69, 0x50019
s_lshl_b32 s7, s7, 10
v_lshl_add_u32 v157, v2, 3, s7
v_mov_b32 v168, 0x350637bd
v_cmp_lt_u32 vcc, 31, v2
s_nop 1
v_cndmask_b32 v168, 0, v168, vcc
s_waitcnt vmcnt(17)
s_barrier
buffer_atomic_add v254, v255, s[52:55], 0 offen sc1
s_waitcnt vmcnt(17)
s_add_u32 s7, s11, 0
buffer_store_dwordx4 v[16:19], v148, s[36:39], s7 offen sc1
v_lshlrev_b32 v104, 16, v16
v_and_b32 v105, 0xffff0000, v16
v_lshlrev_b32 v106, 16, v17
v_and_b32 v107, 0xffff0000, v17
v_lshlrev_b32 v108, 16, v18
v_and_b32 v109, 0xffff0000, v18
v_lshlrev_b32 v110, 16, v19
v_and_b32 v111, 0xffff0000, v19
v_add_f32 v112, v104, v105
v_mul_f32 v113, v104, v104
v_fmac_f32 v113, v105, v105
v_fmac_f32 v113, v106, v106
v_add_f32 v112, v112, v106
v_fmac_f32 v113, v107, v107
v_add_f32 v112, v112, v107
v_fmac_f32 v113, v108, v108
v_add_f32 v112, v112, v108
v_fmac_f32 v113, v109, v109
v_add_f32 v112, v112, v109
v_fmac_f32 v113, v110, v110
v_add_f32 v112, v112, v110
v_fmac_f32 v113, v111, v111
v_add_f32 v112, v112, v111
s_waitcnt vmcnt(17)
s_add_u32 s8, s11, 24576
v_permlane32_swap_b32 v112, v113
v_add_f32 v114, v112, v113
v_add_f32 v115, v112, v113
buffer_store_dwordx4 v[20:23], v148, s[36:39], s8 offen sc1
v_lshlrev_b32 v116, 16, v20
v_permlane16_swap_b32 v114, v115
v_add_f32 v112, v114, v115
v_fma_f32 v112, v112, s76, v168
buffer_store_dword v112, v149, s[36:39], s7 offen sc1
v_and_b32 v117, 0xffff0000, v20
v_lshlrev_b32 v118, 16, v21
v_and_b32 v119, 0xffff0000, v21
v_lshlrev_b32 v120, 16, v22
v_and_b32 v121, 0xffff0000, v22
v_lshlrev_b32 v122, 16, v23
v_and_b32 v123, 0xffff0000, v23
v_add_f32 v124, v116, v117
v_mul_f32 v125, v116, v116
v_fmac_f32 v125, v117, v117
v_fmac_f32 v125, v118, v118
v_add_f32 v124, v124, v118
v_fmac_f32 v125, v119, v119
v_add_f32 v124, v124, v119
v_fmac_f32 v125, v120, v120
v_add_f32 v124, v124, v120
v_fmac_f32 v125, v121, v121
v_add_f32 v124, v124, v121
v_fmac_f32 v125, v122, v122
v_add_f32 v124, v124, v122
v_fmac_f32 v125, v123, v123
v_add_f32 v124, v124, v123
s_nop 1
v_permlane32_swap_b32 v124, v125
v_add_f32 v126, v124, v125
v_add_f32 v127, v124, v125
s_nop 1
v_permlane16_swap_b32 v126, v127
v_add_f32 v124, v126, v127
v_fma_f32 v124, v124, s76, v168
buffer_store_dword v124, v149, s[36:39], s8 offen sc1
s_waitcnt vmcnt(19)
s_add_u32 s7, s11, 49152
buffer_store_dwordx4 v[24:27], v148, s[36:39], s7 offen sc1
v_lshlrev_b32 v104, 16, v24
v_and_b32 v105, 0xffff0000, v24
v_lshlrev_b32 v106, 16, v25
v_and_b32 v107, 0xffff0000, v25
v_lshlrev_b32 v108, 16, v26
v_and_b32 v109, 0xffff0000, v26
v_lshlrev_b32 v110, 16, v27
v_and_b32 v111, 0xffff0000, v27
v_add_f32 v112, v104, v105
v_mul_f32 v113, v104, v104
v_fmac_f32 v113, v105, v105
v_fmac_f32 v113, v106, v106
v_add_f32 v112, v112, v106
v_fmac_f32 v113, v107, v107
v_add_f32 v112, v112, v107
v_fmac_f32 v113, v108, v108
v_add_f32 v112, v112, v108
v_fmac_f32 v113, v109, v109
v_add_f32 v112, v112, v109
v_fmac_f32 v113, v110, v110
v_add_f32 v112, v112, v110
v_fmac_f32 v113, v111, v111
v_add_f32 v112, v112, v111
s_waitcnt vmcnt(19)
s_add_u32 s8, s11, 73728
v_permlane32_swap_b32 v112, v113
v_add_f32 v114, v112, v113
v_add_f32 v115, v112, v113
buffer_store_dwordx4 v[28:31], v148, s[36:39], s8 offen sc1
v_lshlrev_b32 v116, 16, v28
v_permlane16_swap_b32 v114, v115
v_add_f32 v112, v114, v115
v_fma_f32 v112, v112, s76, v168
buffer_store_dword v112, v149, s[36:39], s7 offen sc1
v_and_b32 v117, 0xffff0000, v28
v_lshlrev_b32 v118, 16, v29
v_and_b32 v119, 0xffff0000, v29
v_lshlrev_b32 v120, 16, v30
v_and_b32 v121, 0xffff0000, v30
v_lshlrev_b32 v122, 16, v31
v_and_b32 v123, 0xffff0000, v31
v_add_f32 v124, v116, v117
v_mul_f32 v125, v116, v116
v_fmac_f32 v125, v117, v117
v_fmac_f32 v125, v118, v118
v_add_f32 v124, v124, v118
v_fmac_f32 v125, v119, v119
v_add_f32 v124, v124, v119
v_fmac_f32 v125, v120, v120
v_add_f32 v124, v124, v120
v_fmac_f32 v125, v121, v121
v_add_f32 v124, v124, v121
v_fmac_f32 v125, v122, v122
v_add_f32 v124, v124, v122
v_fmac_f32 v125, v123, v123
v_add_f32 v124, v124, v123
s_nop 1
v_permlane32_swap_b32 v124, v125
v_add_f32 v126, v124, v125
v_add_f32 v127, v124, v125
s_nop 1
v_permlane16_swap_b32 v126, v127
v_add_f32 v124, v126, v127
v_fma_f32 v124, v124, s76, v168
buffer_store_dword v124, v149, s[36:39], s8 offen sc1
s_waitcnt vmcnt(21)
s_add_u32 s7, s11, 98304
buffer_store_dwordx4 v[32:35], v148, s[36:39], s7 offen sc1
v_lshlrev_b32 v104, 16, v32
v_and_b32 v105, 0xffff0000, v32
v_lshlrev_b32 v106, 16, v33
v_and_b32 v107, 0xffff0000, v33
v_lshlrev_b32 v108, 16, v34
v_and_b32 v109, 0xffff0000, v34
v_lshlrev_b32 v110, 16, v35
v_and_b32 v111, 0xffff0000, v35
v_add_f32 v112, v104, v105
v_mul_f32 v113, v104, v104
v_fmac_f32 v113, v105, v105
v_fmac_f32 v113, v106, v106
v_add_f32 v112, v112, v106
v_fmac_f32 v113, v107, v107
v_add_f32 v112, v112, v107
v_fmac_f32 v113, v108, v108
v_add_f32 v112, v112, v108
v_fmac_f32 v113, v109, v109
v_add_f32 v112, v112, v109
v_fmac_f32 v113, v110, v110
v_add_f32 v112, v112, v110
v_fmac_f32 v113, v111, v111
v_add_f32 v112, v112, v111
s_waitcnt vmcnt(21)
s_add_u32 s8, s11, 122880
v_permlane32_swap_b32 v112, v113
v_add_f32 v114, v112, v113
v_add_f32 v115, v112, v113
buffer_store_dwordx4 v[36:39], v148, s[36:39], s8 offen sc1
v_lshlrev_b32 v116, 16, v36
v_permlane16_swap_b32 v114, v115
v_add_f32 v112, v114, v115
v_fma_f32 v112, v112, s76, v168
buffer_store_dword v112, v149, s[36:39], s7 offen sc1
v_and_b32 v117, 0xffff0000, v36
v_lshlrev_b32 v118, 16, v37
v_and_b32 v119, 0xffff0000, v37
v_lshlrev_b32 v120, 16, v38
v_and_b32 v121, 0xffff0000, v38
v_lshlrev_b32 v122, 16, v39
v_and_b32 v123, 0xffff0000, v39
v_add_f32 v124, v116, v117
v_mul_f32 v125, v116, v116
v_fmac_f32 v125, v117, v117
v_fmac_f32 v125, v118, v118
v_add_f32 v124, v124, v118
v_fmac_f32 v125, v119, v119
v_add_f32 v124, v124, v119
v_fmac_f32 v125, v120, v120
v_add_f32 v124, v124, v120
v_fmac_f32 v125, v121, v121
v_add_f32 v124, v124, v121
v_fmac_f32 v125, v122, v122
v_add_f32 v124, v124, v122
v_fmac_f32 v125, v123, v123
v_add_f32 v124, v124, v123
s_nop 1
v_permlane32_swap_b32 v124, v125
v_add_f32 v126, v124, v125
v_add_f32 v127, v124, v125
s_nop 1
v_permlane16_swap_b32 v126, v127
v_add_f32 v124, v126, v127
v_fma_f32 v124, v124, s76, v168
buffer_store_dword v124, v149, s[36:39], s8 offen sc1
s_waitcnt vmcnt(23)
s_add_u32 s7, s11, 147456
buffer_store_dwordx4 v[40:43], v148, s[36:39], s7 offen sc1
v_lshlrev_b32 v104, 16, v40
v_and_b32 v105, 0xffff0000, v40
v_lshlrev_b32 v106, 16, v41
v_and_b32 v107, 0xffff0000, v41
v_lshlrev_b32 v108, 16, v42
v_and_b32 v109, 0xffff0000, v42
v_lshlrev_b32 v110, 16, v43
v_and_b32 v111, 0xffff0000, v43
v_add_f32 v112, v104, v105
v_mul_f32 v113, v104, v104
v_fmac_f32 v113, v105, v105
v_fmac_f32 v113, v106, v106
v_add_f32 v112, v112, v106
v_fmac_f32 v113, v107, v107
v_add_f32 v112, v112, v107
v_fmac_f32 v113, v108, v108
v_add_f32 v112, v112, v108
v_fmac_f32 v113, v109, v109
v_add_f32 v112, v112, v109
v_fmac_f32 v113, v110, v110
v_add_f32 v112, v112, v110
v_fmac_f32 v113, v111, v111
v_add_f32 v112, v112, v111
s_waitcnt vmcnt(23)
s_add_u32 s8, s11, 172032
v_permlane32_swap_b32 v112, v113
v_add_f32 v114, v112, v113
v_add_f32 v115, v112, v113
buffer_store_dwordx4 v[44:47], v148, s[36:39], s8 offen sc1
v_lshlrev_b32 v116, 16, v44
v_permlane16_swap_b32 v114, v115
v_add_f32 v112, v114, v115
v_fma_f32 v112, v112, s76, v168
buffer_store_dword v112, v149, s[36:39], s7 offen sc1
v_and_b32 v117, 0xffff0000, v44
v_lshlrev_b32 v118, 16, v45
v_and_b32 v119, 0xffff0000, v45
v_lshlrev_b32 v120, 16, v46
v_and_b32 v121, 0xffff0000, v46
v_lshlrev_b32 v122, 16, v47
v_and_b32 v123, 0xffff0000, v47
v_add_f32 v124, v116, v117
v_mul_f32 v125, v116, v116
v_fmac_f32 v125, v117, v117
v_fmac_f32 v125, v118, v118
v_add_f32 v124, v124, v118
v_fmac_f32 v125, v119, v119
v_add_f32 v124, v124, v119
v_fmac_f32 v125, v120, v120
v_add_f32 v124, v124, v120
v_fmac_f32 v125, v121, v121
v_add_f32 v124, v124, v121
v_fmac_f32 v125, v122, v122
v_add_f32 v124, v124, v122
v_fmac_f32 v125, v123, v123
v_add_f32 v124, v124, v123
s_nop 1
v_permlane32_swap_b32 v124, v125
v_add_f32 v126, v124, v125
v_add_f32 v127, v124, v125
s_nop 1
v_permlane16_swap_b32 v126, v127
v_add_f32 v124, v126, v127
v_fma_f32 v124, v124, s76, v168
buffer_store_dword v124, v149, s[36:39], s8 offen sc1
s_waitcnt vmcnt(25)
s_add_u32 s7, s11, 196608
buffer_store_dwordx4 v[48:51], v148, s[36:39], s7 offen sc1
v_lshlrev_b32 v104, 16, v48
v_and_b32 v105, 0xffff0000, v48
v_lshlrev_b32 v106, 16, v49
v_and_b32 v107, 0xffff0000, v49
v_lshlrev_b32 v108, 16, v50
v_and_b32 v109, 0xffff0000, v50
v_lshlrev_b32 v110, 16, v51
v_and_b32 v111, 0xffff0000, v51
v_add_f32 v112, v104, v105
v_mul_f32 v113, v104, v104
v_fmac_f32 v113, v105, v105
v_fmac_f32 v113, v106, v106
v_add_f32 v112, v112, v106
v_fmac_f32 v113, v107, v107
v_add_f32 v112, v112, v107
v_fmac_f32 v113, v108, v108
v_add_f32 v112, v112, v108
v_fmac_f32 v113, v109, v109
v_add_f32 v112, v112, v109
v_fmac_f32 v113, v110, v110
v_add_f32 v112, v112, v110
v_fmac_f32 v113, v111, v111
v_add_f32 v112, v112, v111
s_waitcnt vmcnt(25)
s_add_u32 s8, s11, 221184
v_permlane32_swap_b32 v112, v113
v_add_f32 v114, v112, v113
v_add_f32 v115, v112, v113
buffer_store_dwordx4 v[52:55], v148, s[36:39], s8 offen sc1
v_lshlrev_b32 v116, 16, v52
v_permlane16_swap_b32 v114, v115
v_add_f32 v112, v114, v115
v_fma_f32 v112, v112, s76, v168
buffer_store_dword v112, v149, s[36:39], s7 offen sc1
v_and_b32 v117, 0xffff0000, v52
v_lshlrev_b32 v118, 16, v53
v_and_b32 v119, 0xffff0000, v53
v_lshlrev_b32 v120, 16, v54
v_and_b32 v121, 0xffff0000, v54
v_lshlrev_b32 v122, 16, v55
v_and_b32 v123, 0xffff0000, v55
v_add_f32 v124, v116, v117
v_mul_f32 v125, v116, v116
v_fmac_f32 v125, v117, v117
v_fmac_f32 v125, v118, v118
v_add_f32 v124, v124, v118
v_fmac_f32 v125, v119, v119
v_add_f32 v124, v124, v119
v_fmac_f32 v125, v120, v120
v_add_f32 v124, v124, v120
v_fmac_f32 v125, v121, v121
v_add_f32 v124, v124, v121
v_fmac_f32 v125, v122, v122
v_add_f32 v124, v124, v122
v_fmac_f32 v125, v123, v123
v_add_f32 v124, v124, v123
s_nop 1
v_permlane32_swap_b32 v124, v125
v_add_f32 v126, v124, v125
v_add_f32 v127, v124, v125
s_nop 1
v_permlane16_swap_b32 v126, v127
v_add_f32 v124, v126, v127
v_fma_f32 v124, v124, s76, v168
buffer_store_dword v124, v149, s[36:39], s8 offen sc1
v_mov_b32 v8, 5
v_writelane_b32 v8, 9, 2
s_waitcnt vmcnt(12)
buffer_store_dword v8, v7, s[36:39], 0 offen sc1
s_waitcnt vmcnt(28)
s_add_u32 s7, s11, 245760
buffer_store_dwordx4 v[56:59], v148, s[36:39], s7 offen sc1
v_lshlrev_b32 v104, 16, v56
v_and_b32 v105, 0xffff0000, v56
v_lshlrev_b32 v106, 16, v57
v_and_b32 v107, 0xffff0000, v57
v_lshlrev_b32 v108, 16, v58
v_and_b32 v109, 0xffff0000, v58
v_lshlrev_b32 v110, 16, v59
v_and_b32 v111, 0xffff0000, v59
v_add_f32 v112, v104, v105
v_mul_f32 v113, v104, v104
v_fmac_f32 v113, v105, v105
v_fmac_f32 v113, v106, v106
v_add_f32 v112, v112, v106
v_fmac_f32 v113, v107, v107
v_add_f32 v112, v112, v107
v_fmac_f32 v113, v108, v108
v_add_f32 v112, v112, v108
v_fmac_f32 v113, v109, v109
v_add_f32 v112, v112, v109
v_fmac_f32 v113, v110, v110
v_add_f32 v112, v112, v110
v_fmac_f32 v113, v111, v111
v_add_f32 v112, v112, v111
s_waitcnt vmcnt(28)
s_add_u32 s8, s11, 270336
v_permlane32_swap_b32 v112, v113
v_add_f32 v114, v112, v113
v_add_f32 v115, v112, v113
buffer_store_dwordx4 v[60:63], v148, s[36:39], s8 offen sc1
v_lshlrev_b32 v116, 16, v60
v_permlane16_swap_b32 v114, v115
v_add_f32 v112, v114, v115
v_fma_f32 v112, v112, s76, v168
buffer_store_dword v112, v149, s[36:39], s7 offen sc1
v_and_b32 v117, 0xffff0000, v60
v_lshlrev_b32 v118, 16, v61
v_and_b32 v119, 0xffff0000, v61
v_lshlrev_b32 v120, 16, v62
v_and_b32 v121, 0xffff0000, v62
v_lshlrev_b32 v122, 16, v63
v_and_b32 v123, 0xffff0000, v63
v_add_f32 v124, v116, v117
v_mul_f32 v125, v116, v116
v_fmac_f32 v125, v117, v117
v_fmac_f32 v125, v118, v118
v_add_f32 v124, v124, v118
v_fmac_f32 v125, v119, v119
v_add_f32 v124, v124, v119
v_fmac_f32 v125, v120, v120
v_add_f32 v124, v124, v120
v_fmac_f32 v125, v121, v121
v_add_f32 v124, v124, v121
v_fmac_f32 v125, v122, v122
v_add_f32 v124, v124, v122
v_fmac_f32 v125, v123, v123
v_add_f32 v124, v124, v123
s_nop 1
v_permlane32_swap_b32 v124, v125
v_add_f32 v126, v124, v125
v_add_f32 v127, v124, v125
s_nop 1
v_permlane16_swap_b32 v126, v127
v_add_f32 v124, v126, v127
v_fma_f32 v124, v124, s76, v168
buffer_store_dword v124, v149, s[36:39], s8 offen sc1
s_waitcnt vmcnt(30)
s_add_u32 s7, s11, 294912
buffer_store_dwordx4 v[64:67], v148, s[36:39], s7 offen sc1
v_lshlrev_b32 v104, 16, v64
v_and_b32 v105, 0xffff0000, v64
v_lshlrev_b32 v106, 16, v65
v_and_b32 v107, 0xffff0000, v65
v_lshlrev_b32 v108, 16, v66
v_and_b32 v109, 0xffff0000, v66
v_lshlrev_b32 v110, 16, v67
v_and_b32 v111, 0xffff0000, v67
v_add_f32 v112, v104, v105
v_mul_f32 v113, v104, v104
v_fmac_f32 v113, v105, v105
v_fmac_f32 v113, v106, v106
v_add_f32 v112, v112, v106
v_fmac_f32 v113, v107, v107
v_add_f32 v112, v112, v107
v_fmac_f32 v113, v108, v108
v_add_f32 v112, v112, v108
v_fmac_f32 v113, v109, v109
v_add_f32 v112, v112, v109
v_fmac_f32 v113, v110, v110
v_add_f32 v112, v112, v110
v_fmac_f32 v113, v111, v111
v_add_f32 v112, v112, v111
s_waitcnt vmcnt(30)
s_add_u32 s8, s11, 319488
v_permlane32_swap_b32 v112, v113
v_add_f32 v114, v112, v113
v_add_f32 v115, v112, v113
buffer_store_dwordx4 v[68:71], v148, s[36:39], s8 offen sc1
v_lshlrev_b32 v116, 16, v68
v_permlane16_swap_b32 v114, v115
v_add_f32 v112, v114, v115
v_fma_f32 v112, v112, s76, v168
buffer_store_dword v112, v149, s[36:39], s7 offen sc1
v_and_b32 v117, 0xffff0000, v68
v_lshlrev_b32 v118, 16, v69
v_and_b32 v119, 0xffff0000, v69
v_lshlrev_b32 v120, 16, v70
v_and_b32 v121, 0xffff0000, v70
v_lshlrev_b32 v122, 16, v71
v_and_b32 v123, 0xffff0000, v71
v_add_f32 v124, v116, v117
v_mul_f32 v125, v116, v116
v_fmac_f32 v125, v117, v117
v_fmac_f32 v125, v118, v118
v_add_f32 v124, v124, v118
v_fmac_f32 v125, v119, v119
v_add_f32 v124, v124, v119
v_fmac_f32 v125, v120, v120
v_add_f32 v124, v124, v120
v_fmac_f32 v125, v121, v121
v_add_f32 v124, v124, v121
v_fmac_f32 v125, v122, v122
v_add_f32 v124, v124, v122
v_fmac_f32 v125, v123, v123
v_add_f32 v124, v124, v123
s_nop 1
v_permlane32_swap_b32 v124, v125
v_add_f32 v126, v124, v125
v_add_f32 v127, v124, v125
s_nop 1
v_permlane16_swap_b32 v126, v127
v_add_f32 v124, v126, v127
v_fma_f32 v124, v124, s76, v168
buffer_store_dword v124, v149, s[36:39], s8 offen sc1
s_waitcnt vmcnt(32)
s_add_u32 s7, s11, 344064
buffer_store_dwordx4 v[72:75], v148, s[36:39], s7 offen sc1
v_lshlrev_b32 v104, 16, v72
v_and_b32 v105, 0xffff0000, v72
v_lshlrev_b32 v106, 16, v73
v_and_b32 v107, 0xffff0000, v73
v_lshlrev_b32 v108, 16, v74
v_and_b32 v109, 0xffff0000, v74
v_lshlrev_b32 v110, 16, v75
v_and_b32 v111, 0xffff0000, v75
v_add_f32 v112, v104, v105
v_mul_f32 v113, v104, v104
v_fmac_f32 v113, v105, v105
v_fmac_f32 v113, v106, v106
v_add_f32 v112, v112, v106
v_fmac_f32 v113, v107, v107
v_add_f32 v112, v112, v107
v_fmac_f32 v113, v108, v108
v_add_f32 v112, v112, v108
v_fmac_f32 v113, v109, v109
v_add_f32 v112, v112, v109
v_fmac_f32 v113, v110, v110
v_add_f32 v112, v112, v110
v_fmac_f32 v113, v111, v111
v_add_f32 v112, v112, v111
s_waitcnt vmcnt(32)
s_add_u32 s8, s11, 368640
v_permlane32_swap_b32 v112, v113
v_add_f32 v114, v112, v113
v_add_f32 v115, v112, v113
buffer_store_dwordx4 v[76:79], v148, s[36:39], s8 offen sc1
v_lshlrev_b32 v116, 16, v76
v_permlane16_swap_b32 v114, v115
v_add_f32 v112, v114, v115
v_fma_f32 v112, v112, s76, v168
buffer_store_dword v112, v149, s[36:39], s7 offen sc1
v_and_b32 v117, 0xffff0000, v76
v_lshlrev_b32 v118, 16, v77
v_and_b32 v119, 0xffff0000, v77
v_lshlrev_b32 v120, 16, v78
v_and_b32 v121, 0xffff0000, v78
v_lshlrev_b32 v122, 16, v79
v_and_b32 v123, 0xffff0000, v79
v_add_f32 v124, v116, v117
v_mul_f32 v125, v116, v116
v_fmac_f32 v125, v117, v117
v_fmac_f32 v125, v118, v118
v_add_f32 v124, v124, v118
v_fmac_f32 v125, v119, v119
v_add_f32 v124, v124, v119
v_fmac_f32 v125, v120, v120
v_add_f32 v124, v124, v120
v_fmac_f32 v125, v121, v121
v_add_f32 v124, v124, v121
v_fmac_f32 v125, v122, v122
v_add_f32 v124, v124, v122
v_fmac_f32 v125, v123, v123
v_add_f32 v124, v124, v123
s_nop 1
v_permlane32_swap_b32 v124, v125
v_add_f32 v126, v124, v125
v_add_f32 v127, v124, v125
s_nop 1
v_permlane16_swap_b32 v126, v127
v_add_f32 v124, v126, v127
v_fma_f32 v124, v124, s76, v168
buffer_store_dword v124, v149, s[36:39], s8 offen sc1
s_waitcnt vmcnt(34)
s_add_u32 s7, s11, 393216
buffer_store_dwordx4 v[80:83], v148, s[36:39], s7 offen sc1
v_lshlrev_b32 v104, 16, v80
v_and_b32 v105, 0xffff0000, v80
v_lshlrev_b32 v106, 16, v81
v_and_b32 v107, 0xffff0000, v81
v_lshlrev_b32 v108, 16, v82
v_and_b32 v109, 0xffff0000, v82
v_lshlrev_b32 v110, 16, v83
v_and_b32 v111, 0xffff0000, v83
v_add_f32 v112, v104, v105
v_mul_f32 v113, v104, v104
v_fmac_f32 v113, v105, v105
v_fmac_f32 v113, v106, v106
v_add_f32 v112, v112, v106
v_fmac_f32 v113, v107, v107
v_add_f32 v112, v112, v107
v_fmac_f32 v113, v108, v108
v_add_f32 v112, v112, v108
v_fmac_f32 v113, v109, v109
v_add_f32 v112, v112, v109
v_fmac_f32 v113, v110, v110
v_add_f32 v112, v112, v110
v_fmac_f32 v113, v111, v111
v_add_f32 v112, v112, v111
s_nop 1
v_permlane32_swap_b32 v112, v113
v_add_f32 v114, v112, v113
v_add_f32 v115, v112, v113
s_nop 1
v_permlane16_swap_b32 v114, v115
v_add_f32 v112, v114, v115
v_fma_f32 v112, v112, s76, v168
buffer_store_dword v112, v149, s[36:39], s7 offen sc1
v_mov_b32 v8, 18
v_writelane_b32 v8, 9, 2
s_waitcnt vmcnt(0)
buffer_store_dword v8, v7, s[36:39], 0 offen sc1
s_mov_b32 s79, 18
v_lshrrev_b32 v12, 3, v2
v_mul_u32_u24 v12, 24576, v12
v_and_b32 v13, 7, v2
v_lshl_add_u32 v12, v13, 7, v12
v_sub_u32 v13, v148, v1
v_add_u32 v12, v12, v13
v_min_u32 v13, 15, v2
v_mul_u32_u24 v13, 24576, v13
v_add_u32 v13, v13, v149
s_add_u32 s7, s11, 24576
buffer_load_ubyte v140, v12, s[36:39], s7 offen sc1
buffer_load_ubyte v140, v13, s[36:39], s7 offen sc1
s_mov_b32 s75, 0
K4_IQ:
s_lshl_b32 s7, s4, 5
v_mov_b32 v14, s7
buffer_load_dwordx2 v[14:15], v14, s[52:55], 0 offen sc1
s_add_u32 s75, s75, 1
s_cmp_gt_u32 s75, 0x8000
s_cbranch_scc1 L_TIMEOUT
s_waitcnt vmcnt(0)
v_readfirstlane_b32 s7, v14
v_readfirstlane_b32 s8, v15
s_xor_b32 s101, s7, s22
s_xor_b32 s69, s8, s23
s_or_b32 s69, s69, s101
s_cmp_eq_u32 s69, 0
s_cselect_b32 s101, 1, 0
s_add_u32 s7, s7, s8
s_mul_i32 s7, s7, 0x01010101
s_lshr_b32 s7, s7, 24
s_cmp_eq_u32 s7, 32
s_cbranch_scc0 K4_IQ
s_lshl_b32 s7, s4, 15
v_and_b32 v12, 7, v2
v_lshl_add_u32 v12, v12, 9, s7
s_mov_b32 s75, 0
K4_Q:
buffer_load_dword v13, v12, s[36:39], 0 offen sc1
s_add_u32 s75, s75, 1
s_cmp_gt_u32 s75, 0x8000
s_cbranch_scc1 L_TIMEOUT
s_waitcnt vmcnt(0)
v_cmp_le_u32 vcc, 1, v13
s_nop 0
s_cmp_eq_u64 vcc, -1
s_cbranch_scc0 K4_Q
s_lshl_b32 s8, s6, 2
s_add_u32 s8, s8, s3
s_lshl_b32 s8, s8, 13
v_lshl_add_u32 v12, v2, 7, s8
s_mul_i32 s7, s9, 55296
s_add_u32 s7, s7, 10354688
buffer_load_ubyte v140, v12, s[36:39], s7 offen sc1
v_min_u32 v12, 212864, v12
s_add_u32 s7, s7, 229376
buffer_load_ubyte v140, v12, s[36:39], s7 offen sc1
s_mov_b32 s65, 2
s_add_u32 m0, s70, 0
s_add_u32 s7, s15, 0
buffer_load_dwordx4 v165, s[48:51], s7 offen lds
s_add_u32 m0, s70, 1024
s_add_u32 s7, s15, 0
buffer_load_dwordx4 v166, s[48:51], s7 offen lds
s_add_u32 m0, s70, 2048
s_add_u32 s7, s15, 0
buffer_load_dwordx4 v167, s[48:51], s7 offen lds
s_add_u32 m0, s70, 3072
s_add_u32 s7, s15, 20480
buffer_load_dwordx4 v165, s[48:51], s7 offen lds
s_add_u32 m0, s70, 4096
s_add_u32 s7, s15, 20480
buffer_load_dwordx4 v166, s[48:51], s7 offen lds
s_add_u32 m0, s70, 5120
s_add_u32 s7, s15, 20480
buffer_load_dwordx4 v167, s[48:51], s7 offen lds
s_add_u32 s15, s15, 40960
s_cmp_ge_u32 s15, 2211840
s_cselect_b32 s7, 2211840, 0
s_sub_u32 s15, s15, s7
s_add_u32 m0, s70, 6144
s_add_u32 s7, s15, 0
buffer_load_dwordx4 v165, s[48:51], s7 offen lds
s_add_u32 m0, s70, 7168
s_add_u32 s7, s15, 0
buffer_load_dwordx4 v166, s[48:51], s7 offen lds
s_add_u32 m0, s70, 8192
s_add_u32 s7, s15, 0
buffer_load_dwordx4 v167, s[48:51], s7 offen lds
s_add_u32 m0, s70, 9216
s_add_u32 s7, s15, 20480
buffer_load_dwordx4 v165, s[48:51], s7 offen lds
s_add_u32 m0, s70, 10240
s_add_u32 s7, s15, 20480
buffer_load_dwordx4 v166, s[48:51], s7 offen lds
s_add_u32 m0, s70, 11264
s_add_u32 s7, s15, 20480
buffer_load_dwordx4 v167, s[48:51], s7 offen lds
s_add_u32 s15, s15, 40960
s_cmp_ge_u32 s15, 2211840
s_cselect_b32 s7, 2211840, 0
s_sub_u32 s15, s15, s7
s_add_u32 m0, s70, 12288
s_add_u32 s7, s15, 0
buffer_load_dwordx4 v165, s[48:51], s7 offen lds
s_add_u32 m0, s70, 13312
s_add_u32 s7, s15, 0
buffer_load_dwordx4 v166, s[48:51], s7 offen lds
s_add_u32 m0, s70, 14336
s_add_u32 s7, s15, 0
buffer_load_dwordx4 v167, s[48:51], s7 offen lds
s_add_u32 m0, s70, 15360
s_add_u32 s7, s15, 20480
buffer_load_dwordx4 v165, s[48:51], s7 offen lds
s_add_u32 m0, s70, 16384
s_add_u32 s7, s15, 20480
buffer_load_dwordx4 v166, s[48:51], s7 offen lds
s_add_u32 m0, s70, 17408
s_add_u32 s7, s15, 20480
buffer_load_dwordx4 v167, s[48:51], s7 offen lds
s_add_u32 s15, s15, 40960
s_cmp_ge_u32 s15, 2211840
s_cselect_b32 s7, 2211840, 0
s_sub_u32 s15, s15, s7
s_add_u32 m0, s70, 18432
s_add_u32 s7, s15, 0
buffer_load_dwordx4 v165, s[48:51], s7 offen lds
s_add_u32 m0, s70, 19456
s_add_u32 s7, s15, 0
buffer_load_dwordx4 v166, s[48:51], s7 offen lds
s_add_u32 m0, s70, 20480
s_add_u32 s7, s15, 0
buffer_load_dwordx4 v167, s[48:51], s7 offen lds
s_add_u32 m0, s70, 21504
s_add_u32 s7, s15, 20480
buffer_load_dwordx4 v165, s[48:51], s7 offen lds
s_add_u32 m0, s70, 22528
s_add_u32 s7, s15, 20480
buffer_load_dwordx4 v166, s[48:51], s7 offen lds
s_add_u32 m0, s70, 23552
s_add_u32 s7, s15, 20480
buffer_load_dwordx4 v167, s[48:51], s7 offen lds
s_add_u32 s15, s15, 40960
s_cmp_ge_u32 s15, 2211840
s_cselect_b32 s7, 2211840, 0
s_sub_u32 s15, s15, s7
s_add_u32 m0, s70, 24576
s_add_u32 s7, s15, 0
buffer_load_dwordx4 v165, s[48:51], s7 offen lds
s_add_u32 m0, s70, 25600
s_add_u32 s7, s15, 0
buffer_load_dwordx4 v166, s[48:51], s7 offen lds
s_add_u32 m0, s70, 26624
s_add_u32 s7, s15, 0
buffer_load_dwordx4 v167, s[48:51], s7 offen lds
s_add_u32 m0, s70, 27648
s_add_u32 s7, s15, 20480
buffer_load_dwordx4 v165, s[48:51], s7 offen lds
s_add_u32 m0, s70, 28672
s_add_u32 s7, s15, 20480
buffer_load_dwordx4 v166, s[48:51], s7 offen lds
s_add_u32 m0, s70, 29696
s_add_u32 s7, s15, 20480
buffer_load_dwordx4 v167, s[48:51], s7 offen lds
s_add_u32 s15, s15, 40960
s_cmp_ge_u32 s15, 2211840
s_cselect_b32 s7, 2211840, 0
s_sub_u32 s15, s15, s7
s_add_u32 m0, s70, 30720
s_add_u32 s7, s15, 0
buffer_load_dwordx4 v165, s[48:51], s7 offen lds
s_add_u32 m0, s70, 31744
s_add_u32 s7, s15, 0
buffer_load_dwordx4 v166, s[48:51], s7 offen lds
s_add_u32 m0, s70, 32768
s_add_u32 s7, s15, 0
buffer_load_dwordx4 v167, s[48:51], s7 offen lds
s_add_u32 m0, s70, 33792
s_add_u32 s7, s15, 20480
buffer_load_dwordx4 v165, s[48:51], s7 offen lds
s_add_u32 m0, s70, 34816
s_add_u32 s7, s15, 20480
buffer_load_dwordx4 v166, s[48:51], s7 offen lds
s_add_u32 m0, s70, 35840
s_add_u32 s7, s15, 20480
buffer_load_dwordx4 v167, s[48:51], s7 offen lds
s_add_u32 s15, s15, 40960
s_cmp_ge_u32 s15, 2211840
s_cselect_b32 s7, 2211840, 0
s_sub_u32 s15, s15, s7
s_waitcnt vmcnt(30)
ds_read_b64_tr_b16 a[0:1], v159 offset:0
ds_read_b64_tr_b16 a[2:3], v159 offset:768
ds_read_b64_tr_b16 a[4:5], v160 offset:0
ds_read_b64_tr_b16 a[6:7], v160 offset:768
ds_read_b64_tr_b16 a[8:9], v161 offset:0
ds_read_b64_tr_b16 a[10:11], v161 offset:768
ds_read_b64_tr_b16 a[12:13], v162 offset:0
ds_read_b64_tr_b16 a[14:15], v162 offset:768
ds_read_b64_tr_b16 a[16:17], v163 offset:0
ds_read_b64_tr_b16 a[18:19], v163 offset:768
ds_read_b64_tr_b16 a[20:21], v164 offset:0
ds_read_b64_tr_b16 a[22:23], v164 offset:768
s_waitcnt lgkmcnt(0)
s_add_u32 m0, s70, 0
s_add_u32 s7, s15, 0
buffer_load_dwordx4 v165, s[48:51], s7 offen lds
s_add_u32 m0, s70, 1024
s_add_u32 s7, s15, 0
buffer_load_dwordx4 v166, s[48:51], s7 offen lds
s_add_u32 m0, s70, 2048
s_add_u32 s7, s15, 0
buffer_load_dwordx4 v167, s[48:51], s7 offen lds
s_add_u32 m0, s70, 3072
s_add_u32 s7, s15, 20480
buffer_load_dwordx4 v165, s[48:51], s7 offen lds
s_add_u32 m0, s70, 4096
s_add_u32 s7, s15, 20480
buffer_load_dwordx4 v166, s[48:51], s7 offen lds
s_add_u32 m0, s70, 5120
s_add_u32 s7, s15, 20480
buffer_load_dwordx4 v167, s[48:51], s7 offen lds
s_add_u32 s15, s15, 40960
s_cmp_ge_u32 s15, 2211840
s_cselect_b32 s7, 2211840, 0
s_sub_u32 s15, s15, s7
s_waitcnt vmcnt(30)
ds_read_b64_tr_b16 a[24:25], v159 offset:6144
ds_read_b64_tr_b16 a[26:27], v159 offset:6912
ds_read_b64_tr_b16 a[28:29], v160 offset:6144
ds_read_b64_tr_b16 a[30:31], v160 offset:6912
ds_read_b64_tr_b16 a[32:33], v161 offset:6144
ds_read_b64_tr_b16 a[34:35], v161 offset:6912
ds_read_b64_tr_b16 a[36:37], v162 offset:6144
ds_read_b64_tr_b16 a[38:39], v162 offset:6912
ds_read_b64_tr_b16 a[40:41], v163 offset:6144
ds_read_b64_tr_b16 a[42:43], v163 offset:6912
ds_read_b64_tr_b16 a[44:45], v164 offset:6144
ds_read_b64_tr_b16 a[46:47], v164 offset:6912
s_waitcnt lgkmcnt(0)
s_add_u32 m0, s70, 6144
s_add_u32 s7, s15, 0
buffer_load_dwordx4 v165, s[48:51], s7 offen lds
s_add_u32 m0, s70, 7168
s_add_u32 s7, s15, 0
buffer_load_dwordx4 v166, s[48:51], s7 offen lds
s_add_u32 m0, s70, 8192
s_add_u32 s7, s15, 0
buffer_load_dwordx4 v167, s[48:51], s7 offen lds
s_add_u32 m0, s70, 9216
s_add_u32 s7, s15, 20480
buffer_load_dwordx4 v165, s[48:51], s7 offen lds
s_add_u32 m0, s70, 10240
s_add_u32 s7, s15, 20480
buffer_load_dwordx4 v166, s[48:51], s7 offen lds
s_add_u32 m0, s70, 11264
s_add_u32 s7, s15, 20480
buffer_load_dwordx4 v167, s[48:51], s7 offen lds
s_add_u32 s15, s15, 40960
s_cmp_ge_u32 s15, 2211840
s_cselect_b32 s7, 2211840, 0
s_sub_u32 s15, s15, s7
s_waitcnt vmcnt(30)
ds_read_b64_tr_b16 a[48:49], v159 offset:12288
ds_read_b64_tr_b16 a[50:51], v159 offset:13056
ds_read_b64_tr_b16 a[52:53], v160 offset:12288
ds_read_b64_tr_b16 a[54:55], v160 offset:13056
ds_read_b64_tr_b16 a[56:57], v161 offset:12288
ds_read_b64_tr_b16 a[58:59], v161 offset:13056
ds_read_b64_tr_b16 a[60:61], v162 offset:12288
ds_read_b64_tr_b16 a[62:63], v162 offset:13056
ds_read_b64_tr_b16 a[64:65], v163 offset:12288
ds_read_b64_tr_b16 a[66:67], v163 offset:13056
ds_read_b64_tr_b16 a[68:69], v164 offset:12288
ds_read_b64_tr_b16 a[70:71], v164 offset:13056
s_waitcnt lgkmcnt(0)
s_add_u32 m0, s70, 12288
s_add_u32 s7, s15, 0
buffer_load_dwordx4 v165, s[48:51], s7 offen lds
s_add_u32 m0, s70, 13312
s_add_u32 s7, s15, 0
buffer_load_dwordx4 v166, s[48:51], s7 offen lds
s_add_u32 m0, s70, 14336
s_add_u32 s7, s15, 0
buffer_load_dwordx4 v167, s[48:51], s7 offen lds
s_add_u32 m0, s70, 15360
s_add_u32 s7, s15, 20480
buffer_load_dwordx4 v165, s[48:51], s7 offen lds
s_add_u32 m0, s70, 16384
s_add_u32 s7, s15, 20480
buffer_load_dwordx4 v166, s[48:51], s7 offen lds
s_add_u32 m0, s70, 17408
s_add_u32 s7, s15, 20480
buffer_load_dwordx4 v167, s[48:51], s7 offen lds
s_add_u32 s15, s15, 40960
s_cmp_ge_u32 s15, 2211840
s_cselect_b32 s7, 2211840, 0
s_sub_u32 s15, s15, s7
s_waitcnt vmcnt(30)
ds_read_b64_tr_b16 a[72:73], v159 offset:18432
ds_read_b64_tr_b16 a[74:75], v159 offset:19200
ds_read_b64_tr_b16 a[76:77], v160 offset:18432
ds_read_b64_tr_b16 a[78:79], v160 offset:19200
ds_read_b64_tr_b16 a[80:81], v161 offset:18432
ds_read_b64_tr_b16 a[82:83], v161 offset:19200
ds_read_b64_tr_b16 a[84:85], v162 offset:18432
ds_read_b64_tr_b16 a[86:87], v162 offset:19200
ds_read_b64_tr_b16 a[88:89], v163 offset:18432
ds_read_b64_tr_b16 a[90:91], v163 offset:19200
ds_read_b64_tr_b16 a[92:93], v164 offset:18432
ds_read_b64_tr_b16 a[94:95], v164 offset:19200
s_waitcnt lgkmcnt(0)
s_add_u32 m0, s70, 18432
s_add_u32 s7, s15, 0
buffer_load_dwordx4 v165, s[48:51], s7 offen lds
s_add_u32 m0, s70, 19456
s_add_u32 s7, s15, 0
buffer_load_dwordx4 v166, s[48:51], s7 offen lds
s_add_u32 m0, s70, 20480
s_add_u32 s7, s15, 0
buffer_load_dwordx4 v167, s[48:51], s7 offen lds
s_add_u32 m0, s70, 21504
s_add_u32 s7, s15, 20480
buffer_load_dwordx4 v165, s[48:51], s7 offen lds
s_add_u32 m0, s70, 22528
s_add_u32 s7, s15, 20480
buffer_load_dwordx4 v166, s[48:51], s7 offen lds
s_add_u32 m0, s70, 23552
s_add_u32 s7, s15, 20480
buffer_load_dwordx4 v167, s[48:51], s7 offen lds
s_add_u32 s15, s15, 40960
s_cmp_ge_u32 s15, 2211840
s_cselect_b32 s7, 2211840, 0
s_sub_u32 s15, s15, s7
s_waitcnt vmcnt(30)
ds_read_b64_tr_b16 a[96:97], v159 offset:24576
ds_read_b64_tr_b16 a[98:99], v159 offset:25344
ds_read_b64_tr_b16 a[100:101], v160 offset:24576
ds_read_b64_tr_b16 a[102:103], v160 offset:25344
ds_read_b64_tr_b16 a[104:105], v161 offset:24576
ds_read_b64_tr_b16 a[106:107], v161 offset:25344
ds_read_b64_tr_b16 a[108:109], v162 offset:24576
ds_read_b64_tr_b16 a[110:111], v162 offset:25344
ds_read_b64_tr_b16 a[112:113], v163 offset:24576
ds_read_b64_tr_b16 a[114:115], v163 offset:25344
ds_read_b64_tr_b16 a[116:117], v164 offset:24576
ds_read_b64_tr_b16 a[118:119], v164 offset:25344
s_waitcnt lgkmcnt(0)
s_add_u32 m0, s70, 24576
s_add_u32 s7, s15, 0
buffer_load_dwordx4 v165, s[48:51], s7 offen lds
s_add_u32 m0, s70, 25600
s_add_u32 s7, s15, 0
buffer_load_dwordx4 v166, s[48:51], s7 offen lds
s_add_u32 m0, s70, 26624
s_add_u32 s7, s15, 0
buffer_load_dwordx4 v167, s[48:51], s7 offen lds
s_add_u32 m0, s70, 27648
s_add_u32 s7, s15, 20480
buffer_load_dwordx4 v165, s[48:51], s7 offen lds
s_add_u32 m0, s70, 28672
s_add_u32 s7, s15, 20480
buffer_load_dwordx4 v166, s[48:51], s7 offen lds
s_add_u32 m0, s70, 29696
s_add_u32 s7, s15, 20480
buffer_load_dwordx4 v167, s[48:51], s7 offen lds
s_add_u32 s15, s15, 40960
s_cmp_ge_u32 s15, 2211840
s_cselect_b32 s7, 2211840, 0
s_sub_u32 s15, s15, s7
s_waitcnt vmcnt(30)
ds_read_b64_tr_b16 a[120:121], v159 offset:30720
ds_read_b64_tr_b16 a[122:123], v159 offset:31488
ds_read_b64_tr_b16 a[124:125], v160 offset:30720
ds_read_b64_tr_b16 a[126:127], v160 offset:31488
ds_read_b64_tr_b16 a[128:129], v161 offset:30720
ds_read_b64_tr_b16 a[130:131], v161 offset:31488
ds_read_b64_tr_b16 a[132:133], v162 offset:30720
ds_read_b64_tr_b16 a[134:135], v162 offset:31488
ds_read_b64_tr_b16 a[136:137], v163 offset:30720
ds_read_b64_tr_b16 a[138:139], v163 offset:31488
ds_read_b64_tr_b16 a[140:141], v164 offset:30720
ds_read_b64_tr_b16 a[142:143], v164 offset:31488
s_waitcnt lgkmcnt(0)
s_add_u32 m0, s70, 30720
s_add_u32 s7, s15, 0
buffer_load_dwordx4 v165, s[48:51], s7 offen lds
s_add_u32 m0, s70, 31744
s_add_u32 s7, s15, 0
buffer_load_dwordx4 v166, s[48:51], s7 offen lds
s_add_u32 m0, s70, 32768
s_add_u32 s7, s15, 0
buffer_load_dwordx4 v167, s[48:51], s7 offen lds
s_add_u32 m0, s70, 33792
s_add_u32 s7, s15, 20480
buffer_load_dwordx4 v165, s[48:51], s7 offen lds
s_add_u32 m0, s70, 34816
s_add_u32 s7, s15, 20480
buffer_load_dwordx4 v166, s[48:51], s7 offen lds
s_add_u32 m0, s70, 35840
s_add_u32 s7, s15, 20480
buffer_load_dwordx4 v167, s[48:51], s7 offen lds
s_add_u32 s15, s15, 40960
s_cmp_ge_u32 s15, 2211840
s_cselect_b32 s7, 2211840, 0
s_sub_u32 s15, s15, s7
s_waitcnt vmcnt(30)
ds_read_b64_tr_b16 a[144:145], v159 offset:0
ds_read_b64_tr_b16 a[146:147], v159 offset:768
ds_read_b64_tr_b16 a[148:149], v160 offset:0
ds_read_b64_tr_b16 a[150:151], v160 offset:768
ds_read_b64_tr_b16 a[152:153], v161 offset:0
ds_read_b64_tr_b16 a[154:155], v161 offset:768
ds_read_b64_tr_b16 a[156:157], v162 offset:0
ds_read_b64_tr_b16 a[158:159], v162 offset:768
ds_read_b64_tr_b16 a[160:161], v163 offset:0
ds_read_b64_tr_b16 a[162:163], v163 offset:768
ds_read_b64_tr_b16 a[164:165], v164 offset:0
ds_read_b64_tr_b16 a[166:167], v164 offset:768
s_waitcnt lgkmcnt(0)
s_add_u32 m0, s70, 0
s_add_u32 s7, s15, 0
buffer_load_dwordx4 v165, s[48:51], s7 offen lds
s_add_u32 m0, s70, 1024
s_add_u32 s7, s15, 0
buffer_load_dwordx4 v166, s[48:51], s7 offen lds
s_add_u32 m0, s70, 2048
s_add_u32 s7, s15, 0
buffer_load_dwordx4 v167, s[48:51], s7 offen lds
s_add_u32 m0, s70, 3072
s_add_u32 s7, s15, 20480
buffer_load_dwordx4 v165, s[48:51], s7 offen lds
s_add_u32 m0, s70, 4096
s_add_u32 s7, s15, 20480
buffer_load_dwordx4 v166, s[48:51], s7 offen lds
s_add_u32 m0, s70, 5120
s_add_u32 s7, s15, 20480
buffer_load_dwordx4 v167, s[48:51], s7 offen lds
s_add_u32 s15, s15, 40960
s_cmp_ge_u32 s15, 2211840
s_cselect_b32 s7, 2211840, 0
s_sub_u32 s15, s15, s7
s_waitcnt vmcnt(30)
ds_read_b64_tr_b16 a[168:169], v159 offset:6144
ds_read_b64_tr_b16 a[170:171], v159 offset:6912
ds_read_b64_tr_b16 a[172:173], v160 offset:6144
ds_read_b64_tr_b16 a[174:175], v160 offset:6912
ds_read_b64_tr_b16 a[176:177], v161 offset:6144
ds_read_b64_tr_b16 a[178:179], v161 offset:6912
ds_read_b64_tr_b16 a[180:181], v162 offset:6144
ds_read_b64_tr_b16 a[182:183], v162 offset:6912
ds_read_b64_tr_b16 a[184:185], v163 offset:6144
ds_read_b64_tr_b16 a[186:187], v163 offset:6912
ds_read_b64_tr_b16 a[188:189], v164 offset:6144
ds_read_b64_tr_b16 a[190:191], v164 offset:6912
s_waitcnt lgkmcnt(0)
s_bitcmp1_b32 s3, 0
s_cselect_b32 s15, s85, s15
s_add_u32 m0, s70, 6144
s_add_u32 s7, s15, 0
buffer_load_dwordx4 v165, s[48:51], s7 offen lds
s_add_u32 m0, s70, 7168
s_add_u32 s7, s15, 0
buffer_load_dwordx4 v166, s[48:51], s7 offen lds
s_add_u32 m0, s70, 8192
s_add_u32 s7, s15, 0
buffer_load_dwordx4 v167, s[48:51], s7 offen lds
s_add_u32 m0, s70, 9216
s_add_u32 s7, s15, 20480
buffer_load_dwordx4 v165, s[48:51], s7 offen lds
s_add_u32 m0, s70, 10240
s_add_u32 s7, s15, 20480
buffer_load_dwordx4 v166, s[48:51], s7 offen lds
s_add_u32 m0, s70, 11264
s_add_u32 s7, s15, 20480
buffer_load_dwordx4 v167, s[48:51], s7 offen lds
s_add_u32 s15, s15, 40960
s_cmp_ge_u32 s15, 2211840
s_cselect_b32 s7, 2211840, 0
s_sub_u32 s15, s15, s7
s_waitcnt vmcnt(30)
ds_read_b64_tr_b16 a[192:193], v159 offset:12288
ds_read_b64_tr_b16 a[194:195], v159 offset:13056
ds_read_b64_tr_b16 a[196:197], v160 offset:12288
ds_read_b64_tr_b16 a[198:199], v160 offset:13056
ds_read_b64_tr_b16 a[200:201], v161 offset:12288
ds_read_b64_tr_b16 a[202:203], v161 offset:13056
ds_read_b64_tr_b16 a[204:205], v162 offset:12288
ds_read_b64_tr_b16 a[206:207], v162 offset:13056
ds_read_b64_tr_b16 a[208:209], v163 offset:12288
ds_read_b64_tr_b16 a[210:211], v163 offset:13056
ds_read_b64_tr_b16 a[212:213], v164 offset:12288
ds_read_b64_tr_b16 a[214:215], v164 offset:13056
s_waitcnt lgkmcnt(0)
s_waitcnt vmcnt(24)
buffer_load_dword v6, v5, s[36:39], 0 offen sc1
ds_read_b64_tr_b16 a[216:217], v159 offset:18432
ds_read_b64_tr_b16 a[218:219], v159 offset:19200
ds_read_b64_tr_b16 a[220:221], v160 offset:18432
ds_read_b64_tr_b16 a[222:223], v160 offset:19200
ds_read_b64_tr_b16 a[224:225], v161 offset:18432
ds_read_b64_tr_b16 a[226:227], v161 offset:19200
ds_read_b64_tr_b16 a[228:229], v162 offset:18432
ds_read_b64_tr_b16 a[230:231], v162 offset:19200
ds_read_b64_tr_b16 a[232:233], v163 offset:18432
ds_read_b64_tr_b16 a[234:235], v163 offset:19200
ds_read_b64_tr_b16 a[236:237], v164 offset:18432
ds_read_b64_tr_b16 a[238:239], v164 offset:19200
s_waitcnt lgkmcnt(0)
s_lshl_b32 s8, s6, 2
s_add_u32 s8, s8, s3
s_getpc_b64 s[96:97]
K4_PC:
s_sub_u32 s96, s96, K4_PC-interleave_layers__sliding_local_dilated__glu_gated_bilinear__prompt_kernel
s_subb_u32 s97, s97, 0
s_lshl_b32 s7, s8, 13
v_lshl_add_u32 v12, v2, 7, s7
v_min_u32 v12, L_CODE_END-interleave_layers__sliding_local_dilated__glu_gated_bilinear__prompt_kernel-4, v12
v_mov_b32 v15, s97
v_add_co_u32 v14, vcc, s96, v12
s_nop 1
v_addc_co_u32 v15, vcc, 0, v15, vcc
global_load_dword v140, v[14:15], off
s_waitcnt vmcnt(20)
ds_read_b64_tr_b16 a[240:241], v159 offset:24576
ds_read_b64_tr_b16 a[242:243], v159 offset:25344
ds_read_b64_tr_b16 a[244:245], v160 offset:24576
ds_read_b64_tr_b16 a[246:247], v160 offset:25344
ds_read_b64_tr_b16 a[248:249], v161 offset:24576
ds_read_b64_tr_b16 a[250:251], v161 offset:25344
ds_read_b64_tr_b16 a[252:253], v162 offset:24576
ds_read_b64_tr_b16 a[254:255], v162 offset:25344
ds_read_b64_tr_b16 v[188:189], v163 offset:24576
ds_read_b64_tr_b16 v[190:191], v163 offset:25344
ds_read_b64_tr_b16 v[192:193], v164 offset:24576
ds_read_b64_tr_b16 v[194:195], v164 offset:25344
s_waitcnt lgkmcnt(0)
s_waitcnt vmcnt(14)
ds_read_b64_tr_b16 v[196:197], v159 offset:30720
ds_read_b64_tr_b16 v[198:199], v159 offset:31488
ds_read_b64_tr_b16 v[200:201], v160 offset:30720
ds_read_b64_tr_b16 v[202:203], v160 offset:31488
ds_read_b64_tr_b16 v[204:205], v161 offset:30720
ds_read_b64_tr_b16 v[206:207], v161 offset:31488
ds_read_b64_tr_b16 v[208:209], v162 offset:30720
ds_read_b64_tr_b16 v[210:211], v162 offset:31488
ds_read_b64_tr_b16 v[212:213], v163 offset:30720
ds_read_b64_tr_b16 v[214:215], v163 offset:31488
ds_read_b64_tr_b16 v[216:217], v164 offset:30720
ds_read_b64_tr_b16 v[218:219], v164 offset:31488
s_waitcnt lgkmcnt(0)
s_waitcnt vmcnt(8)
ds_read_b64_tr_b16 v[220:221], v159 offset:0
ds_read_b64_tr_b16 v[222:223], v159 offset:768
ds_read_b64_tr_b16 v[224:225], v160 offset:0
ds_read_b64_tr_b16 v[226:227], v160 offset:768
ds_read_b64_tr_b16 v[228:229], v161 offset:0
ds_read_b64_tr_b16 v[230:231], v161 offset:768
ds_read_b64_tr_b16 v[232:233], v162 offset:0
ds_read_b64_tr_b16 v[234:235], v162 offset:768
ds_read_b64_tr_b16 v[236:237], v163 offset:0
ds_read_b64_tr_b16 v[238:239], v163 offset:768
ds_read_b64_tr_b16 v[240:241], v164 offset:0
ds_read_b64_tr_b16 v[242:243], v164 offset:768
s_waitcnt lgkmcnt(0)
s_waitcnt vmcnt(2)
s_waitcnt vmcnt(1)
v_cmp_le_u32 vcc, s65, v6
s_nop 0
s_cmp_eq_u64 vcc, -1
s_cselect_b32 s68, 1, 0
s_cselect_b32 s42, 0x4000000, 0
buffer_load_dwordx4 v[16:19], v1, s[40:43], s66 offen offset:0 sc1
s_mul_i32 s71, s1, 24576
s_add_u32 s71, s71, s12
buffer_load_dwordx4 v[128:131], v150, s[40:43], s71 offen sc1
s_add_u32 s80, s66, 10240
s_add_u32 s86, s80, s84
buffer_load_dwordx4 v[20:23], v1, s[40:43], s66 offen offset:1024 sc1
buffer_load_dwordx4 v[24:27], v1, s[40:43], s66 offen offset:2048 sc1
buffer_load_dwordx4 v[28:31], v1, s[40:43], s66 offen offset:3072 sc1
s_add_u32 s69, s66, 4096
buffer_load_dwordx4 v[32:35], v1, s[40:43], s69 offen offset:0 sc1
buffer_load_dwordx4 v[36:39], v1, s[40:43], s69 offen offset:1024 sc1
buffer_load_dwordx4 v[40:43], v1, s[40:43], s69 offen offset:2048 sc1
buffer_load_dwordx4 v[44:47], v1, s[40:43], s69 offen offset:3072 sc1
s_add_u32 s69, s66, 8192
buffer_load_dwordx4 v[48:51], v1, s[40:43], s69 offen offset:0 sc1
buffer_load_dwordx4 v[52:55], v1, s[40:43], s69 offen offset:1024 sc1
ds_read_b64_tr_b16 v[244:245], v159 offset:6144
ds_read_b64_tr_b16 v[246:247], v159 offset:6912
ds_read_b64_tr_b16 v[248:249], v160 offset:6144
ds_read_b64_tr_b16 v[250:251], v160 offset:6912
ds_read_b64_tr_b16 v[252:253], v161 offset:6144
ds_read_b64_tr_b16 v[254:255], v161 offset:6912
s_waitcnt lgkmcnt(0)
s_barrier
s_cmp_eq_u32 s68, 0
s_cbranch_scc1 K4_LATE
s_waitcnt vmcnt(0)
s_cmp_eq_u32 s3, 3
s_cbranch_scc1 K4_E3
s_cmp_eq_u32 s101, 1
s_cbranch_scc1 K4_G0f
s_branch K4_G0s
K4_E3:
s_cmp_eq_u32 s101, 1
s_cbranch_scc1 K5_G0f
s_branch K5_G0s
K4_LATE:
s_cmp_eq_u32 s3, 3
s_cbranch_scc1 K4_W3
s_cmp_eq_u32 s101, 1
s_cbranch_scc1 K4_SW1f
s_branch K4_SW1s
K4_W3:
s_cmp_eq_u32 s101, 1
s_cbranch_scc1 K5_SW1f
s_branch K5_SW1s
.p2align 6
K4_F0f:
v_mfma_f32_16x16x32_bf16 v[72:75], a[0:3], v[16:19], 0
buffer_load_dword v6, v5, s[36:39], 0 offen sc1
v_mfma_f32_16x16x32_bf16 v[72:75], a[24:27], v[20:23], v[72:75]
ds_write_b32 v151, v84 offset:27648
v_mfma_f32_16x16x32_bf16 v[72:75], a[48:51], v[24:27], v[72:75]
buffer_load_dwordx4 v[56:59], v1, s[36:39], s80 offen offset:0 sc1
v_mfma_f32_16x16x32_bf16 v[72:75], a[72:75], v[28:31], v[72:75]
s_waitcnt vmcnt(4)
ds_write_b32 v151, v85 offset:27652
v_mfma_f32_16x16x32_bf16 v[76:79], a[4:7], v[16:19], 0
buffer_store_dword v8, v7, s[36:39], 0 offen
v_mfma_f32_16x16x32_bf16 v[76:79], a[28:31], v[20:23], v[76:79]
ds_write_b32 v151, v86 offset:28160
v_mfma_f32_16x16x32_bf16 v[76:79], a[52:55], v[24:27], v[76:79]
ds_write_b32 v151, v87 offset:28164
v_mfma_f32_16x16x32_bf16 v[76:79], a[76:79], v[28:31], v[76:79]
buffer_load_dwordx4 v[60:63], v1, s[36:39], s80 offen offset:1024 sc1
v_mfma_f32_16x16x32_bf16 v[80:83], a[8:11], v[16:19], 0
v_add_u32 v8, s79, v11
v_mfma_f32_16x16x32_bf16 v[80:83], a[32:35], v[20:23], v[80:83]
s_waitcnt lgkmcnt(0)
v_mfma_f32_16x16x32_bf16 v[80:83], a[56:59], v[24:27], v[80:83]
s_barrier
K4_B0f:
v_mfma_f32_16x16x32_bf16 v[80:83], a[80:83], v[28:31], v[80:83]
s_add_u32 s13, s64, 1
ds_read2st64_b64 v[104:107], v152 offset0:48 offset1:49
s_cmp_eq_u32 s13, 17
v_mfma_f32_16x16x32_bf16 v[84:87], a[12:15], v[16:19], 0
buffer_load_dwordx4 v[64:67], v1, s[36:39], s80 offen offset:2048 sc1
v_mfma_f32_16x16x32_bf16 v[84:87], a[36:39], v[20:23], v[84:87]
s_addc_u32 s13, s13, 0
ds_read2st64_b64 v[108:111], v153 offset0:48 offset1:49
s_sub_u32 s1, s13, 17
v_mfma_f32_16x16x32_bf16 v[84:87], a[60:63], v[24:27], v[84:87]
s_cselect_b32 s1, s13, s1
ds_read2st64_b64 v[112:115], v154 offset0:48 offset1:49
s_and_b32 s66, s13, 7
v_mfma_f32_16x16x32_bf16 v[84:87], a[84:87], v[28:31], v[84:87]
s_mul_i32 s66, s66, 55296
ds_read2st64_b64 v[116:119], v155 offset0:48 offset1:49
s_add_u32 s66, s66, s10
v_mfma_f32_16x16x32_bf16 v[88:91], a[16:19], v[16:19], v[132:135]
s_add_u32 s65, s13, 2
ds_read2st64_b64 v[120:123], v156 offset0:48 offset1:49
v_mfma_f32_16x16x32_bf16 v[88:91], a[40:43], v[20:23], v[88:91]
buffer_load_dwordx4 v[68:71], v1, s[36:39], s86 offen offset:3072 sc1
v_mfma_f32_16x16x32_bf16 v[88:91], a[64:67], v[24:27], v[88:91]
ds_read2st64_b64 v[124:127], v157 offset0:48 offset1:49
v_mfma_f32_16x16x32_bf16 v[88:91], a[88:91], v[28:31], v[88:91]
v_mfma_f32_16x16x32_bf16 v[92:95], a[20:23], v[16:19], v[136:139]
s_waitcnt vmcnt(5)
v_cmp_le_u32 vcc, s65, v6
s_waitcnt lgkmcnt(4)
v_mfma_f32_16x16x32_bf16 v[92:95], a[44:47], v[20:23], v[92:95]
s_cmp_eq_u64 vcc, -1
v_add_f32 v104, v104, v96
v_add_f32 v105, v105, v97
v_mfma_f32_16x16x32_bf16 v[92:95], a[68:71], v[24:27], v[92:95]
s_cbranch_scc0 K4_W0f
K4_W0fR:
s_cselect_b32 s68, 1, 0
v_mfma_f32_16x16x32_bf16 v[92:95], a[92:95], v[28:31], v[92:95]
s_waitcnt vmcnt(10)
s_cselect_b32 s42, 0x4000000, 0
v_add_f32 v106, v106, v98
v_mfma_f32_16x16x32_bf16 v[72:75], a[96:99], v[32:35], v[72:75]
buffer_load_dwordx4 v[16:19], v1, s[40:43], s66 offen offset:0 sc1
v_mfma_f32_16x16x32_bf16 v[72:75], a[120:123], v[36:39], v[72:75]
s_mul_i32 s71, s1, 24576
s_add_u32 s71, s71, s12
v_add_f32 v107, v107, v99
v_mfma_f32_16x16x32_bf16 v[72:75], a[144:147], v[40:43], v[72:75]
v_add_f32 v108, v108, v100
v_add_f32 v109, v109, v101
v_mfma_f32_16x16x32_bf16 v[76:79], a[100:103], v[32:35], v[76:79]
buffer_load_dwordx4 v[128:131], v150, s[40:43], s71 offen sc1
v_mfma_f32_16x16x32_bf16 v[76:79], a[124:127], v[36:39], v[76:79]
s_add_u32 s80, s66, 10240
s_add_u32 s86, s80, s84
v_add_f32 v110, v110, v102
v_mfma_f32_16x16x32_bf16 v[76:79], a[148:151], v[40:43], v[76:79]
v_add_f32 v111, v111, v103
s_waitcnt lgkmcnt(0)
v_mfma_f32_16x16x32_bf16 v[80:83], a[104:107], v[32:35], v[80:83]
buffer_load_dwordx4 v[20:23], v1, s[40:43], s66 offen offset:1024 sc1
v_mfma_f32_16x16x32_bf16 v[80:83], a[128:131], v[36:39], v[80:83]
v_add_f32 v112, v112, v120
v_add_f32 v113, v113, v121
v_mfma_f32_16x16x32_bf16 v[80:83], a[152:155], v[40:43], v[80:83]
v_add_f32 v114, v114, v122
v_add_f32 v115, v115, v123
v_mfma_f32_16x16x32_bf16 v[84:87], a[108:111], v[32:35], v[84:87]
v_add_f32 v116, v116, v124
v_add_f32 v117, v117, v125
v_mfma_f32_16x16x32_bf16 v[84:87], a[132:135], v[36:39], v[84:87]
v_add_f32 v118, v118, v126
v_add_f32 v119, v119, v127
v_mfma_f32_16x16x32_bf16 v[84:87], a[156:159], v[40:43], v[84:87]
v_add_f32 v104, v104, v112
v_add_f32 v105, v105, v113
v_mfma_f32_16x16x32_bf16 v[88:91], a[112:115], v[32:35], v[88:91]
buffer_load_dwordx4 v[24:27], v1, s[40:43], s66 offen offset:2048 sc1
v_mfma_f32_16x16x32_bf16 v[88:91], a[136:139], v[36:39], v[88:91]
v_add_f32 v106, v106, v114
v_add_f32 v107, v107, v115
v_mfma_f32_16x16x32_bf16 v[88:91], a[160:163], v[40:43], v[88:91]
v_add_f32 v108, v108, v116
v_add_f32 v109, v109, v117
v_mfma_f32_16x16x32_bf16 v[92:95], a[116:119], v[32:35], v[92:95]
v_add_f32 v110, v110, v118
v_add_f32 v111, v111, v119
v_mfma_f32_16x16x32_bf16 v[92:95], a[140:143], v[36:39], v[92:95]
v_cvt_pk_bf16_f32 v140, v104, v105
v_cvt_pk_bf16_f32 v141, v106, v107
v_mfma_f32_16x16x32_bf16 v[92:95], a[164:167], v[40:43], v[92:95]
s_waitcnt vmcnt(10)
v_cvt_pk_bf16_f32 v142, v108, v109
v_cvt_pk_bf16_f32 v143, v110, v111
v_mfma_f32_16x16x32_bf16 v[72:75], a[168:171], v[44:47], v[72:75]
buffer_load_dwordx4 v[28:31], v1, s[40:43], s66 offen offset:3072 sc1
v_mfma_f32_16x16x32_bf16 v[72:75], a[192:195], v[48:51], v[72:75]
buffer_store_dwordx4 v[140:143], v148, s[44:47], s67 offen
v_mfma_f32_16x16x32_bf16 v[72:75], a[216:219], v[52:55], v[72:75]
s_add_u32 s69, s66, 4096
v_add_f32 v144, v104, v105
v_mul_f32 v145, v104, v104
v_mfma_f32_16x16x32_bf16 v[76:79], a[172:175], v[44:47], v[76:79]
v_fmac_f32 v145, v105, v105
v_fmac_f32 v145, v106, v106
v_mfma_f32_16x16x32_bf16 v[76:79], a[196:199], v[48:51], v[76:79]
buffer_load_dwordx4 v[32:35], v1, s[40:43], s69 offen offset:0 sc1
v_mfma_f32_16x16x32_bf16 v[76:79], a[220:223], v[52:55], v[76:79]
v_add_f32 v144, v144, v106
v_fmac_f32 v145, v107, v107
v_mfma_f32_16x16x32_bf16 v[80:83], a[176:179], v[44:47], v[80:83]
v_add_f32 v144, v144, v107
v_fmac_f32 v145, v108, v108
v_mfma_f32_16x16x32_bf16 v[80:83], a[200:203], v[48:51], v[80:83]
v_add_f32 v144, v144, v108
v_fmac_f32 v145, v109, v109
v_mfma_f32_16x16x32_bf16 v[80:83], a[224:227], v[52:55], v[80:83]
v_add_f32 v144, v144, v109
v_fmac_f32 v145, v110, v110
v_mfma_f32_16x16x32_bf16 v[84:87], a[180:183], v[44:47], v[84:87]
buffer_load_dwordx4 v[36:39], v1, s[40:43], s69 offen offset:1024 sc1
v_mfma_f32_16x16x32_bf16 v[84:87], a[204:207], v[48:51], v[84:87]
s_waitcnt vmcnt(6)
v_add_f32 v144, v144, v110
v_fmac_f32 v145, v111, v111
v_mfma_f32_16x16x32_bf16 v[84:87], a[228:231], v[52:55], v[84:87]
v_add_f32 v144, v144, v111
v_lshlrev_b32 v132, 16, v128
v_mfma_f32_16x16x32_bf16 v[88:91], a[184:187], v[44:47], v[88:91]
v_permlane32_swap_b32 v144, v145
v_mfma_f32_16x16x32_bf16 v[88:91], a[208:211], v[48:51], v[88:91]
v_add_f32 v146, v144, v145
v_add_f32 v147, v144, v145
v_mfma_f32_16x16x32_bf16 v[88:91], a[232:235], v[52:55], v[88:91]
buffer_load_dwordx4 v[40:43], v1, s[40:43], s69 offen offset:2048 sc1
v_mfma_f32_16x16x32_bf16 v[92:95], a[188:191], v[44:47], v[92:95]
v_permlane16_swap_b32 v146, v147
v_mfma_f32_16x16x32_bf16 v[92:95], a[212:215], v[48:51], v[92:95]
v_add_f32 v144, v146, v147
v_fma_f32 v144, v144, s76, v168
v_mfma_f32_16x16x32_bf16 v[92:95], a[236:239], v[52:55], v[92:95]
s_waitcnt vmcnt(9)
v_and_b32 v133, 0xffff0000, v128
v_lshlrev_b32 v134, 16, v129
v_mfma_f32_16x16x32_bf16 v[72:75], a[240:243], v[56:59], v[72:75]
buffer_load_dwordx4 v[44:47], v1, s[40:43], s69 offen offset:3072 sc1
v_mfma_f32_16x16x32_bf16 v[72:75], v[196:199], v[60:63], v[72:75]
buffer_store_dword v144, v149, s[60:63], s67 offen
v_mfma_f32_16x16x32_bf16 v[72:75], v[220:223], v[64:67], v[72:75]
s_add_u32 s69, s66, 8192
v_and_b32 v135, 0xffff0000, v129
v_lshlrev_b32 v136, 16, v130
v_mfma_f32_16x16x32_bf16 v[72:75], v[244:247], v[68:71], v[72:75]
buffer_load_dwordx4 v[48:51], v1, s[40:43], s69 offen offset:0 sc1
v_mfma_f32_16x16x32_bf16 v[76:79], a[244:247], v[56:59], v[76:79]
s_mul_i32 s67, s0, s100
v_and_b32 v137, 0xffff0000, v130
v_lshlrev_b32 v138, 16, v131
v_mfma_f32_16x16x32_bf16 v[76:79], v[200:203], v[60:63], v[76:79]
s_add_u32 s67, s67, s11
v_and_b32 v139, 0xffff0000, v131
s_mov_b32 s46, s74
v_mfma_f32_16x16x32_bf16 v[76:79], v[224:227], v[64:67], v[76:79]
s_add_u32 s79, s64, 19
ds_write_b32 v151, v72 offset:0
v_mfma_f32_16x16x32_bf16 v[76:79], v[248:251], v[68:71], v[76:79]
s_mov_b32 s62, s81
ds_write_b32 v151, v73 offset:4
v_mfma_f32_16x16x32_bf16 v[80:83], a[248:251], v[56:59], v[80:83]
s_mov_b32 s64, s13
ds_write_b32 v151, v74 offset:512
v_mfma_f32_16x16x32_bf16 v[80:83], v[204:207], v[60:63], v[80:83]
s_mov_b32 s0, s1
ds_write_b32 v151, v75 offset:516
v_mfma_f32_16x16x32_bf16 v[80:83], v[228:231], v[64:67], v[80:83]
buffer_load_dwordx4 v[52:55], v1, s[40:43], s69 offen offset:1024 sc1
v_mfma_f32_16x16x32_bf16 v[80:83], v[252:255], v[68:71], v[80:83]
s_cmp_eq_u32 s64, 19
ds_write_b32 v151, v76 offset:1024
v_mfma_f32_16x16x32_bf16 v[84:87], a[252:255], v[56:59], v[84:87]
s_cselect_b32 s69, 0, s68
ds_write_b32 v151, v77 offset:1028
v_mfma_f32_16x16x32_bf16 v[84:87], v[208:211], v[60:63], v[84:87]
s_cmp_eq_u32 s69, 0
ds_write_b32 v151, v78 offset:1536
v_mfma_f32_16x16x32_bf16 v[84:87], v[232:235], v[64:67], v[84:87]
ds_write_b32 v151, v79 offset:1540
v_mfma_f32_16x16x32_bf16 v[88:91], v[188:191], v[56:59], v[88:91]
ds_write_b32 v151, v80 offset:2048
v_mfma_f32_16x16x32_bf16 v[88:91], v[212:215], v[60:63], v[88:91]
ds_write_b32 v151, v81 offset:2052
v_mfma_f32_16x16x32_bf16 v[88:91], v[236:239], v[64:67], v[88:91]
ds_write_b32 v151, v82 offset:2560
v_mfma_f32_16x16x32_bf16 v[92:95], v[192:195], v[56:59], v[92:95]
ds_write_b32 v151, v83 offset:2564
v_mfma_f32_16x16x32_bf16 v[92:95], v[216:219], v[60:63], v[92:95]
s_waitcnt vmcnt(8)
v_mfma_f32_16x16x32_bf16 v[92:95], v[240:243], v[64:67], v[92:95]
s_cbranch_scc1 K4_X0f
K4_F1f:
v_mfma_f32_16x16x32_bf16 v[72:75], a[0:3], v[16:19], 0
buffer_load_dword v6, v5, s[36:39], 0 offen sc1
v_mfma_f32_16x16x32_bf16 v[72:75], a[24:27], v[20:23], v[72:75]
ds_write_b32 v151, v84 offset:3072
v_mfma_f32_16x16x32_bf16 v[72:75], a[48:51], v[24:27], v[72:75]
buffer_load_dwordx4 v[56:59], v1, s[36:39], s80 offen offset:0 sc1
v_mfma_f32_16x16x32_bf16 v[72:75], a[72:75], v[28:31], v[72:75]
s_waitcnt vmcnt(4)
ds_write_b32 v151, v85 offset:3076
v_mfma_f32_16x16x32_bf16 v[76:79], a[4:7], v[16:19], 0
buffer_store_dword v8, v7, s[36:39], 0 offen
v_mfma_f32_16x16x32_bf16 v[76:79], a[28:31], v[20:23], v[76:79]
ds_write_b32 v151, v86 offset:3584
v_mfma_f32_16x16x32_bf16 v[76:79], a[52:55], v[24:27], v[76:79]
ds_write_b32 v151, v87 offset:3588
v_mfma_f32_16x16x32_bf16 v[76:79], a[76:79], v[28:31], v[76:79]
buffer_load_dwordx4 v[60:63], v1, s[36:39], s80 offen offset:1024 sc1
v_mfma_f32_16x16x32_bf16 v[80:83], a[8:11], v[16:19], 0
v_add_u32 v8, s79, v11
v_mfma_f32_16x16x32_bf16 v[80:83], a[32:35], v[20:23], v[80:83]
s_waitcnt lgkmcnt(0)
v_mfma_f32_16x16x32_bf16 v[80:83], a[56:59], v[24:27], v[80:83]
s_barrier
K4_B1f:
v_mfma_f32_16x16x32_bf16 v[80:83], a[80:83], v[28:31], v[80:83]
s_add_u32 s13, s64, 1
ds_read2st64_b64 v[104:107], v152 offset0:0 offset1:1
s_cmp_eq_u32 s13, 17
v_mfma_f32_16x16x32_bf16 v[84:87], a[12:15], v[16:19], 0
buffer_load_dwordx4 v[64:67], v1, s[36:39], s80 offen offset:2048 sc1
v_mfma_f32_16x16x32_bf16 v[84:87], a[36:39], v[20:23], v[84:87]
s_addc_u32 s13, s13, 0
ds_read2st64_b64 v[108:111], v153 offset0:0 offset1:1
s_sub_u32 s1, s13, 17
v_mfma_f32_16x16x32_bf16 v[84:87], a[60:63], v[24:27], v[84:87]
s_cselect_b32 s1, s13, s1
ds_read2st64_b64 v[112:115], v154 offset0:0 offset1:1
s_and_b32 s66, s13, 7
v_mfma_f32_16x16x32_bf16 v[84:87], a[84:87], v[28:31], v[84:87]
s_mul_i32 s66, s66, 55296
ds_read2st64_b64 v[116:119], v155 offset0:0 offset1:1
s_add_u32 s66, s66, s10
v_mfma_f32_16x16x32_bf16 v[96:99], a[16:19], v[16:19], v[132:135]
s_add_u32 s65, s13, 2
ds_read2st64_b64 v[120:123], v156 offset0:0 offset1:1
v_mfma_f32_16x16x32_bf16 v[96:99], a[40:43], v[20:23], v[96:99]
buffer_load_dwordx4 v[68:71], v1, s[36:39], s86 offen offset:3072 sc1
v_mfma_f32_16x16x32_bf16 v[96:99], a[64:67], v[24:27], v[96:99]
ds_read2st64_b64 v[124:127], v157 offset0:0 offset1:1
v_mfma_f32_16x16x32_bf16 v[96:99], a[88:91], v[28:31], v[96:99]
v_mfma_f32_16x16x32_bf16 v[100:103], a[20:23], v[16:19], v[136:139]
s_waitcnt vmcnt(5)
v_cmp_le_u32 vcc, s65, v6
s_waitcnt lgkmcnt(4)
v_mfma_f32_16x16x32_bf16 v[100:103], a[44:47], v[20:23], v[100:103]
s_cmp_eq_u64 vcc, -1
v_add_f32 v104, v104, v88
v_add_f32 v105, v105, v89
v_mfma_f32_16x16x32_bf16 v[100:103], a[68:71], v[24:27], v[100:103]
s_cbranch_scc0 K4_W1f
K4_W1fR:
s_cselect_b32 s68, 1, 0
v_mfma_f32_16x16x32_bf16 v[100:103], a[92:95], v[28:31], v[100:103]
s_waitcnt vmcnt(10)
s_cselect_b32 s42, 0x4000000, 0
v_add_f32 v106, v106, v90
v_mfma_f32_16x16x32_bf16 v[72:75], a[96:99], v[32:35], v[72:75]
buffer_load_dwordx4 v[16:19], v1, s[40:43], s66 offen offset:0 sc1
v_mfma_f32_16x16x32_bf16 v[72:75], a[120:123], v[36:39], v[72:75]
s_mul_i32 s71, s1, 24576
s_add_u32 s71, s71, s12
v_add_f32 v107, v107, v91
v_mfma_f32_16x16x32_bf16 v[72:75], a[144:147], v[40:43], v[72:75]
v_add_f32 v108, v108, v92
v_add_f32 v109, v109, v93
v_mfma_f32_16x16x32_bf16 v[76:79], a[100:103], v[32:35], v[76:79]
buffer_load_dwordx4 v[128:131], v150, s[40:43], s71 offen sc1
v_mfma_f32_16x16x32_bf16 v[76:79], a[124:127], v[36:39], v[76:79]
s_add_u32 s80, s66, 10240
s_add_u32 s86, s80, s84
v_add_f32 v110, v110, v94
v_mfma_f32_16x16x32_bf16 v[76:79], a[148:151], v[40:43], v[76:79]
v_add_f32 v111, v111, v95
s_waitcnt lgkmcnt(0)
v_mfma_f32_16x16x32_bf16 v[80:83], a[104:107], v[32:35], v[80:83]
buffer_load_dwordx4 v[20:23], v1, s[40:43], s66 offen offset:1024 sc1
v_mfma_f32_16x16x32_bf16 v[80:83], a[128:131], v[36:39], v[80:83]
v_add_f32 v112, v112, v120
v_add_f32 v113, v113, v121
v_mfma_f32_16x16x32_bf16 v[80:83], a[152:155], v[40:43], v[80:83]
v_add_f32 v114, v114, v122
v_add_f32 v115, v115, v123
v_mfma_f32_16x16x32_bf16 v[84:87], a[108:111], v[32:35], v[84:87]
v_add_f32 v116, v116, v124
v_add_f32 v117, v117, v125
v_mfma_f32_16x16x32_bf16 v[84:87], a[132:135], v[36:39], v[84:87]
v_add_f32 v118, v118, v126
v_add_f32 v119, v119, v127
v_mfma_f32_16x16x32_bf16 v[84:87], a[156:159], v[40:43], v[84:87]
v_add_f32 v104, v104, v112
v_add_f32 v105, v105, v113
v_mfma_f32_16x16x32_bf16 v[96:99], a[112:115], v[32:35], v[96:99]
buffer_load_dwordx4 v[24:27], v1, s[40:43], s66 offen offset:2048 sc1
v_mfma_f32_16x16x32_bf16 v[96:99], a[136:139], v[36:39], v[96:99]
v_add_f32 v106, v106, v114
v_add_f32 v107, v107, v115
v_mfma_f32_16x16x32_bf16 v[96:99], a[160:163], v[40:43], v[96:99]
v_add_f32 v108, v108, v116
v_add_f32 v109, v109, v117
v_mfma_f32_16x16x32_bf16 v[100:103], a[116:119], v[32:35], v[100:103]
v_add_f32 v110, v110, v118
v_add_f32 v111, v111, v119
v_mfma_f32_16x16x32_bf16 v[100:103], a[140:143], v[36:39], v[100:103]
v_cvt_pk_bf16_f32 v140, v104, v105
v_cvt_pk_bf16_f32 v141, v106, v107
v_mfma_f32_16x16x32_bf16 v[100:103], a[164:167], v[40:43], v[100:103]
s_waitcnt vmcnt(10)
v_cvt_pk_bf16_f32 v142, v108, v109
v_cvt_pk_bf16_f32 v143, v110, v111
v_mfma_f32_16x16x32_bf16 v[72:75], a[168:171], v[44:47], v[72:75]
buffer_load_dwordx4 v[28:31], v1, s[40:43], s66 offen offset:3072 sc1
v_mfma_f32_16x16x32_bf16 v[72:75], a[192:195], v[48:51], v[72:75]
buffer_store_dwordx4 v[140:143], v148, s[44:47], s67 offen
v_mfma_f32_16x16x32_bf16 v[72:75], a[216:219], v[52:55], v[72:75]
s_add_u32 s69, s66, 4096
v_add_f32 v144, v104, v105
v_mul_f32 v145, v104, v104
v_mfma_f32_16x16x32_bf16 v[76:79], a[172:175], v[44:47], v[76:79]
v_fmac_f32 v145, v105, v105
v_fmac_f32 v145, v106, v106
v_mfma_f32_16x16x32_bf16 v[76:79], a[196:199], v[48:51], v[76:79]
buffer_load_dwordx4 v[32:35], v1, s[40:43], s69 offen offset:0 sc1
v_mfma_f32_16x16x32_bf16 v[76:79], a[220:223], v[52:55], v[76:79]
v_add_f32 v144, v144, v106
v_fmac_f32 v145, v107, v107
v_mfma_f32_16x16x32_bf16 v[80:83], a[176:179], v[44:47], v[80:83]
v_add_f32 v144, v144, v107
v_fmac_f32 v145, v108, v108
v_mfma_f32_16x16x32_bf16 v[80:83], a[200:203], v[48:51], v[80:83]
v_add_f32 v144, v144, v108
v_fmac_f32 v145, v109, v109
v_mfma_f32_16x16x32_bf16 v[80:83], a[224:227], v[52:55], v[80:83]
v_add_f32 v144, v144, v109
v_fmac_f32 v145, v110, v110
v_mfma_f32_16x16x32_bf16 v[84:87], a[180:183], v[44:47], v[84:87]
buffer_load_dwordx4 v[36:39], v1, s[40:43], s69 offen offset:1024 sc1
v_mfma_f32_16x16x32_bf16 v[84:87], a[204:207], v[48:51], v[84:87]
s_waitcnt vmcnt(6)
v_add_f32 v144, v144, v110
v_fmac_f32 v145, v111, v111
v_mfma_f32_16x16x32_bf16 v[84:87], a[228:231], v[52:55], v[84:87]
v_add_f32 v144, v144, v111
v_lshlrev_b32 v132, 16, v128
v_mfma_f32_16x16x32_bf16 v[96:99], a[184:187], v[44:47], v[96:99]
v_permlane32_swap_b32 v144, v145
v_mfma_f32_16x16x32_bf16 v[96:99], a[208:211], v[48:51], v[96:99]
v_add_f32 v146, v144, v145
v_add_f32 v147, v144, v145
v_mfma_f32_16x16x32_bf16 v[96:99], a[232:235], v[52:55], v[96:99]
buffer_load_dwordx4 v[40:43], v1, s[40:43], s69 offen offset:2048 sc1
v_mfma_f32_16x16x32_bf16 v[100:103], a[188:191], v[44:47], v[100:103]
v_permlane16_swap_b32 v146, v147
v_mfma_f32_16x16x32_bf16 v[100:103], a[212:215], v[48:51], v[100:103]
v_add_f32 v144, v146, v147
v_fma_f32 v144, v144, s76, v168
v_mfma_f32_16x16x32_bf16 v[100:103], a[236:239], v[52:55], v[100:103]
s_waitcnt vmcnt(9)
v_and_b32 v133, 0xffff0000, v128
v_lshlrev_b32 v134, 16, v129
v_mfma_f32_16x16x32_bf16 v[72:75], a[240:243], v[56:59], v[72:75]
buffer_load_dwordx4 v[44:47], v1, s[40:43], s69 offen offset:3072 sc1
v_mfma_f32_16x16x32_bf16 v[72:75], v[196:199], v[60:63], v[72:75]
buffer_store_dword v144, v149, s[60:63], s67 offen
v_mfma_f32_16x16x32_bf16 v[72:75], v[220:223], v[64:67], v[72:75]
s_add_u32 s69, s66, 8192
v_and_b32 v135, 0xffff0000, v129
v_lshlrev_b32 v136, 16, v130
v_mfma_f32_16x16x32_bf16 v[72:75], v[244:247], v[68:71], v[72:75]
buffer_load_dwordx4 v[48:51], v1, s[40:43], s69 offen offset:0 sc1
v_mfma_f32_16x16x32_bf16 v[76:79], a[244:247], v[56:59], v[76:79]
s_mul_i32 s67, s0, s100
v_and_b32 v137, 0xffff0000, v130
v_lshlrev_b32 v138, 16, v131
v_mfma_f32_16x16x32_bf16 v[76:79], v[200:203], v[60:63], v[76:79]
s_add_u32 s67, s67, s11
v_and_b32 v139, 0xffff0000, v131
s_mov_b32 s46, s74
v_mfma_f32_16x16x32_bf16 v[76:79], v[224:227], v[64:67], v[76:79]
s_add_u32 s79, s64, 19
ds_write_b32 v151, v72 offset:24576
v_mfma_f32_16x16x32_bf16 v[76:79], v[248:251], v[68:71], v[76:79]
s_mov_b32 s62, s81
ds_write_b32 v151, v73 offset:24580
v_mfma_f32_16x16x32_bf16 v[80:83], a[248:251], v[56:59], v[80:83]
s_mov_b32 s64, s13
ds_write_b32 v151, v74 offset:25088
v_mfma_f32_16x16x32_bf16 v[80:83], v[204:207], v[60:63], v[80:83]
s_mov_b32 s0, s1
ds_write_b32 v151, v75 offset:25092
v_mfma_f32_16x16x32_bf16 v[80:83], v[228:231], v[64:67], v[80:83]
buffer_load_dwordx4 v[52:55], v1, s[40:43], s69 offen offset:1024 sc1
v_mfma_f32_16x16x32_bf16 v[80:83], v[252:255], v[68:71], v[80:83]
s_cmp_eq_u32 s64, 19
ds_write_b32 v151, v76 offset:25600
v_mfma_f32_16x16x32_bf16 v[84:87], a[252:255], v[56:59], v[84:87]
s_cselect_b32 s69, 0, s68
ds_write_b32 v151, v77 offset:25604
v_mfma_f32_16x16x32_bf16 v[84:87], v[208:211], v[60:63], v[84:87]
s_cmp_eq_u32 s69, 0
ds_write_b32 v151, v78 offset:26112
v_mfma_f32_16x16x32_bf16 v[84:87], v[232:235], v[64:67], v[84:87]
ds_write_b32 v151, v79 offset:26116
v_mfma_f32_16x16x32_bf16 v[96:99], v[188:191], v[56:59], v[96:99]
ds_write_b32 v151, v80 offset:26624
v_mfma_f32_16x16x32_bf16 v[96:99], v[212:215], v[60:63], v[96:99]
ds_write_b32 v151, v81 offset:26628
v_mfma_f32_16x16x32_bf16 v[96:99], v[236:239], v[64:67], v[96:99]
ds_write_b32 v151, v82 offset:27136
v_mfma_f32_16x16x32_bf16 v[100:103], v[192:195], v[56:59], v[100:103]
ds_write_b32 v151, v83 offset:27140
v_mfma_f32_16x16x32_bf16 v[100:103], v[216:219], v[60:63], v[100:103]
s_waitcnt vmcnt(8)
v_mfma_f32_16x16x32_bf16 v[100:103], v[240:243], v[64:67], v[100:103]
s_cbranch_scc1 K4_X1f
s_branch K4_F0f
K4_X0f:
s_cmp_lg_u32 s64, 19
s_cbranch_scc1 K4_NR0f
s_mov_b32 s44, s30
s_mov_b32 s45, s31
s_mov_b32 s74, 2621440
s_mov_b32 s46, s74
s_mov_b32 s81, 0
s_mov_b32 s62, 0
s_mov_b32 s100, 40960
s_mov_b32 s11, 4294926336
s_mov_b32 s67, 0
v_mov_b32 v148, v158
s_waitcnt vmcnt(0)
buffer_store_dword v8, v7, s[36:39], 0 offen
s_mov_b32 s7, 0x7ff00000
s_nop 1
v_writelane_b32 v7, s7, 0
s_cmp_eq_u32 s68, 1
s_cbranch_scc1 K4_F1g
s_branch K4_NR0g
K4_NR0f:
s_cmp_gt_u32 s64, 33
s_cbranch_scc1 K4_E0f
buffer_load_dword v6, v5, s[36:39], 0 offen sc1
ds_write_b32 v151, v84 offset:3072
ds_write_b32 v151, v85 offset:3076
ds_write_b32 v151, v86 offset:3584
ds_write_b32 v151, v87 offset:3588
s_waitcnt lgkmcnt(0)
s_barrier
ds_read2st64_b64 v[104:107], v152 offset0:0 offset1:1
ds_read2st64_b64 v[108:111], v153 offset0:0 offset1:1
ds_read2st64_b64 v[112:115], v154 offset0:0 offset1:1
ds_read2st64_b64 v[116:119], v155 offset0:0 offset1:1
ds_read2st64_b64 v[120:123], v156 offset0:0 offset1:1
ds_read2st64_b64 v[124:127], v157 offset0:0 offset1:1
s_waitcnt vmcnt(0)
buffer_store_dword v8, v7, s[36:39], 0 offen
v_cmp_le_u32 vcc, s65, v6
s_nop 0
s_cmp_eq_u64 vcc, -1
s_cselect_b32 s68, 1, 0
s_cselect_b32 s42, 0x4000000, 0
buffer_load_dwordx4 v[16:19], v1, s[40:43], s66 offen offset:0 sc1
s_mul_i32 s71, s1, 24576
s_add_u32 s71, s71, s12
buffer_load_dwordx4 v[128:131], v150, s[40:43], s71 offen sc1
s_add_u32 s80, s66, 10240
s_add_u32 s86, s80, s84
buffer_load_dwordx4 v[20:23], v1, s[40:43], s66 offen offset:1024 sc1
buffer_load_dwordx4 v[24:27], v1, s[40:43], s66 offen offset:2048 sc1
buffer_load_dwordx4 v[28:31], v1, s[40:43], s66 offen offset:3072 sc1
s_add_u32 s69, s66, 4096
buffer_load_dwordx4 v[32:35], v1, s[40:43], s69 offen offset:0 sc1
buffer_load_dwordx4 v[36:39], v1, s[40:43], s69 offen offset:1024 sc1
buffer_load_dwordx4 v[40:43], v1, s[40:43], s69 offen offset:2048 sc1
buffer_load_dwordx4 v[44:47], v1, s[40:43], s69 offen offset:3072 sc1
s_add_u32 s69, s66, 8192
buffer_load_dwordx4 v[48:51], v1, s[40:43], s69 offen offset:0 sc1
buffer_load_dwordx4 v[52:55], v1, s[40:43], s69 offen offset:1024 sc1
buffer_load_dword v6, v5, s[36:39], 0 offen sc1
s_waitcnt lgkmcnt(4)
v_add_f32 v104, v104, v88
v_add_f32 v105, v105, v89
v_add_f32 v106, v106, v90
v_add_f32 v107, v107, v91
v_add_f32 v108, v108, v92
v_add_f32 v109, v109, v93
v_add_f32 v110, v110, v94
v_add_f32 v111, v111, v95
s_waitcnt lgkmcnt(0)
v_add_f32 v112, v112, v120
v_add_f32 v113, v113, v121
v_add_f32 v114, v114, v122
v_add_f32 v115, v115, v123
v_add_f32 v116, v116, v124
v_add_f32 v117, v117, v125
v_add_f32 v118, v118, v126
v_add_f32 v119, v119, v127
v_add_f32 v104, v104, v112
v_add_f32 v105, v105, v113
v_add_f32 v106, v106, v114
v_add_f32 v107, v107, v115
v_add_f32 v108, v108, v116
v_add_f32 v109, v109, v117
v_add_f32 v110, v110, v118
v_add_f32 v111, v111, v119
v_cvt_pk_bf16_f32 v140, v104, v105
v_cvt_pk_bf16_f32 v141, v106, v107
v_cvt_pk_bf16_f32 v142, v108, v109
v_cvt_pk_bf16_f32 v143, v110, v111
buffer_store_dwordx4 v[140:143], v148, s[44:47], s67 offen
v_add_f32 v144, v104, v105
v_mul_f32 v145, v104, v104
v_fmac_f32 v145, v105, v105
v_fmac_f32 v145, v106, v106
v_add_f32 v144, v144, v106
v_fmac_f32 v145, v107, v107
v_add_f32 v144, v144, v107
v_fmac_f32 v145, v108, v108
v_add_f32 v144, v144, v108
v_fmac_f32 v145, v109, v109
v_add_f32 v144, v144, v109
v_fmac_f32 v145, v110, v110
v_add_f32 v144, v144, v110
v_fmac_f32 v145, v111, v111
v_add_f32 v144, v144, v111
s_nop 1
v_permlane32_swap_b32 v144, v145
v_add_f32 v146, v144, v145
v_add_f32 v147, v144, v145
s_nop 1
v_permlane16_swap_b32 v146, v147
v_add_f32 v144, v146, v147
v_fma_f32 v144, v144, s76, v168
buffer_store_dword v144, v149, s[60:63], s67 offen
v_add_u32 v8, s79, v11
s_mov_b32 s46, 0
s_mov_b32 s62, 0
s_cmp_eq_u32 s68, 0
s_cbranch_scc1 K4_N20f
s_waitcnt vmcnt(0)
buffer_store_dword v8, v7, s[36:39], 0 offen
s_branch K4_G1f
K4_N20f:
s_waitcnt vmcnt(2)
v_cmp_le_u32 vcc, s65, v6
s_nop 0
s_cmp_eq_u64 vcc, -1
s_cselect_b32 s68, 1, 0
s_cselect_b32 s42, 0x4000000, 0
buffer_load_dwordx4 v[16:19], v1, s[40:43], s66 offen offset:0 sc1
s_mul_i32 s71, s1, 24576
s_add_u32 s71, s71, s12
buffer_load_dwordx4 v[128:131], v150, s[40:43], s71 offen sc1
s_add_u32 s80, s66, 10240
s_add_u32 s86, s80, s84
buffer_load_dwordx4 v[20:23], v1, s[40:43], s66 offen offset:1024 sc1
buffer_load_dwordx4 v[24:27], v1, s[40:43], s66 offen offset:2048 sc1
buffer_load_dwordx4 v[28:31], v1, s[40:43], s66 offen offset:3072 sc1
s_add_u32 s69, s66, 4096
buffer_load_dwordx4 v[32:35], v1, s[40:43], s69 offen offset:0 sc1
buffer_load_dwordx4 v[36:39], v1, s[40:43], s69 offen offset:1024 sc1
buffer_load_dwordx4 v[40:43], v1, s[40:43], s69 offen offset:2048 sc1
buffer_load_dwordx4 v[44:47], v1, s[40:43], s69 offen offset:3072 sc1
s_add_u32 s69, s66, 8192
buffer_load_dwordx4 v[48:51], v1, s[40:43], s69 offen offset:0 sc1
buffer_load_dwordx4 v[52:55], v1, s[40:43], s69 offen offset:1024 sc1
buffer_load_dword v6, v5, s[36:39], 0 offen sc1
s_waitcnt vmcnt(12)
buffer_store_dword v8, v7, s[36:39], 0 offen
s_waitcnt vmcnt(1)
s_cmp_eq_u32 s68, 1
s_cbranch_scc1 K4_G1f
s_cmp_gt_u32 s64, 33
s_cbranch_scc1 L_FIN
K4_SW0f:
s_mov_b32 s75, 0
K4_SP0f:
buffer_load_dword v6, v5, s[36:39], 0 offen sc1
s_add_u32 s75, s75, 1
s_cmp_gt_u32 s75, 0x8000
s_cbranch_scc1 L_TIMEOUT
s_waitcnt vmcnt(0)
v_cmp_le_u32 vcc, s65, v6
s_nop 0
s_cmp_eq_u64 vcc, -1
s_cbranch_scc0 K4_SP0f
K4_LC0f:
s_mov_b32 s42, 0x4000000
buffer_load_dwordx4 v[16:19], v1, s[40:43], s66 offen offset:0 sc1
s_mul_i32 s71, s1, 24576
s_add_u32 s71, s71, s12
buffer_load_dwordx4 v[128:131], v150, s[40:43], s71 offen sc1
s_add_u32 s80, s66, 10240
s_add_u32 s86, s80, s84
buffer_load_dwordx4 v[20:23], v1, s[40:43], s66 offen offset:1024 sc1
buffer_load_dwordx4 v[24:27], v1, s[40:43], s66 offen offset:2048 sc1
buffer_load_dwordx4 v[28:31], v1, s[40:43], s66 offen offset:3072 sc1
s_add_u32 s69, s66, 4096
buffer_load_dwordx4 v[32:35], v1, s[40:43], s69 offen offset:0 sc1
buffer_load_dwordx4 v[36:39], v1, s[40:43], s69 offen offset:1024 sc1
buffer_load_dwordx4 v[40:43], v1, s[40:43], s69 offen offset:2048 sc1
buffer_load_dwordx4 v[44:47], v1, s[40:43], s69 offen offset:3072 sc1
s_add_u32 s69, s66, 8192
buffer_load_dwordx4 v[48:51], v1, s[40:43], s69 offen offset:0 sc1
buffer_load_dwordx4 v[52:55], v1, s[40:43], s69 offen offset:1024 sc1
buffer_load_dword v6, v5, s[36:39], 0 offen sc1
s_waitcnt vmcnt(0)
s_branch K4_G1f
K4_W0f:
s_mov_b32 s75, 6
s_cmp_lt_u32 s65, 36
s_cbranch_scc0 K4_W0fR
K4_W0fL:
buffer_load_dword v6, v5, s[36:39], 0 offen sc1
s_waitcnt vmcnt(0)
v_cmp_le_u32 vcc, s65, v6
s_nop 0
s_cmp_eq_u64 vcc, -1
s_cbranch_scc1 K4_W0fR
s_sub_u32 s75, s75, 1
s_cmp_lg_u32 s75, 0
s_cbranch_scc1 K4_W0fL
s_branch K4_W0fR
K4_E0f:
ds_write_b32 v151, v84 offset:3072
ds_write_b32 v151, v85 offset:3076
ds_write_b32 v151, v86 offset:3584
ds_write_b32 v151, v87 offset:3588
s_waitcnt lgkmcnt(0)
s_barrier
ds_read2st64_b64 v[104:107], v152 offset0:0 offset1:1
ds_read2st64_b64 v[108:111], v153 offset0:0 offset1:1
ds_read2st64_b64 v[112:115], v154 offset0:0 offset1:1
ds_read2st64_b64 v[116:119], v155 offset0:0 offset1:1
ds_read2st64_b64 v[120:123], v156 offset0:0 offset1:1
ds_read2st64_b64 v[124:127], v157 offset0:0 offset1:1
s_waitcnt lgkmcnt(4)
v_add_f32 v104, v104, v88
v_add_f32 v105, v105, v89
v_add_f32 v106, v106, v90
v_add_f32 v107, v107, v91
v_add_f32 v108, v108, v92
v_add_f32 v109, v109, v93
v_add_f32 v110, v110, v94
v_add_f32 v111, v111, v95
s_waitcnt lgkmcnt(0)
v_add_f32 v112, v112, v120
v_add_f32 v113, v113, v121
v_add_f32 v114, v114, v122
v_add_f32 v115, v115, v123
v_add_f32 v116, v116, v124
v_add_f32 v117, v117, v125
v_add_f32 v118, v118, v126
v_add_f32 v119, v119, v127
v_add_f32 v104, v104, v112
v_add_f32 v105, v105, v113
v_add_f32 v106, v106, v114
v_add_f32 v107, v107, v115
v_add_f32 v108, v108, v116
v_add_f32 v109, v109, v117
v_add_f32 v110, v110, v118
v_add_f32 v111, v111, v119
v_cvt_pk_bf16_f32 v140, v104, v105
v_cvt_pk_bf16_f32 v141, v106, v107
v_cvt_pk_bf16_f32 v142, v108, v109
v_cvt_pk_bf16_f32 v143, v110, v111
buffer_store_dwordx4 v[140:143], v148, s[44:47], s67 offen
s_branch L_FIN
K4_X1f:
s_cmp_lg_u32 s64, 19
s_cbranch_scc1 K4_NR1f
s_mov_b32 s44, s30
s_mov_b32 s45, s31
s_mov_b32 s74, 2621440
s_mov_b32 s46, s74
s_mov_b32 s81, 0
s_mov_b32 s62, 0
s_mov_b32 s100, 40960
s_mov_b32 s11, 4294926336
s_mov_b32 s67, 0
v_mov_b32 v148, v158
s_waitcnt vmcnt(0)
buffer_store_dword v8, v7, s[36:39], 0 offen
s_mov_b32 s7, 0x7ff00000
s_nop 1
v_writelane_b32 v7, s7, 0
s_cmp_eq_u32 s68, 1
s_cbranch_scc1 K4_F0g
s_branch K4_NR1g
K4_NR1f:
s_cmp_gt_u32 s64, 33
s_cbranch_scc1 K4_E1f
buffer_load_dword v6, v5, s[36:39], 0 offen sc1
ds_write_b32 v151, v84 offset:27648
ds_write_b32 v151, v85 offset:27652
ds_write_b32 v151, v86 offset:28160
ds_write_b32 v151, v87 offset:28164
s_waitcnt lgkmcnt(0)
s_barrier
ds_read2st64_b64 v[104:107], v152 offset0:48 offset1:49
ds_read2st64_b64 v[108:111], v153 offset0:48 offset1:49
ds_read2st64_b64 v[112:115], v154 offset0:48 offset1:49
ds_read2st64_b64 v[116:119], v155 offset0:48 offset1:49
ds_read2st64_b64 v[120:123], v156 offset0:48 offset1:49
ds_read2st64_b64 v[124:127], v157 offset0:48 offset1:49
s_waitcnt vmcnt(0)
buffer_store_dword v8, v7, s[36:39], 0 offen
v_cmp_le_u32 vcc, s65, v6
s_nop 0
s_cmp_eq_u64 vcc, -1
s_cselect_b32 s68, 1, 0
s_cselect_b32 s42, 0x4000000, 0
buffer_load_dwordx4 v[16:19], v1, s[40:43], s66 offen offset:0 sc1
s_mul_i32 s71, s1, 24576
s_add_u32 s71, s71, s12
buffer_load_dwordx4 v[128:131], v150, s[40:43], s71 offen sc1
s_add_u32 s80, s66, 10240
s_add_u32 s86, s80, s84
buffer_load_dwordx4 v[20:23], v1, s[40:43], s66 offen offset:1024 sc1
buffer_load_dwordx4 v[24:27], v1, s[40:43], s66 offen offset:2048 sc1
buffer_load_dwordx4 v[28:31], v1, s[40:43], s66 offen offset:3072 sc1
s_add_u32 s69, s66, 4096
buffer_load_dwordx4 v[32:35], v1, s[40:43], s69 offen offset:0 sc1
buffer_load_dwordx4 v[36:39], v1, s[40:43], s69 offen offset:1024 sc1
buffer_load_dwordx4 v[40:43], v1, s[40:43], s69 offen offset:2048 sc1
buffer_load_dwordx4 v[44:47], v1, s[40:43], s69 offen offset:3072 sc1
s_add_u32 s69, s66, 8192
buffer_load_dwordx4 v[48:51], v1, s[40:43], s69 offen offset:0 sc1
buffer_load_dwordx4 v[52:55], v1, s[40:43], s69 offen offset:1024 sc1
buffer_load_dword v6, v5, s[36:39], 0 offen sc1
s_waitcnt lgkmcnt(4)
v_add_f32 v104, v104, v96
v_add_f32 v105, v105, v97
v_add_f32 v106, v106, v98
v_add_f32 v107, v107, v99
v_add_f32 v108, v108, v100
v_add_f32 v109, v109, v101
v_add_f32 v110, v110, v102
v_add_f32 v111, v111, v103
s_waitcnt lgkmcnt(0)
v_add_f32 v112, v112, v120
v_add_f32 v113, v113, v121
v_add_f32 v114, v114, v122
v_add_f32 v115, v115, v123
v_add_f32 v116, v116, v124
v_add_f32 v117, v117, v125
v_add_f32 v118, v118, v126
v_add_f32 v119, v119, v127
v_add_f32 v104, v104, v112
v_add_f32 v105, v105, v113
v_add_f32 v106, v106, v114
v_add_f32 v107, v107, v115
v_add_f32 v108, v108, v116
v_add_f32 v109, v109, v117
v_add_f32 v110, v110, v118
v_add_f32 v111, v111, v119
v_cvt_pk_bf16_f32 v140, v104, v105
v_cvt_pk_bf16_f32 v141, v106, v107
v_cvt_pk_bf16_f32 v142, v108, v109
v_cvt_pk_bf16_f32 v143, v110, v111
buffer_store_dwordx4 v[140:143], v148, s[44:47], s67 offen
v_add_f32 v144, v104, v105
v_mul_f32 v145, v104, v104
v_fmac_f32 v145, v105, v105
v_fmac_f32 v145, v106, v106
v_add_f32 v144, v144, v106
v_fmac_f32 v145, v107, v107
v_add_f32 v144, v144, v107
v_fmac_f32 v145, v108, v108
v_add_f32 v144, v144, v108
v_fmac_f32 v145, v109, v109
v_add_f32 v144, v144, v109
v_fmac_f32 v145, v110, v110
v_add_f32 v144, v144, v110
v_fmac_f32 v145, v111, v111
v_add_f32 v144, v144, v111
s_nop 1
v_permlane32_swap_b32 v144, v145
v_add_f32 v146, v144, v145
v_add_f32 v147, v144, v145
s_nop 1
v_permlane16_swap_b32 v146, v147
v_add_f32 v144, v146, v147
v_fma_f32 v144, v144, s76, v168
buffer_store_dword v144, v149, s[60:63], s67 offen
v_add_u32 v8, s79, v11
s_mov_b32 s46, 0
s_mov_b32 s62, 0
s_cmp_eq_u32 s68, 0
s_cbranch_scc1 K4_N21f
s_waitcnt vmcnt(0)
buffer_store_dword v8, v7, s[36:39], 0 offen
s_branch K4_G0f
K4_N21f:
s_waitcnt vmcnt(2)
v_cmp_le_u32 vcc, s65, v6
s_nop 0
s_cmp_eq_u64 vcc, -1
s_cselect_b32 s68, 1, 0
s_cselect_b32 s42, 0x4000000, 0
buffer_load_dwordx4 v[16:19], v1, s[40:43], s66 offen offset:0 sc1
s_mul_i32 s71, s1, 24576
s_add_u32 s71, s71, s12
buffer_load_dwordx4 v[128:131], v150, s[40:43], s71 offen sc1
s_add_u32 s80, s66, 10240
s_add_u32 s86, s80, s84
buffer_load_dwordx4 v[20:23], v1, s[40:43], s66 offen offset:1024 sc1
buffer_load_dwordx4 v[24:27], v1, s[40:43], s66 offen offset:2048 sc1
buffer_load_dwordx4 v[28:31], v1, s[40:43], s66 offen offset:3072 sc1
s_add_u32 s69, s66, 4096
buffer_load_dwordx4 v[32:35], v1, s[40:43], s69 offen offset:0 sc1
buffer_load_dwordx4 v[36:39], v1, s[40:43], s69 offen offset:1024 sc1
buffer_load_dwordx4 v[40:43], v1, s[40:43], s69 offen offset:2048 sc1
buffer_load_dwordx4 v[44:47], v1, s[40:43], s69 offen offset:3072 sc1
s_add_u32 s69, s66, 8192
buffer_load_dwordx4 v[48:51], v1, s[40:43], s69 offen offset:0 sc1
buffer_load_dwordx4 v[52:55], v1, s[40:43], s69 offen offset:1024 sc1
buffer_load_dword v6, v5, s[36:39], 0 offen sc1
s_waitcnt vmcnt(12)
buffer_store_dword v8, v7, s[36:39], 0 offen
s_waitcnt vmcnt(1)
s_cmp_eq_u32 s68, 1
s_cbranch_scc1 K4_G0f
s_cmp_gt_u32 s64, 33
s_cbranch_scc1 L_FIN
K4_SW1f:
s_mov_b32 s75, 0
K4_SP1f:
buffer_load_dword v6, v5, s[36:39], 0 offen sc1
s_add_u32 s75, s75, 1
s_cmp_gt_u32 s75, 0x8000
s_cbranch_scc1 L_TIMEOUT
s_waitcnt vmcnt(0)
v_cmp_le_u32 vcc, s65, v6
s_nop 0
s_cmp_eq_u64 vcc, -1
s_cbranch_scc0 K4_SP1f
K4_LC1f:
s_mov_b32 s42, 0x4000000
buffer_load_dwordx4 v[16:19], v1, s[40:43], s66 offen offset:0 sc1
s_mul_i32 s71, s1, 24576
s_add_u32 s71, s71, s12
buffer_load_dwordx4 v[128:131], v150, s[40:43], s71 offen sc1
s_add_u32 s80, s66, 10240
s_add_u32 s86, s80, s84
buffer_load_dwordx4 v[20:23], v1, s[40:43], s66 offen offset:1024 sc1
buffer_load_dwordx4 v[24:27], v1, s[40:43], s66 offen offset:2048 sc1
buffer_load_dwordx4 v[28:31], v1, s[40:43], s66 offen offset:3072 sc1
s_add_u32 s69, s66, 4096
buffer_load_dwordx4 v[32:35], v1, s[40:43], s69 offen offset:0 sc1
buffer_load_dwordx4 v[36:39], v1, s[40:43], s69 offen offset:1024 sc1
buffer_load_dwordx4 v[40:43], v1, s[40:43], s69 offen offset:2048 sc1
buffer_load_dwordx4 v[44:47], v1, s[40:43], s69 offen offset:3072 sc1
s_add_u32 s69, s66, 8192
buffer_load_dwordx4 v[48:51], v1, s[40:43], s69 offen offset:0 sc1
buffer_load_dwordx4 v[52:55], v1, s[40:43], s69 offen offset:1024 sc1
buffer_load_dword v6, v5, s[36:39], 0 offen sc1
s_waitcnt vmcnt(0)
s_branch K4_G0f
K4_W1f:
s_mov_b32 s75, 6
s_cmp_lt_u32 s65, 36
s_cbranch_scc0 K4_W1fR
K4_W1fL:
buffer_load_dword v6, v5, s[36:39], 0 offen sc1
s_waitcnt vmcnt(0)
v_cmp_le_u32 vcc, s65, v6
s_nop 0
s_cmp_eq_u64 vcc, -1
s_cbranch_scc1 K4_W1fR
s_sub_u32 s75, s75, 1
s_cmp_lg_u32 s75, 0
s_cbranch_scc1 K4_W1fL
s_branch K4_W1fR
K4_E1f:
ds_write_b32 v151, v84 offset:27648
ds_write_b32 v151, v85 offset:27652
ds_write_b32 v151, v86 offset:28160
ds_write_b32 v151, v87 offset:28164
s_waitcnt lgkmcnt(0)
s_barrier
ds_read2st64_b64 v[104:107], v152 offset0:48 offset1:49
ds_read2st64_b64 v[108:111], v153 offset0:48 offset1:49
ds_read2st64_b64 v[112:115], v154 offset0:48 offset1:49
ds_read2st64_b64 v[116:119], v155 offset0:48 offset1:49
ds_read2st64_b64 v[120:123], v156 offset0:48 offset1:49
ds_read2st64_b64 v[124:127], v157 offset0:48 offset1:49
s_waitcnt lgkmcnt(4)
v_add_f32 v104, v104, v96
v_add_f32 v105, v105, v97
v_add_f32 v106, v106, v98
v_add_f32 v107, v107, v99
v_add_f32 v108, v108, v100
v_add_f32 v109, v109, v101
v_add_f32 v110, v110, v102
v_add_f32 v111, v111, v103
s_waitcnt lgkmcnt(0)
v_add_f32 v112, v112, v120
v_add_f32 v113, v113, v121
v_add_f32 v114, v114, v122
v_add_f32 v115, v115, v123
v_add_f32 v116, v116, v124
v_add_f32 v117, v117, v125
v_add_f32 v118, v118, v126
v_add_f32 v119, v119, v127
v_add_f32 v104, v104, v112
v_add_f32 v105, v105, v113
v_add_f32 v106, v106, v114
v_add_f32 v107, v107, v115
v_add_f32 v108, v108, v116
v_add_f32 v109, v109, v117
v_add_f32 v110, v110, v118
v_add_f32 v111, v111, v119
v_cvt_pk_bf16_f32 v140, v104, v105
v_cvt_pk_bf16_f32 v141, v106, v107
v_cvt_pk_bf16_f32 v142, v108, v109
v_cvt_pk_bf16_f32 v143, v110, v111
buffer_store_dwordx4 v[140:143], v148, s[44:47], s67 offen
s_branch L_FIN
K4_G0f:
v_lshlrev_b32 v132, 16, v128
v_and_b32 v133, 0xffff0000, v128
v_lshlrev_b32 v134, 16, v129
v_and_b32 v135, 0xffff0000, v129
v_lshlrev_b32 v136, 16, v130
v_and_b32 v137, 0xffff0000, v130
v_lshlrev_b32 v138, 16, v131
v_and_b32 v139, 0xffff0000, v131
v_mfma_f32_16x16x32_bf16 v[72:75], a[0:3], v[16:19], 0
buffer_load_dword v6, v5, s[36:39], 0 offen sc1
v_mfma_f32_16x16x32_bf16 v[72:75], a[24:27], v[20:23], v[72:75]
ds_write_b32 v151, v84 offset:27648
v_mfma_f32_16x16x32_bf16 v[72:75], a[48:51], v[24:27], v[72:75]
buffer_load_dwordx4 v[56:59], v1, s[36:39], s80 offen offset:0 sc1
v_mfma_f32_16x16x32_bf16 v[72:75], a[72:75], v[28:31], v[72:75]
s_waitcnt vmcnt(4)
ds_write_b32 v151, v85 offset:27652
v_mfma_f32_16x16x32_bf16 v[76:79], a[4:7], v[16:19], 0
buffer_store_dword v8, v7, s[36:39], 0 offen
v_mfma_f32_16x16x32_bf16 v[76:79], a[28:31], v[20:23], v[76:79]
ds_write_b32 v151, v86 offset:28160
v_mfma_f32_16x16x32_bf16 v[76:79], a[52:55], v[24:27], v[76:79]
ds_write_b32 v151, v87 offset:28164
v_mfma_f32_16x16x32_bf16 v[76:79], a[76:79], v[28:31], v[76:79]
buffer_load_dwordx4 v[60:63], v1, s[36:39], s80 offen offset:1024 sc1
v_mfma_f32_16x16x32_bf16 v[80:83], a[8:11], v[16:19], 0
v_add_u32 v8, s79, v11
v_mfma_f32_16x16x32_bf16 v[80:83], a[32:35], v[20:23], v[80:83]
s_waitcnt lgkmcnt(0)
v_mfma_f32_16x16x32_bf16 v[80:83], a[56:59], v[24:27], v[80:83]
s_branch K4_B0f
K4_G1f:
v_lshlrev_b32 v132, 16, v128
v_and_b32 v133, 0xffff0000, v128
v_lshlrev_b32 v134, 16, v129
v_and_b32 v135, 0xffff0000, v129
v_lshlrev_b32 v136, 16, v130
v_and_b32 v137, 0xffff0000, v130
v_lshlrev_b32 v138, 16, v131
v_and_b32 v139, 0xffff0000, v131
v_mfma_f32_16x16x32_bf16 v[72:75], a[0:3], v[16:19], 0
buffer_load_dword v6, v5, s[36:39], 0 offen sc1
v_mfma_f32_16x16x32_bf16 v[72:75], a[24:27], v[20:23], v[72:75]
ds_write_b32 v151, v84 offset:3072
v_mfma_f32_16x16x32_bf16 v[72:75], a[48:51], v[24:27], v[72:75]
buffer_load_dwordx4 v[56:59], v1, s[36:39], s80 offen offset:0 sc1
v_mfma_f32_16x16x32_bf16 v[72:75], a[72:75], v[28:31], v[72:75]
s_waitcnt vmcnt(4)
ds_write_b32 v151, v85 offset:3076
v_mfma_f32_16x16x32_bf16 v[76:79], a[4:7], v[16:19], 0
buffer_store_dword v8, v7, s[36:39], 0 offen
v_mfma_f32_16x16x32_bf16 v[76:79], a[28:31], v[20:23], v[76:79]
ds_write_b32 v151, v86 offset:3584
v_mfma_f32_16x16x32_bf16 v[76:79], a[52:55], v[24:27], v[76:79]
ds_write_b32 v151, v87 offset:3588
v_mfma_f32_16x16x32_bf16 v[76:79], a[76:79], v[28:31], v[76:79]
buffer_load_dwordx4 v[60:63], v1, s[36:39], s80 offen offset:1024 sc1
v_mfma_f32_16x16x32_bf16 v[80:83], a[8:11], v[16:19], 0
v_add_u32 v8, s79, v11
v_mfma_f32_16x16x32_bf16 v[80:83], a[32:35], v[20:23], v[80:83]
s_waitcnt lgkmcnt(0)
v_mfma_f32_16x16x32_bf16 v[80:83], a[56:59], v[24:27], v[80:83]
s_branch K4_B1f
.p2align 6
K4_F0g:
v_mfma_f32_16x16x32_bf16 v[72:75], a[0:3], v[16:19], 0
buffer_load_dword v6, v5, s[36:39], 0 offen sc1
v_mfma_f32_16x16x32_bf16 v[72:75], a[24:27], v[20:23], v[72:75]
ds_write_b32 v151, v84 offset:27648
v_mfma_f32_16x16x32_bf16 v[72:75], a[48:51], v[24:27], v[72:75]
buffer_load_dwordx4 v[56:59], v1, s[36:39], s80 offen offset:0 sc1
v_mfma_f32_16x16x32_bf16 v[72:75], a[72:75], v[28:31], v[72:75]
ds_write_b32 v151, v85 offset:27652
v_mfma_f32_16x16x32_bf16 v[76:79], a[4:7], v[16:19], 0
ds_write_b32 v151, v86 offset:28160
v_mfma_f32_16x16x32_bf16 v[76:79], a[28:31], v[20:23], v[76:79]
ds_write_b32 v151, v87 offset:28164
v_mfma_f32_16x16x32_bf16 v[76:79], a[52:55], v[24:27], v[76:79]
v_add_u32 v8, s79, v11
v_mfma_f32_16x16x32_bf16 v[76:79], a[76:79], v[28:31], v[76:79]
buffer_load_dwordx4 v[60:63], v1, s[36:39], s80 offen offset:1024 sc1
v_mfma_f32_16x16x32_bf16 v[80:83], a[8:11], v[16:19], 0
s_waitcnt lgkmcnt(0)
v_mfma_f32_16x16x32_bf16 v[80:83], a[32:35], v[20:23], v[80:83]
s_barrier
K4_B0g:
v_mfma_f32_16x16x32_bf16 v[80:83], a[56:59], v[24:27], v[80:83]
buffer_store_dword v8, v7, s[36:39], 0 offen
v_mfma_f32_16x16x32_bf16 v[80:83], a[80:83], v[28:31], v[80:83]
s_add_u32 s13, s64, 1
ds_read2st64_b64 v[104:107], v152 offset0:48 offset1:49
s_cmp_eq_u32 s13, 17
v_mfma_f32_16x16x32_bf16 v[84:87], a[12:15], v[16:19], 0
buffer_load_dwordx4 v[64:67], v1, s[36:39], s80 offen offset:2048 sc1
v_mfma_f32_16x16x32_bf16 v[84:87], a[36:39], v[20:23], v[84:87]
s_addc_u32 s13, s13, 0
ds_read2st64_b64 v[108:111], v153 offset0:48 offset1:49
s_sub_u32 s1, s13, 17
v_mfma_f32_16x16x32_bf16 v[84:87], a[60:63], v[24:27], v[84:87]
s_cselect_b32 s1, s13, s1
ds_read2st64_b64 v[112:115], v154 offset0:48 offset1:49
s_and_b32 s66, s13, 7
v_mfma_f32_16x16x32_bf16 v[84:87], a[84:87], v[28:31], v[84:87]
s_mul_i32 s66, s66, 55296
ds_read2st64_b64 v[116:119], v155 offset0:48 offset1:49
s_add_u32 s66, s66, s10
v_mfma_f32_16x16x32_bf16 v[88:91], a[16:19], v[16:19], v[132:135]
s_add_u32 s65, s13, 2
ds_read2st64_b64 v[120:123], v156 offset0:48 offset1:49
v_mfma_f32_16x16x32_bf16 v[88:91], a[40:43], v[20:23], v[88:91]
buffer_load_dwordx4 v[68:71], v1, s[36:39], s86 offen offset:3072 sc1
v_mfma_f32_16x16x32_bf16 v[88:91], a[64:67], v[24:27], v[88:91]
ds_read2st64_b64 v[124:127], v157 offset0:48 offset1:49
v_mfma_f32_16x16x32_bf16 v[88:91], a[88:91], v[28:31], v[88:91]
v_mfma_f32_16x16x32_bf16 v[92:95], a[20:23], v[16:19], v[136:139]
s_waitcnt vmcnt(5)
v_cmp_le_u32 vcc, s65, v6
s_waitcnt lgkmcnt(4)
v_mfma_f32_16x16x32_bf16 v[92:95], a[44:47], v[20:23], v[92:95]
s_cmp_eq_u64 vcc, -1
v_add_f32 v104, v104, v96
v_add_f32 v105, v105, v97
v_mfma_f32_16x16x32_bf16 v[92:95], a[68:71], v[24:27], v[92:95]
s_cbranch_scc0 K4_W0g
K4_W0gR:
s_cselect_b32 s68, 1, 0
v_mfma_f32_16x16x32_bf16 v[92:95], a[92:95], v[28:31], v[92:95]
s_waitcnt vmcnt(9)
s_cselect_b32 s42, 0x4000000, 0
v_add_f32 v106, v106, v98
v_mfma_f32_16x16x32_bf16 v[72:75], a[96:99], v[32:35], v[72:75]
buffer_load_dwordx4 v[16:19], v1, s[40:43], s66 offen offset:0 sc1
v_mfma_f32_16x16x32_bf16 v[72:75], a[120:123], v[36:39], v[72:75]
s_mul_i32 s71, s1, 24576
s_add_u32 s71, s71, s12
v_add_f32 v107, v107, v99
v_mfma_f32_16x16x32_bf16 v[72:75], a[144:147], v[40:43], v[72:75]
v_add_f32 v108, v108, v100
v_add_f32 v109, v109, v101
v_mfma_f32_16x16x32_bf16 v[76:79], a[100:103], v[32:35], v[76:79]
buffer_load_dwordx4 v[128:131], v150, s[40:43], s71 offen sc1
v_mfma_f32_16x16x32_bf16 v[76:79], a[124:127], v[36:39], v[76:79]
s_add_u32 s80, s66, 10240
s_add_u32 s86, s80, s84
v_add_f32 v110, v110, v102
v_mfma_f32_16x16x32_bf16 v[76:79], a[148:151], v[40:43], v[76:79]
v_add_f32 v111, v111, v103
s_waitcnt lgkmcnt(0)
v_mfma_f32_16x16x32_bf16 v[80:83], a[104:107], v[32:35], v[80:83]
buffer_load_dwordx4 v[20:23], v1, s[40:43], s66 offen offset:1024 sc1
v_mfma_f32_16x16x32_bf16 v[80:83], a[128:131], v[36:39], v[80:83]
v_add_f32 v112, v112, v120
v_add_f32 v113, v113, v121
v_mfma_f32_16x16x32_bf16 v[80:83], a[152:155], v[40:43], v[80:83]
v_add_f32 v114, v114, v122
v_add_f32 v115, v115, v123
v_mfma_f32_16x16x32_bf16 v[84:87], a[108:111], v[32:35], v[84:87]
v_add_f32 v116, v116, v124
v_add_f32 v117, v117, v125
v_mfma_f32_16x16x32_bf16 v[84:87], a[132:135], v[36:39], v[84:87]
v_add_f32 v118, v118, v126
v_add_f32 v119, v119, v127
v_mfma_f32_16x16x32_bf16 v[84:87], a[156:159], v[40:43], v[84:87]
v_add_f32 v104, v104, v112
v_add_f32 v105, v105, v113
v_mfma_f32_16x16x32_bf16 v[88:91], a[112:115], v[32:35], v[88:91]
buffer_load_dwordx4 v[24:27], v1, s[40:43], s66 offen offset:2048 sc1
v_mfma_f32_16x16x32_bf16 v[88:91], a[136:139], v[36:39], v[88:91]
v_add_f32 v106, v106, v114
v_add_f32 v107, v107, v115
v_mfma_f32_16x16x32_bf16 v[88:91], a[160:163], v[40:43], v[88:91]
v_add_f32 v108, v108, v116
v_add_f32 v109, v109, v117
v_mfma_f32_16x16x32_bf16 v[92:95], a[116:119], v[32:35], v[92:95]
v_add_f32 v110, v110, v118
v_add_f32 v111, v111, v119
v_mfma_f32_16x16x32_bf16 v[92:95], a[140:143], v[36:39], v[92:95]
v_cvt_pk_bf16_f32 v140, v104, v105
v_cvt_pk_bf16_f32 v141, v106, v107
v_mfma_f32_16x16x32_bf16 v[92:95], a[164:167], v[40:43], v[92:95]
s_waitcnt vmcnt(10)
v_cvt_pk_bf16_f32 v142, v108, v109
v_cvt_pk_bf16_f32 v143, v110, v111
v_mfma_f32_16x16x32_bf16 v[72:75], a[168:171], v[44:47], v[72:75]
buffer_load_dwordx4 v[28:31], v1, s[40:43], s66 offen offset:3072 sc1
v_mfma_f32_16x16x32_bf16 v[72:75], a[192:195], v[48:51], v[72:75]
buffer_store_dwordx4 v[140:143], v148, s[44:47], s67 offen
v_mfma_f32_16x16x32_bf16 v[72:75], a[216:219], v[52:55], v[72:75]
s_add_u32 s69, s66, 4096
v_mfma_f32_16x16x32_bf16 v[76:79], a[172:175], v[44:47], v[76:79]
v_mfma_f32_16x16x32_bf16 v[76:79], a[196:199], v[48:51], v[76:79]
buffer_load_dwordx4 v[32:35], v1, s[40:43], s69 offen offset:0 sc1
v_mfma_f32_16x16x32_bf16 v[76:79], a[220:223], v[52:55], v[76:79]
v_mfma_f32_16x16x32_bf16 v[80:83], a[176:179], v[44:47], v[80:83]
v_mfma_f32_16x16x32_bf16 v[80:83], a[200:203], v[48:51], v[80:83]
v_mfma_f32_16x16x32_bf16 v[80:83], a[224:227], v[52:55], v[80:83]
v_mfma_f32_16x16x32_bf16 v[84:87], a[180:183], v[44:47], v[84:87]
buffer_load_dwordx4 v[36:39], v1, s[40:43], s69 offen offset:1024 sc1
v_mfma_f32_16x16x32_bf16 v[84:87], a[204:207], v[48:51], v[84:87]
s_waitcnt vmcnt(6)
v_lshlrev_b32 v132, 16, v128
v_and_b32 v133, 0xffff0000, v128
v_mfma_f32_16x16x32_bf16 v[84:87], a[228:231], v[52:55], v[84:87]
v_lshlrev_b32 v134, 16, v129
v_and_b32 v135, 0xffff0000, v129
v_mfma_f32_16x16x32_bf16 v[88:91], a[184:187], v[44:47], v[88:91]
v_lshlrev_b32 v136, 16, v130
v_and_b32 v137, 0xffff0000, v130
v_mfma_f32_16x16x32_bf16 v[88:91], a[208:211], v[48:51], v[88:91]
v_lshlrev_b32 v138, 16, v131
v_and_b32 v139, 0xffff0000, v131
v_mfma_f32_16x16x32_bf16 v[88:91], a[232:235], v[52:55], v[88:91]
buffer_load_dwordx4 v[40:43], v1, s[40:43], s69 offen offset:2048 sc1
v_mfma_f32_16x16x32_bf16 v[92:95], a[188:191], v[44:47], v[92:95]
v_mfma_f32_16x16x32_bf16 v[92:95], a[212:215], v[48:51], v[92:95]
v_mfma_f32_16x16x32_bf16 v[92:95], a[236:239], v[52:55], v[92:95]
s_waitcnt vmcnt(9)
v_mfma_f32_16x16x32_bf16 v[72:75], a[240:243], v[56:59], v[72:75]
buffer_load_dwordx4 v[44:47], v1, s[40:43], s69 offen offset:3072 sc1
v_mfma_f32_16x16x32_bf16 v[72:75], v[196:199], v[60:63], v[72:75]
s_add_u32 s69, s66, 8192
v_mfma_f32_16x16x32_bf16 v[72:75], v[220:223], v[64:67], v[72:75]
v_mfma_f32_16x16x32_bf16 v[72:75], v[244:247], v[68:71], v[72:75]
buffer_load_dwordx4 v[48:51], v1, s[40:43], s69 offen offset:0 sc1
v_mfma_f32_16x16x32_bf16 v[76:79], a[244:247], v[56:59], v[76:79]
s_mul_i32 s67, s0, s100
s_add_u32 s67, s67, s11
s_mov_b32 s46, s74
v_mfma_f32_16x16x32_bf16 v[76:79], v[200:203], v[60:63], v[76:79]
s_add_u32 s79, s64, 19
s_mov_b32 s62, s81
s_mov_b32 s64, s13
v_mfma_f32_16x16x32_bf16 v[76:79], v[224:227], v[64:67], v[76:79]
s_mov_b32 s0, s1
ds_write_b32 v151, v72 offset:0
v_mfma_f32_16x16x32_bf16 v[76:79], v[248:251], v[68:71], v[76:79]
buffer_load_dwordx4 v[52:55], v1, s[40:43], s69 offen offset:1024 sc1
v_mfma_f32_16x16x32_bf16 v[80:83], a[248:251], v[56:59], v[80:83]
s_cmp_eq_u32 s68, 0
ds_write_b32 v151, v73 offset:4
v_mfma_f32_16x16x32_bf16 v[80:83], v[204:207], v[60:63], v[80:83]
ds_write_b32 v151, v74 offset:512
v_mfma_f32_16x16x32_bf16 v[80:83], v[228:231], v[64:67], v[80:83]
ds_write_b32 v151, v75 offset:516
v_mfma_f32_16x16x32_bf16 v[80:83], v[252:255], v[68:71], v[80:83]
ds_write_b32 v151, v76 offset:1024
v_mfma_f32_16x16x32_bf16 v[84:87], a[252:255], v[56:59], v[84:87]
ds_write_b32 v151, v77 offset:1028
v_mfma_f32_16x16x32_bf16 v[84:87], v[208:211], v[60:63], v[84:87]
ds_write_b32 v151, v78 offset:1536
v_mfma_f32_16x16x32_bf16 v[84:87], v[232:235], v[64:67], v[84:87]
ds_write_b32 v151, v79 offset:1540
v_mfma_f32_16x16x32_bf16 v[88:91], v[188:191], v[56:59], v[88:91]
ds_write_b32 v151, v80 offset:2048
v_mfma_f32_16x16x32_bf16 v[88:91], v[212:215], v[60:63], v[88:91]
ds_write_b32 v151, v81 offset:2052
v_mfma_f32_16x16x32_bf16 v[88:91], v[236:239], v[64:67], v[88:91]
ds_write_b32 v151, v82 offset:2560
v_mfma_f32_16x16x32_bf16 v[92:95], v[192:195], v[56:59], v[92:95]
ds_write_b32 v151, v83 offset:2564
v_mfma_f32_16x16x32_bf16 v[92:95], v[216:219], v[60:63], v[92:95]
s_waitcnt vmcnt(7)
v_mfma_f32_16x16x32_bf16 v[92:95], v[240:243], v[64:67], v[92:95]
s_cbranch_scc1 K4_X0g
K4_F1g:
v_mfma_f32_16x16x32_bf16 v[72:75], a[0:3], v[16:19], 0
buffer_load_dword v6, v5, s[36:39], 0 offen sc1
v_mfma_f32_16x16x32_bf16 v[72:75], a[24:27], v[20:23], v[72:75]
ds_write_b32 v151, v84 offset:3072
v_mfma_f32_16x16x32_bf16 v[72:75], a[48:51], v[24:27], v[72:75]
buffer_load_dwordx4 v[56:59], v1, s[36:39], s80 offen offset:0 sc1
v_mfma_f32_16x16x32_bf16 v[72:75], a[72:75], v[28:31], v[72:75]
ds_write_b32 v151, v85 offset:3076
v_mfma_f32_16x16x32_bf16 v[76:79], a[4:7], v[16:19], 0
ds_write_b32 v151, v86 offset:3584
v_mfma_f32_16x16x32_bf16 v[76:79], a[28:31], v[20:23], v[76:79]
ds_write_b32 v151, v87 offset:3588
v_mfma_f32_16x16x32_bf16 v[76:79], a[52:55], v[24:27], v[76:79]
v_add_u32 v8, s79, v11
v_mfma_f32_16x16x32_bf16 v[76:79], a[76:79], v[28:31], v[76:79]
buffer_load_dwordx4 v[60:63], v1, s[36:39], s80 offen offset:1024 sc1
v_mfma_f32_16x16x32_bf16 v[80:83], a[8:11], v[16:19], 0
s_waitcnt lgkmcnt(0)
v_mfma_f32_16x16x32_bf16 v[80:83], a[32:35], v[20:23], v[80:83]
s_barrier
K4_B1g:
v_mfma_f32_16x16x32_bf16 v[80:83], a[56:59], v[24:27], v[80:83]
buffer_store_dword v8, v7, s[36:39], 0 offen
v_mfma_f32_16x16x32_bf16 v[80:83], a[80:83], v[28:31], v[80:83]
s_add_u32 s13, s64, 1
ds_read2st64_b64 v[104:107], v152 offset0:0 offset1:1
s_cmp_eq_u32 s13, 17
v_mfma_f32_16x16x32_bf16 v[84:87], a[12:15], v[16:19], 0
buffer_load_dwordx4 v[64:67], v1, s[36:39], s80 offen offset:2048 sc1
v_mfma_f32_16x16x32_bf16 v[84:87], a[36:39], v[20:23], v[84:87]
s_addc_u32 s13, s13, 0
ds_read2st64_b64 v[108:111], v153 offset0:0 offset1:1
s_sub_u32 s1, s13, 17
v_mfma_f32_16x16x32_bf16 v[84:87], a[60:63], v[24:27], v[84:87]
s_cselect_b32 s1, s13, s1
ds_read2st64_b64 v[112:115], v154 offset0:0 offset1:1
s_and_b32 s66, s13, 7
v_mfma_f32_16x16x32_bf16 v[84:87], a[84:87], v[28:31], v[84:87]
s_mul_i32 s66, s66, 55296
ds_read2st64_b64 v[116:119], v155 offset0:0 offset1:1
s_add_u32 s66, s66, s10
v_mfma_f32_16x16x32_bf16 v[96:99], a[16:19], v[16:19], v[132:135]
s_add_u32 s65, s13, 2
ds_read2st64_b64 v[120:123], v156 offset0:0 offset1:1
v_mfma_f32_16x16x32_bf16 v[96:99], a[40:43], v[20:23], v[96:99]
buffer_load_dwordx4 v[68:71], v1, s[36:39], s86 offen offset:3072 sc1
v_mfma_f32_16x16x32_bf16 v[96:99], a[64:67], v[24:27], v[96:99]
ds_read2st64_b64 v[124:127], v157 offset0:0 offset1:1
v_mfma_f32_16x16x32_bf16 v[96:99], a[88:91], v[28:31], v[96:99]
v_mfma_f32_16x16x32_bf16 v[100:103], a[20:23], v[16:19], v[136:139]
s_waitcnt vmcnt(5)
v_cmp_le_u32 vcc, s65, v6
s_waitcnt lgkmcnt(4)
v_mfma_f32_16x16x32_bf16 v[100:103], a[44:47], v[20:23], v[100:103]
s_cmp_eq_u64 vcc, -1
v_add_f32 v104, v104, v88
v_add_f32 v105, v105, v89
v_mfma_f32_16x16x32_bf16 v[100:103], a[68:71], v[24:27], v[100:103]
s_cbranch_scc0 K4_W1g
K4_W1gR:
s_cselect_b32 s68, 1, 0
v_mfma_f32_16x16x32_bf16 v[100:103], a[92:95], v[28:31], v[100:103]
s_waitcnt vmcnt(9)
s_cselect_b32 s42, 0x4000000, 0
v_add_f32 v106, v106, v90
v_mfma_f32_16x16x32_bf16 v[72:75], a[96:99], v[32:35], v[72:75]
buffer_load_dwordx4 v[16:19], v1, s[40:43], s66 offen offset:0 sc1
v_mfma_f32_16x16x32_bf16 v[72:75], a[120:123], v[36:39], v[72:75]
s_mul_i32 s71, s1, 24576
s_add_u32 s71, s71, s12
v_add_f32 v107, v107, v91
v_mfma_f32_16x16x32_bf16 v[72:75], a[144:147], v[40:43], v[72:75]
v_add_f32 v108, v108, v92
v_add_f32 v109, v109, v93
v_mfma_f32_16x16x32_bf16 v[76:79], a[100:103], v[32:35], v[76:79]
buffer_load_dwordx4 v[128:131], v150, s[40:43], s71 offen sc1
v_mfma_f32_16x16x32_bf16 v[76:79], a[124:127], v[36:39], v[76:79]
s_add_u32 s80, s66, 10240
s_add_u32 s86, s80, s84
v_add_f32 v110, v110, v94
v_mfma_f32_16x16x32_bf16 v[76:79], a[148:151], v[40:43], v[76:79]
v_add_f32 v111, v111, v95
s_waitcnt lgkmcnt(0)
v_mfma_f32_16x16x32_bf16 v[80:83], a[104:107], v[32:35], v[80:83]
buffer_load_dwordx4 v[20:23], v1, s[40:43], s66 offen offset:1024 sc1
v_mfma_f32_16x16x32_bf16 v[80:83], a[128:131], v[36:39], v[80:83]
v_add_f32 v112, v112, v120
v_add_f32 v113, v113, v121
v_mfma_f32_16x16x32_bf16 v[80:83], a[152:155], v[40:43], v[80:83]
v_add_f32 v114, v114, v122
v_add_f32 v115, v115, v123
v_mfma_f32_16x16x32_bf16 v[84:87], a[108:111], v[32:35], v[84:87]
v_add_f32 v116, v116, v124
v_add_f32 v117, v117, v125
v_mfma_f32_16x16x32_bf16 v[84:87], a[132:135], v[36:39], v[84:87]
v_add_f32 v118, v118, v126
v_add_f32 v119, v119, v127
v_mfma_f32_16x16x32_bf16 v[84:87], a[156:159], v[40:43], v[84:87]
v_add_f32 v104, v104, v112
v_add_f32 v105, v105, v113
v_mfma_f32_16x16x32_bf16 v[96:99], a[112:115], v[32:35], v[96:99]
buffer_load_dwordx4 v[24:27], v1, s[40:43], s66 offen offset:2048 sc1
v_mfma_f32_16x16x32_bf16 v[96:99], a[136:139], v[36:39], v[96:99]
v_add_f32 v106, v106, v114
v_add_f32 v107, v107, v115
v_mfma_f32_16x16x32_bf16 v[96:99], a[160:163], v[40:43], v[96:99]
v_add_f32 v108, v108, v116
v_add_f32 v109, v109, v117
v_mfma_f32_16x16x32_bf16 v[100:103], a[116:119], v[32:35], v[100:103]
v_add_f32 v110, v110, v118
v_add_f32 v111, v111, v119
v_mfma_f32_16x16x32_bf16 v[100:103], a[140:143], v[36:39], v[100:103]
v_cvt_pk_bf16_f32 v140, v104, v105
v_cvt_pk_bf16_f32 v141, v106, v107
v_mfma_f32_16x16x32_bf16 v[100:103], a[164:167], v[40:43], v[100:103]
s_waitcnt vmcnt(10)
v_cvt_pk_bf16_f32 v142, v108, v109
v_cvt_pk_bf16_f32 v143, v110, v111
v_mfma_f32_16x16x32_bf16 v[72:75], a[168:171], v[44:47], v[72:75]
buffer_load_dwordx4 v[28:31], v1, s[40:43], s66 offen offset:3072 sc1
v_mfma_f32_16x16x32_bf16 v[72:75], a[192:195], v[48:51], v[72:75]
buffer_store_dwordx4 v[140:143], v148, s[44:47], s67 offen
v_mfma_f32_16x16x32_bf16 v[72:75], a[216:219], v[52:55], v[72:75]
s_add_u32 s69, s66, 4096
v_mfma_f32_16x16x32_bf16 v[76:79], a[172:175], v[44:47], v[76:79]
v_mfma_f32_16x16x32_bf16 v[76:79], a[196:199], v[48:51], v[76:79]
buffer_load_dwordx4 v[32:35], v1, s[40:43], s69 offen offset:0 sc1
v_mfma_f32_16x16x32_bf16 v[76:79], a[220:223], v[52:55], v[76:79]
v_mfma_f32_16x16x32_bf16 v[80:83], a[176:179], v[44:47], v[80:83]
v_mfma_f32_16x16x32_bf16 v[80:83], a[200:203], v[48:51], v[80:83]
v_mfma_f32_16x16x32_bf16 v[80:83], a[224:227], v[52:55], v[80:83]
v_mfma_f32_16x16x32_bf16 v[84:87], a[180:183], v[44:47], v[84:87]
buffer_load_dwordx4 v[36:39], v1, s[40:43], s69 offen offset:1024 sc1
v_mfma_f32_16x16x32_bf16 v[84:87], a[204:207], v[48:51], v[84:87]
s_waitcnt vmcnt(6)
v_lshlrev_b32 v132, 16, v128
v_and_b32 v133, 0xffff0000, v128
v_mfma_f32_16x16x32_bf16 v[84:87], a[228:231], v[52:55], v[84:87]
v_lshlrev_b32 v134, 16, v129
v_and_b32 v135, 0xffff0000, v129
v_mfma_f32_16x16x32_bf16 v[96:99], a[184:187], v[44:47], v[96:99]
v_lshlrev_b32 v136, 16, v130
v_and_b32 v137, 0xffff0000, v130
v_mfma_f32_16x16x32_bf16 v[96:99], a[208:211], v[48:51], v[96:99]
v_lshlrev_b32 v138, 16, v131
v_and_b32 v139, 0xffff0000, v131
v_mfma_f32_16x16x32_bf16 v[96:99], a[232:235], v[52:55], v[96:99]
buffer_load_dwordx4 v[40:43], v1, s[40:43], s69 offen offset:2048 sc1
v_mfma_f32_16x16x32_bf16 v[100:103], a[188:191], v[44:47], v[100:103]
v_mfma_f32_16x16x32_bf16 v[100:103], a[212:215], v[48:51], v[100:103]
v_mfma_f32_16x16x32_bf16 v[100:103], a[236:239], v[52:55], v[100:103]
s_waitcnt vmcnt(9)
v_mfma_f32_16x16x32_bf16 v[72:75], a[240:243], v[56:59], v[72:75]
buffer_load_dwordx4 v[44:47], v1, s[40:43], s69 offen offset:3072 sc1
v_mfma_f32_16x16x32_bf16 v[72:75], v[196:199], v[60:63], v[72:75]
s_add_u32 s69, s66, 8192
v_mfma_f32_16x16x32_bf16 v[72:75], v[220:223], v[64:67], v[72:75]
v_mfma_f32_16x16x32_bf16 v[72:75], v[244:247], v[68:71], v[72:75]
buffer_load_dwordx4 v[48:51], v1, s[40:43], s69 offen offset:0 sc1
v_mfma_f32_16x16x32_bf16 v[76:79], a[244:247], v[56:59], v[76:79]
s_mul_i32 s67, s0, s100
s_add_u32 s67, s67, s11
s_mov_b32 s46, s74
v_mfma_f32_16x16x32_bf16 v[76:79], v[200:203], v[60:63], v[76:79]
s_add_u32 s79, s64, 19
s_mov_b32 s62, s81
s_mov_b32 s64, s13
v_mfma_f32_16x16x32_bf16 v[76:79], v[224:227], v[64:67], v[76:79]
s_mov_b32 s0, s1
ds_write_b32 v151, v72 offset:24576
v_mfma_f32_16x16x32_bf16 v[76:79], v[248:251], v[68:71], v[76:79]
buffer_load_dwordx4 v[52:55], v1, s[40:43], s69 offen offset:1024 sc1
v_mfma_f32_16x16x32_bf16 v[80:83], a[248:251], v[56:59], v[80:83]
s_cmp_eq_u32 s68, 0
ds_write_b32 v151, v73 offset:24580
v_mfma_f32_16x16x32_bf16 v[80:83], v[204:207], v[60:63], v[80:83]
ds_write_b32 v151, v74 offset:25088
v_mfma_f32_16x16x32_bf16 v[80:83], v[228:231], v[64:67], v[80:83]
ds_write_b32 v151, v75 offset:25092
v_mfma_f32_16x16x32_bf16 v[80:83], v[252:255], v[68:71], v[80:83]
ds_write_b32 v151, v76 offset:25600
v_mfma_f32_16x16x32_bf16 v[84:87], a[252:255], v[56:59], v[84:87]
ds_write_b32 v151, v77 offset:25604
v_mfma_f32_16x16x32_bf16 v[84:87], v[208:211], v[60:63], v[84:87]
ds_write_b32 v151, v78 offset:26112
v_mfma_f32_16x16x32_bf16 v[84:87], v[232:235], v[64:67], v[84:87]
ds_write_b32 v151, v79 offset:26116
v_mfma_f32_16x16x32_bf16 v[96:99], v[188:191], v[56:59], v[96:99]
ds_write_b32 v151, v80 offset:26624
v_mfma_f32_16x16x32_bf16 v[96:99], v[212:215], v[60:63], v[96:99]
ds_write_b32 v151, v81 offset:26628
v_mfma_f32_16x16x32_bf16 v[96:99], v[236:239], v[64:67], v[96:99]
ds_write_b32 v151, v82 offset:27136
v_mfma_f32_16x16x32_bf16 v[100:103], v[192:195], v[56:59], v[100:103]
ds_write_b32 v151, v83 offset:27140
v_mfma_f32_16x16x32_bf16 v[100:103], v[216:219], v[60:63], v[100:103]
s_waitcnt vmcnt(7)
v_mfma_f32_16x16x32_bf16 v[100:103], v[240:243], v[64:67], v[100:103]
s_cbranch_scc1 K4_X1g
s_branch K4_F0g
K4_X0g:
s_cmp_lg_u32 s64, 19
s_cbranch_scc1 K4_NR0g
s_mov_b32 s44, s30
s_mov_b32 s45, s31
s_mov_b32 s74, 2621440
s_mov_b32 s46, s74
s_mov_b32 s81, 0
s_mov_b32 s62, 0
s_mov_b32 s100, 40960
s_mov_b32 s11, 4294926336
s_mov_b32 s67, 0
v_mov_b32 v148, v158
s_waitcnt vmcnt(0)
buffer_store_dword v8, v7, s[36:39], 0 offen
s_mov_b32 s7, 0x7ff00000
s_nop 1
v_writelane_b32 v7, s7, 0
s_cmp_eq_u32 s68, 1
s_cbranch_scc1 K4_F1g
s_branch K4_NR0g
K4_NR0g:
s_cmp_gt_u32 s64, 33
s_cbranch_scc1 K4_E0g
buffer_load_dword v6, v5, s[36:39], 0 offen sc1
ds_write_b32 v151, v84 offset:3072
ds_write_b32 v151, v85 offset:3076
ds_write_b32 v151, v86 offset:3584
ds_write_b32 v151, v87 offset:3588
s_waitcnt lgkmcnt(0)
s_barrier
ds_read2st64_b64 v[104:107], v152 offset0:0 offset1:1
ds_read2st64_b64 v[108:111], v153 offset0:0 offset1:1
ds_read2st64_b64 v[112:115], v154 offset0:0 offset1:1
ds_read2st64_b64 v[116:119], v155 offset0:0 offset1:1
ds_read2st64_b64 v[120:123], v156 offset0:0 offset1:1
ds_read2st64_b64 v[124:127], v157 offset0:0 offset1:1
s_waitcnt vmcnt(0)
buffer_store_dword v8, v7, s[36:39], 0 offen
v_cmp_le_u32 vcc, s65, v6
s_nop 0
s_cmp_eq_u64 vcc, -1
s_cselect_b32 s68, 1, 0
s_cselect_b32 s42, 0x4000000, 0
buffer_load_dwordx4 v[16:19], v1, s[40:43], s66 offen offset:0 sc1
s_mul_i32 s71, s1, 24576
s_add_u32 s71, s71, s12
buffer_load_dwordx4 v[128:131], v150, s[40:43], s71 offen sc1
s_add_u32 s80, s66, 10240
s_add_u32 s86, s80, s84
buffer_load_dwordx4 v[20:23], v1, s[40:43], s66 offen offset:1024 sc1
buffer_load_dwordx4 v[24:27], v1, s[40:43], s66 offen offset:2048 sc1
buffer_load_dwordx4 v[28:31], v1, s[40:43], s66 offen offset:3072 sc1
s_add_u32 s69, s66, 4096
buffer_load_dwordx4 v[32:35], v1, s[40:43], s69 offen offset:0 sc1
buffer_load_dwordx4 v[36:39], v1, s[40:43], s69 offen offset:1024 sc1
buffer_load_dwordx4 v[40:43], v1, s[40:43], s69 offen offset:2048 sc1
buffer_load_dwordx4 v[44:47], v1, s[40:43], s69 offen offset:3072 sc1
s_add_u32 s69, s66, 8192
buffer_load_dwordx4 v[48:51], v1, s[40:43], s69 offen offset:0 sc1
buffer_load_dwordx4 v[52:55], v1, s[40:43], s69 offen offset:1024 sc1
buffer_load_dword v6, v5, s[36:39], 0 offen sc1
s_waitcnt lgkmcnt(4)
v_add_f32 v104, v104, v88
v_add_f32 v105, v105, v89
v_add_f32 v106, v106, v90
v_add_f32 v107, v107, v91
v_add_f32 v108, v108, v92
v_add_f32 v109, v109, v93
v_add_f32 v110, v110, v94
v_add_f32 v111, v111, v95
s_waitcnt lgkmcnt(0)
v_add_f32 v112, v112, v120
v_add_f32 v113, v113, v121
v_add_f32 v114, v114, v122
v_add_f32 v115, v115, v123
v_add_f32 v116, v116, v124
v_add_f32 v117, v117, v125
v_add_f32 v118, v118, v126
v_add_f32 v119, v119, v127
v_add_f32 v104, v104, v112
v_add_f32 v105, v105, v113
v_add_f32 v106, v106, v114
v_add_f32 v107, v107, v115
v_add_f32 v108, v108, v116
v_add_f32 v109, v109, v117
v_add_f32 v110, v110, v118
v_add_f32 v111, v111, v119
v_cvt_pk_bf16_f32 v140, v104, v105
v_cvt_pk_bf16_f32 v141, v106, v107
v_cvt_pk_bf16_f32 v142, v108, v109
v_cvt_pk_bf16_f32 v143, v110, v111
buffer_store_dwordx4 v[140:143], v148, s[44:47], s67 offen
v_add_u32 v8, s79, v11
s_mov_b32 s46, 0
s_mov_b32 s62, 0
s_cmp_eq_u32 s68, 0
s_cbranch_scc1 K4_N20g
s_waitcnt vmcnt(0)
buffer_store_dword v8, v7, s[36:39], 0 offen
s_branch K4_G1g
K4_N20g:
s_waitcnt vmcnt(1)
v_cmp_le_u32 vcc, s65, v6
s_nop 0
s_cmp_eq_u64 vcc, -1
s_cselect_b32 s68, 1, 0
s_cselect_b32 s42, 0x4000000, 0
buffer_load_dwordx4 v[16:19], v1, s[40:43], s66 offen offset:0 sc1
s_mul_i32 s71, s1, 24576
s_add_u32 s71, s71, s12
buffer_load_dwordx4 v[128:131], v150, s[40:43], s71 offen sc1
s_add_u32 s80, s66, 10240
s_add_u32 s86, s80, s84
buffer_load_dwordx4 v[20:23], v1, s[40:43], s66 offen offset:1024 sc1
buffer_load_dwordx4 v[24:27], v1, s[40:43], s66 offen offset:2048 sc1
buffer_load_dwordx4 v[28:31], v1, s[40:43], s66 offen offset:3072 sc1
s_add_u32 s69, s66, 4096
buffer_load_dwordx4 v[32:35], v1, s[40:43], s69 offen offset:0 sc1
buffer_load_dwordx4 v[36:39], v1, s[40:43], s69 offen offset:1024 sc1
buffer_load_dwordx4 v[40:43], v1, s[40:43], s69 offen offset:2048 sc1
buffer_load_dwordx4 v[44:47], v1, s[40:43], s69 offen offset:3072 sc1
s_add_u32 s69, s66, 8192
buffer_load_dwordx4 v[48:51], v1, s[40:43], s69 offen offset:0 sc1
buffer_load_dwordx4 v[52:55], v1, s[40:43], s69 offen offset:1024 sc1
buffer_load_dword v6, v5, s[36:39], 0 offen sc1
s_waitcnt vmcnt(12)
buffer_store_dword v8, v7, s[36:39], 0 offen
s_waitcnt vmcnt(1)
s_cmp_eq_u32 s68, 1
s_cbranch_scc1 K4_G1g
s_cmp_gt_u32 s64, 33
s_cbranch_scc1 L_FIN
K4_SW0g:
s_mov_b32 s75, 0
K4_SP0g:
buffer_load_dword v6, v5, s[36:39], 0 offen sc1
s_add_u32 s75, s75, 1
s_cmp_gt_u32 s75, 0x8000
s_cbranch_scc1 L_TIMEOUT
s_waitcnt vmcnt(0)
v_cmp_le_u32 vcc, s65, v6
s_nop 0
s_cmp_eq_u64 vcc, -1
s_cbranch_scc0 K4_SP0g
K4_LC0g:
s_mov_b32 s42, 0x4000000
buffer_load_dwordx4 v[16:19], v1, s[40:43], s66 offen offset:0 sc1
s_mul_i32 s71, s1, 24576
s_add_u32 s71, s71, s12
buffer_load_dwordx4 v[128:131], v150, s[40:43], s71 offen sc1
s_add_u32 s80, s66, 10240
s_add_u32 s86, s80, s84
buffer_load_dwordx4 v[20:23], v1, s[40:43], s66 offen offset:1024 sc1
buffer_load_dwordx4 v[24:27], v1, s[40:43], s66 offen offset:2048 sc1
buffer_load_dwordx4 v[28:31], v1, s[40:43], s66 offen offset:3072 sc1
s_add_u32 s69, s66, 4096
buffer_load_dwordx4 v[32:35], v1, s[40:43], s69 offen offset:0 sc1
buffer_load_dwordx4 v[36:39], v1, s[40:43], s69 offen offset:1024 sc1
buffer_load_dwordx4 v[40:43], v1, s[40:43], s69 offen offset:2048 sc1
buffer_load_dwordx4 v[44:47], v1, s[40:43], s69 offen offset:3072 sc1
s_add_u32 s69, s66, 8192
buffer_load_dwordx4 v[48:51], v1, s[40:43], s69 offen offset:0 sc1
buffer_load_dwordx4 v[52:55], v1, s[40:43], s69 offen offset:1024 sc1
buffer_load_dword v6, v5, s[36:39], 0 offen sc1
s_waitcnt vmcnt(0)
s_branch K4_G1g
K4_W0g:
s_mov_b32 s75, 6
s_cmp_lt_u32 s65, 36
s_cbranch_scc0 K4_W0gR
K4_W0gL:
buffer_load_dword v6, v5, s[36:39], 0 offen sc1
s_waitcnt vmcnt(0)
v_cmp_le_u32 vcc, s65, v6
s_nop 0
s_cmp_eq_u64 vcc, -1
s_cbranch_scc1 K4_W0gR
s_sub_u32 s75, s75, 1
s_cmp_lg_u32 s75, 0
s_cbranch_scc1 K4_W0gL
s_branch K4_W0gR
K4_E0g:
ds_write_b32 v151, v84 offset:3072
ds_write_b32 v151, v85 offset:3076
ds_write_b32 v151, v86 offset:3584
ds_write_b32 v151, v87 offset:3588
s_waitcnt lgkmcnt(0)
s_barrier
ds_read2st64_b64 v[104:107], v152 offset0:0 offset1:1
ds_read2st64_b64 v[108:111], v153 offset0:0 offset1:1
ds_read2st64_b64 v[112:115], v154 offset0:0 offset1:1
ds_read2st64_b64 v[116:119], v155 offset0:0 offset1:1
ds_read2st64_b64 v[120:123], v156 offset0:0 offset1:1
ds_read2st64_b64 v[124:127], v157 offset0:0 offset1:1
s_waitcnt lgkmcnt(4)
v_add_f32 v104, v104, v88
v_add_f32 v105, v105, v89
v_add_f32 v106, v106, v90
v_add_f32 v107, v107, v91
v_add_f32 v108, v108, v92
v_add_f32 v109, v109, v93
v_add_f32 v110, v110, v94
v_add_f32 v111, v111, v95
s_waitcnt lgkmcnt(0)
v_add_f32 v112, v112, v120
v_add_f32 v113, v113, v121
v_add_f32 v114, v114, v122
v_add_f32 v115, v115, v123
v_add_f32 v116, v116, v124
v_add_f32 v117, v117, v125
v_add_f32 v118, v118, v126
v_add_f32 v119, v119, v127
v_add_f32 v104, v104, v112
v_add_f32 v105, v105, v113
v_add_f32 v106, v106, v114
v_add_f32 v107, v107, v115
v_add_f32 v108, v108, v116
v_add_f32 v109, v109, v117
v_add_f32 v110, v110, v118
v_add_f32 v111, v111, v119
v_cvt_pk_bf16_f32 v140, v104, v105
v_cvt_pk_bf16_f32 v141, v106, v107
v_cvt_pk_bf16_f32 v142, v108, v109
v_cvt_pk_bf16_f32 v143, v110, v111
buffer_store_dwordx4 v[140:143], v148, s[44:47], s67 offen
s_branch L_FIN
K4_X1g:
s_cmp_lg_u32 s64, 19
s_cbranch_scc1 K4_NR1g
s_mov_b32 s44, s30
s_mov_b32 s45, s31
s_mov_b32 s74, 2621440
s_mov_b32 s46, s74
s_mov_b32 s81, 0
s_mov_b32 s62, 0
s_mov_b32 s100, 40960
s_mov_b32 s11, 4294926336
s_mov_b32 s67, 0
v_mov_b32 v148, v158
s_waitcnt vmcnt(0)
buffer_store_dword v8, v7, s[36:39], 0 offen
s_mov_b32 s7, 0x7ff00000
s_nop 1
v_writelane_b32 v7, s7, 0
s_cmp_eq_u32 s68, 1
s_cbranch_scc1 K4_F0g
s_branch K4_NR1g
K4_NR1g:
s_cmp_gt_u32 s64, 33
s_cbranch_scc1 K4_E1g
buffer_load_dword v6, v5, s[36:39], 0 offen sc1
ds_write_b32 v151, v84 offset:27648
ds_write_b32 v151, v85 offset:27652
ds_write_b32 v151, v86 offset:28160
ds_write_b32 v151, v87 offset:28164
s_waitcnt lgkmcnt(0)
s_barrier
ds_read2st64_b64 v[104:107], v152 offset0:48 offset1:49
ds_read2st64_b64 v[108:111], v153 offset0:48 offset1:49
ds_read2st64_b64 v[112:115], v154 offset0:48 offset1:49
ds_read2st64_b64 v[116:119], v155 offset0:48 offset1:49
ds_read2st64_b64 v[120:123], v156 offset0:48 offset1:49
ds_read2st64_b64 v[124:127], v157 offset0:48 offset1:49
s_waitcnt vmcnt(0)
buffer_store_dword v8, v7, s[36:39], 0 offen
v_cmp_le_u32 vcc, s65, v6
s_nop 0
s_cmp_eq_u64 vcc, -1
s_cselect_b32 s68, 1, 0
s_cselect_b32 s42, 0x4000000, 0
buffer_load_dwordx4 v[16:19], v1, s[40:43], s66 offen offset:0 sc1
s_mul_i32 s71, s1, 24576
s_add_u32 s71, s71, s12
buffer_load_dwordx4 v[128:131], v150, s[40:43], s71 offen sc1
s_add_u32 s80, s66, 10240
s_add_u32 s86, s80, s84
buffer_load_dwordx4 v[20:23], v1, s[40:43], s66 offen offset:1024 sc1
buffer_load_dwordx4 v[24:27], v1, s[40:43], s66 offen offset:2048 sc1
buffer_load_dwordx4 v[28:31], v1, s[40:43], s66 offen offset:3072 sc1
s_add_u32 s69, s66, 4096
buffer_load_dwordx4 v[32:35], v1, s[40:43], s69 offen offset:0 sc1
buffer_load_dwordx4 v[36:39], v1, s[40:43], s69 offen offset:1024 sc1
buffer_load_dwordx4 v[40:43], v1, s[40:43], s69 offen offset:2048 sc1
buffer_load_dwordx4 v[44:47], v1, s[40:43], s69 offen offset:3072 sc1
s_add_u32 s69, s66, 8192
buffer_load_dwordx4 v[48:51], v1, s[40:43], s69 offen offset:0 sc1
buffer_load_dwordx4 v[52:55], v1, s[40:43], s69 offen offset:1024 sc1
buffer_load_dword v6, v5, s[36:39], 0 offen sc1
s_waitcnt lgkmcnt(4)
v_add_f32 v104, v104, v96
v_add_f32 v105, v105, v97
v_add_f32 v106, v106, v98
v_add_f32 v107, v107, v99
v_add_f32 v108, v108, v100
v_add_f32 v109, v109, v101
v_add_f32 v110, v110, v102
v_add_f32 v111, v111, v103
s_waitcnt lgkmcnt(0)
v_add_f32 v112, v112, v120
v_add_f32 v113, v113, v121
v_add_f32 v114, v114, v122
v_add_f32 v115, v115, v123
v_add_f32 v116, v116, v124
v_add_f32 v117, v117, v125
v_add_f32 v118, v118, v126
v_add_f32 v119, v119, v127
v_add_f32 v104, v104, v112
v_add_f32 v105, v105, v113
v_add_f32 v106, v106, v114
v_add_f32 v107, v107, v115
v_add_f32 v108, v108, v116
v_add_f32 v109, v109, v117
v_add_f32 v110, v110, v118
v_add_f32 v111, v111, v119
v_cvt_pk_bf16_f32 v140, v104, v105
v_cvt_pk_bf16_f32 v141, v106, v107
v_cvt_pk_bf16_f32 v142, v108, v109
v_cvt_pk_bf16_f32 v143, v110, v111
buffer_store_dwordx4 v[140:143], v148, s[44:47], s67 offen
v_add_u32 v8, s79, v11
s_mov_b32 s46, 0
s_mov_b32 s62, 0
s_cmp_eq_u32 s68, 0
s_cbranch_scc1 K4_N21g
s_waitcnt vmcnt(0)
buffer_store_dword v8, v7, s[36:39], 0 offen
s_branch K4_G0g
K4_N21g:
s_waitcnt vmcnt(1)
v_cmp_le_u32 vcc, s65, v6
s_nop 0
s_cmp_eq_u64 vcc, -1
s_cselect_b32 s68, 1, 0
s_cselect_b32 s42, 0x4000000, 0
buffer_load_dwordx4 v[16:19], v1, s[40:43], s66 offen offset:0 sc1
s_mul_i32 s71, s1, 24576
s_add_u32 s71, s71, s12
buffer_load_dwordx4 v[128:131], v150, s[40:43], s71 offen sc1
s_add_u32 s80, s66, 10240
s_add_u32 s86, s80, s84
buffer_load_dwordx4 v[20:23], v1, s[40:43], s66 offen offset:1024 sc1
buffer_load_dwordx4 v[24:27], v1, s[40:43], s66 offen offset:2048 sc1
buffer_load_dwordx4 v[28:31], v1, s[40:43], s66 offen offset:3072 sc1
s_add_u32 s69, s66, 4096
buffer_load_dwordx4 v[32:35], v1, s[40:43], s69 offen offset:0 sc1
buffer_load_dwordx4 v[36:39], v1, s[40:43], s69 offen offset:1024 sc1
buffer_load_dwordx4 v[40:43], v1, s[40:43], s69 offen offset:2048 sc1
buffer_load_dwordx4 v[44:47], v1, s[40:43], s69 offen offset:3072 sc1
s_add_u32 s69, s66, 8192
buffer_load_dwordx4 v[48:51], v1, s[40:43], s69 offen offset:0 sc1
buffer_load_dwordx4 v[52:55], v1, s[40:43], s69 offen offset:1024 sc1
buffer_load_dword v6, v5, s[36:39], 0 offen sc1
s_waitcnt vmcnt(12)
buffer_store_dword v8, v7, s[36:39], 0 offen
s_waitcnt vmcnt(1)
s_cmp_eq_u32 s68, 1
s_cbranch_scc1 K4_G0g
s_cmp_gt_u32 s64, 33
s_cbranch_scc1 L_FIN
K4_SW1g:
s_mov_b32 s75, 0
K4_SP1g:
buffer_load_dword v6, v5, s[36:39], 0 offen sc1
s_add_u32 s75, s75, 1
s_cmp_gt_u32 s75, 0x8000
s_cbranch_scc1 L_TIMEOUT
s_waitcnt vmcnt(0)
v_cmp_le_u32 vcc, s65, v6
s_nop 0
s_cmp_eq_u64 vcc, -1
s_cbranch_scc0 K4_SP1g
K4_LC1g:
s_mov_b32 s42, 0x4000000
buffer_load_dwordx4 v[16:19], v1, s[40:43], s66 offen offset:0 sc1
s_mul_i32 s71, s1, 24576
s_add_u32 s71, s71, s12
buffer_load_dwordx4 v[128:131], v150, s[40:43], s71 offen sc1
s_add_u32 s80, s66, 10240
s_add_u32 s86, s80, s84
buffer_load_dwordx4 v[20:23], v1, s[40:43], s66 offen offset:1024 sc1
buffer_load_dwordx4 v[24:27], v1, s[40:43], s66 offen offset:2048 sc1
buffer_load_dwordx4 v[28:31], v1, s[40:43], s66 offen offset:3072 sc1
s_add_u32 s69, s66, 4096
buffer_load_dwordx4 v[32:35], v1, s[40:43], s69 offen offset:0 sc1
buffer_load_dwordx4 v[36:39], v1, s[40:43], s69 offen offset:1024 sc1
buffer_load_dwordx4 v[40:43], v1, s[40:43], s69 offen offset:2048 sc1
buffer_load_dwordx4 v[44:47], v1, s[40:43], s69 offen offset:3072 sc1
s_add_u32 s69, s66, 8192
buffer_load_dwordx4 v[48:51], v1, s[40:43], s69 offen offset:0 sc1
buffer_load_dwordx4 v[52:55], v1, s[40:43], s69 offen offset:1024 sc1
buffer_load_dword v6, v5, s[36:39], 0 offen sc1
s_waitcnt vmcnt(0)
s_branch K4_G0g
K4_W1g:
s_mov_b32 s75, 6
s_cmp_lt_u32 s65, 36
s_cbranch_scc0 K4_W1gR
K4_W1gL:
buffer_load_dword v6, v5, s[36:39], 0 offen sc1
s_waitcnt vmcnt(0)
v_cmp_le_u32 vcc, s65, v6
s_nop 0
s_cmp_eq_u64 vcc, -1
s_cbranch_scc1 K4_W1gR
s_sub_u32 s75, s75, 1
s_cmp_lg_u32 s75, 0
s_cbranch_scc1 K4_W1gL
s_branch K4_W1gR
K4_E1g:
ds_write_b32 v151, v84 offset:27648
ds_write_b32 v151, v85 offset:27652
ds_write_b32 v151, v86 offset:28160
ds_write_b32 v151, v87 offset:28164
s_waitcnt lgkmcnt(0)
s_barrier
ds_read2st64_b64 v[104:107], v152 offset0:48 offset1:49
ds_read2st64_b64 v[108:111], v153 offset0:48 offset1:49
ds_read2st64_b64 v[112:115], v154 offset0:48 offset1:49
ds_read2st64_b64 v[116:119], v155 offset0:48 offset1:49
ds_read2st64_b64 v[120:123], v156 offset0:48 offset1:49
ds_read2st64_b64 v[124:127], v157 offset0:48 offset1:49
s_waitcnt lgkmcnt(4)
v_add_f32 v104, v104, v96
v_add_f32 v105, v105, v97
v_add_f32 v106, v106, v98
v_add_f32 v107, v107, v99
v_add_f32 v108, v108, v100
v_add_f32 v109, v109, v101
v_add_f32 v110, v110, v102
v_add_f32 v111, v111, v103
s_waitcnt lgkmcnt(0)
v_add_f32 v112, v112, v120
v_add_f32 v113, v113, v121
v_add_f32 v114, v114, v122
v_add_f32 v115, v115, v123
v_add_f32 v116, v116, v124
v_add_f32 v117, v117, v125
v_add_f32 v118, v118, v126
v_add_f32 v119, v119, v127
v_add_f32 v104, v104, v112
v_add_f32 v105, v105, v113
v_add_f32 v106, v106, v114
v_add_f32 v107, v107, v115
v_add_f32 v108, v108, v116
v_add_f32 v109, v109, v117
v_add_f32 v110, v110, v118
v_add_f32 v111, v111, v119
v_cvt_pk_bf16_f32 v140, v104, v105
v_cvt_pk_bf16_f32 v141, v106, v107
v_cvt_pk_bf16_f32 v142, v108, v109
v_cvt_pk_bf16_f32 v143, v110, v111
buffer_store_dwordx4 v[140:143], v148, s[44:47], s67 offen
s_branch L_FIN
K4_G0g:
v_lshlrev_b32 v132, 16, v128
v_and_b32 v133, 0xffff0000, v128
v_lshlrev_b32 v134, 16, v129
v_and_b32 v135, 0xffff0000, v129
v_lshlrev_b32 v136, 16, v130
v_and_b32 v137, 0xffff0000, v130
v_lshlrev_b32 v138, 16, v131
v_and_b32 v139, 0xffff0000, v131
v_mfma_f32_16x16x32_bf16 v[72:75], a[0:3], v[16:19], 0
buffer_load_dword v6, v5, s[36:39], 0 offen sc1
v_mfma_f32_16x16x32_bf16 v[72:75], a[24:27], v[20:23], v[72:75]
ds_write_b32 v151, v84 offset:27648
v_mfma_f32_16x16x32_bf16 v[72:75], a[48:51], v[24:27], v[72:75]
buffer_load_dwordx4 v[56:59], v1, s[36:39], s80 offen offset:0 sc1
v_mfma_f32_16x16x32_bf16 v[72:75], a[72:75], v[28:31], v[72:75]
ds_write_b32 v151, v85 offset:27652
v_mfma_f32_16x16x32_bf16 v[76:79], a[4:7], v[16:19], 0
ds_write_b32 v151, v86 offset:28160
v_mfma_f32_16x16x32_bf16 v[76:79], a[28:31], v[20:23], v[76:79]
ds_write_b32 v151, v87 offset:28164
v_mfma_f32_16x16x32_bf16 v[76:79], a[52:55], v[24:27], v[76:79]
v_add_u32 v8, s79, v11
v_mfma_f32_16x16x32_bf16 v[76:79], a[76:79], v[28:31], v[76:79]
buffer_load_dwordx4 v[60:63], v1, s[36:39], s80 offen offset:1024 sc1
v_mfma_f32_16x16x32_bf16 v[80:83], a[8:11], v[16:19], 0
s_waitcnt lgkmcnt(0)
v_mfma_f32_16x16x32_bf16 v[80:83], a[32:35], v[20:23], v[80:83]
s_branch K4_B0g
K4_G1g:
v_lshlrev_b32 v132, 16, v128
v_and_b32 v133, 0xffff0000, v128
v_lshlrev_b32 v134, 16, v129
v_and_b32 v135, 0xffff0000, v129
v_lshlrev_b32 v136, 16, v130
v_and_b32 v137, 0xffff0000, v130
v_lshlrev_b32 v138, 16, v131
v_and_b32 v139, 0xffff0000, v131
v_mfma_f32_16x16x32_bf16 v[72:75], a[0:3], v[16:19], 0
buffer_load_dword v6, v5, s[36:39], 0 offen sc1
v_mfma_f32_16x16x32_bf16 v[72:75], a[24:27], v[20:23], v[72:75]
ds_write_b32 v151, v84 offset:3072
v_mfma_f32_16x16x32_bf16 v[72:75], a[48:51], v[24:27], v[72:75]
buffer_load_dwordx4 v[56:59], v1, s[36:39], s80 offen offset:0 sc1
v_mfma_f32_16x16x32_bf16 v[72:75], a[72:75], v[28:31], v[72:75]
ds_write_b32 v151, v85 offset:3076
v_mfma_f32_16x16x32_bf16 v[76:79], a[4:7], v[16:19], 0
ds_write_b32 v151, v86 offset:3584
v_mfma_f32_16x16x32_bf16 v[76:79], a[28:31], v[20:23], v[76:79]
ds_write_b32 v151, v87 offset:3588
v_mfma_f32_16x16x32_bf16 v[76:79], a[52:55], v[24:27], v[76:79]
v_add_u32 v8, s79, v11
v_mfma_f32_16x16x32_bf16 v[76:79], a[76:79], v[28:31], v[76:79]
buffer_load_dwordx4 v[60:63], v1, s[36:39], s80 offen offset:1024 sc1
v_mfma_f32_16x16x32_bf16 v[80:83], a[8:11], v[16:19], 0
s_waitcnt lgkmcnt(0)
v_mfma_f32_16x16x32_bf16 v[80:83], a[32:35], v[20:23], v[80:83]
s_branch K4_B1g
.p2align 6
K5_F0f:
v_mfma_f32_16x16x32_bf16 v[72:75], a[0:3], v[16:19], 0
buffer_load_dword v6, v5, s[36:39], 0 offen sc1
v_mfma_f32_16x16x32_bf16 v[72:75], a[24:27], v[20:23], v[72:75]
ds_write_b32 v151, v84 offset:27648
v_mfma_f32_16x16x32_bf16 v[72:75], a[48:51], v[24:27], v[72:75]
buffer_load_dwordx4 v[56:59], v1, s[36:39], s80 offen offset:0 sc1
v_mfma_f32_16x16x32_bf16 v[72:75], a[72:75], v[28:31], v[72:75]
ds_write_b32 v151, v85 offset:27652
v_mfma_f32_16x16x32_bf16 v[76:79], a[4:7], v[16:19], 0
ds_write_b32 v151, v86 offset:28160
v_mfma_f32_16x16x32_bf16 v[76:79], a[28:31], v[20:23], v[76:79]
ds_write_b32 v151, v87 offset:28164
v_mfma_f32_16x16x32_bf16 v[76:79], a[52:55], v[24:27], v[76:79]
ds_write_b32 v151, v96 offset:28672
v_mfma_f32_16x16x32_bf16 v[76:79], a[76:79], v[28:31], v[76:79]
buffer_load_dwordx4 v[60:63], v1, s[36:39], s80 offen offset:1024 sc1
v_mfma_f32_16x16x32_bf16 v[80:83], a[8:11], v[16:19], 0
ds_write_b32 v151, v97 offset:28676
v_mfma_f32_16x16x32_bf16 v[80:83], a[32:35], v[20:23], v[80:83]
ds_write_b32 v151, v98 offset:29184
v_mfma_f32_16x16x32_bf16 v[80:83], a[56:59], v[24:27], v[80:83]
ds_write_b32 v151, v99 offset:29188
v_mfma_f32_16x16x32_bf16 v[80:83], a[80:83], v[28:31], v[80:83]
ds_write_b32 v151, v100 offset:29696
v_mfma_f32_16x16x32_bf16 v[84:87], a[12:15], v[16:19], 0
buffer_load_dwordx4 v[64:67], v1, s[36:39], s80 offen offset:2048 sc1
v_mfma_f32_16x16x32_bf16 v[84:87], a[36:39], v[20:23], v[84:87]
ds_write_b32 v151, v101 offset:29700
v_mfma_f32_16x16x32_bf16 v[84:87], a[60:63], v[24:27], v[84:87]
ds_write_b32 v151, v102 offset:30208
v_mfma_f32_16x16x32_bf16 v[84:87], a[84:87], v[28:31], v[84:87]
ds_write_b32 v151, v103 offset:30212
v_mfma_f32_16x16x32_bf16 v[88:91], a[16:19], v[16:19], 0
v_mfma_f32_16x16x32_bf16 v[88:91], a[40:43], v[20:23], v[88:91]
buffer_load_dwordx4 v[68:71], v1, s[36:39], s86 offen offset:3072 sc1
v_mfma_f32_16x16x32_bf16 v[88:91], a[64:67], v[24:27], v[88:91]
s_waitcnt lgkmcnt(0)
v_mfma_f32_16x16x32_bf16 v[88:91], a[88:91], v[28:31], v[88:91]
s_barrier
K5_B0f:
v_mfma_f32_16x16x32_bf16 v[92:95], a[20:23], v[16:19], 0
s_add_u32 s13, s64, 1
s_cmp_eq_u32 s13, 17
s_addc_u32 s13, s13, 0
v_mfma_f32_16x16x32_bf16 v[92:95], a[44:47], v[20:23], v[92:95]
s_sub_u32 s1, s13, 17
s_cselect_b32 s1, s13, s1
s_and_b32 s66, s13, 7
v_mfma_f32_16x16x32_bf16 v[92:95], a[68:71], v[24:27], v[92:95]
s_mul_i32 s66, s66, 55296
s_add_u32 s66, s66, s10
s_add_u32 s65, s13, 2
v_mfma_f32_16x16x32_bf16 v[92:95], a[92:95], v[28:31], v[92:95]
s_waitcnt vmcnt(8)
s_waitcnt vmcnt(4)
v_cmp_le_u32 vcc, s65, v6
v_mfma_f32_16x16x32_bf16 v[72:75], a[96:99], v[32:35], v[72:75]
s_cmp_eq_u64 vcc, -1
v_mfma_f32_16x16x32_bf16 v[72:75], a[120:123], v[36:39], v[72:75]
s_cbranch_scc0 K5_W0f
K5_W0fR:
s_cselect_b32 s68, 1, 0
v_mfma_f32_16x16x32_bf16 v[72:75], a[144:147], v[40:43], v[72:75]
s_cselect_b32 s42, 0x4000000, 0
v_mfma_f32_16x16x32_bf16 v[76:79], a[100:103], v[32:35], v[76:79]
buffer_load_dwordx4 v[16:19], v1, s[40:43], s66 offen offset:0 sc1
v_mfma_f32_16x16x32_bf16 v[76:79], a[124:127], v[36:39], v[76:79]
s_add_u32 s80, s66, 10240
s_add_u32 s86, s80, s84
v_mfma_f32_16x16x32_bf16 v[76:79], a[148:151], v[40:43], v[76:79]
v_mfma_f32_16x16x32_bf16 v[80:83], a[104:107], v[32:35], v[80:83]
buffer_load_dwordx4 v[20:23], v1, s[40:43], s66 offen offset:1024 sc1
v_mfma_f32_16x16x32_bf16 v[80:83], a[128:131], v[36:39], v[80:83]
v_mfma_f32_16x16x32_bf16 v[80:83], a[152:155], v[40:43], v[80:83]
v_mfma_f32_16x16x32_bf16 v[84:87], a[108:111], v[32:35], v[84:87]
v_mfma_f32_16x16x32_bf16 v[84:87], a[132:135], v[36:39], v[84:87]
v_mfma_f32_16x16x32_bf16 v[84:87], a[156:159], v[40:43], v[84:87]
v_mfma_f32_16x16x32_bf16 v[88:91], a[112:115], v[32:35], v[88:91]
buffer_load_dwordx4 v[24:27], v1, s[40:43], s66 offen offset:2048 sc1
v_mfma_f32_16x16x32_bf16 v[88:91], a[136:139], v[36:39], v[88:91]
v_mfma_f32_16x16x32_bf16 v[88:91], a[160:163], v[40:43], v[88:91]
v_mfma_f32_16x16x32_bf16 v[92:95], a[116:119], v[32:35], v[92:95]
v_mfma_f32_16x16x32_bf16 v[92:95], a[140:143], v[36:39], v[92:95]
v_mfma_f32_16x16x32_bf16 v[92:95], a[164:167], v[40:43], v[92:95]
s_waitcnt vmcnt(8)
v_mfma_f32_16x16x32_bf16 v[72:75], a[168:171], v[44:47], v[72:75]
buffer_load_dwordx4 v[28:31], v1, s[40:43], s66 offen offset:3072 sc1
v_mfma_f32_16x16x32_bf16 v[72:75], a[192:195], v[48:51], v[72:75]
s_add_u32 s69, s66, 4096
v_mfma_f32_16x16x32_bf16 v[72:75], a[216:219], v[52:55], v[72:75]
v_mfma_f32_16x16x32_bf16 v[76:79], a[172:175], v[44:47], v[76:79]
v_mfma_f32_16x16x32_bf16 v[76:79], a[196:199], v[48:51], v[76:79]
buffer_load_dwordx4 v[32:35], v1, s[40:43], s69 offen offset:0 sc1
v_mfma_f32_16x16x32_bf16 v[76:79], a[220:223], v[52:55], v[76:79]
v_mfma_f32_16x16x32_bf16 v[80:83], a[176:179], v[44:47], v[80:83]
v_mfma_f32_16x16x32_bf16 v[80:83], a[200:203], v[48:51], v[80:83]
v_mfma_f32_16x16x32_bf16 v[80:83], a[224:227], v[52:55], v[80:83]
v_mfma_f32_16x16x32_bf16 v[84:87], a[180:183], v[44:47], v[84:87]
buffer_load_dwordx4 v[36:39], v1, s[40:43], s69 offen offset:1024 sc1
v_mfma_f32_16x16x32_bf16 v[84:87], a[204:207], v[48:51], v[84:87]
v_mfma_f32_16x16x32_bf16 v[84:87], a[228:231], v[52:55], v[84:87]
v_mfma_f32_16x16x32_bf16 v[88:91], a[184:187], v[44:47], v[88:91]
v_mfma_f32_16x16x32_bf16 v[88:91], a[208:211], v[48:51], v[88:91]
v_mfma_f32_16x16x32_bf16 v[88:91], a[232:235], v[52:55], v[88:91]
buffer_load_dwordx4 v[40:43], v1, s[40:43], s69 offen offset:2048 sc1
v_mfma_f32_16x16x32_bf16 v[92:95], a[188:191], v[44:47], v[92:95]
v_mfma_f32_16x16x32_bf16 v[92:95], a[212:215], v[48:51], v[92:95]
v_mfma_f32_16x16x32_bf16 v[92:95], a[236:239], v[52:55], v[92:95]
s_waitcnt vmcnt(7)
v_mfma_f32_16x16x32_bf16 v[72:75], a[240:243], v[56:59], v[72:75]
buffer_load_dwordx4 v[44:47], v1, s[40:43], s69 offen offset:3072 sc1
v_mfma_f32_16x16x32_bf16 v[72:75], v[196:199], v[60:63], v[72:75]
s_add_u32 s69, s66, 8192
v_mfma_f32_16x16x32_bf16 v[72:75], v[220:223], v[64:67], v[72:75]
v_mfma_f32_16x16x32_bf16 v[72:75], v[244:247], v[68:71], v[72:75]
buffer_load_dwordx4 v[48:51], v1, s[40:43], s69 offen offset:0 sc1
v_mfma_f32_16x16x32_bf16 v[76:79], a[244:247], v[56:59], v[76:79]
s_mul_i32 s67, s0, s100
s_add_u32 s67, s67, s11
s_mov_b32 s46, s74
v_mfma_f32_16x16x32_bf16 v[76:79], v[200:203], v[60:63], v[76:79]
s_add_u32 s79, s64, 19
s_mov_b32 s62, s81
s_mov_b32 s64, s13
v_mfma_f32_16x16x32_bf16 v[76:79], v[224:227], v[64:67], v[76:79]
s_mov_b32 s0, s1
ds_write_b32 v151, v72 offset:0
v_mfma_f32_16x16x32_bf16 v[76:79], v[248:251], v[68:71], v[76:79]
buffer_load_dwordx4 v[52:55], v1, s[40:43], s69 offen offset:1024 sc1
v_mfma_f32_16x16x32_bf16 v[80:83], a[248:251], v[56:59], v[80:83]
s_cmp_eq_u32 s64, 19
ds_write_b32 v151, v73 offset:4
v_mfma_f32_16x16x32_bf16 v[80:83], v[204:207], v[60:63], v[80:83]
s_cselect_b32 s69, 0, s68
ds_write_b32 v151, v74 offset:512
v_mfma_f32_16x16x32_bf16 v[80:83], v[228:231], v[64:67], v[80:83]
s_cmp_eq_u32 s69, 0
ds_write_b32 v151, v75 offset:516
v_mfma_f32_16x16x32_bf16 v[80:83], v[252:255], v[68:71], v[80:83]
ds_write_b32 v151, v76 offset:1024
v_mfma_f32_16x16x32_bf16 v[84:87], a[252:255], v[56:59], v[84:87]
ds_write_b32 v151, v77 offset:1028
v_mfma_f32_16x16x32_bf16 v[84:87], v[208:211], v[60:63], v[84:87]
ds_write_b32 v151, v78 offset:1536
v_mfma_f32_16x16x32_bf16 v[84:87], v[232:235], v[64:67], v[84:87]
ds_write_b32 v151, v79 offset:1540
v_mfma_f32_16x16x32_bf16 v[88:91], v[188:191], v[56:59], v[88:91]
ds_write_b32 v151, v80 offset:2048
v_mfma_f32_16x16x32_bf16 v[88:91], v[212:215], v[60:63], v[88:91]
ds_write_b32 v151, v81 offset:2052
v_mfma_f32_16x16x32_bf16 v[88:91], v[236:239], v[64:67], v[88:91]
ds_write_b32 v151, v82 offset:2560
v_mfma_f32_16x16x32_bf16 v[92:95], v[192:195], v[56:59], v[92:95]
ds_write_b32 v151, v83 offset:2564
v_mfma_f32_16x16x32_bf16 v[92:95], v[216:219], v[60:63], v[92:95]
s_waitcnt vmcnt(6)
v_mfma_f32_16x16x32_bf16 v[92:95], v[240:243], v[64:67], v[92:95]
s_cbranch_scc1 K5_X0f
K5_F1f:
v_mfma_f32_16x16x32_bf16 v[72:75], a[0:3], v[16:19], 0
buffer_load_dword v6, v5, s[36:39], 0 offen sc1
v_mfma_f32_16x16x32_bf16 v[72:75], a[24:27], v[20:23], v[72:75]
ds_write_b32 v151, v84 offset:3072
v_mfma_f32_16x16x32_bf16 v[72:75], a[48:51], v[24:27], v[72:75]
buffer_load_dwordx4 v[56:59], v1, s[36:39], s80 offen offset:0 sc1
v_mfma_f32_16x16x32_bf16 v[72:75], a[72:75], v[28:31], v[72:75]
ds_write_b32 v151, v85 offset:3076
v_mfma_f32_16x16x32_bf16 v[76:79], a[4:7], v[16:19], 0
ds_write_b32 v151, v86 offset:3584
v_mfma_f32_16x16x32_bf16 v[76:79], a[28:31], v[20:23], v[76:79]
ds_write_b32 v151, v87 offset:3588
v_mfma_f32_16x16x32_bf16 v[76:79], a[52:55], v[24:27], v[76:79]
ds_write_b32 v151, v88 offset:4096
v_mfma_f32_16x16x32_bf16 v[76:79], a[76:79], v[28:31], v[76:79]
buffer_load_dwordx4 v[60:63], v1, s[36:39], s80 offen offset:1024 sc1
v_mfma_f32_16x16x32_bf16 v[80:83], a[8:11], v[16:19], 0
ds_write_b32 v151, v89 offset:4100
v_mfma_f32_16x16x32_bf16 v[80:83], a[32:35], v[20:23], v[80:83]
ds_write_b32 v151, v90 offset:4608
v_mfma_f32_16x16x32_bf16 v[80:83], a[56:59], v[24:27], v[80:83]
ds_write_b32 v151, v91 offset:4612
v_mfma_f32_16x16x32_bf16 v[80:83], a[80:83], v[28:31], v[80:83]
ds_write_b32 v151, v92 offset:5120
v_mfma_f32_16x16x32_bf16 v[84:87], a[12:15], v[16:19], 0
buffer_load_dwordx4 v[64:67], v1, s[36:39], s80 offen offset:2048 sc1
v_mfma_f32_16x16x32_bf16 v[84:87], a[36:39], v[20:23], v[84:87]
ds_write_b32 v151, v93 offset:5124
v_mfma_f32_16x16x32_bf16 v[84:87], a[60:63], v[24:27], v[84:87]
ds_write_b32 v151, v94 offset:5632
v_mfma_f32_16x16x32_bf16 v[84:87], a[84:87], v[28:31], v[84:87]
ds_write_b32 v151, v95 offset:5636
v_mfma_f32_16x16x32_bf16 v[96:99], a[16:19], v[16:19], 0
v_mfma_f32_16x16x32_bf16 v[96:99], a[40:43], v[20:23], v[96:99]
buffer_load_dwordx4 v[68:71], v1, s[36:39], s86 offen offset:3072 sc1
v_mfma_f32_16x16x32_bf16 v[96:99], a[64:67], v[24:27], v[96:99]
s_waitcnt lgkmcnt(0)
v_mfma_f32_16x16x32_bf16 v[96:99], a[88:91], v[28:31], v[96:99]
s_barrier
K5_B1f:
v_mfma_f32_16x16x32_bf16 v[100:103], a[20:23], v[16:19], 0
s_add_u32 s13, s64, 1
s_cmp_eq_u32 s13, 17
s_addc_u32 s13, s13, 0
v_mfma_f32_16x16x32_bf16 v[100:103], a[44:47], v[20:23], v[100:103]
s_sub_u32 s1, s13, 17
s_cselect_b32 s1, s13, s1
s_and_b32 s66, s13, 7
v_mfma_f32_16x16x32_bf16 v[100:103], a[68:71], v[24:27], v[100:103]
s_mul_i32 s66, s66, 55296
s_add_u32 s66, s66, s10
s_add_u32 s65, s13, 2
v_mfma_f32_16x16x32_bf16 v[100:103], a[92:95], v[28:31], v[100:103]
s_waitcnt vmcnt(8)
s_waitcnt vmcnt(4)
v_cmp_le_u32 vcc, s65, v6
v_mfma_f32_16x16x32_bf16 v[72:75], a[96:99], v[32:35], v[72:75]
s_cmp_eq_u64 vcc, -1
v_mfma_f32_16x16x32_bf16 v[72:75], a[120:123], v[36:39], v[72:75]
s_cbranch_scc0 K5_W1f
K5_W1fR:
s_cselect_b32 s68, 1, 0
v_mfma_f32_16x16x32_bf16 v[72:75], a[144:147], v[40:43], v[72:75]
s_cselect_b32 s42, 0x4000000, 0
v_mfma_f32_16x16x32_bf16 v[76:79], a[100:103], v[32:35], v[76:79]
buffer_load_dwordx4 v[16:19], v1, s[40:43], s66 offen offset:0 sc1
v_mfma_f32_16x16x32_bf16 v[76:79], a[124:127], v[36:39], v[76:79]
s_add_u32 s80, s66, 10240
s_add_u32 s86, s80, s84
v_mfma_f32_16x16x32_bf16 v[76:79], a[148:151], v[40:43], v[76:79]
v_mfma_f32_16x16x32_bf16 v[80:83], a[104:107], v[32:35], v[80:83]
buffer_load_dwordx4 v[20:23], v1, s[40:43], s66 offen offset:1024 sc1
v_mfma_f32_16x16x32_bf16 v[80:83], a[128:131], v[36:39], v[80:83]
v_mfma_f32_16x16x32_bf16 v[80:83], a[152:155], v[40:43], v[80:83]
v_mfma_f32_16x16x32_bf16 v[84:87], a[108:111], v[32:35], v[84:87]
v_mfma_f32_16x16x32_bf16 v[84:87], a[132:135], v[36:39], v[84:87]
v_mfma_f32_16x16x32_bf16 v[84:87], a[156:159], v[40:43], v[84:87]
v_mfma_f32_16x16x32_bf16 v[96:99], a[112:115], v[32:35], v[96:99]
buffer_load_dwordx4 v[24:27], v1, s[40:43], s66 offen offset:2048 sc1
v_mfma_f32_16x16x32_bf16 v[96:99], a[136:139], v[36:39], v[96:99]
v_mfma_f32_16x16x32_bf16 v[96:99], a[160:163], v[40:43], v[96:99]
v_mfma_f32_16x16x32_bf16 v[100:103], a[116:119], v[32:35], v[100:103]
v_mfma_f32_16x16x32_bf16 v[100:103], a[140:143], v[36:39], v[100:103]
v_mfma_f32_16x16x32_bf16 v[100:103], a[164:167], v[40:43], v[100:103]
s_waitcnt vmcnt(8)
v_mfma_f32_16x16x32_bf16 v[72:75], a[168:171], v[44:47], v[72:75]
buffer_load_dwordx4 v[28:31], v1, s[40:43], s66 offen offset:3072 sc1
v_mfma_f32_16x16x32_bf16 v[72:75], a[192:195], v[48:51], v[72:75]
s_add_u32 s69, s66, 4096
v_mfma_f32_16x16x32_bf16 v[72:75], a[216:219], v[52:55], v[72:75]
v_mfma_f32_16x16x32_bf16 v[76:79], a[172:175], v[44:47], v[76:79]
v_mfma_f32_16x16x32_bf16 v[76:79], a[196:199], v[48:51], v[76:79]
buffer_load_dwordx4 v[32:35], v1, s[40:43], s69 offen offset:0 sc1
v_mfma_f32_16x16x32_bf16 v[76:79], a[220:223], v[52:55], v[76:79]
v_mfma_f32_16x16x32_bf16 v[80:83], a[176:179], v[44:47], v[80:83]
v_mfma_f32_16x16x32_bf16 v[80:83], a[200:203], v[48:51], v[80:83]
v_mfma_f32_16x16x32_bf16 v[80:83], a[224:227], v[52:55], v[80:83]
v_mfma_f32_16x16x32_bf16 v[84:87], a[180:183], v[44:47], v[84:87]
buffer_load_dwordx4 v[36:39], v1, s[40:43], s69 offen offset:1024 sc1
v_mfma_f32_16x16x32_bf16 v[84:87], a[204:207], v[48:51], v[84:87]
v_mfma_f32_16x16x32_bf16 v[84:87], a[228:231], v[52:55], v[84:87]
v_mfma_f32_16x16x32_bf16 v[96:99], a[184:187], v[44:47], v[96:99]
v_mfma_f32_16x16x32_bf16 v[96:99], a[208:211], v[48:51], v[96:99]
v_mfma_f32_16x16x32_bf16 v[96:99], a[232:235], v[52:55], v[96:99]
buffer_load_dwordx4 v[40:43], v1, s[40:43], s69 offen offset:2048 sc1
v_mfma_f32_16x16x32_bf16 v[100:103], a[188:191], v[44:47], v[100:103]
v_mfma_f32_16x16x32_bf16 v[100:103], a[212:215], v[48:51], v[100:103]
v_mfma_f32_16x16x32_bf16 v[100:103], a[236:239], v[52:55], v[100:103]
s_waitcnt vmcnt(7)
v_mfma_f32_16x16x32_bf16 v[72:75], a[240:243], v[56:59], v[72:75]
buffer_load_dwordx4 v[44:47], v1, s[40:43], s69 offen offset:3072 sc1
v_mfma_f32_16x16x32_bf16 v[72:75], v[196:199], v[60:63], v[72:75]
s_add_u32 s69, s66, 8192
v_mfma_f32_16x16x32_bf16 v[72:75], v[220:223], v[64:67], v[72:75]
v_mfma_f32_16x16x32_bf16 v[72:75], v[244:247], v[68:71], v[72:75]
buffer_load_dwordx4 v[48:51], v1, s[40:43], s69 offen offset:0 sc1
v_mfma_f32_16x16x32_bf16 v[76:79], a[244:247], v[56:59], v[76:79]
s_mul_i32 s67, s0, s100
s_add_u32 s67, s67, s11
s_mov_b32 s46, s74
v_mfma_f32_16x16x32_bf16 v[76:79], v[200:203], v[60:63], v[76:79]
s_add_u32 s79, s64, 19
s_mov_b32 s62, s81
s_mov_b32 s64, s13
v_mfma_f32_16x16x32_bf16 v[76:79], v[224:227], v[64:67], v[76:79]
s_mov_b32 s0, s1
ds_write_b32 v151, v72 offset:24576
v_mfma_f32_16x16x32_bf16 v[76:79], v[248:251], v[68:71], v[76:79]
buffer_load_dwordx4 v[52:55], v1, s[40:43], s69 offen offset:1024 sc1
v_mfma_f32_16x16x32_bf16 v[80:83], a[248:251], v[56:59], v[80:83]
s_cmp_eq_u32 s64, 19
ds_write_b32 v151, v73 offset:24580
v_mfma_f32_16x16x32_bf16 v[80:83], v[204:207], v[60:63], v[80:83]
s_cselect_b32 s69, 0, s68
ds_write_b32 v151, v74 offset:25088
v_mfma_f32_16x16x32_bf16 v[80:83], v[228:231], v[64:67], v[80:83]
s_cmp_eq_u32 s69, 0
ds_write_b32 v151, v75 offset:25092
v_mfma_f32_16x16x32_bf16 v[80:83], v[252:255], v[68:71], v[80:83]
ds_write_b32 v151, v76 offset:25600
v_mfma_f32_16x16x32_bf16 v[84:87], a[252:255], v[56:59], v[84:87]
ds_write_b32 v151, v77 offset:25604
v_mfma_f32_16x16x32_bf16 v[84:87], v[208:211], v[60:63], v[84:87]
ds_write_b32 v151, v78 offset:26112
v_mfma_f32_16x16x32_bf16 v[84:87], v[232:235], v[64:67], v[84:87]
ds_write_b32 v151, v79 offset:26116
v_mfma_f32_16x16x32_bf16 v[96:99], v[188:191], v[56:59], v[96:99]
ds_write_b32 v151, v80 offset:26624
v_mfma_f32_16x16x32_bf16 v[96:99], v[212:215], v[60:63], v[96:99]
ds_write_b32 v151, v81 offset:26628
v_mfma_f32_16x16x32_bf16 v[96:99], v[236:239], v[64:67], v[96:99]
ds_write_b32 v151, v82 offset:27136
v_mfma_f32_16x16x32_bf16 v[100:103], v[192:195], v[56:59], v[100:103]
ds_write_b32 v151, v83 offset:27140
v_mfma_f32_16x16x32_bf16 v[100:103], v[216:219], v[60:63], v[100:103]
s_waitcnt vmcnt(6)
v_mfma_f32_16x16x32_bf16 v[100:103], v[240:243], v[64:67], v[100:103]
s_cbranch_scc1 K5_X1f
s_branch K5_F0f
K5_X0f:
s_cmp_lg_u32 s64, 19
s_cbranch_scc1 K5_NR0f
s_mov_b32 s44, s30
s_mov_b32 s45, s31
s_mov_b32 s74, 2621440
s_mov_b32 s46, s74
s_mov_b32 s81, 0
s_mov_b32 s62, 0
s_mov_b32 s100, 40960
s_mov_b32 s11, 4294926336
s_mov_b32 s67, 0
v_mov_b32 v148, v158
s_waitcnt vmcnt(0)
buffer_store_dword v8, v7, s[36:39], 0 offen
s_mov_b32 s7, 0x7ff00000
s_nop 1
v_writelane_b32 v7, s7, 0
s_cmp_eq_u32 s68, 1
s_cbranch_scc1 K5_F1g
s_branch K5_NR0g
K5_NR0f:
s_cmp_gt_u32 s64, 33
s_cbranch_scc1 K5_E0f
buffer_load_dword v6, v5, s[36:39], 0 offen sc1
ds_write_b32 v151, v84 offset:3072
ds_write_b32 v151, v85 offset:3076
ds_write_b32 v151, v86 offset:3584
ds_write_b32 v151, v87 offset:3588
ds_write_b32 v151, v88 offset:4096
ds_write_b32 v151, v89 offset:4100
ds_write_b32 v151, v90 offset:4608
ds_write_b32 v151, v91 offset:4612
ds_write_b32 v151, v92 offset:5120
ds_write_b32 v151, v93 offset:5124
ds_write_b32 v151, v94 offset:5632
ds_write_b32 v151, v95 offset:5636
s_waitcnt lgkmcnt(0)
s_barrier
s_waitcnt vmcnt(0)
buffer_store_dword v8, v7, s[36:39], 0 offen
v_cmp_le_u32 vcc, s65, v6
s_nop 0
s_cmp_eq_u64 vcc, -1
s_cselect_b32 s68, 1, 0
s_cselect_b32 s42, 0x4000000, 0
buffer_load_dwordx4 v[16:19], v1, s[40:43], s66 offen offset:0 sc1
s_add_u32 s80, s66, 10240
s_add_u32 s86, s80, s84
buffer_load_dwordx4 v[20:23], v1, s[40:43], s66 offen offset:1024 sc1
buffer_load_dwordx4 v[24:27], v1, s[40:43], s66 offen offset:2048 sc1
buffer_load_dwordx4 v[28:31], v1, s[40:43], s66 offen offset:3072 sc1
s_add_u32 s69, s66, 4096
buffer_load_dwordx4 v[32:35], v1, s[40:43], s69 offen offset:0 sc1
buffer_load_dwordx4 v[36:39], v1, s[40:43], s69 offen offset:1024 sc1
buffer_load_dwordx4 v[40:43], v1, s[40:43], s69 offen offset:2048 sc1
buffer_load_dwordx4 v[44:47], v1, s[40:43], s69 offen offset:3072 sc1
s_add_u32 s69, s66, 8192
buffer_load_dwordx4 v[48:51], v1, s[40:43], s69 offen offset:0 sc1
buffer_load_dwordx4 v[52:55], v1, s[40:43], s69 offen offset:1024 sc1
buffer_load_dword v6, v5, s[36:39], 0 offen sc1
v_add_u32 v8, s79, v11
s_mov_b32 s46, 0
s_mov_b32 s62, 0
s_cmp_eq_u32 s68, 0
s_cbranch_scc1 K5_N20f
s_waitcnt vmcnt(0)
buffer_store_dword v8, v7, s[36:39], 0 offen
s_branch K5_G1f
K5_N20f:
s_waitcnt vmcnt(0)
v_cmp_le_u32 vcc, s65, v6
s_nop 0
s_cmp_eq_u64 vcc, -1
s_cselect_b32 s68, 1, 0
s_cselect_b32 s42, 0x4000000, 0
buffer_load_dwordx4 v[16:19], v1, s[40:43], s66 offen offset:0 sc1
s_add_u32 s80, s66, 10240
s_add_u32 s86, s80, s84
buffer_load_dwordx4 v[20:23], v1, s[40:43], s66 offen offset:1024 sc1
buffer_load_dwordx4 v[24:27], v1, s[40:43], s66 offen offset:2048 sc1
buffer_load_dwordx4 v[28:31], v1, s[40:43], s66 offen offset:3072 sc1
s_add_u32 s69, s66, 4096
buffer_load_dwordx4 v[32:35], v1, s[40:43], s69 offen offset:0 sc1
buffer_load_dwordx4 v[36:39], v1, s[40:43], s69 offen offset:1024 sc1
buffer_load_dwordx4 v[40:43], v1, s[40:43], s69 offen offset:2048 sc1
buffer_load_dwordx4 v[44:47], v1, s[40:43], s69 offen offset:3072 sc1
s_add_u32 s69, s66, 8192
buffer_load_dwordx4 v[48:51], v1, s[40:43], s69 offen offset:0 sc1
buffer_load_dwordx4 v[52:55], v1, s[40:43], s69 offen offset:1024 sc1
buffer_load_dword v6, v5, s[36:39], 0 offen sc1
buffer_store_dword v8, v7, s[36:39], 0 offen
s_waitcnt vmcnt(1)
s_cmp_eq_u32 s68, 1
s_cbranch_scc1 K5_G1f
s_cmp_gt_u32 s64, 33
s_cbranch_scc1 L_FIN
K5_SW0f:
s_mov_b32 s75, 0
K5_SP0f:
buffer_load_dword v6, v5, s[36:39], 0 offen sc1
s_add_u32 s75, s75, 1
s_cmp_gt_u32 s75, 0x8000
s_cbranch_scc1 L_TIMEOUT
s_waitcnt vmcnt(0)
v_cmp_le_u32 vcc, s65, v6
s_nop 0
s_cmp_eq_u64 vcc, -1
s_cbranch_scc0 K5_SP0f
K5_LC0f:
s_mov_b32 s42, 0x4000000
buffer_load_dwordx4 v[16:19], v1, s[40:43], s66 offen offset:0 sc1
s_add_u32 s80, s66, 10240
s_add_u32 s86, s80, s84
buffer_load_dwordx4 v[20:23], v1, s[40:43], s66 offen offset:1024 sc1
buffer_load_dwordx4 v[24:27], v1, s[40:43], s66 offen offset:2048 sc1
buffer_load_dwordx4 v[28:31], v1, s[40:43], s66 offen offset:3072 sc1
s_add_u32 s69, s66, 4096
buffer_load_dwordx4 v[32:35], v1, s[40:43], s69 offen offset:0 sc1
buffer_load_dwordx4 v[36:39], v1, s[40:43], s69 offen offset:1024 sc1
buffer_load_dwordx4 v[40:43], v1, s[40:43], s69 offen offset:2048 sc1
buffer_load_dwordx4 v[44:47], v1, s[40:43], s69 offen offset:3072 sc1
s_add_u32 s69, s66, 8192
buffer_load_dwordx4 v[48:51], v1, s[40:43], s69 offen offset:0 sc1
buffer_load_dwordx4 v[52:55], v1, s[40:43], s69 offen offset:1024 sc1
buffer_load_dword v6, v5, s[36:39], 0 offen sc1
s_waitcnt vmcnt(0)
s_branch K5_G1f
K5_W0f:
s_mov_b32 s75, 6
s_cmp_lt_u32 s65, 36
s_cbranch_scc0 K5_W0fR
K5_W0fL:
buffer_load_dword v6, v5, s[36:39], 0 offen sc1
s_waitcnt vmcnt(0)
v_cmp_le_u32 vcc, s65, v6
s_nop 0
s_cmp_eq_u64 vcc, -1
s_cbranch_scc1 K5_W0fR
s_sub_u32 s75, s75, 1
s_cmp_lg_u32 s75, 0
s_cbranch_scc1 K5_W0fL
s_branch K5_W0fR
K5_E0f:
ds_write_b32 v151, v84 offset:3072
ds_write_b32 v151, v85 offset:3076
ds_write_b32 v151, v86 offset:3584
ds_write_b32 v151, v87 offset:3588
ds_write_b32 v151, v88 offset:4096
ds_write_b32 v151, v89 offset:4100
ds_write_b32 v151, v90 offset:4608
ds_write_b32 v151, v91 offset:4612
ds_write_b32 v151, v92 offset:5120
ds_write_b32 v151, v93 offset:5124
ds_write_b32 v151, v94 offset:5632
ds_write_b32 v151, v95 offset:5636
s_waitcnt lgkmcnt(0)
s_barrier
s_branch L_FIN
K5_X1f:
s_cmp_lg_u32 s64, 19
s_cbranch_scc1 K5_NR1f
s_mov_b32 s44, s30
s_mov_b32 s45, s31
s_mov_b32 s74, 2621440
s_mov_b32 s46, s74
s_mov_b32 s81, 0
s_mov_b32 s62, 0
s_mov_b32 s100, 40960
s_mov_b32 s11, 4294926336
s_mov_b32 s67, 0
v_mov_b32 v148, v158
s_waitcnt vmcnt(0)
buffer_store_dword v8, v7, s[36:39], 0 offen
s_mov_b32 s7, 0x7ff00000
s_nop 1
v_writelane_b32 v7, s7, 0
s_cmp_eq_u32 s68, 1
s_cbranch_scc1 K5_F0g
s_branch K5_NR1g
K5_NR1f:
s_cmp_gt_u32 s64, 33
s_cbranch_scc1 K5_E1f
buffer_load_dword v6, v5, s[36:39], 0 offen sc1
ds_write_b32 v151, v84 offset:27648
ds_write_b32 v151, v85 offset:27652
ds_write_b32 v151, v86 offset:28160
ds_write_b32 v151, v87 offset:28164
ds_write_b32 v151, v96 offset:28672
ds_write_b32 v151, v97 offset:28676
ds_write_b32 v151, v98 offset:29184
ds_write_b32 v151, v99 offset:29188
ds_write_b32 v151, v100 offset:29696
ds_write_b32 v151, v101 offset:29700
ds_write_b32 v151, v102 offset:30208
ds_write_b32 v151, v103 offset:30212
s_waitcnt lgkmcnt(0)
s_barrier
s_waitcnt vmcnt(0)
buffer_store_dword v8, v7, s[36:39], 0 offen
v_cmp_le_u32 vcc, s65, v6
s_nop 0
s_cmp_eq_u64 vcc, -1
s_cselect_b32 s68, 1, 0
s_cselect_b32 s42, 0x4000000, 0
buffer_load_dwordx4 v[16:19], v1, s[40:43], s66 offen offset:0 sc1
s_add_u32 s80, s66, 10240
s_add_u32 s86, s80, s84
buffer_load_dwordx4 v[20:23], v1, s[40:43], s66 offen offset:1024 sc1
buffer_load_dwordx4 v[24:27], v1, s[40:43], s66 offen offset:2048 sc1
buffer_load_dwordx4 v[28:31], v1, s[40:43], s66 offen offset:3072 sc1
s_add_u32 s69, s66, 4096
buffer_load_dwordx4 v[32:35], v1, s[40:43], s69 offen offset:0 sc1
buffer_load_dwordx4 v[36:39], v1, s[40:43], s69 offen offset:1024 sc1
buffer_load_dwordx4 v[40:43], v1, s[40:43], s69 offen offset:2048 sc1
buffer_load_dwordx4 v[44:47], v1, s[40:43], s69 offen offset:3072 sc1
s_add_u32 s69, s66, 8192
buffer_load_dwordx4 v[48:51], v1, s[40:43], s69 offen offset:0 sc1
buffer_load_dwordx4 v[52:55], v1, s[40:43], s69 offen offset:1024 sc1
buffer_load_dword v6, v5, s[36:39], 0 offen sc1
v_add_u32 v8, s79, v11
s_mov_b32 s46, 0
s_mov_b32 s62, 0
s_cmp_eq_u32 s68, 0
s_cbranch_scc1 K5_N21f
s_waitcnt vmcnt(0)
buffer_store_dword v8, v7, s[36:39], 0 offen
s_branch K5_G0f
K5_N21f:
s_waitcnt vmcnt(0)
v_cmp_le_u32 vcc, s65, v6
s_nop 0
s_cmp_eq_u64 vcc, -1
s_cselect_b32 s68, 1, 0
s_cselect_b32 s42, 0x4000000, 0
buffer_load_dwordx4 v[16:19], v1, s[40:43], s66 offen offset:0 sc1
s_add_u32 s80, s66, 10240
s_add_u32 s86, s80, s84
buffer_load_dwordx4 v[20:23], v1, s[40:43], s66 offen offset:1024 sc1
buffer_load_dwordx4 v[24:27], v1, s[40:43], s66 offen offset:2048 sc1
buffer_load_dwordx4 v[28:31], v1, s[40:43], s66 offen offset:3072 sc1
s_add_u32 s69, s66, 4096
buffer_load_dwordx4 v[32:35], v1, s[40:43], s69 offen offset:0 sc1
buffer_load_dwordx4 v[36:39], v1, s[40:43], s69 offen offset:1024 sc1
buffer_load_dwordx4 v[40:43], v1, s[40:43], s69 offen offset:2048 sc1
buffer_load_dwordx4 v[44:47], v1, s[40:43], s69 offen offset:3072 sc1
s_add_u32 s69, s66, 8192
buffer_load_dwordx4 v[48:51], v1, s[40:43], s69 offen offset:0 sc1
buffer_load_dwordx4 v[52:55], v1, s[40:43], s69 offen offset:1024 sc1
buffer_load_dword v6, v5, s[36:39], 0 offen sc1
buffer_store_dword v8, v7, s[36:39], 0 offen
s_waitcnt vmcnt(1)
s_cmp_eq_u32 s68, 1
s_cbranch_scc1 K5_G0f
s_cmp_gt_u32 s64, 33
s_cbranch_scc1 L_FIN
K5_SW1f:
s_mov_b32 s75, 0
K5_SP1f:
buffer_load_dword v6, v5, s[36:39], 0 offen sc1
s_add_u32 s75, s75, 1
s_cmp_gt_u32 s75, 0x8000
s_cbranch_scc1 L_TIMEOUT
s_waitcnt vmcnt(0)
v_cmp_le_u32 vcc, s65, v6
s_nop 0
s_cmp_eq_u64 vcc, -1
s_cbranch_scc0 K5_SP1f
K5_LC1f:
s_mov_b32 s42, 0x4000000
buffer_load_dwordx4 v[16:19], v1, s[40:43], s66 offen offset:0 sc1
s_add_u32 s80, s66, 10240
s_add_u32 s86, s80, s84
buffer_load_dwordx4 v[20:23], v1, s[40:43], s66 offen offset:1024 sc1
buffer_load_dwordx4 v[24:27], v1, s[40:43], s66 offen offset:2048 sc1
buffer_load_dwordx4 v[28:31], v1, s[40:43], s66 offen offset:3072 sc1
s_add_u32 s69, s66, 4096
buffer_load_dwordx4 v[32:35], v1, s[40:43], s69 offen offset:0 sc1
buffer_load_dwordx4 v[36:39], v1, s[40:43], s69 offen offset:1024 sc1
buffer_load_dwordx4 v[40:43], v1, s[40:43], s69 offen offset:2048 sc1
buffer_load_dwordx4 v[44:47], v1, s[40:43], s69 offen offset:3072 sc1
s_add_u32 s69, s66, 8192
buffer_load_dwordx4 v[48:51], v1, s[40:43], s69 offen offset:0 sc1
buffer_load_dwordx4 v[52:55], v1, s[40:43], s69 offen offset:1024 sc1
buffer_load_dword v6, v5, s[36:39], 0 offen sc1
s_waitcnt vmcnt(0)
s_branch K5_G0f
K5_W1f:
s_mov_b32 s75, 6
s_cmp_lt_u32 s65, 36
s_cbranch_scc0 K5_W1fR
K5_W1fL:
buffer_load_dword v6, v5, s[36:39], 0 offen sc1
s_waitcnt vmcnt(0)
v_cmp_le_u32 vcc, s65, v6
s_nop 0
s_cmp_eq_u64 vcc, -1
s_cbranch_scc1 K5_W1fR
s_sub_u32 s75, s75, 1
s_cmp_lg_u32 s75, 0
s_cbranch_scc1 K5_W1fL
s_branch K5_W1fR
K5_E1f:
ds_write_b32 v151, v84 offset:27648
ds_write_b32 v151, v85 offset:27652
ds_write_b32 v151, v86 offset:28160
ds_write_b32 v151, v87 offset:28164
ds_write_b32 v151, v96 offset:28672
ds_write_b32 v151, v97 offset:28676
ds_write_b32 v151, v98 offset:29184
ds_write_b32 v151, v99 offset:29188
ds_write_b32 v151, v100 offset:29696
ds_write_b32 v151, v101 offset:29700
ds_write_b32 v151, v102 offset:30208
ds_write_b32 v151, v103 offset:30212
s_waitcnt lgkmcnt(0)
s_barrier
s_branch L_FIN
K5_G0f:
v_mfma_f32_16x16x32_bf16 v[72:75], a[0:3], v[16:19], 0
buffer_load_dword v6, v5, s[36:39], 0 offen sc1
v_mfma_f32_16x16x32_bf16 v[72:75], a[24:27], v[20:23], v[72:75]
ds_write_b32 v151, v84 offset:27648
v_mfma_f32_16x16x32_bf16 v[72:75], a[48:51], v[24:27], v[72:75]
buffer_load_dwordx4 v[56:59], v1, s[36:39], s80 offen offset:0 sc1
v_mfma_f32_16x16x32_bf16 v[72:75], a[72:75], v[28:31], v[72:75]
ds_write_b32 v151, v85 offset:27652
v_mfma_f32_16x16x32_bf16 v[76:79], a[4:7], v[16:19], 0
ds_write_b32 v151, v86 offset:28160
v_mfma_f32_16x16x32_bf16 v[76:79], a[28:31], v[20:23], v[76:79]
ds_write_b32 v151, v87 offset:28164
v_mfma_f32_16x16x32_bf16 v[76:79], a[52:55], v[24:27], v[76:79]
ds_write_b32 v151, v96 offset:28672
v_mfma_f32_16x16x32_bf16 v[76:79], a[76:79], v[28:31], v[76:79]
buffer_load_dwordx4 v[60:63], v1, s[36:39], s80 offen offset:1024 sc1
v_mfma_f32_16x16x32_bf16 v[80:83], a[8:11], v[16:19], 0
ds_write_b32 v151, v97 offset:28676
v_mfma_f32_16x16x32_bf16 v[80:83], a[32:35], v[20:23], v[80:83]
ds_write_b32 v151, v98 offset:29184
v_mfma_f32_16x16x32_bf16 v[80:83], a[56:59], v[24:27], v[80:83]
ds_write_b32 v151, v99 offset:29188
v_mfma_f32_16x16x32_bf16 v[80:83], a[80:83], v[28:31], v[80:83]
ds_write_b32 v151, v100 offset:29696
v_mfma_f32_16x16x32_bf16 v[84:87], a[12:15], v[16:19], 0
buffer_load_dwordx4 v[64:67], v1, s[36:39], s80 offen offset:2048 sc1
v_mfma_f32_16x16x32_bf16 v[84:87], a[36:39], v[20:23], v[84:87]
ds_write_b32 v151, v101 offset:29700
v_mfma_f32_16x16x32_bf16 v[84:87], a[60:63], v[24:27], v[84:87]
ds_write_b32 v151, v102 offset:30208
v_mfma_f32_16x16x32_bf16 v[84:87], a[84:87], v[28:31], v[84:87]
ds_write_b32 v151, v103 offset:30212
v_mfma_f32_16x16x32_bf16 v[88:91], a[16:19], v[16:19], 0
v_mfma_f32_16x16x32_bf16 v[88:91], a[40:43], v[20:23], v[88:91]
buffer_load_dwordx4 v[68:71], v1, s[36:39], s86 offen offset:3072 sc1
v_mfma_f32_16x16x32_bf16 v[88:91], a[64:67], v[24:27], v[88:91]
s_waitcnt lgkmcnt(0)
v_mfma_f32_16x16x32_bf16 v[88:91], a[88:91], v[28:31], v[88:91]
s_branch K5_B0f
K5_G1f:
v_mfma_f32_16x16x32_bf16 v[72:75], a[0:3], v[16:19], 0
buffer_load_dword v6, v5, s[36:39], 0 offen sc1
v_mfma_f32_16x16x32_bf16 v[72:75], a[24:27], v[20:23], v[72:75]
ds_write_b32 v151, v84 offset:3072
v_mfma_f32_16x16x32_bf16 v[72:75], a[48:51], v[24:27], v[72:75]
buffer_load_dwordx4 v[56:59], v1, s[36:39], s80 offen offset:0 sc1
v_mfma_f32_16x16x32_bf16 v[72:75], a[72:75], v[28:31], v[72:75]
ds_write_b32 v151, v85 offset:3076
v_mfma_f32_16x16x32_bf16 v[76:79], a[4:7], v[16:19], 0
ds_write_b32 v151, v86 offset:3584
v_mfma_f32_16x16x32_bf16 v[76:79], a[28:31], v[20:23], v[76:79]
ds_write_b32 v151, v87 offset:3588
v_mfma_f32_16x16x32_bf16 v[76:79], a[52:55], v[24:27], v[76:79]
ds_write_b32 v151, v88 offset:4096
v_mfma_f32_16x16x32_bf16 v[76:79], a[76:79], v[28:31], v[76:79]
buffer_load_dwordx4 v[60:63], v1, s[36:39], s80 offen offset:1024 sc1
v_mfma_f32_16x16x32_bf16 v[80:83], a[8:11], v[16:19], 0
ds_write_b32 v151, v89 offset:4100
v_mfma_f32_16x16x32_bf16 v[80:83], a[32:35], v[20:23], v[80:83]
ds_write_b32 v151, v90 offset:4608
v_mfma_f32_16x16x32_bf16 v[80:83], a[56:59], v[24:27], v[80:83]
ds_write_b32 v151, v91 offset:4612
v_mfma_f32_16x16x32_bf16 v[80:83], a[80:83], v[28:31], v[80:83]
ds_write_b32 v151, v92 offset:5120
v_mfma_f32_16x16x32_bf16 v[84:87], a[12:15], v[16:19], 0
buffer_load_dwordx4 v[64:67], v1, s[36:39], s80 offen offset:2048 sc1
v_mfma_f32_16x16x32_bf16 v[84:87], a[36:39], v[20:23], v[84:87]
ds_write_b32 v151, v93 offset:5124
v_mfma_f32_16x16x32_bf16 v[84:87], a[60:63], v[24:27], v[84:87]
ds_write_b32 v151, v94 offset:5632
v_mfma_f32_16x16x32_bf16 v[84:87], a[84:87], v[28:31], v[84:87]
ds_write_b32 v151, v95 offset:5636
v_mfma_f32_16x16x32_bf16 v[96:99], a[16:19], v[16:19], 0
v_mfma_f32_16x16x32_bf16 v[96:99], a[40:43], v[20:23], v[96:99]
buffer_load_dwordx4 v[68:71], v1, s[36:39], s86 offen offset:3072 sc1
v_mfma_f32_16x16x32_bf16 v[96:99], a[64:67], v[24:27], v[96:99]
s_waitcnt lgkmcnt(0)
v_mfma_f32_16x16x32_bf16 v[96:99], a[88:91], v[28:31], v[96:99]
s_branch K5_B1f
.p2align 6
K5_F0g:
v_mfma_f32_16x16x32_bf16 v[72:75], a[0:3], v[16:19], 0
buffer_load_dword v6, v5, s[36:39], 0 offen sc1
v_mfma_f32_16x16x32_bf16 v[72:75], a[24:27], v[20:23], v[72:75]
ds_write_b32 v151, v84 offset:27648
v_mfma_f32_16x16x32_bf16 v[72:75], a[48:51], v[24:27], v[72:75]
buffer_load_dwordx4 v[56:59], v1, s[36:39], s80 offen offset:0 sc1
v_mfma_f32_16x16x32_bf16 v[72:75], a[72:75], v[28:31], v[72:75]
ds_write_b32 v151, v85 offset:27652
v_mfma_f32_16x16x32_bf16 v[76:79], a[4:7], v[16:19], 0
ds_write_b32 v151, v86 offset:28160
v_mfma_f32_16x16x32_bf16 v[76:79], a[28:31], v[20:23], v[76:79]
ds_write_b32 v151, v87 offset:28164
v_mfma_f32_16x16x32_bf16 v[76:79], a[52:55], v[24:27], v[76:79]
ds_write_b32 v151, v96 offset:28672
v_mfma_f32_16x16x32_bf16 v[76:79], a[76:79], v[28:31], v[76:79]
buffer_load_dwordx4 v[60:63], v1, s[36:39], s80 offen offset:1024 sc1
v_mfma_f32_16x16x32_bf16 v[80:83], a[8:11], v[16:19], 0
ds_write_b32 v151, v97 offset:28676
v_mfma_f32_16x16x32_bf16 v[80:83], a[32:35], v[20:23], v[80:83]
ds_write_b32 v151, v98 offset:29184
v_mfma_f32_16x16x32_bf16 v[80:83], a[56:59], v[24:27], v[80:83]
ds_write_b32 v151, v99 offset:29188
v_mfma_f32_16x16x32_bf16 v[80:83], a[80:83], v[28:31], v[80:83]
ds_write_b32 v151, v100 offset:29696
v_mfma_f32_16x16x32_bf16 v[84:87], a[12:15], v[16:19], 0
buffer_load_dwordx4 v[64:67], v1, s[36:39], s80 offen offset:2048 sc1
v_mfma_f32_16x16x32_bf16 v[84:87], a[36:39], v[20:23], v[84:87]
ds_write_b32 v151, v101 offset:29700
v_mfma_f32_16x16x32_bf16 v[84:87], a[60:63], v[24:27], v[84:87]
ds_write_b32 v151, v102 offset:30208
v_mfma_f32_16x16x32_bf16 v[84:87], a[84:87], v[28:31], v[84:87]
ds_write_b32 v151, v103 offset:30212
v_mfma_f32_16x16x32_bf16 v[88:91], a[16:19], v[16:19], 0
v_mfma_f32_16x16x32_bf16 v[88:91], a[40:43], v[20:23], v[88:91]
buffer_load_dwordx4 v[68:71], v1, s[36:39], s86 offen offset:3072 sc1
v_mfma_f32_16x16x32_bf16 v[88:91], a[64:67], v[24:27], v[88:91]
s_waitcnt lgkmcnt(0)
v_mfma_f32_16x16x32_bf16 v[88:91], a[88:91], v[28:31], v[88:91]
s_barrier
K5_B0g:
v_mfma_f32_16x16x32_bf16 v[92:95], a[20:23], v[16:19], 0
s_add_u32 s13, s64, 1
s_cmp_eq_u32 s13, 17
s_addc_u32 s13, s13, 0
v_mfma_f32_16x16x32_bf16 v[92:95], a[44:47], v[20:23], v[92:95]
s_sub_u32 s1, s13, 17
s_cselect_b32 s1, s13, s1
s_and_b32 s66, s13, 7
v_mfma_f32_16x16x32_bf16 v[92:95], a[68:71], v[24:27], v[92:95]
s_mul_i32 s66, s66, 55296
s_add_u32 s66, s66, s10
s_add_u32 s65, s13, 2
v_mfma_f32_16x16x32_bf16 v[92:95], a[92:95], v[28:31], v[92:95]
s_waitcnt vmcnt(8)
s_waitcnt vmcnt(4)
v_cmp_le_u32 vcc, s65, v6
v_mfma_f32_16x16x32_bf16 v[72:75], a[96:99], v[32:35], v[72:75]
s_cmp_eq_u64 vcc, -1
v_mfma_f32_16x16x32_bf16 v[72:75], a[120:123], v[36:39], v[72:75]
s_cbranch_scc0 K5_W0g
K5_W0gR:
s_cselect_b32 s68, 1, 0
v_mfma_f32_16x16x32_bf16 v[72:75], a[144:147], v[40:43], v[72:75]
s_cselect_b32 s42, 0x4000000, 0
v_mfma_f32_16x16x32_bf16 v[76:79], a[100:103], v[32:35], v[76:79]
buffer_load_dwordx4 v[16:19], v1, s[40:43], s66 offen offset:0 sc1
v_mfma_f32_16x16x32_bf16 v[76:79], a[124:127], v[36:39], v[76:79]
s_add_u32 s80, s66, 10240
s_add_u32 s86, s80, s84
v_mfma_f32_16x16x32_bf16 v[76:79], a[148:151], v[40:43], v[76:79]
v_mfma_f32_16x16x32_bf16 v[80:83], a[104:107], v[32:35], v[80:83]
buffer_load_dwordx4 v[20:23], v1, s[40:43], s66 offen offset:1024 sc1
v_mfma_f32_16x16x32_bf16 v[80:83], a[128:131], v[36:39], v[80:83]
v_mfma_f32_16x16x32_bf16 v[80:83], a[152:155], v[40:43], v[80:83]
v_mfma_f32_16x16x32_bf16 v[84:87], a[108:111], v[32:35], v[84:87]
v_mfma_f32_16x16x32_bf16 v[84:87], a[132:135], v[36:39], v[84:87]
v_mfma_f32_16x16x32_bf16 v[84:87], a[156:159], v[40:43], v[84:87]
v_mfma_f32_16x16x32_bf16 v[88:91], a[112:115], v[32:35], v[88:91]
buffer_load_dwordx4 v[24:27], v1, s[40:43], s66 offen offset:2048 sc1
v_mfma_f32_16x16x32_bf16 v[88:91], a[136:139], v[36:39], v[88:91]
v_mfma_f32_16x16x32_bf16 v[88:91], a[160:163], v[40:43], v[88:91]
v_mfma_f32_16x16x32_bf16 v[92:95], a[116:119], v[32:35], v[92:95]
v_mfma_f32_16x16x32_bf16 v[92:95], a[140:143], v[36:39], v[92:95]
v_mfma_f32_16x16x32_bf16 v[92:95], a[164:167], v[40:43], v[92:95]
s_waitcnt vmcnt(8)
v_mfma_f32_16x16x32_bf16 v[72:75], a[168:171], v[44:47], v[72:75]
buffer_load_dwordx4 v[28:31], v1, s[40:43], s66 offen offset:3072 sc1
v_mfma_f32_16x16x32_bf16 v[72:75], a[192:195], v[48:51], v[72:75]
s_add_u32 s69, s66, 4096
v_mfma_f32_16x16x32_bf16 v[72:75], a[216:219], v[52:55], v[72:75]
v_mfma_f32_16x16x32_bf16 v[76:79], a[172:175], v[44:47], v[76:79]
v_mfma_f32_16x16x32_bf16 v[76:79], a[196:199], v[48:51], v[76:79]
buffer_load_dwordx4 v[32:35], v1, s[40:43], s69 offen offset:0 sc1
v_mfma_f32_16x16x32_bf16 v[76:79], a[220:223], v[52:55], v[76:79]
v_mfma_f32_16x16x32_bf16 v[80:83], a[176:179], v[44:47], v[80:83]
v_mfma_f32_16x16x32_bf16 v[80:83], a[200:203], v[48:51], v[80:83]
v_mfma_f32_16x16x32_bf16 v[80:83], a[224:227], v[52:55], v[80:83]
v_mfma_f32_16x16x32_bf16 v[84:87], a[180:183], v[44:47], v[84:87]
buffer_load_dwordx4 v[36:39], v1, s[40:43], s69 offen offset:1024 sc1
v_mfma_f32_16x16x32_bf16 v[84:87], a[204:207], v[48:51], v[84:87]
v_mfma_f32_16x16x32_bf16 v[84:87], a[228:231], v[52:55], v[84:87]
v_mfma_f32_16x16x32_bf16 v[88:91], a[184:187], v[44:47], v[88:91]
v_mfma_f32_16x16x32_bf16 v[88:91], a[208:211], v[48:51], v[88:91]
v_mfma_f32_16x16x32_bf16 v[88:91], a[232:235], v[52:55], v[88:91]
buffer_load_dwordx4 v[40:43], v1, s[40:43], s69 offen offset:2048 sc1
v_mfma_f32_16x16x32_bf16 v[92:95], a[188:191], v[44:47], v[92:95]
v_mfma_f32_16x16x32_bf16 v[92:95], a[212:215], v[48:51], v[92:95]
v_mfma_f32_16x16x32_bf16 v[92:95], a[236:239], v[52:55], v[92:95]
s_waitcnt vmcnt(7)
v_mfma_f32_16x16x32_bf16 v[72:75], a[240:243], v[56:59], v[72:75]
buffer_load_dwordx4 v[44:47], v1, s[40:43], s69 offen offset:3072 sc1
v_mfma_f32_16x16x32_bf16 v[72:75], v[196:199], v[60:63], v[72:75]
s_add_u32 s69, s66, 8192
v_mfma_f32_16x16x32_bf16 v[72:75], v[220:223], v[64:67], v[72:75]
v_mfma_f32_16x16x32_bf16 v[72:75], v[244:247], v[68:71], v[72:75]
buffer_load_dwordx4 v[48:51], v1, s[40:43], s69 offen offset:0 sc1
v_mfma_f32_16x16x32_bf16 v[76:79], a[244:247], v[56:59], v[76:79]
s_mul_i32 s67, s0, s100
s_add_u32 s67, s67, s11
s_mov_b32 s46, s74
v_mfma_f32_16x16x32_bf16 v[76:79], v[200:203], v[60:63], v[76:79]
s_add_u32 s79, s64, 19
s_mov_b32 s62, s81
s_mov_b32 s64, s13
v_mfma_f32_16x16x32_bf16 v[76:79], v[224:227], v[64:67], v[76:79]
s_mov_b32 s0, s1
ds_write_b32 v151, v72 offset:0
v_mfma_f32_16x16x32_bf16 v[76:79], v[248:251], v[68:71], v[76:79]
buffer_load_dwordx4 v[52:55], v1, s[40:43], s69 offen offset:1024 sc1
v_mfma_f32_16x16x32_bf16 v[80:83], a[248:251], v[56:59], v[80:83]
s_cmp_eq_u32 s68, 0
ds_write_b32 v151, v73 offset:4
v_mfma_f32_16x16x32_bf16 v[80:83], v[204:207], v[60:63], v[80:83]
ds_write_b32 v151, v74 offset:512
v_mfma_f32_16x16x32_bf16 v[80:83], v[228:231], v[64:67], v[80:83]
ds_write_b32 v151, v75 offset:516
v_mfma_f32_16x16x32_bf16 v[80:83], v[252:255], v[68:71], v[80:83]
ds_write_b32 v151, v76 offset:1024
v_mfma_f32_16x16x32_bf16 v[84:87], a[252:255], v[56:59], v[84:87]
ds_write_b32 v151, v77 offset:1028
v_mfma_f32_16x16x32_bf16 v[84:87], v[208:211], v[60:63], v[84:87]
ds_write_b32 v151, v78 offset:1536
v_mfma_f32_16x16x32_bf16 v[84:87], v[232:235], v[64:67], v[84:87]
ds_write_b32 v151, v79 offset:1540
v_mfma_f32_16x16x32_bf16 v[88:91], v[188:191], v[56:59], v[88:91]
ds_write_b32 v151, v80 offset:2048
v_mfma_f32_16x16x32_bf16 v[88:91], v[212:215], v[60:63], v[88:91]
ds_write_b32 v151, v81 offset:2052
v_mfma_f32_16x16x32_bf16 v[88:91], v[236:239], v[64:67], v[88:91]
ds_write_b32 v151, v82 offset:2560
v_mfma_f32_16x16x32_bf16 v[92:95], v[192:195], v[56:59], v[92:95]
ds_write_b32 v151, v83 offset:2564
v_mfma_f32_16x16x32_bf16 v[92:95], v[216:219], v[60:63], v[92:95]
s_waitcnt vmcnt(6)
v_mfma_f32_16x16x32_bf16 v[92:95], v[240:243], v[64:67], v[92:95]
s_cbranch_scc1 K5_X0g
K5_F1g:
v_mfma_f32_16x16x32_bf16 v[72:75], a[0:3], v[16:19], 0
buffer_load_dword v6, v5, s[36:39], 0 offen sc1
v_mfma_f32_16x16x32_bf16 v[72:75], a[24:27], v[20:23], v[72:75]
ds_write_b32 v151, v84 offset:3072
v_mfma_f32_16x16x32_bf16 v[72:75], a[48:51], v[24:27], v[72:75]
buffer_load_dwordx4 v[56:59], v1, s[36:39], s80 offen offset:0 sc1
v_mfma_f32_16x16x32_bf16 v[72:75], a[72:75], v[28:31], v[72:75]
ds_write_b32 v151, v85 offset:3076
v_mfma_f32_16x16x32_bf16 v[76:79], a[4:7], v[16:19], 0
ds_write_b32 v151, v86 offset:3584
v_mfma_f32_16x16x32_bf16 v[76:79], a[28:31], v[20:23], v[76:79]
ds_write_b32 v151, v87 offset:3588
v_mfma_f32_16x16x32_bf16 v[76:79], a[52:55], v[24:27], v[76:79]
ds_write_b32 v151, v88 offset:4096
v_mfma_f32_16x16x32_bf16 v[76:79], a[76:79], v[28:31], v[76:79]
buffer_load_dwordx4 v[60:63], v1, s[36:39], s80 offen offset:1024 sc1
v_mfma_f32_16x16x32_bf16 v[80:83], a[8:11], v[16:19], 0
ds_write_b32 v151, v89 offset:4100
v_mfma_f32_16x16x32_bf16 v[80:83], a[32:35], v[20:23], v[80:83]
ds_write_b32 v151, v90 offset:4608
v_mfma_f32_16x16x32_bf16 v[80:83], a[56:59], v[24:27], v[80:83]
ds_write_b32 v151, v91 offset:4612
v_mfma_f32_16x16x32_bf16 v[80:83], a[80:83], v[28:31], v[80:83]
ds_write_b32 v151, v92 offset:5120
v_mfma_f32_16x16x32_bf16 v[84:87], a[12:15], v[16:19], 0
buffer_load_dwordx4 v[64:67], v1, s[36:39], s80 offen offset:2048 sc1
v_mfma_f32_16x16x32_bf16 v[84:87], a[36:39], v[20:23], v[84:87]
ds_write_b32 v151, v93 offset:5124
v_mfma_f32_16x16x32_bf16 v[84:87], a[60:63], v[24:27], v[84:87]
ds_write_b32 v151, v94 offset:5632
v_mfma_f32_16x16x32_bf16 v[84:87], a[84:87], v[28:31], v[84:87]
ds_write_b32 v151, v95 offset:5636
v_mfma_f32_16x16x32_bf16 v[96:99], a[16:19], v[16:19], 0
v_mfma_f32_16x16x32_bf16 v[96:99], a[40:43], v[20:23], v[96:99]
buffer_load_dwordx4 v[68:71], v1, s[36:39], s86 offen offset:3072 sc1
v_mfma_f32_16x16x32_bf16 v[96:99], a[64:67], v[24:27], v[96:99]
s_waitcnt lgkmcnt(0)
v_mfma_f32_16x16x32_bf16 v[96:99], a[88:91], v[28:31], v[96:99]
s_barrier
K5_B1g:
v_mfma_f32_16x16x32_bf16 v[100:103], a[20:23], v[16:19], 0
s_add_u32 s13, s64, 1
s_cmp_eq_u32 s13, 17
s_addc_u32 s13, s13, 0
v_mfma_f32_16x16x32_bf16 v[100:103], a[44:47], v[20:23], v[100:103]
s_sub_u32 s1, s13, 17
s_cselect_b32 s1, s13, s1
s_and_b32 s66, s13, 7
v_mfma_f32_16x16x32_bf16 v[100:103], a[68:71], v[24:27], v[100:103]
s_mul_i32 s66, s66, 55296
s_add_u32 s66, s66, s10
s_add_u32 s65, s13, 2
v_mfma_f32_16x16x32_bf16 v[100:103], a[92:95], v[28:31], v[100:103]
s_waitcnt vmcnt(8)
s_waitcnt vmcnt(4)
v_cmp_le_u32 vcc, s65, v6
v_mfma_f32_16x16x32_bf16 v[72:75], a[96:99], v[32:35], v[72:75]
s_cmp_eq_u64 vcc, -1
v_mfma_f32_16x16x32_bf16 v[72:75], a[120:123], v[36:39], v[72:75]
s_cbranch_scc0 K5_W1g
K5_W1gR:
s_cselect_b32 s68, 1, 0
v_mfma_f32_16x16x32_bf16 v[72:75], a[144:147], v[40:43], v[72:75]
s_cselect_b32 s42, 0x4000000, 0
v_mfma_f32_16x16x32_bf16 v[76:79], a[100:103], v[32:35], v[76:79]
buffer_load_dwordx4 v[16:19], v1, s[40:43], s66 offen offset:0 sc1
v_mfma_f32_16x16x32_bf16 v[76:79], a[124:127], v[36:39], v[76:79]
s_add_u32 s80, s66, 10240
s_add_u32 s86, s80, s84
v_mfma_f32_16x16x32_bf16 v[76:79], a[148:151], v[40:43], v[76:79]
v_mfma_f32_16x16x32_bf16 v[80:83], a[104:107], v[32:35], v[80:83]
buffer_load_dwordx4 v[20:23], v1, s[40:43], s66 offen offset:1024 sc1
v_mfma_f32_16x16x32_bf16 v[80:83], a[128:131], v[36:39], v[80:83]
v_mfma_f32_16x16x32_bf16 v[80:83], a[152:155], v[40:43], v[80:83]
v_mfma_f32_16x16x32_bf16 v[84:87], a[108:111], v[32:35], v[84:87]
v_mfma_f32_16x16x32_bf16 v[84:87], a[132:135], v[36:39], v[84:87]
v_mfma_f32_16x16x32_bf16 v[84:87], a[156:159], v[40:43], v[84:87]
v_mfma_f32_16x16x32_bf16 v[96:99], a[112:115], v[32:35], v[96:99]
buffer_load_dwordx4 v[24:27], v1, s[40:43], s66 offen offset:2048 sc1
v_mfma_f32_16x16x32_bf16 v[96:99], a[136:139], v[36:39], v[96:99]
v_mfma_f32_16x16x32_bf16 v[96:99], a[160:163], v[40:43], v[96:99]
v_mfma_f32_16x16x32_bf16 v[100:103], a[116:119], v[32:35], v[100:103]
v_mfma_f32_16x16x32_bf16 v[100:103], a[140:143], v[36:39], v[100:103]
v_mfma_f32_16x16x32_bf16 v[100:103], a[164:167], v[40:43], v[100:103]
s_waitcnt vmcnt(8)
v_mfma_f32_16x16x32_bf16 v[72:75], a[168:171], v[44:47], v[72:75]
buffer_load_dwordx4 v[28:31], v1, s[40:43], s66 offen offset:3072 sc1
v_mfma_f32_16x16x32_bf16 v[72:75], a[192:195], v[48:51], v[72:75]
s_add_u32 s69, s66, 4096
v_mfma_f32_16x16x32_bf16 v[72:75], a[216:219], v[52:55], v[72:75]
v_mfma_f32_16x16x32_bf16 v[76:79], a[172:175], v[44:47], v[76:79]
v_mfma_f32_16x16x32_bf16 v[76:79], a[196:199], v[48:51], v[76:79]
buffer_load_dwordx4 v[32:35], v1, s[40:43], s69 offen offset:0 sc1
v_mfma_f32_16x16x32_bf16 v[76:79], a[220:223], v[52:55], v[76:79]
v_mfma_f32_16x16x32_bf16 v[80:83], a[176:179], v[44:47], v[80:83]
v_mfma_f32_16x16x32_bf16 v[80:83], a[200:203], v[48:51], v[80:83]
v_mfma_f32_16x16x32_bf16 v[80:83], a[224:227], v[52:55], v[80:83]
v_mfma_f32_16x16x32_bf16 v[84:87], a[180:183], v[44:47], v[84:87]
buffer_load_dwordx4 v[36:39], v1, s[40:43], s69 offen offset:1024 sc1
v_mfma_f32_16x16x32_bf16 v[84:87], a[204:207], v[48:51], v[84:87]
v_mfma_f32_16x16x32_bf16 v[84:87], a[228:231], v[52:55], v[84:87]
v_mfma_f32_16x16x32_bf16 v[96:99], a[184:187], v[44:47], v[96:99]
v_mfma_f32_16x16x32_bf16 v[96:99], a[208:211], v[48:51], v[96:99]
v_mfma_f32_16x16x32_bf16 v[96:99], a[232:235], v[52:55], v[96:99]
buffer_load_dwordx4 v[40:43], v1, s[40:43], s69 offen offset:2048 sc1
v_mfma_f32_16x16x32_bf16 v[100:103], a[188:191], v[44:47], v[100:103]
v_mfma_f32_16x16x32_bf16 v[100:103], a[212:215], v[48:51], v[100:103]
v_mfma_f32_16x16x32_bf16 v[100:103], a[236:239], v[52:55], v[100:103]
s_waitcnt vmcnt(7)
v_mfma_f32_16x16x32_bf16 v[72:75], a[240:243], v[56:59], v[72:75]
buffer_load_dwordx4 v[44:47], v1, s[40:43], s69 offen offset:3072 sc1
v_mfma_f32_16x16x32_bf16 v[72:75], v[196:199], v[60:63], v[72:75]
s_add_u32 s69, s66, 8192
v_mfma_f32_16x16x32_bf16 v[72:75], v[220:223], v[64:67], v[72:75]
v_mfma_f32_16x16x32_bf16 v[72:75], v[244:247], v[68:71], v[72:75]
buffer_load_dwordx4 v[48:51], v1, s[40:43], s69 offen offset:0 sc1
v_mfma_f32_16x16x32_bf16 v[76:79], a[244:247], v[56:59], v[76:79]
s_mul_i32 s67, s0, s100
s_add_u32 s67, s67, s11
s_mov_b32 s46, s74
v_mfma_f32_16x16x32_bf16 v[76:79], v[200:203], v[60:63], v[76:79]
s_add_u32 s79, s64, 19
s_mov_b32 s62, s81
s_mov_b32 s64, s13
v_mfma_f32_16x16x32_bf16 v[76:79], v[224:227], v[64:67], v[76:79]
s_mov_b32 s0, s1
ds_write_b32 v151, v72 offset:24576
v_mfma_f32_16x16x32_bf16 v[76:79], v[248:251], v[68:71], v[76:79]
buffer_load_dwordx4 v[52:55], v1, s[40:43], s69 offen offset:1024 sc1
v_mfma_f32_16x16x32_bf16 v[80:83], a[248:251], v[56:59], v[80:83]
s_cmp_eq_u32 s68, 0
ds_write_b32 v151, v73 offset:24580
v_mfma_f32_16x16x32_bf16 v[80:83], v[204:207], v[60:63], v[80:83]
ds_write_b32 v151, v74 offset:25088
v_mfma_f32_16x16x32_bf16 v[80:83], v[228:231], v[64:67], v[80:83]
ds_write_b32 v151, v75 offset:25092
v_mfma_f32_16x16x32_bf16 v[80:83], v[252:255], v[68:71], v[80:83]
ds_write_b32 v151, v76 offset:25600
v_mfma_f32_16x16x32_bf16 v[84:87], a[252:255], v[56:59], v[84:87]
ds_write_b32 v151, v77 offset:25604
v_mfma_f32_16x16x32_bf16 v[84:87], v[208:211], v[60:63], v[84:87]
ds_write_b32 v151, v78 offset:26112
v_mfma_f32_16x16x32_bf16 v[84:87], v[232:235], v[64:67], v[84:87]
ds_write_b32 v151, v79 offset:26116
v_mfma_f32_16x16x32_bf16 v[96:99], v[188:191], v[56:59], v[96:99]
ds_write_b32 v151, v80 offset:26624
v_mfma_f32_16x16x32_bf16 v[96:99], v[212:215], v[60:63], v[96:99]
ds_write_b32 v151, v81 offset:26628
v_mfma_f32_16x16x32_bf16 v[96:99], v[236:239], v[64:67], v[96:99]
ds_write_b32 v151, v82 offset:27136
v_mfma_f32_16x16x32_bf16 v[100:103], v[192:195], v[56:59], v[100:103]
ds_write_b32 v151, v83 offset:27140
v_mfma_f32_16x16x32_bf16 v[100:103], v[216:219], v[60:63], v[100:103]
s_waitcnt vmcnt(6)
v_mfma_f32_16x16x32_bf16 v[100:103], v[240:243], v[64:67], v[100:103]
s_cbranch_scc1 K5_X1g
s_branch K5_F0g
K5_X0g:
s_cmp_lg_u32 s64, 19
s_cbranch_scc1 K5_NR0g
s_mov_b32 s44, s30
s_mov_b32 s45, s31
s_mov_b32 s74, 2621440
s_mov_b32 s46, s74
s_mov_b32 s81, 0
s_mov_b32 s62, 0
s_mov_b32 s100, 40960
s_mov_b32 s11, 4294926336
s_mov_b32 s67, 0
v_mov_b32 v148, v158
s_waitcnt vmcnt(0)
buffer_store_dword v8, v7, s[36:39], 0 offen
s_mov_b32 s7, 0x7ff00000
s_nop 1
v_writelane_b32 v7, s7, 0
s_cmp_eq_u32 s68, 1
s_cbranch_scc1 K5_F1g
s_branch K5_NR0g
K5_NR0g:
s_cmp_gt_u32 s64, 33
s_cbranch_scc1 K5_E0g
buffer_load_dword v6, v5, s[36:39], 0 offen sc1
ds_write_b32 v151, v84 offset:3072
ds_write_b32 v151, v85 offset:3076
ds_write_b32 v151, v86 offset:3584
ds_write_b32 v151, v87 offset:3588
ds_write_b32 v151, v88 offset:4096
ds_write_b32 v151, v89 offset:4100
ds_write_b32 v151, v90 offset:4608
ds_write_b32 v151, v91 offset:4612
ds_write_b32 v151, v92 offset:5120
ds_write_b32 v151, v93 offset:5124
ds_write_b32 v151, v94 offset:5632
ds_write_b32 v151, v95 offset:5636
s_waitcnt lgkmcnt(0)
s_barrier
s_waitcnt vmcnt(0)
buffer_store_dword v8, v7, s[36:39], 0 offen
v_cmp_le_u32 vcc, s65, v6
s_nop 0
s_cmp_eq_u64 vcc, -1
s_cselect_b32 s68, 1, 0
s_cselect_b32 s42, 0x4000000, 0
buffer_load_dwordx4 v[16:19], v1, s[40:43], s66 offen offset:0 sc1
s_add_u32 s80, s66, 10240
s_add_u32 s86, s80, s84
buffer_load_dwordx4 v[20:23], v1, s[40:43], s66 offen offset:1024 sc1
buffer_load_dwordx4 v[24:27], v1, s[40:43], s66 offen offset:2048 sc1
buffer_load_dwordx4 v[28:31], v1, s[40:43], s66 offen offset:3072 sc1
s_add_u32 s69, s66, 4096
buffer_load_dwordx4 v[32:35], v1, s[40:43], s69 offen offset:0 sc1
buffer_load_dwordx4 v[36:39], v1, s[40:43], s69 offen offset:1024 sc1
buffer_load_dwordx4 v[40:43], v1, s[40:43], s69 offen offset:2048 sc1
buffer_load_dwordx4 v[44:47], v1, s[40:43], s69 offen offset:3072 sc1
s_add_u32 s69, s66, 8192
buffer_load_dwordx4 v[48:51], v1, s[40:43], s69 offen offset:0 sc1
buffer_load_dwordx4 v[52:55], v1, s[40:43], s69 offen offset:1024 sc1
buffer_load_dword v6, v5, s[36:39], 0 offen sc1
v_add_u32 v8, s79, v11
s_mov_b32 s46, 0
s_mov_b32 s62, 0
s_cmp_eq_u32 s68, 0
s_cbranch_scc1 K5_N20g
s_waitcnt vmcnt(0)
buffer_store_dword v8, v7, s[36:39], 0 offen
s_branch K5_G1g
K5_N20g:
s_waitcnt vmcnt(0)
v_cmp_le_u32 vcc, s65, v6
s_nop 0
s_cmp_eq_u64 vcc, -1
s_cselect_b32 s68, 1, 0
s_cselect_b32 s42, 0x4000000, 0
buffer_load_dwordx4 v[16:19], v1, s[40:43], s66 offen offset:0 sc1
s_add_u32 s80, s66, 10240
s_add_u32 s86, s80, s84
buffer_load_dwordx4 v[20:23], v1, s[40:43], s66 offen offset:1024 sc1
buffer_load_dwordx4 v[24:27], v1, s[40:43], s66 offen offset:2048 sc1
buffer_load_dwordx4 v[28:31], v1, s[40:43], s66 offen offset:3072 sc1
s_add_u32 s69, s66, 4096
buffer_load_dwordx4 v[32:35], v1, s[40:43], s69 offen offset:0 sc1
buffer_load_dwordx4 v[36:39], v1, s[40:43], s69 offen offset:1024 sc1
buffer_load_dwordx4 v[40:43], v1, s[40:43], s69 offen offset:2048 sc1
buffer_load_dwordx4 v[44:47], v1, s[40:43], s69 offen offset:3072 sc1
s_add_u32 s69, s66, 8192
buffer_load_dwordx4 v[48:51], v1, s[40:43], s69 offen offset:0 sc1
buffer_load_dwordx4 v[52:55], v1, s[40:43], s69 offen offset:1024 sc1
buffer_load_dword v6, v5, s[36:39], 0 offen sc1
buffer_store_dword v8, v7, s[36:39], 0 offen
s_waitcnt vmcnt(1)
s_cmp_eq_u32 s68, 1
s_cbranch_scc1 K5_G1g
s_cmp_gt_u32 s64, 33
s_cbranch_scc1 L_FIN
K5_SW0g:
s_mov_b32 s75, 0
K5_SP0g:
buffer_load_dword v6, v5, s[36:39], 0 offen sc1
s_add_u32 s75, s75, 1
s_cmp_gt_u32 s75, 0x8000
s_cbranch_scc1 L_TIMEOUT
s_waitcnt vmcnt(0)
v_cmp_le_u32 vcc, s65, v6
s_nop 0
s_cmp_eq_u64 vcc, -1
s_cbranch_scc0 K5_SP0g
K5_LC0g:
s_mov_b32 s42, 0x4000000
buffer_load_dwordx4 v[16:19], v1, s[40:43], s66 offen offset:0 sc1
s_add_u32 s80, s66, 10240
s_add_u32 s86, s80, s84
buffer_load_dwordx4 v[20:23], v1, s[40:43], s66 offen offset:1024 sc1
buffer_load_dwordx4 v[24:27], v1, s[40:43], s66 offen offset:2048 sc1
buffer_load_dwordx4 v[28:31], v1, s[40:43], s66 offen offset:3072 sc1
s_add_u32 s69, s66, 4096
buffer_load_dwordx4 v[32:35], v1, s[40:43], s69 offen offset:0 sc1
buffer_load_dwordx4 v[36:39], v1, s[40:43], s69 offen offset:1024 sc1
buffer_load_dwordx4 v[40:43], v1, s[40:43], s69 offen offset:2048 sc1
buffer_load_dwordx4 v[44:47], v1, s[40:43], s69 offen offset:3072 sc1
s_add_u32 s69, s66, 8192
buffer_load_dwordx4 v[48:51], v1, s[40:43], s69 offen offset:0 sc1
buffer_load_dwordx4 v[52:55], v1, s[40:43], s69 offen offset:1024 sc1
buffer_load_dword v6, v5, s[36:39], 0 offen sc1
s_waitcnt vmcnt(0)
s_branch K5_G1g
K5_W0g:
s_mov_b32 s75, 6
s_cmp_lt_u32 s65, 36
s_cbranch_scc0 K5_W0gR
K5_W0gL:
buffer_load_dword v6, v5, s[36:39], 0 offen sc1
s_waitcnt vmcnt(0)
v_cmp_le_u32 vcc, s65, v6
s_nop 0
s_cmp_eq_u64 vcc, -1
s_cbranch_scc1 K5_W0gR
s_sub_u32 s75, s75, 1
s_cmp_lg_u32 s75, 0
s_cbranch_scc1 K5_W0gL
s_branch K5_W0gR
K5_E0g:
ds_write_b32 v151, v84 offset:3072
ds_write_b32 v151, v85 offset:3076
ds_write_b32 v151, v86 offset:3584
ds_write_b32 v151, v87 offset:3588
ds_write_b32 v151, v88 offset:4096
ds_write_b32 v151, v89 offset:4100
ds_write_b32 v151, v90 offset:4608
ds_write_b32 v151, v91 offset:4612
ds_write_b32 v151, v92 offset:5120
ds_write_b32 v151, v93 offset:5124
ds_write_b32 v151, v94 offset:5632
ds_write_b32 v151, v95 offset:5636
s_waitcnt lgkmcnt(0)
s_barrier
s_branch L_FIN
K5_X1g:
s_cmp_lg_u32 s64, 19
s_cbranch_scc1 K5_NR1g
s_mov_b32 s44, s30
s_mov_b32 s45, s31
s_mov_b32 s74, 2621440
s_mov_b32 s46, s74
s_mov_b32 s81, 0
s_mov_b32 s62, 0
s_mov_b32 s100, 40960
s_mov_b32 s11, 4294926336
s_mov_b32 s67, 0
v_mov_b32 v148, v158
s_waitcnt vmcnt(0)
buffer_store_dword v8, v7, s[36:39], 0 offen
s_mov_b32 s7, 0x7ff00000
s_nop 1
v_writelane_b32 v7, s7, 0
s_cmp_eq_u32 s68, 1
s_cbranch_scc1 K5_F0g
s_branch K5_NR1g
K5_NR1g:
s_cmp_gt_u32 s64, 33
s_cbranch_scc1 K5_E1g
buffer_load_dword v6, v5, s[36:39], 0 offen sc1
ds_write_b32 v151, v84 offset:27648
ds_write_b32 v151, v85 offset:27652
ds_write_b32 v151, v86 offset:28160
ds_write_b32 v151, v87 offset:28164
ds_write_b32 v151, v96 offset:28672
ds_write_b32 v151, v97 offset:28676
ds_write_b32 v151, v98 offset:29184
ds_write_b32 v151, v99 offset:29188
ds_write_b32 v151, v100 offset:29696
ds_write_b32 v151, v101 offset:29700
ds_write_b32 v151, v102 offset:30208
ds_write_b32 v151, v103 offset:30212
s_waitcnt lgkmcnt(0)
s_barrier
s_waitcnt vmcnt(0)
buffer_store_dword v8, v7, s[36:39], 0 offen
v_cmp_le_u32 vcc, s65, v6
s_nop 0
s_cmp_eq_u64 vcc, -1
s_cselect_b32 s68, 1, 0
s_cselect_b32 s42, 0x4000000, 0
buffer_load_dwordx4 v[16:19], v1, s[40:43], s66 offen offset:0 sc1
s_add_u32 s80, s66, 10240
s_add_u32 s86, s80, s84
buffer_load_dwordx4 v[20:23], v1, s[40:43], s66 offen offset:1024 sc1
buffer_load_dwordx4 v[24:27], v1, s[40:43], s66 offen offset:2048 sc1
buffer_load_dwordx4 v[28:31], v1, s[40:43], s66 offen offset:3072 sc1
s_add_u32 s69, s66, 4096
buffer_load_dwordx4 v[32:35], v1, s[40:43], s69 offen offset:0 sc1
buffer_load_dwordx4 v[36:39], v1, s[40:43], s69 offen offset:1024 sc1
buffer_load_dwordx4 v[40:43], v1, s[40:43], s69 offen offset:2048 sc1
buffer_load_dwordx4 v[44:47], v1, s[40:43], s69 offen offset:3072 sc1
s_add_u32 s69, s66, 8192
buffer_load_dwordx4 v[48:51], v1, s[40:43], s69 offen offset:0 sc1
buffer_load_dwordx4 v[52:55], v1, s[40:43], s69 offen offset:1024 sc1
buffer_load_dword v6, v5, s[36:39], 0 offen sc1
v_add_u32 v8, s79, v11
s_mov_b32 s46, 0
s_mov_b32 s62, 0
s_cmp_eq_u32 s68, 0
s_cbranch_scc1 K5_N21g
s_waitcnt vmcnt(0)
buffer_store_dword v8, v7, s[36:39], 0 offen
s_branch K5_G0g
K5_N21g:
s_waitcnt vmcnt(0)
v_cmp_le_u32 vcc, s65, v6
s_nop 0
s_cmp_eq_u64 vcc, -1
s_cselect_b32 s68, 1, 0
s_cselect_b32 s42, 0x4000000, 0
buffer_load_dwordx4 v[16:19], v1, s[40:43], s66 offen offset:0 sc1
s_add_u32 s80, s66, 10240
s_add_u32 s86, s80, s84
buffer_load_dwordx4 v[20:23], v1, s[40:43], s66 offen offset:1024 sc1
buffer_load_dwordx4 v[24:27], v1, s[40:43], s66 offen offset:2048 sc1
buffer_load_dwordx4 v[28:31], v1, s[40:43], s66 offen offset:3072 sc1
s_add_u32 s69, s66, 4096
buffer_load_dwordx4 v[32:35], v1, s[40:43], s69 offen offset:0 sc1
buffer_load_dwordx4 v[36:39], v1, s[40:43], s69 offen offset:1024 sc1
buffer_load_dwordx4 v[40:43], v1, s[40:43], s69 offen offset:2048 sc1
buffer_load_dwordx4 v[44:47], v1, s[40:43], s69 offen offset:3072 sc1
s_add_u32 s69, s66, 8192
buffer_load_dwordx4 v[48:51], v1, s[40:43], s69 offen offset:0 sc1
buffer_load_dwordx4 v[52:55], v1, s[40:43], s69 offen offset:1024 sc1
buffer_load_dword v6, v5, s[36:39], 0 offen sc1
buffer_store_dword v8, v7, s[36:39], 0 offen
s_waitcnt vmcnt(1)
s_cmp_eq_u32 s68, 1
s_cbranch_scc1 K5_G0g
s_cmp_gt_u32 s64, 33
s_cbranch_scc1 L_FIN
K5_SW1g:
s_mov_b32 s75, 0
K5_SP1g:
buffer_load_dword v6, v5, s[36:39], 0 offen sc1
s_add_u32 s75, s75, 1
s_cmp_gt_u32 s75, 0x8000
s_cbranch_scc1 L_TIMEOUT
s_waitcnt vmcnt(0)
v_cmp_le_u32 vcc, s65, v6
s_nop 0
s_cmp_eq_u64 vcc, -1
s_cbranch_scc0 K5_SP1g
K5_LC1g:
s_mov_b32 s42, 0x4000000
buffer_load_dwordx4 v[16:19], v1, s[40:43], s66 offen offset:0 sc1
s_add_u32 s80, s66, 10240
s_add_u32 s86, s80, s84
buffer_load_dwordx4 v[20:23], v1, s[40:43], s66 offen offset:1024 sc1
buffer_load_dwordx4 v[24:27], v1, s[40:43], s66 offen offset:2048 sc1
buffer_load_dwordx4 v[28:31], v1, s[40:43], s66 offen offset:3072 sc1
s_add_u32 s69, s66, 4096
buffer_load_dwordx4 v[32:35], v1, s[40:43], s69 offen offset:0 sc1
buffer_load_dwordx4 v[36:39], v1, s[40:43], s69 offen offset:1024 sc1
buffer_load_dwordx4 v[40:43], v1, s[40:43], s69 offen offset:2048 sc1
buffer_load_dwordx4 v[44:47], v1, s[40:43], s69 offen offset:3072 sc1
s_add_u32 s69, s66, 8192
buffer_load_dwordx4 v[48:51], v1, s[40:43], s69 offen offset:0 sc1
buffer_load_dwordx4 v[52:55], v1, s[40:43], s69 offen offset:1024 sc1
buffer_load_dword v6, v5, s[36:39], 0 offen sc1
s_waitcnt vmcnt(0)
s_branch K5_G0g
K5_W1g:
s_mov_b32 s75, 6
s_cmp_lt_u32 s65, 36
s_cbranch_scc0 K5_W1gR
K5_W1gL:
buffer_load_dword v6, v5, s[36:39], 0 offen sc1
s_waitcnt vmcnt(0)
v_cmp_le_u32 vcc, s65, v6
s_nop 0
s_cmp_eq_u64 vcc, -1
s_cbranch_scc1 K5_W1gR
s_sub_u32 s75, s75, 1
s_cmp_lg_u32 s75, 0
s_cbranch_scc1 K5_W1gL
s_branch K5_W1gR
K5_E1g:
ds_write_b32 v151, v84 offset:27648
ds_write_b32 v151, v85 offset:27652
ds_write_b32 v151, v86 offset:28160
ds_write_b32 v151, v87 offset:28164
ds_write_b32 v151, v96 offset:28672
ds_write_b32 v151, v97 offset:28676
ds_write_b32 v151, v98 offset:29184
ds_write_b32 v151, v99 offset:29188
ds_write_b32 v151, v100 offset:29696
ds_write_b32 v151, v101 offset:29700
ds_write_b32 v151, v102 offset:30208
ds_write_b32 v151, v103 offset:30212
s_waitcnt lgkmcnt(0)
s_barrier
s_branch L_FIN
K5_G0g:
v_mfma_f32_16x16x32_bf16 v[72:75], a[0:3], v[16:19], 0
buffer_load_dword v6, v5, s[36:39], 0 offen sc1
v_mfma_f32_16x16x32_bf16 v[72:75], a[24:27], v[20:23], v[72:75]
ds_write_b32 v151, v84 offset:27648
v_mfma_f32_16x16x32_bf16 v[72:75], a[48:51], v[24:27], v[72:75]
buffer_load_dwordx4 v[56:59], v1, s[36:39], s80 offen offset:0 sc1
v_mfma_f32_16x16x32_bf16 v[72:75], a[72:75], v[28:31], v[72:75]
ds_write_b32 v151, v85 offset:27652
v_mfma_f32_16x16x32_bf16 v[76:79], a[4:7], v[16:19], 0
ds_write_b32 v151, v86 offset:28160
v_mfma_f32_16x16x32_bf16 v[76:79], a[28:31], v[20:23], v[76:79]
ds_write_b32 v151, v87 offset:28164
v_mfma_f32_16x16x32_bf16 v[76:79], a[52:55], v[24:27], v[76:79]
ds_write_b32 v151, v96 offset:28672
v_mfma_f32_16x16x32_bf16 v[76:79], a[76:79], v[28:31], v[76:79]
buffer_load_dwordx4 v[60:63], v1, s[36:39], s80 offen offset:1024 sc1
v_mfma_f32_16x16x32_bf16 v[80:83], a[8:11], v[16:19], 0
ds_write_b32 v151, v97 offset:28676
v_mfma_f32_16x16x32_bf16 v[80:83], a[32:35], v[20:23], v[80:83]
ds_write_b32 v151, v98 offset:29184
v_mfma_f32_16x16x32_bf16 v[80:83], a[56:59], v[24:27], v[80:83]
ds_write_b32 v151, v99 offset:29188
v_mfma_f32_16x16x32_bf16 v[80:83], a[80:83], v[28:31], v[80:83]
ds_write_b32 v151, v100 offset:29696
v_mfma_f32_16x16x32_bf16 v[84:87], a[12:15], v[16:19], 0
buffer_load_dwordx4 v[64:67], v1, s[36:39], s80 offen offset:2048 sc1
v_mfma_f32_16x16x32_bf16 v[84:87], a[36:39], v[20:23], v[84:87]
ds_write_b32 v151, v101 offset:29700
v_mfma_f32_16x16x32_bf16 v[84:87], a[60:63], v[24:27], v[84:87]
ds_write_b32 v151, v102 offset:30208
v_mfma_f32_16x16x32_bf16 v[84:87], a[84:87], v[28:31], v[84:87]
ds_write_b32 v151, v103 offset:30212
v_mfma_f32_16x16x32_bf16 v[88:91], a[16:19], v[16:19], 0
v_mfma_f32_16x16x32_bf16 v[88:91], a[40:43], v[20:23], v[88:91]
buffer_load_dwordx4 v[68:71], v1, s[36:39], s86 offen offset:3072 sc1
v_mfma_f32_16x16x32_bf16 v[88:91], a[64:67], v[24:27], v[88:91]
s_waitcnt lgkmcnt(0)
v_mfma_f32_16x16x32_bf16 v[88:91], a[88:91], v[28:31], v[88:91]
s_branch K5_B0g
K5_G1g:
v_mfma_f32_16x16x32_bf16 v[72:75], a[0:3], v[16:19], 0
buffer_load_dword v6, v5, s[36:39], 0 offen sc1
v_mfma_f32_16x16x32_bf16 v[72:75], a[24:27], v[20:23], v[72:75]
ds_write_b32 v151, v84 offset:3072
v_mfma_f32_16x16x32_bf16 v[72:75], a[48:51], v[24:27], v[72:75]
buffer_load_dwordx4 v[56:59], v1, s[36:39], s80 offen offset:0 sc1
v_mfma_f32_16x16x32_bf16 v[72:75], a[72:75], v[28:31], v[72:75]
ds_write_b32 v151, v85 offset:3076
v_mfma_f32_16x16x32_bf16 v[76:79], a[4:7], v[16:19], 0
ds_write_b32 v151, v86 offset:3584
v_mfma_f32_16x16x32_bf16 v[76:79], a[28:31], v[20:23], v[76:79]
ds_write_b32 v151, v87 offset:3588
v_mfma_f32_16x16x32_bf16 v[76:79], a[52:55], v[24:27], v[76:79]
ds_write_b32 v151, v88 offset:4096
v_mfma_f32_16x16x32_bf16 v[76:79], a[76:79], v[28:31], v[76:79]
buffer_load_dwordx4 v[60:63], v1, s[36:39], s80 offen offset:1024 sc1
v_mfma_f32_16x16x32_bf16 v[80:83], a[8:11], v[16:19], 0
ds_write_b32 v151, v89 offset:4100
v_mfma_f32_16x16x32_bf16 v[80:83], a[32:35], v[20:23], v[80:83]
ds_write_b32 v151, v90 offset:4608
v_mfma_f32_16x16x32_bf16 v[80:83], a[56:59], v[24:27], v[80:83]
ds_write_b32 v151, v91 offset:4612
v_mfma_f32_16x16x32_bf16 v[80:83], a[80:83], v[28:31], v[80:83]
ds_write_b32 v151, v92 offset:5120
v_mfma_f32_16x16x32_bf16 v[84:87], a[12:15], v[16:19], 0
buffer_load_dwordx4 v[64:67], v1, s[36:39], s80 offen offset:2048 sc1
v_mfma_f32_16x16x32_bf16 v[84:87], a[36:39], v[20:23], v[84:87]
ds_write_b32 v151, v93 offset:5124
v_mfma_f32_16x16x32_bf16 v[84:87], a[60:63], v[24:27], v[84:87]
ds_write_b32 v151, v94 offset:5632
v_mfma_f32_16x16x32_bf16 v[84:87], a[84:87], v[28:31], v[84:87]
ds_write_b32 v151, v95 offset:5636
v_mfma_f32_16x16x32_bf16 v[96:99], a[16:19], v[16:19], 0
v_mfma_f32_16x16x32_bf16 v[96:99], a[40:43], v[20:23], v[96:99]
buffer_load_dwordx4 v[68:71], v1, s[36:39], s86 offen offset:3072 sc1
v_mfma_f32_16x16x32_bf16 v[96:99], a[64:67], v[24:27], v[96:99]
s_waitcnt lgkmcnt(0)
v_mfma_f32_16x16x32_bf16 v[96:99], a[88:91], v[28:31], v[96:99]
s_branch K5_B1g
K2_START:
s_sub_u32 s6, s5, 15
s_lshl_b32 s71, s6, 2
s_add_u32 s71, s71, s3
s_getpc_b64 s[96:97]
K2_PC:
s_sub_u32 s96, s96, K2_PC-interleave_layers__sliding_local_dilated__glu_gated_bilinear__prompt_kernel
s_subb_u32 s97, s97, 0
s_lshl_b32 s7, s71, 13
v_lshl_add_u32 v12, v2, 7, s7
v_min_u32 v12, L_CODE_END-interleave_layers__sliding_local_dilated__glu_gated_bilinear__prompt_kernel-4, v12
v_mov_b32 v15, s97
v_add_co_u32 v14, vcc, s96, v12
s_nop 1
v_addc_co_u32 v15, vcc, 0, v15, vcc
global_load_dword v16, v[14:15], off
s_mov_b32 s73, s71
s_lshl_b32 s73, s71, 1
s_add_u32 s73, s73, 0
s_mov_b32 s69, s73
s_mul_i32 s7, s4, 5
s_lshr_b32 s7, s7, 1
s_sub_u32 s73, s73, s7
s_cselect_b32 s7, 20, 0
s_add_u32 s73, s73, s7
s_cmp_lt_u32 s71, 10
s_cselect_b32 s73, s73, s69
s_lshl_b32 s68, s71, 1
s_add_u32 s68, s68, 1
s_mov_b32 s69, s68
s_mul_i32 s7, s4, 5
s_lshr_b32 s7, s7, 1
s_sub_u32 s68, s68, s7
s_cselect_b32 s7, 20, 0
s_add_u32 s68, s68, s7
s_cmp_lt_u32 s71, 10
s_cselect_b32 s68, s68, s69
s_mul_i32 s69, s3, 8
s_lshl_b32 s7, s4, 15
s_lshl_b32 s8, s73, 7
s_add_u32 s8, s8, s7
s_add_u32 s8, s8, 8192
v_mov_b32 v12, s8
v_mov_b32 v13, 0x7ff00000
v_cmp_eq_u32 vcc, 0, v2
s_nop 1
v_cndmask_b32 v7, v13, v12, vcc
s_lshl_b32 s8, s68, 7
s_add_u32 s8, s8, s7
s_add_u32 s8, s8, 8192
v_mov_b32 v12, s8
v_cmp_eq_u32 vcc, 1, v2
s_nop 1
v_cndmask_b32 v7, v7, v12, vcc
s_add_u32 s7, s7, 0
v_min_u32 v5, 7, v2
s_lshl_b32 s8, s4, 8
s_add_u32 s8, s8, s6
s_lshl_b32 s8, s8, 7
s_add_u32 s8, s8, 12288
s_cmp_eq_u32 s3, 0
s_cselect_b32 s8, s8, 0x7ff00000
v_writelane_b32 v7, s8, 2
v_mov_b32 v11, 0
v_writelane_b32 v11, 8, 2
v_mov_b32 v8, 0
v_writelane_b32 v8, 9, 2
buffer_store_dword v8, v7, s[36:39], 0 offen sc1
v_add_u32 v5, s69, v5
v_lshl_add_u32 v5, v5, 7, s7
v_lshlrev_b32 v12, 2, v4
v_xor_b32 v12, v12, v3
s_lshr_b32 s7, s3, 1
s_and_b32 s8, s3, 1
v_mov_b32 v15, 0x7ff00000
s_lshl_b32 s7, s7, 8
s_lshl_b32 s15, s6, 9
s_add_u32 s7, s7, s15
v_lshl_add_u32 v14, v12, 4, s7
s_mul_i32 s15, s8, 10240
s_mov_b32 s48, s20
s_mov_b32 s49, s21
s_mov_b32 s50, 819200
v_cmp_gt_u32 vcc, 1280, v14
s_nop 1
v_cndmask_b32 v14, v15, v14, vcc
v_mul_u32_u24 v13, 1280, v4
v_add_u32 v88, v13, v14
s_lshl_b32 s70, s3, 12
s_mul_i32 s13, s15, 5
s_add_u32 m0, s70, 0
s_add_u32 s7, s15, 0
buffer_load_dwordx4 v88, s[48:51], s7 offen lds
s_add_u32 m0, s70, 1024
s_add_u32 s7, s15, 25600
buffer_load_dwordx4 v88, s[48:51], s7 offen lds
s_add_u32 m0, s70, 2048
s_add_u32 s7, s15, 5120
buffer_load_dwordx4 v88, s[48:51], s7 offen lds
s_add_u32 m0, s70, 3072
s_add_u32 s7, s15, 30720
buffer_load_dwordx4 v88, s[48:51], s7 offen lds
s_add_u32 m0, s70, 16384
s_add_u32 s7, s15, 51200
buffer_load_dwordx4 v88, s[48:51], s7 offen lds
s_add_u32 m0, s70, 17408
s_add_u32 s7, s15, 76800
buffer_load_dwordx4 v88, s[48:51], s7 offen lds
s_add_u32 m0, s70, 18432
s_add_u32 s7, s15, 56320
buffer_load_dwordx4 v88, s[48:51], s7 offen lds
s_add_u32 m0, s70, 19456
s_add_u32 s7, s15, 81920
buffer_load_dwordx4 v88, s[48:51], s7 offen lds
s_add_u32 m0, s70, 32768
s_add_u32 s7, s15, 102400
buffer_load_dwordx4 v88, s[48:51], s7 offen lds
s_add_u32 m0, s70, 33792
s_add_u32 s7, s15, 128000
buffer_load_dwordx4 v88, s[48:51], s7 offen lds
s_add_u32 m0, s70, 34816
s_add_u32 s7, s15, 107520
buffer_load_dwordx4 v88, s[48:51], s7 offen lds
s_add_u32 m0, s70, 35840
s_add_u32 s7, s15, 133120
buffer_load_dwordx4 v88, s[48:51], s7 offen lds
s_add_u32 m0, s70, 49152
s_add_u32 s7, s15, 153600
buffer_load_dwordx4 v88, s[48:51], s7 offen lds
s_add_u32 m0, s70, 50176
s_add_u32 s7, s15, 179200
buffer_load_dwordx4 v88, s[48:51], s7 offen lds
s_add_u32 m0, s70, 51200
s_add_u32 s7, s15, 158720
buffer_load_dwordx4 v88, s[48:51], s7 offen lds
s_add_u32 m0, s70, 52224
s_add_u32 s7, s15, 184320
buffer_load_dwordx4 v88, s[48:51], s7 offen lds
s_add_u32 m0, s70, 65536
s_add_u32 s7, s13, 20480
buffer_load_dwordx4 v88, s[48:51], s7 offen lds
s_add_u32 m0, s70, 66560
s_add_u32 s7, s13, 122880
buffer_load_dwordx4 v88, s[48:51], s7 offen lds
s_add_u32 m0, s70, 67584
s_add_u32 s7, s13, 46080
buffer_load_dwordx4 v88, s[48:51], s7 offen lds
s_add_u32 m0, s70, 68608
s_add_u32 s7, s13, 148480
buffer_load_dwordx4 v88, s[48:51], s7 offen lds
v_lshrrev_b32 v12, 2, v3
v_and_b32 v13, 3, v3
v_lshl_add_u32 v14, v4, 3, v12
v_lshlrev_b32 v14, 8, v14
v_lshlrev_b32 v12, 2, v12
s_lshl_b32 s7, s3, 7
s_add_u32 s7, s7, 0
v_lshl_add_u32 v15, v13, 4, s7
v_bfe_u32 v84, v15, 4, 4
v_xor_b32 v84, v84, v12
v_lshl_add_u32 v80, v84, 4, v14
v_lshrrev_b32 v84, 8, v15
v_lshl_add_u32 v80, v84, 13, v80
v_and_b32 v84, 8, v15
v_add_u32 v80, v80, v84
s_lshl_b32 s7, s3, 7
s_add_u32 s7, s7, 8
v_lshl_add_u32 v15, v13, 4, s7
v_bfe_u32 v84, v15, 4, 4
v_xor_b32 v84, v84, v12
v_lshl_add_u32 v81, v84, 4, v14
v_lshrrev_b32 v84, 8, v15
v_lshl_add_u32 v81, v84, 13, v81
v_and_b32 v84, 8, v15
v_add_u32 v81, v81, v84
s_lshl_b32 s7, s3, 7
s_add_u32 s7, s7, 64
v_lshl_add_u32 v15, v13, 4, s7
v_bfe_u32 v84, v15, 4, 4
v_xor_b32 v84, v84, v12
v_lshl_add_u32 v82, v84, 4, v14
v_lshrrev_b32 v84, 8, v15
v_lshl_add_u32 v82, v84, 13, v82
v_and_b32 v84, 8, v15
v_add_u32 v82, v82, v84
s_lshl_b32 s7, s3, 7
s_add_u32 s7, s7, 72
v_lshl_add_u32 v15, v13, 4, s7
v_bfe_u32 v84, v15, 4, 4
v_xor_b32 v84, v84, v12
v_lshl_add_u32 v83, v84, 4, v14
v_lshrrev_b32 v84, 8, v15
v_lshl_add_u32 v83, v84, 13, v83
v_and_b32 v84, 8, v15
v_add_u32 v83, v83, v84
v_lshrrev_b32 v15, 2, v3
v_lshl_add_u32 v15, v13, 2, v15
v_lshl_add_u32 v15, v4, 4, v15
v_lshlrev_b32 v89, 2, v15
v_mov_b32 v84, 0x3f803f80
v_mov_b32 v85, 0x3f803f80
v_mov_b32 v86, 0x3f803f80
v_mov_b32 v87, 0x3f803f80
s_mul_i32 s10, s9, 24576
s_add_u32 s12, s10, 327680
s_mul_i32 s7, s3, 5120
s_add_u32 s10, s10, s7
s_add_u32 s10, s10, 7012352
s_mov_b32 s66, s10
s_add_u32 s72, s7, 98304
s_mul_i32 s11, s9, 24576
s_add_u32 s11, s11, 327680
s_mov_b32 s100, 24576
v_mov_b32 v48, 0
v_mov_b32 v49, 0
v_mov_b32 v50, 0
v_mov_b32 v51, 0
v_mov_b32 v52, 0
v_mov_b32 v53, 0
v_mov_b32 v54, 0
v_mov_b32 v55, 0
v_mov_b32 v56, 0
v_mov_b32 v57, 0
v_mov_b32 v58, 0
v_mov_b32 v59, 0
v_mov_b32 v60, 0
v_mov_b32 v61, 0
v_mov_b32 v62, 0
v_mov_b32 v63, 0
v_mov_b32 v64, 0
v_mov_b32 v65, 0
v_mov_b32 v66, 0
v_mov_b32 v67, 0
v_mov_b32 v68, 0
v_mov_b32 v69, 0
v_mov_b32 v70, 0
v_mov_b32 v71, 0
v_mov_b32 v72, 0
v_mov_b32 v73, 0
v_mov_b32 v74, 0
v_mov_b32 v75, 0
v_mov_b32 v76, 0
v_mov_b32 v77, 0
v_mov_b32 v78, 0
v_mov_b32 v79, 0
v_lshlrev_b32 v104, 3, v2
v_add_u32 v104, 98304, v104
v_mov_b32 v137, 0x350637bd
v_cmp_lt_u32 vcc, 31, v2
s_nop 1
v_cndmask_b32 v137, 0, v137, vcc
s_mul_i32 s8, s73, 52
s_lshr_b32 s8, s8, 8
s_mul_i32 s8, s8, 1024
s_mul_i32 s7, s73, 1024
s_add_u32 s7, s7, s8
s_add_u32 s7, s7, 0
s_cmp_lt_u32 s71, 10
s_cselect_b32 s7, s7, 0x7ff00000
v_add_u32 v105, s7, v1
s_mul_i32 s8, s68, 52
s_lshr_b32 s8, s8, 8
s_mul_i32 s8, s8, 1024
s_mul_i32 s7, s68, 1024
s_add_u32 s7, s7, s8
s_add_u32 s7, s7, 0
s_cmp_lt_u32 s71, 10
s_cselect_b32 s7, s7, 0x7ff00000
v_add_u32 v106, s7, v1
v_and_b32 v12, 1, v4
v_cmp_eq_u32 vcc, 1, v12
v_mov_b32 v12, s73
v_mov_b32 v13, s68
v_cndmask_b32 v12, v12, v13, vcc
s_mov_b32 s68, 0
v_mul_u32_u24 v14, 52, v12
v_lshrrev_b32 v14, 8, v14
v_mul_u32_u24 v13, 5, v14
v_sub_u32 v13, v12, v13
v_mul_u32_u24 v14, 6144, v14
v_lshl_add_u32 v14, v13, 7, v14
v_lshl_add_u32 v14, v3, 3, v14
v_lshrrev_b32 v13, 1, v4
v_lshl_add_u32 v14, v13, 2, v14
s_mov_b32 s7, 5120
s_cmp_lt_u32 s71, 10
s_cselect_b32 s7, s7, 0x7ff00000
v_add_u32 v136, s7, v14
s_mov_b32 s60, s11
v_and_b32 v12, 7, v2
v_cmp_eq_u32 vcc, 1, v12
s_nop 1
v_cndmask_b32 v13, v105, v106, vcc
v_cmp_eq_u32 vcc, 2, v12
s_nop 1
v_cndmask_b32 v4, v13, v136, vcc
s_mov_b32 s65, 2
s_waitcnt vmcnt(16)
s_barrier
buffer_atomic_add v254, v255, s[52:55], 0 offen sc1
s_add_u32 m0, s70, 81920
s_add_u32 s7, s15, 204800
buffer_load_dwordx4 v88, s[48:51], s7 offen lds
ds_read_b64_tr_b16 a[0:1], v80 offset:0
ds_read_b64_tr_b16 a[2:3], v80 offset:1024
s_add_u32 m0, s70, 82944
s_add_u32 s7, s15, 230400
buffer_load_dwordx4 v88, s[48:51], s7 offen lds
ds_read_b64_tr_b16 a[4:5], v81 offset:0
ds_read_b64_tr_b16 a[6:7], v81 offset:1024
s_add_u32 m0, s70, 83968
s_add_u32 s7, s15, 209920
buffer_load_dwordx4 v88, s[48:51], s7 offen lds
ds_read_b64_tr_b16 a[8:9], v82 offset:0
ds_read_b64_tr_b16 a[10:11], v82 offset:1024
s_add_u32 m0, s70, 84992
s_add_u32 s7, s15, 235520
buffer_load_dwordx4 v88, s[48:51], s7 offen lds
ds_read_b64_tr_b16 a[12:13], v83 offset:0
ds_read_b64_tr_b16 a[14:15], v83 offset:1024
s_waitcnt lgkmcnt(0)
s_waitcnt vmcnt(17)
s_barrier
s_add_u32 m0, s70, 0
s_add_u32 s7, s15, 256000
buffer_load_dwordx4 v88, s[48:51], s7 offen lds
ds_read_b64_tr_b16 a[16:17], v80 offset:16384
ds_read_b64_tr_b16 a[18:19], v80 offset:17408
s_add_u32 m0, s70, 1024
s_add_u32 s7, s15, 281600
buffer_load_dwordx4 v88, s[48:51], s7 offen lds
ds_read_b64_tr_b16 a[20:21], v81 offset:16384
ds_read_b64_tr_b16 a[22:23], v81 offset:17408
s_add_u32 m0, s70, 2048
s_add_u32 s7, s15, 261120
buffer_load_dwordx4 v88, s[48:51], s7 offen lds
ds_read_b64_tr_b16 a[24:25], v82 offset:16384
ds_read_b64_tr_b16 a[26:27], v82 offset:17408
s_add_u32 m0, s70, 3072
s_add_u32 s7, s15, 286720
buffer_load_dwordx4 v88, s[48:51], s7 offen lds
ds_read_b64_tr_b16 a[28:29], v83 offset:16384
ds_read_b64_tr_b16 a[30:31], v83 offset:17408
s_waitcnt lgkmcnt(0)
s_waitcnt vmcnt(17)
s_barrier
s_add_u32 m0, s70, 16384
s_add_u32 s7, s15, 307200
buffer_load_dwordx4 v88, s[48:51], s7 offen lds
ds_read_b64_tr_b16 a[32:33], v80 offset:32768
ds_read_b64_tr_b16 a[34:35], v80 offset:33792
s_add_u32 m0, s70, 17408
s_add_u32 s7, s15, 332800
buffer_load_dwordx4 v88, s[48:51], s7 offen lds
ds_read_b64_tr_b16 a[36:37], v81 offset:32768
ds_read_b64_tr_b16 a[38:39], v81 offset:33792
s_add_u32 m0, s70, 18432
s_add_u32 s7, s15, 312320
buffer_load_dwordx4 v88, s[48:51], s7 offen lds
ds_read_b64_tr_b16 a[40:41], v82 offset:32768
ds_read_b64_tr_b16 a[42:43], v82 offset:33792
s_add_u32 m0, s70, 19456
s_add_u32 s7, s15, 337920
buffer_load_dwordx4 v88, s[48:51], s7 offen lds
ds_read_b64_tr_b16 a[44:45], v83 offset:32768
ds_read_b64_tr_b16 a[46:47], v83 offset:33792
s_waitcnt lgkmcnt(0)
s_waitcnt vmcnt(17)
s_barrier
s_add_u32 m0, s70, 32768
s_add_u32 s7, s15, 358400
buffer_load_dwordx4 v88, s[48:51], s7 offen lds
ds_read_b64_tr_b16 a[48:49], v80 offset:49152
ds_read_b64_tr_b16 a[50:51], v80 offset:50176
s_add_u32 m0, s70, 33792
s_add_u32 s7, s15, 384000
buffer_load_dwordx4 v88, s[48:51], s7 offen lds
ds_read_b64_tr_b16 a[52:53], v81 offset:49152
ds_read_b64_tr_b16 a[54:55], v81 offset:50176
s_add_u32 m0, s70, 34816
s_add_u32 s7, s15, 363520
buffer_load_dwordx4 v88, s[48:51], s7 offen lds
ds_read_b64_tr_b16 a[56:57], v82 offset:49152
ds_read_b64_tr_b16 a[58:59], v82 offset:50176
s_add_u32 m0, s70, 35840
s_add_u32 s7, s15, 389120
buffer_load_dwordx4 v88, s[48:51], s7 offen lds
ds_read_b64_tr_b16 a[60:61], v83 offset:49152
ds_read_b64_tr_b16 a[62:63], v83 offset:50176
s_waitcnt lgkmcnt(0)
s_waitcnt vmcnt(17)
s_barrier
v_add_u32 v80, 0x10000, v80
v_add_u32 v81, 0x10000, v81
v_add_u32 v82, 0x10000, v82
v_add_u32 v83, 0x10000, v83
s_add_u32 m0, s70, 49152
s_add_u32 s7, s13, 225280
buffer_load_dwordx4 v88, s[48:51], s7 offen lds
ds_read_b64_tr_b16 a[64:65], v80 offset:0
ds_read_b64_tr_b16 a[66:67], v80 offset:1024
s_add_u32 m0, s70, 50176
s_add_u32 s7, s13, 327680
buffer_load_dwordx4 v88, s[48:51], s7 offen lds
ds_read_b64_tr_b16 a[68:69], v81 offset:0
ds_read_b64_tr_b16 a[70:71], v81 offset:1024
s_add_u32 m0, s70, 51200
s_add_u32 s7, s13, 250880
buffer_load_dwordx4 v88, s[48:51], s7 offen lds
ds_read_b64_tr_b16 a[72:73], v82 offset:0
ds_read_b64_tr_b16 a[74:75], v82 offset:1024
s_add_u32 m0, s70, 52224
s_add_u32 s7, s13, 353280
buffer_load_dwordx4 v88, s[48:51], s7 offen lds
ds_read_b64_tr_b16 a[76:77], v83 offset:0
ds_read_b64_tr_b16 a[78:79], v83 offset:1024
s_waitcnt lgkmcnt(0)
s_waitcnt vmcnt(16)
s_barrier
s_add_u32 m0, s70, 65536
s_add_u32 s7, s15, 409600
buffer_load_dwordx4 v88, s[48:51], s7 offen lds
ds_read_b64_tr_b16 a[80:81], v80 offset:16384
ds_read_b64_tr_b16 a[82:83], v80 offset:17408
s_add_u32 m0, s70, 66560
s_add_u32 s7, s15, 435200
buffer_load_dwordx4 v88, s[48:51], s7 offen lds
ds_read_b64_tr_b16 a[84:85], v81 offset:16384
ds_read_b64_tr_b16 a[86:87], v81 offset:17408
s_add_u32 m0, s70, 67584
s_add_u32 s7, s15, 414720
buffer_load_dwordx4 v88, s[48:51], s7 offen lds
ds_read_b64_tr_b16 a[88:89], v82 offset:16384
ds_read_b64_tr_b16 a[90:91], v82 offset:17408
s_add_u32 m0, s70, 68608
s_add_u32 s7, s15, 440320
buffer_load_dwordx4 v88, s[48:51], s7 offen lds
ds_read_b64_tr_b16 a[92:93], v83 offset:16384
ds_read_b64_tr_b16 a[94:95], v83 offset:17408
s_waitcnt lgkmcnt(0)
s_waitcnt vmcnt(16)
s_barrier
v_add_u32 v80, 0xffff0000, v80
v_add_u32 v81, 0xffff0000, v81
v_add_u32 v82, 0xffff0000, v82
v_add_u32 v83, 0xffff0000, v83
s_add_u32 m0, s70, 81920
s_add_u32 s7, s15, 460800
buffer_load_dwordx4 v88, s[48:51], s7 offen lds
ds_read_b64_tr_b16 a[96:97], v80 offset:0
ds_read_b64_tr_b16 a[98:99], v80 offset:1024
s_add_u32 m0, s70, 82944
s_add_u32 s7, s15, 486400
buffer_load_dwordx4 v88, s[48:51], s7 offen lds
ds_read_b64_tr_b16 a[100:101], v81 offset:0
ds_read_b64_tr_b16 a[102:103], v81 offset:1024
s_add_u32 m0, s70, 83968
s_add_u32 s7, s15, 465920
buffer_load_dwordx4 v88, s[48:51], s7 offen lds
ds_read_b64_tr_b16 a[104:105], v82 offset:0
ds_read_b64_tr_b16 a[106:107], v82 offset:1024
s_add_u32 m0, s70, 84992
s_add_u32 s7, s15, 491520
buffer_load_dwordx4 v88, s[48:51], s7 offen lds
ds_read_b64_tr_b16 a[108:109], v83 offset:0
ds_read_b64_tr_b16 a[110:111], v83 offset:1024
s_waitcnt lgkmcnt(0)
s_waitcnt vmcnt(16)
s_barrier
s_add_u32 m0, s70, 0
s_add_u32 s7, s15, 512000
buffer_load_dwordx4 v88, s[48:51], s7 offen lds
ds_read_b64_tr_b16 a[112:113], v80 offset:16384
ds_read_b64_tr_b16 a[114:115], v80 offset:17408
s_add_u32 m0, s70, 1024
s_add_u32 s7, s15, 537600
buffer_load_dwordx4 v88, s[48:51], s7 offen lds
ds_read_b64_tr_b16 a[116:117], v81 offset:16384
ds_read_b64_tr_b16 a[118:119], v81 offset:17408
s_add_u32 m0, s70, 2048
s_add_u32 s7, s15, 517120
buffer_load_dwordx4 v88, s[48:51], s7 offen lds
ds_read_b64_tr_b16 a[120:121], v82 offset:16384
ds_read_b64_tr_b16 a[122:123], v82 offset:17408
s_add_u32 m0, s70, 3072
s_add_u32 s7, s15, 542720
buffer_load_dwordx4 v88, s[48:51], s7 offen lds
ds_read_b64_tr_b16 a[124:125], v83 offset:16384
ds_read_b64_tr_b16 a[126:127], v83 offset:17408
s_waitcnt lgkmcnt(0)
s_waitcnt vmcnt(16)
s_barrier
s_add_u32 m0, s70, 16384
s_add_u32 s7, s15, 563200
buffer_load_dwordx4 v88, s[48:51], s7 offen lds
ds_read_b64_tr_b16 a[128:129], v80 offset:32768
ds_read_b64_tr_b16 a[130:131], v80 offset:33792
s_add_u32 m0, s70, 17408
s_add_u32 s7, s15, 588800
buffer_load_dwordx4 v88, s[48:51], s7 offen lds
ds_read_b64_tr_b16 a[132:133], v81 offset:32768
ds_read_b64_tr_b16 a[134:135], v81 offset:33792
s_add_u32 m0, s70, 18432
s_add_u32 s7, s15, 568320
buffer_load_dwordx4 v88, s[48:51], s7 offen lds
ds_read_b64_tr_b16 a[136:137], v82 offset:32768
ds_read_b64_tr_b16 a[138:139], v82 offset:33792
s_add_u32 m0, s70, 19456
s_add_u32 s7, s15, 593920
buffer_load_dwordx4 v88, s[48:51], s7 offen lds
ds_read_b64_tr_b16 a[140:141], v83 offset:32768
ds_read_b64_tr_b16 a[142:143], v83 offset:33792
s_waitcnt lgkmcnt(0)
s_waitcnt vmcnt(16)
s_barrier
s_add_u32 m0, s70, 32768
s_add_u32 s7, s13, 430080
buffer_load_dwordx4 v88, s[48:51], s7 offen lds
ds_read_b64_tr_b16 a[144:145], v80 offset:49152
ds_read_b64_tr_b16 a[146:147], v80 offset:50176
s_add_u32 m0, s70, 33792
s_add_u32 s7, s13, 532480
buffer_load_dwordx4 v88, s[48:51], s7 offen lds
ds_read_b64_tr_b16 a[148:149], v81 offset:49152
ds_read_b64_tr_b16 a[150:151], v81 offset:50176
s_add_u32 m0, s70, 34816
s_add_u32 s7, s13, 455680
buffer_load_dwordx4 v88, s[48:51], s7 offen lds
ds_read_b64_tr_b16 a[152:153], v82 offset:49152
ds_read_b64_tr_b16 a[154:155], v82 offset:50176
s_add_u32 m0, s70, 35840
s_add_u32 s7, s13, 558080
buffer_load_dwordx4 v88, s[48:51], s7 offen lds
ds_read_b64_tr_b16 a[156:157], v83 offset:49152
ds_read_b64_tr_b16 a[158:159], v83 offset:50176
s_waitcnt lgkmcnt(0)
s_waitcnt vmcnt(16)
s_barrier
v_add_u32 v80, 0x10000, v80
v_add_u32 v81, 0x10000, v81
v_add_u32 v82, 0x10000, v82
v_add_u32 v83, 0x10000, v83
s_add_u32 m0, s70, 49152
s_add_u32 s7, s15, 614400
buffer_load_dwordx4 v88, s[48:51], s7 offen lds
ds_read_b64_tr_b16 a[160:161], v80 offset:0
ds_read_b64_tr_b16 a[162:163], v80 offset:1024
s_add_u32 m0, s70, 50176
s_add_u32 s7, s15, 640000
buffer_load_dwordx4 v88, s[48:51], s7 offen lds
ds_read_b64_tr_b16 a[164:165], v81 offset:0
ds_read_b64_tr_b16 a[166:167], v81 offset:1024
s_add_u32 m0, s70, 51200
s_add_u32 s7, s15, 619520
buffer_load_dwordx4 v88, s[48:51], s7 offen lds
ds_read_b64_tr_b16 a[168:169], v82 offset:0
ds_read_b64_tr_b16 a[170:171], v82 offset:1024
s_add_u32 m0, s70, 52224
s_add_u32 s7, s15, 645120
buffer_load_dwordx4 v88, s[48:51], s7 offen lds
ds_read_b64_tr_b16 a[172:173], v83 offset:0
ds_read_b64_tr_b16 a[174:175], v83 offset:1024
s_waitcnt lgkmcnt(0)
s_waitcnt vmcnt(16)
s_barrier
s_add_u32 m0, s70, 65536
s_add_u32 s7, s15, 665600
buffer_load_dwordx4 v88, s[48:51], s7 offen lds
ds_read_b64_tr_b16 a[176:177], v80 offset:16384
ds_read_b64_tr_b16 a[178:179], v80 offset:17408
s_add_u32 m0, s70, 66560
s_add_u32 s7, s15, 691200
buffer_load_dwordx4 v88, s[48:51], s7 offen lds
ds_read_b64_tr_b16 a[180:181], v81 offset:16384
ds_read_b64_tr_b16 a[182:183], v81 offset:17408
s_add_u32 m0, s70, 67584
s_add_u32 s7, s15, 670720
buffer_load_dwordx4 v88, s[48:51], s7 offen lds
ds_read_b64_tr_b16 a[184:185], v82 offset:16384
ds_read_b64_tr_b16 a[186:187], v82 offset:17408
s_add_u32 m0, s70, 68608
s_add_u32 s7, s15, 696320
buffer_load_dwordx4 v88, s[48:51], s7 offen lds
ds_read_b64_tr_b16 a[188:189], v83 offset:16384
ds_read_b64_tr_b16 a[190:191], v83 offset:17408
s_waitcnt lgkmcnt(0)
s_waitcnt vmcnt(16)
s_barrier
v_add_u32 v80, 0xffff0000, v80
v_add_u32 v81, 0xffff0000, v81
v_add_u32 v82, 0xffff0000, v82
v_add_u32 v83, 0xffff0000, v83
s_add_u32 m0, s70, 81920
s_add_u32 s7, s15, 716800
buffer_load_dwordx4 v88, s[48:51], s7 offen lds
ds_read_b64_tr_b16 a[192:193], v80 offset:0
ds_read_b64_tr_b16 a[194:195], v80 offset:1024
s_add_u32 m0, s70, 82944
s_add_u32 s7, s15, 742400
buffer_load_dwordx4 v88, s[48:51], s7 offen lds
ds_read_b64_tr_b16 a[196:197], v81 offset:0
ds_read_b64_tr_b16 a[198:199], v81 offset:1024
s_add_u32 m0, s70, 83968
s_add_u32 s7, s15, 721920
buffer_load_dwordx4 v88, s[48:51], s7 offen lds
ds_read_b64_tr_b16 a[200:201], v82 offset:0
ds_read_b64_tr_b16 a[202:203], v82 offset:1024
s_add_u32 m0, s70, 84992
s_add_u32 s7, s15, 747520
buffer_load_dwordx4 v88, s[48:51], s7 offen lds
ds_read_b64_tr_b16 a[204:205], v83 offset:0
ds_read_b64_tr_b16 a[206:207], v83 offset:1024
s_waitcnt lgkmcnt(0)
s_waitcnt vmcnt(16)
s_barrier
s_add_u32 m0, s70, 0
s_add_u32 s7, s15, 768000
buffer_load_dwordx4 v88, s[48:51], s7 offen lds
ds_read_b64_tr_b16 a[208:209], v80 offset:16384
ds_read_b64_tr_b16 a[210:211], v80 offset:17408
s_add_u32 m0, s70, 1024
s_add_u32 s7, s15, 793600
buffer_load_dwordx4 v88, s[48:51], s7 offen lds
ds_read_b64_tr_b16 a[212:213], v81 offset:16384
ds_read_b64_tr_b16 a[214:215], v81 offset:17408
s_add_u32 m0, s70, 2048
s_add_u32 s7, s15, 773120
buffer_load_dwordx4 v88, s[48:51], s7 offen lds
ds_read_b64_tr_b16 a[216:217], v82 offset:16384
ds_read_b64_tr_b16 a[218:219], v82 offset:17408
s_add_u32 m0, s70, 3072
s_add_u32 s7, s15, 798720
buffer_load_dwordx4 v88, s[48:51], s7 offen lds
ds_read_b64_tr_b16 a[220:221], v83 offset:16384
ds_read_b64_tr_b16 a[222:223], v83 offset:17408
s_waitcnt lgkmcnt(0)
s_waitcnt vmcnt(16)
s_barrier
s_add_u32 m0, s70, 16384
s_add_u32 s7, s13, 634880
buffer_load_dwordx4 v88, s[48:51], s7 offen lds
ds_read_b64_tr_b16 a[224:225], v80 offset:32768
ds_read_b64_tr_b16 a[226:227], v80 offset:33792
s_add_u32 m0, s70, 17408
s_add_u32 s7, s13, 737280
buffer_load_dwordx4 v88, s[48:51], s7 offen lds
ds_read_b64_tr_b16 a[228:229], v81 offset:32768
ds_read_b64_tr_b16 a[230:231], v81 offset:33792
s_add_u32 m0, s70, 18432
s_add_u32 s7, s13, 660480
buffer_load_dwordx4 v88, s[48:51], s7 offen lds
ds_read_b64_tr_b16 a[232:233], v82 offset:32768
ds_read_b64_tr_b16 a[234:235], v82 offset:33792
s_add_u32 m0, s70, 19456
s_add_u32 s7, s13, 762880
buffer_load_dwordx4 v88, s[48:51], s7 offen lds
ds_read_b64_tr_b16 a[236:237], v83 offset:32768
ds_read_b64_tr_b16 a[238:239], v83 offset:33792
s_mul_i32 s8, s6, 24576
s_mul_i32 s7, s3, 6144
s_add_u32 s8, s8, s7
v_min_u32 v12, 44, v2
v_lshl_add_u32 v12, v12, 7, s8
s_add_u32 s7, s12, 49152
buffer_load_ubyte v3, v12, s[36:39], s7 offen sc1
s_add_u32 s7, s12, 122880
buffer_load_ubyte v3, v12, s[36:39], s7 offen sc1
s_waitcnt lgkmcnt(0)
s_waitcnt vmcnt(18)
s_barrier
ds_read_b64_tr_b16 a[240:241], v80 offset:49152
ds_read_b64_tr_b16 a[242:243], v80 offset:50176
ds_read_b64_tr_b16 a[244:245], v81 offset:49152
ds_read_b64_tr_b16 a[246:247], v81 offset:50176
ds_read_b64_tr_b16 a[248:249], v82 offset:49152
ds_read_b64_tr_b16 a[250:251], v82 offset:50176
ds_read_b64_tr_b16 a[252:253], v83 offset:49152
ds_read_b64_tr_b16 a[254:255], v83 offset:50176
s_lshl_b32 s8, s6, 2
s_add_u32 s8, s8, s3
s_min_u32 s8, s8, 9
s_lshl_b32 s8, s8, 11
v_lshrrev_b32 v12, 4, v2
v_mul_u32_u24 v12, 24576, v12
v_and_b32 v13, 15, v2
v_lshl_add_u32 v12, v13, 7, v12
v_add_u32 v12, s8, v12
s_add_u32 s7, s12, 6684672
buffer_load_ubyte v3, v12, s[36:39], s7 offen sc1
s_add_u32 s7, s12, 6782976
buffer_load_ubyte v3, v12, s[36:39], s7 offen sc1
s_waitcnt lgkmcnt(0)
s_waitcnt vmcnt(16)
s_barrier
v_add_u32 v80, 0x10000, v80
v_add_u32 v81, 0x10000, v81
v_add_u32 v82, 0x10000, v82
v_add_u32 v83, 0x10000, v83
ds_read_b64_tr_b16 v[192:193], v80 offset:0
ds_read_b64_tr_b16 v[194:195], v80 offset:1024
ds_read_b64_tr_b16 v[196:197], v81 offset:0
ds_read_b64_tr_b16 v[198:199], v81 offset:1024
ds_read_b64_tr_b16 v[200:201], v82 offset:0
ds_read_b64_tr_b16 v[202:203], v82 offset:1024
ds_read_b64_tr_b16 v[204:205], v83 offset:0
ds_read_b64_tr_b16 v[206:207], v83 offset:1024
s_waitcnt lgkmcnt(0)
s_waitcnt vmcnt(12)
s_barrier
ds_read_b64_tr_b16 v[208:209], v80 offset:16384
ds_read_b64_tr_b16 v[210:211], v80 offset:17408
ds_read_b64_tr_b16 v[212:213], v81 offset:16384
ds_read_b64_tr_b16 v[214:215], v81 offset:17408
ds_read_b64_tr_b16 v[216:217], v82 offset:16384
ds_read_b64_tr_b16 v[218:219], v82 offset:17408
ds_read_b64_tr_b16 v[220:221], v83 offset:16384
ds_read_b64_tr_b16 v[222:223], v83 offset:17408
s_waitcnt lgkmcnt(0)
s_waitcnt vmcnt(8)
s_barrier
v_add_u32 v80, 0xffff0000, v80
v_add_u32 v81, 0xffff0000, v81
v_add_u32 v82, 0xffff0000, v82
v_add_u32 v83, 0xffff0000, v83
ds_read_b64_tr_b16 v[224:225], v80 offset:0
ds_read_b64_tr_b16 v[226:227], v80 offset:1024
ds_read_b64_tr_b16 v[228:229], v81 offset:0
ds_read_b64_tr_b16 v[230:231], v81 offset:1024
ds_read_b64_tr_b16 v[232:233], v82 offset:0
ds_read_b64_tr_b16 v[234:235], v82 offset:1024
ds_read_b64_tr_b16 v[236:237], v83 offset:0
ds_read_b64_tr_b16 v[238:239], v83 offset:1024
s_waitcnt lgkmcnt(0)
s_waitcnt vmcnt(4)
s_barrier
ds_read_b64_tr_b16 v[240:241], v80 offset:16384
ds_read_b64_tr_b16 v[242:243], v80 offset:17408
ds_read_b64_tr_b16 v[244:245], v81 offset:16384
ds_read_b64_tr_b16 v[246:247], v81 offset:17408
ds_read_b64_tr_b16 v[248:249], v82 offset:16384
ds_read_b64_tr_b16 v[250:251], v82 offset:17408
ds_read_b64_tr_b16 v[252:253], v83 offset:16384
ds_read_b64_tr_b16 v[254:255], v83 offset:17408
s_waitcnt lgkmcnt(0)
s_mov_b32 s75, 0
K2_IW:
s_lshl_b32 s7, s4, 5
v_mov_b32 v14, s7
buffer_load_dwordx2 v[14:15], v14, s[52:55], 0 offen sc1
s_add_u32 s75, s75, 1
s_cmp_gt_u32 s75, 0x8000
s_cbranch_scc1 L_TIMEOUT
s_waitcnt vmcnt(0)
v_readfirstlane_b32 s7, v14
v_readfirstlane_b32 s8, v15
s_xor_b32 s101, s7, s22
s_xor_b32 s69, s8, s23
s_or_b32 s69, s69, s101
s_cmp_eq_u32 s69, 0
s_cselect_b32 s101, 1, 0
s_add_u32 s7, s7, s8
s_mul_i32 s7, s7, 0x01010101
s_lshr_b32 s7, s7, 24
s_cmp_eq_u32 s7, 32
s_cbranch_scc0 K2_IW
v_add_u32 v8, 1, v11
buffer_store_dword v8, v7, s[36:39], 0 offen sc1
s_cmp_eq_u32 s101, 1
s_cbranch_scc1 K2_SW1f
s_branch K2_SW1s
.p2align 6
K2_U0f:
v_mfma_f32_16x16x32_bf16 v[64:67], v[224:227], v[40:43], v[64:67]
s_barrier

v_mfma_f32_16x16x32_bf16 v[64:67], v[240:243], v[44:47], v[64:67]
s_mul_i32 s67, s0, s100
ds_read2st64_b64 v[16:19], v104 offset0:0 offset1:1
s_add_u32 s67, s67, s11
v_mfma_f32_16x16x32_bf16 v[68:71], v[196:199], v[32:35], v[68:71]
s_mov_b32 s46, s74
ds_read2st64_b64 v[20:23], v104 offset0:2 offset1:3
s_add_u32 s79, s13, 1
v_mfma_f32_16x16x32_bf16 v[68:71], v[212:215], v[36:39], v[68:71]
s_mov_b32 s64, s13
ds_read2st64_b64 v[24:27], v104 offset0:4 offset1:5
s_mov_b32 s0, s1
v_mfma_f32_16x16x32_bf16 v[68:71], v[228:231], v[40:43], v[68:71]
s_add_u32 s13, s64, 1
ds_read2st64_b64 v[28:31], v104 offset0:6 offset1:7
s_cmp_eq_u32 s13, 17
v_mfma_f32_16x16x32_bf16 v[68:71], v[244:247], v[44:47], v[68:71]
s_addc_u32 s13, s13, 0
s_sub_u32 s1, s13, 17
s_cselect_b32 s1, s13, s1
v_mfma_f32_16x16x32_bf16 v[72:75], v[200:203], v[32:35], v[72:75]
s_and_b32 s66, s13, 7
s_mul_i32 s66, s66, 24576
s_add_u32 s66, s66, s10
v_mfma_f32_16x16x32_bf16 v[72:75], v[216:219], v[36:39], v[72:75]
s_add_u32 s65, s13, 2
v_add_u32 v8, s79, v11
v_add_f32 v132, v64, v65
v_mfma_f32_16x16x32_bf16 v[72:75], v[232:235], v[40:43], v[72:75]
v_mul_f32 v133, v64, v64
v_fmac_f32 v133, v65, v65
v_mfma_f32_16x16x32_bf16 v[72:75], v[248:251], v[44:47], v[72:75]
v_fmac_f32 v133, v66, v66
v_add_f32 v132, v132, v66
v_mfma_f32_16x16x32_bf16 v[76:79], v[204:207], v[32:35], v[76:79]
s_waitcnt vmcnt(1)
v_cmp_le_u32 vcc, s65, v6
v_fmac_f32 v133, v67, v67
v_mfma_f32_16x16x32_bf16 v[76:79], v[220:223], v[36:39], v[76:79]
s_cmp_eq_u64 vcc, -1
v_add_f32 v132, v132, v67
v_fmac_f32 v133, v68, v68
v_mfma_f32_16x16x32_bf16 v[76:79], v[236:239], v[40:43], v[76:79]
s_cbranch_scc0 K2_W0f
K2_W0fR:
s_cselect_b32 s68, 1, 0
v_mfma_f32_16x16x32_bf16 v[76:79], v[252:255], v[44:47], v[76:79]
s_waitcnt lgkmcnt(0)
s_cselect_b32 s42, 0x4000000, 0
s_mul_i32 s71, s1, 24576
K2_F0f:
v_mfma_f32_16x16x32_bf16 v[48:51], a[0:3], v[16:19], v[116:119]
s_add_u32 s71, s71, s12
ds_read2st64_b64 v[32:35], v104 offset0:8 offset1:9
v_add_f32 v132, v132, v68
v_mfma_f32_16x16x32_bf16 v[48:51], a[16:19], v[20:23], v[48:51]
buffer_load_dwordx4 v[108:111], v105, s[40:43], s71 offen sc1
v_mfma_f32_16x16x32_bf16 v[48:51], a[32:35], v[24:27], v[48:51]
ds_read2st64_b64 v[36:39], v104 offset0:10 offset1:11
v_fmac_f32 v133, v69, v69
v_mfma_f32_16x16x32_bf16 v[48:51], a[48:51], v[28:31], v[48:51]
v_add_f32 v132, v132, v69
v_fmac_f32 v133, v70, v70
v_mfma_f32_16x16x32_bf16 v[52:55], a[4:7], v[16:19], v[120:123]
ds_read2st64_b64 v[40:43], v104 offset0:12 offset1:13
v_add_f32 v132, v132, v70
v_mfma_f32_16x16x32_bf16 v[52:55], a[20:23], v[20:23], v[52:55]
buffer_load_dwordx4 v[112:115], v106, s[40:43], s71 offen sc1
v_mfma_f32_16x16x32_bf16 v[52:55], a[36:39], v[24:27], v[52:55]
s_add_u32 s69, s66, 4096
ds_read2st64_b64 v[44:47], v104 offset0:14 offset1:15
s_add_u32 m0, s72, 28672
v_mfma_f32_16x16x32_bf16 v[52:55], a[52:55], v[28:31], v[52:55]
v_fmac_f32 v133, v71, v71
v_add_f32 v132, v132, v71
v_mfma_f32_16x16x32_bf16 v[56:59], a[8:11], v[16:19], v[124:127]
v_cvt_pk_bf16_f32 v96, v64, v65
v_cvt_pk_bf16_f32 v97, v66, v67
v_mfma_f32_16x16x32_bf16 v[56:59], a[24:27], v[20:23], v[56:59]
buffer_load_dwordx4 v1, s[40:43], s69 offen offset:0 sc1 lds
v_mfma_f32_16x16x32_bf16 v[56:59], a[40:43], v[24:27], v[56:59]
s_add_u32 m0, s72, 24576
v_cvt_pk_bf16_f32 v98, v68, v69
v_cvt_pk_bf16_f32 v99, v70, v71
v_mfma_f32_16x16x32_bf16 v[56:59], a[56:59], v[28:31], v[56:59]
buffer_store_dwordx4 v[96:99], v105, s[44:47], s67 offen
v_mfma_f32_16x16x32_bf16 v[60:63], a[12:15], v[16:19], v[128:131]
v_add_f32 v134, v72, v73
v_mul_f32 v135, v72, v72
v_mfma_f32_16x16x32_bf16 v[60:63], a[28:31], v[20:23], v[60:63]
buffer_load_dwordx4 v1, s[40:43], s66 offen offset:0 sc1 lds
v_mfma_f32_16x16x32_bf16 v[60:63], a[44:47], v[24:27], v[60:63]
v_fmac_f32 v135, v73, v73
v_fmac_f32 v135, v74, v74
v_mfma_f32_16x16x32_bf16 v[60:63], a[60:63], v[28:31], v[60:63]
s_waitcnt lgkmcnt(0)
v_add_f32 v134, v134, v74
v_fmac_f32 v135, v75, v75
v_mfma_f32_16x16x32_bf16 v[48:51], a[64:67], v[32:35], v[48:51]
ds_read2st64_b64 v[16:19], v104 offset0:16 offset1:17
v_add_f32 v134, v134, v75
v_mfma_f32_16x16x32_bf16 v[48:51], a[80:83], v[36:39], v[48:51]
buffer_load_dwordx4 v1, s[40:43], s66 offen offset:1024 sc1 lds
v_mfma_f32_16x16x32_bf16 v[48:51], a[96:99], v[40:43], v[48:51]
ds_read2st64_b64 v[20:23], v104 offset0:18 offset1:19
v_fmac_f32 v135, v76, v76
v_mfma_f32_16x16x32_bf16 v[48:51], a[112:115], v[44:47], v[48:51]
v_add_f32 v134, v134, v76
v_fmac_f32 v135, v77, v77
v_mfma_f32_16x16x32_bf16 v[52:55], a[68:71], v[32:35], v[52:55]
ds_read2st64_b64 v[24:27], v104 offset0:20 offset1:21
v_add_f32 v134, v134, v77
v_mfma_f32_16x16x32_bf16 v[52:55], a[84:87], v[36:39], v[52:55]
buffer_load_dwordx4 v1, s[40:43], s66 offen offset:2048 sc1 lds
v_mfma_f32_16x16x32_bf16 v[52:55], a[100:103], v[40:43], v[52:55]
ds_read2st64_b64 v[28:31], v104 offset0:22 offset1:23
v_fmac_f32 v135, v78, v78
v_mfma_f32_16x16x32_bf16 v[52:55], a[116:119], v[44:47], v[52:55]
v_add_f32 v134, v134, v78
v_fmac_f32 v135, v79, v79
v_mfma_f32_16x16x32_bf16 v[56:59], a[72:75], v[32:35], v[56:59]
buffer_load_dwordx4 v1, s[40:43], s66 offen offset:3072 sc1 lds
v_mfma_f32_16x16x32_bf16 v[56:59], a[88:91], v[36:39], v[56:59]
v_add_f32 v134, v134, v79
v_cvt_pk_bf16_f32 v100, v72, v73
v_mfma_f32_16x16x32_bf16 v[56:59], a[104:107], v[40:43], v[56:59]
v_cvt_pk_bf16_f32 v101, v74, v75
v_cvt_pk_bf16_f32 v102, v76, v77
v_mfma_f32_16x16x32_bf16 v[56:59], a[120:123], v[44:47], v[56:59]
v_cvt_pk_bf16_f32 v103, v78, v79
v_mfma_f32_16x16x32_bf16 v[60:63], a[76:79], v[32:35], v[60:63]
buffer_store_dwordx4 v[100:103], v106, s[44:47], s67 offen
v_mfma_f32_16x16x32_bf16 v[60:63], a[92:95], v[36:39], v[60:63]
v_permlane32_swap_b32 v132, v133
v_mfma_f32_16x16x32_bf16 v[60:63], a[108:111], v[40:43], v[60:63]
v_permlane32_swap_b32 v134, v135
v_mfma_f32_16x16x32_bf16 v[60:63], a[124:127], v[44:47], v[60:63]
s_waitcnt lgkmcnt(0)
v_add_f32 v132, v132, v133
v_add_f32 v134, v134, v135
v_mfma_f32_16x16x32_bf16 v[48:51], a[128:131], v[16:19], v[48:51]
ds_read2st64_b64 v[32:35], v104 offset0:24 offset1:25
v_mfma_f32_16x16x32_bf16 v[48:51], a[144:147], v[20:23], v[48:51]
v_permlane16_swap_b32 v132, v134
v_mfma_f32_16x16x32_bf16 v[48:51], a[160:163], v[24:27], v[48:51]
ds_read2st64_b64 v[36:39], v104 offset0:26 offset1:27
v_add_f32 v132, v132, v134
v_mfma_f32_16x16x32_bf16 v[48:51], a[176:179], v[28:31], v[48:51]
v_fma_f32 v132, v132, s76, v137
v_mfma_f32_16x16x32_bf16 v[52:55], a[132:135], v[16:19], v[52:55]
ds_read2st64_b64 v[40:43], v104 offset0:28 offset1:29
v_mfma_f32_16x16x32_bf16 v[52:55], a[148:151], v[20:23], v[52:55]
buffer_store_dword v132, v136, s[44:47], s67 offen
v_mfma_f32_16x16x32_bf16 v[52:55], a[164:167], v[24:27], v[52:55]
ds_read2st64_b64 v[44:47], v104 offset0:30 offset1:31
v_mfma_f32_16x16x32_bf16 v[52:55], a[180:183], v[28:31], v[52:55]
v_mfma_f32_16x16x32_bf16 v[56:59], a[136:139], v[16:19], v[56:59]
v_mfma_f32_16x16x32_bf16 v[56:59], a[152:155], v[20:23], v[56:59]
v_mfma_f32_16x16x32_bf16 v[56:59], a[168:171], v[24:27], v[56:59]
v_mfma_f32_16x16x32_bf16 v[56:59], a[184:187], v[28:31], v[56:59]
v_mfma_f32_16x16x32_bf16 v[60:63], a[140:143], v[16:19], v[60:63]
v_mfma_f32_16x16x32_bf16 v[60:63], a[156:159], v[20:23], v[60:63]
v_mfma_f32_16x16x32_bf16 v[60:63], a[172:175], v[24:27], v[60:63]
v_mfma_f32_16x16x32_bf16 v[60:63], a[188:191], v[28:31], v[60:63]
s_waitcnt lgkmcnt(0)
v_mfma_f32_16x16x32_bf16 v[48:51], a[192:195], v[32:35], v[48:51]
ds_read2st64_b64 v[16:19], v104 offset0:32 offset1:33
v_mfma_f32_16x16x32_bf16 v[48:51], a[208:211], v[36:39], v[48:51]
v_mfma_f32_16x16x32_bf16 v[48:51], a[224:227], v[40:43], v[48:51]
ds_read2st64_b64 v[20:23], v104 offset0:34 offset1:35
v_mfma_f32_16x16x32_bf16 v[48:51], a[240:243], v[44:47], v[48:51]
v_mfma_f32_16x16x32_bf16 v[52:55], a[196:199], v[32:35], v[52:55]
s_waitcnt vmcnt(8)
ds_read2st64_b64 v[24:27], v104 offset0:36 offset1:37
v_lshlrev_b32 v116, 16, v108
v_mfma_f32_16x16x32_bf16 v[52:55], a[212:215], v[36:39], v[52:55]
buffer_load_dword v6, v5, s[36:39], 0 offen sc1
v_mfma_f32_16x16x32_bf16 v[52:55], a[228:231], v[40:43], v[52:55]
s_cmp_eq_u32 s68, 0
ds_read2st64_b64 v[28:31], v104 offset0:38 offset1:39
v_and_b32 v117, 0xffff0000, v108
v_mfma_f32_16x16x32_bf16 v[52:55], a[244:247], v[44:47], v[52:55]
v_lshlrev_b32 v118, 16, v109
v_and_b32 v119, 0xffff0000, v109
v_mfma_f32_16x16x32_bf16 v[56:59], a[200:203], v[32:35], v[56:59]
v_lshlrev_b32 v120, 16, v110
v_and_b32 v121, 0xffff0000, v110
v_mfma_f32_16x16x32_bf16 v[56:59], a[216:219], v[36:39], v[56:59]
v_lshlrev_b32 v122, 16, v111
v_and_b32 v123, 0xffff0000, v111
v_mfma_f32_16x16x32_bf16 v[56:59], a[232:235], v[40:43], v[56:59]
v_lshlrev_b32 v124, 16, v112
v_and_b32 v125, 0xffff0000, v112
v_mfma_f32_16x16x32_bf16 v[56:59], a[248:251], v[44:47], v[56:59]
s_waitcnt vmcnt(1)
v_lshlrev_b32 v126, 16, v113
v_and_b32 v127, 0xffff0000, v113
v_mfma_f32_16x16x32_bf16 v[60:63], a[204:207], v[32:35], v[60:63]
buffer_store_dword v8, v7, s[36:39], 0 offen
v_mfma_f32_16x16x32_bf16 v[60:63], a[220:223], v[36:39], v[60:63]
v_lshlrev_b32 v128, 16, v114
v_and_b32 v129, 0xffff0000, v114
v_mfma_f32_16x16x32_bf16 v[60:63], a[236:239], v[40:43], v[60:63]
v_lshlrev_b32 v130, 16, v115
v_and_b32 v131, 0xffff0000, v115
v_mfma_f32_16x16x32_bf16 v[60:63], a[252:255], v[44:47], v[60:63]
s_waitcnt lgkmcnt(0)
v_mfma_f32_16x16x32_bf16 v[48:51], v[192:195], v[16:19], v[48:51]
s_waitcnt vmcnt(4) lgkmcnt(0)
v_mfma_f32_16x16x32_bf16 v[48:51], v[208:211], v[20:23], v[48:51]
s_cbranch_scc1 K2_X0f
K2_U1f:
v_mfma_f32_16x16x32_bf16 v[48:51], v[224:227], v[24:27], v[48:51]
s_barrier

v_mfma_f32_16x16x32_bf16 v[48:51], v[240:243], v[28:31], v[48:51]
s_mul_i32 s67, s0, s100
ds_read2st64_b64 v[32:35], v104 offset0:48 offset1:49
s_add_u32 s67, s67, s11
v_mfma_f32_16x16x32_bf16 v[52:55], v[196:199], v[16:19], v[52:55]
s_mov_b32 s46, s74
ds_read2st64_b64 v[36:39], v104 offset0:50 offset1:51
s_add_u32 s79, s13, 1
v_mfma_f32_16x16x32_bf16 v[52:55], v[212:215], v[20:23], v[52:55]
s_mov_b32 s64, s13
ds_read2st64_b64 v[40:43], v104 offset0:52 offset1:53
s_mov_b32 s0, s1
v_mfma_f32_16x16x32_bf16 v[52:55], v[228:231], v[24:27], v[52:55]
s_add_u32 s13, s64, 1
ds_read2st64_b64 v[44:47], v104 offset0:54 offset1:55
s_cmp_eq_u32 s13, 17
v_mfma_f32_16x16x32_bf16 v[52:55], v[244:247], v[28:31], v[52:55]
s_addc_u32 s13, s13, 0
s_sub_u32 s1, s13, 17
s_cselect_b32 s1, s13, s1
v_mfma_f32_16x16x32_bf16 v[56:59], v[200:203], v[16:19], v[56:59]
s_and_b32 s66, s13, 7
s_mul_i32 s66, s66, 24576
s_add_u32 s66, s66, s10
v_mfma_f32_16x16x32_bf16 v[56:59], v[216:219], v[20:23], v[56:59]
s_add_u32 s65, s13, 2
v_add_u32 v8, s79, v11
v_add_f32 v132, v48, v49
v_mfma_f32_16x16x32_bf16 v[56:59], v[232:235], v[24:27], v[56:59]
v_mul_f32 v133, v48, v48
v_fmac_f32 v133, v49, v49
v_mfma_f32_16x16x32_bf16 v[56:59], v[248:251], v[28:31], v[56:59]
v_fmac_f32 v133, v50, v50
v_add_f32 v132, v132, v50
v_mfma_f32_16x16x32_bf16 v[60:63], v[204:207], v[16:19], v[60:63]
s_waitcnt vmcnt(1)
v_cmp_le_u32 vcc, s65, v6
v_fmac_f32 v133, v51, v51
v_mfma_f32_16x16x32_bf16 v[60:63], v[220:223], v[20:23], v[60:63]
s_cmp_eq_u64 vcc, -1
v_add_f32 v132, v132, v51
v_fmac_f32 v133, v52, v52
v_mfma_f32_16x16x32_bf16 v[60:63], v[236:239], v[24:27], v[60:63]
s_cbranch_scc0 K2_W1f
K2_W1fR:
s_cselect_b32 s68, 1, 0
v_mfma_f32_16x16x32_bf16 v[60:63], v[252:255], v[28:31], v[60:63]
s_waitcnt lgkmcnt(0)
s_cselect_b32 s42, 0x4000000, 0
s_mul_i32 s71, s1, 24576
K2_F1f:
v_mfma_f32_16x16x32_bf16 v[64:67], a[0:3], v[32:35], v[116:119]
s_add_u32 s71, s71, s12
ds_read2st64_b64 v[16:19], v104 offset0:56 offset1:57
v_add_f32 v132, v132, v52
v_mfma_f32_16x16x32_bf16 v[64:67], a[16:19], v[36:39], v[64:67]
buffer_load_dwordx4 v[108:111], v105, s[40:43], s71 offen sc1
v_mfma_f32_16x16x32_bf16 v[64:67], a[32:35], v[40:43], v[64:67]
ds_read2st64_b64 v[20:23], v104 offset0:58 offset1:59
v_fmac_f32 v133, v53, v53
v_mfma_f32_16x16x32_bf16 v[64:67], a[48:51], v[44:47], v[64:67]
v_add_f32 v132, v132, v53
v_fmac_f32 v133, v54, v54
v_mfma_f32_16x16x32_bf16 v[68:71], a[4:7], v[32:35], v[120:123]
ds_read2st64_b64 v[24:27], v104 offset0:60 offset1:61
v_add_f32 v132, v132, v54
v_mfma_f32_16x16x32_bf16 v[68:71], a[20:23], v[36:39], v[68:71]
buffer_load_dwordx4 v[112:115], v106, s[40:43], s71 offen sc1
v_mfma_f32_16x16x32_bf16 v[68:71], a[36:39], v[40:43], v[68:71]
s_add_u32 s69, s66, 4096
ds_read2st64_b64 v[28:31], v104 offset0:62 offset1:63
s_add_u32 m0, s72, 4096
v_mfma_f32_16x16x32_bf16 v[68:71], a[52:55], v[44:47], v[68:71]
v_fmac_f32 v133, v55, v55
v_add_f32 v132, v132, v55
v_mfma_f32_16x16x32_bf16 v[72:75], a[8:11], v[32:35], v[124:127]
v_cvt_pk_bf16_f32 v96, v48, v49
v_cvt_pk_bf16_f32 v97, v50, v51
v_mfma_f32_16x16x32_bf16 v[72:75], a[24:27], v[36:39], v[72:75]
buffer_load_dwordx4 v1, s[40:43], s69 offen offset:0 sc1 lds
v_mfma_f32_16x16x32_bf16 v[72:75], a[40:43], v[40:43], v[72:75]
s_add_u32 m0, s72, 0
v_cvt_pk_bf16_f32 v98, v52, v53
v_cvt_pk_bf16_f32 v99, v54, v55
v_mfma_f32_16x16x32_bf16 v[72:75], a[56:59], v[44:47], v[72:75]
buffer_store_dwordx4 v[96:99], v105, s[44:47], s67 offen
v_mfma_f32_16x16x32_bf16 v[76:79], a[12:15], v[32:35], v[128:131]
v_add_f32 v134, v56, v57
v_mul_f32 v135, v56, v56
v_mfma_f32_16x16x32_bf16 v[76:79], a[28:31], v[36:39], v[76:79]
buffer_load_dwordx4 v1, s[40:43], s66 offen offset:0 sc1 lds
v_mfma_f32_16x16x32_bf16 v[76:79], a[44:47], v[40:43], v[76:79]
v_fmac_f32 v135, v57, v57
v_fmac_f32 v135, v58, v58
v_mfma_f32_16x16x32_bf16 v[76:79], a[60:63], v[44:47], v[76:79]
s_waitcnt lgkmcnt(0)
v_add_f32 v134, v134, v58
v_fmac_f32 v135, v59, v59
v_mfma_f32_16x16x32_bf16 v[64:67], a[64:67], v[16:19], v[64:67]
ds_read2st64_b64 v[32:35], v104 offset0:64 offset1:65
v_add_f32 v134, v134, v59
v_mfma_f32_16x16x32_bf16 v[64:67], a[80:83], v[20:23], v[64:67]
buffer_load_dwordx4 v1, s[40:43], s66 offen offset:1024 sc1 lds
v_mfma_f32_16x16x32_bf16 v[64:67], a[96:99], v[24:27], v[64:67]
ds_read2st64_b64 v[36:39], v104 offset0:66 offset1:67
v_fmac_f32 v135, v60, v60
v_mfma_f32_16x16x32_bf16 v[64:67], a[112:115], v[28:31], v[64:67]
v_add_f32 v134, v134, v60
v_fmac_f32 v135, v61, v61
v_mfma_f32_16x16x32_bf16 v[68:71], a[68:71], v[16:19], v[68:71]
ds_read2st64_b64 v[40:43], v104 offset0:68 offset1:69
v_add_f32 v134, v134, v61
v_mfma_f32_16x16x32_bf16 v[68:71], a[84:87], v[20:23], v[68:71]
buffer_load_dwordx4 v1, s[40:43], s66 offen offset:2048 sc1 lds
v_mfma_f32_16x16x32_bf16 v[68:71], a[100:103], v[24:27], v[68:71]
ds_read2st64_b64 v[44:47], v104 offset0:70 offset1:71
v_fmac_f32 v135, v62, v62
v_mfma_f32_16x16x32_bf16 v[68:71], a[116:119], v[28:31], v[68:71]
v_add_f32 v134, v134, v62
v_fmac_f32 v135, v63, v63
v_mfma_f32_16x16x32_bf16 v[72:75], a[72:75], v[16:19], v[72:75]
buffer_load_dwordx4 v1, s[40:43], s66 offen offset:3072 sc1 lds
v_mfma_f32_16x16x32_bf16 v[72:75], a[88:91], v[20:23], v[72:75]
v_add_f32 v134, v134, v63
v_cvt_pk_bf16_f32 v100, v56, v57
v_mfma_f32_16x16x32_bf16 v[72:75], a[104:107], v[24:27], v[72:75]
v_cvt_pk_bf16_f32 v101, v58, v59
v_cvt_pk_bf16_f32 v102, v60, v61
v_mfma_f32_16x16x32_bf16 v[72:75], a[120:123], v[28:31], v[72:75]
v_cvt_pk_bf16_f32 v103, v62, v63
v_mfma_f32_16x16x32_bf16 v[76:79], a[76:79], v[16:19], v[76:79]
buffer_store_dwordx4 v[100:103], v106, s[44:47], s67 offen
v_mfma_f32_16x16x32_bf16 v[76:79], a[92:95], v[20:23], v[76:79]
v_permlane32_swap_b32 v132, v133
v_mfma_f32_16x16x32_bf16 v[76:79], a[108:111], v[24:27], v[76:79]
v_permlane32_swap_b32 v134, v135
v_mfma_f32_16x16x32_bf16 v[76:79], a[124:127], v[28:31], v[76:79]
s_waitcnt lgkmcnt(0)
v_add_f32 v132, v132, v133
v_add_f32 v134, v134, v135
v_mfma_f32_16x16x32_bf16 v[64:67], a[128:131], v[32:35], v[64:67]
ds_read2st64_b64 v[16:19], v104 offset0:72 offset1:73
v_mfma_f32_16x16x32_bf16 v[64:67], a[144:147], v[36:39], v[64:67]
v_permlane16_swap_b32 v132, v134
v_mfma_f32_16x16x32_bf16 v[64:67], a[160:163], v[40:43], v[64:67]
ds_read2st64_b64 v[20:23], v104 offset0:74 offset1:75
v_add_f32 v132, v132, v134
v_mfma_f32_16x16x32_bf16 v[64:67], a[176:179], v[44:47], v[64:67]
v_fma_f32 v132, v132, s76, v137
v_mfma_f32_16x16x32_bf16 v[68:71], a[132:135], v[32:35], v[68:71]
ds_read2st64_b64 v[24:27], v104 offset0:76 offset1:77
v_mfma_f32_16x16x32_bf16 v[68:71], a[148:151], v[36:39], v[68:71]
buffer_store_dword v132, v136, s[44:47], s67 offen
v_mfma_f32_16x16x32_bf16 v[68:71], a[164:167], v[40:43], v[68:71]
ds_read2st64_b64 v[28:31], v104 offset0:78 offset1:79
v_mfma_f32_16x16x32_bf16 v[68:71], a[180:183], v[44:47], v[68:71]
v_mfma_f32_16x16x32_bf16 v[72:75], a[136:139], v[32:35], v[72:75]
v_mfma_f32_16x16x32_bf16 v[72:75], a[152:155], v[36:39], v[72:75]
v_mfma_f32_16x16x32_bf16 v[72:75], a[168:171], v[40:43], v[72:75]
v_mfma_f32_16x16x32_bf16 v[72:75], a[184:187], v[44:47], v[72:75]
v_mfma_f32_16x16x32_bf16 v[76:79], a[140:143], v[32:35], v[76:79]
v_mfma_f32_16x16x32_bf16 v[76:79], a[156:159], v[36:39], v[76:79]
v_mfma_f32_16x16x32_bf16 v[76:79], a[172:175], v[40:43], v[76:79]
v_mfma_f32_16x16x32_bf16 v[76:79], a[188:191], v[44:47], v[76:79]
s_waitcnt lgkmcnt(0)
v_mfma_f32_16x16x32_bf16 v[64:67], a[192:195], v[16:19], v[64:67]
ds_read2st64_b64 v[32:35], v104 offset0:80 offset1:81
v_mfma_f32_16x16x32_bf16 v[64:67], a[208:211], v[20:23], v[64:67]
v_mfma_f32_16x16x32_bf16 v[64:67], a[224:227], v[24:27], v[64:67]
ds_read2st64_b64 v[36:39], v104 offset0:82 offset1:83
v_mfma_f32_16x16x32_bf16 v[64:67], a[240:243], v[28:31], v[64:67]
v_mfma_f32_16x16x32_bf16 v[68:71], a[196:199], v[16:19], v[68:71]
s_waitcnt vmcnt(8)
ds_read2st64_b64 v[40:43], v104 offset0:84 offset1:85
v_lshlrev_b32 v116, 16, v108
v_mfma_f32_16x16x32_bf16 v[68:71], a[212:215], v[20:23], v[68:71]
buffer_load_dword v6, v5, s[36:39], 0 offen sc1
v_mfma_f32_16x16x32_bf16 v[68:71], a[228:231], v[24:27], v[68:71]
s_cmp_eq_u32 s68, 0
ds_read2st64_b64 v[44:47], v104 offset0:86 offset1:87
v_and_b32 v117, 0xffff0000, v108
v_mfma_f32_16x16x32_bf16 v[68:71], a[244:247], v[28:31], v[68:71]
v_lshlrev_b32 v118, 16, v109
v_and_b32 v119, 0xffff0000, v109
v_mfma_f32_16x16x32_bf16 v[72:75], a[200:203], v[16:19], v[72:75]
v_lshlrev_b32 v120, 16, v110
v_and_b32 v121, 0xffff0000, v110
v_mfma_f32_16x16x32_bf16 v[72:75], a[216:219], v[20:23], v[72:75]
v_lshlrev_b32 v122, 16, v111
v_and_b32 v123, 0xffff0000, v111
v_mfma_f32_16x16x32_bf16 v[72:75], a[232:235], v[24:27], v[72:75]
v_lshlrev_b32 v124, 16, v112
v_and_b32 v125, 0xffff0000, v112
v_mfma_f32_16x16x32_bf16 v[72:75], a[248:251], v[28:31], v[72:75]
s_waitcnt vmcnt(1)
v_lshlrev_b32 v126, 16, v113
v_and_b32 v127, 0xffff0000, v113
v_mfma_f32_16x16x32_bf16 v[76:79], a[204:207], v[16:19], v[76:79]
buffer_store_dword v8, v7, s[36:39], 0 offen
v_mfma_f32_16x16x32_bf16 v[76:79], a[220:223], v[20:23], v[76:79]
v_lshlrev_b32 v128, 16, v114
v_and_b32 v129, 0xffff0000, v114
v_mfma_f32_16x16x32_bf16 v[76:79], a[236:239], v[24:27], v[76:79]
v_lshlrev_b32 v130, 16, v115
v_and_b32 v131, 0xffff0000, v115
v_mfma_f32_16x16x32_bf16 v[76:79], a[252:255], v[28:31], v[76:79]
s_waitcnt lgkmcnt(0)
v_mfma_f32_16x16x32_bf16 v[64:67], v[192:195], v[32:35], v[64:67]
s_waitcnt vmcnt(4) lgkmcnt(0)
v_mfma_f32_16x16x32_bf16 v[64:67], v[208:211], v[36:39], v[64:67]
s_cbranch_scc0 K2_U0f
K2_X1f:
K2_NR1f:
buffer_load_dword v6, v5, s[36:39], 0 offen sc1
v_mfma_f32_16x16x32_bf16 v[64:67], v[224:227], v[40:43], v[64:67]
s_mul_i32 s67, s0, s100
s_add_u32 s67, s67, s11
s_mov_b32 s46, s74
v_mfma_f32_16x16x32_bf16 v[64:67], v[240:243], v[44:47], v[64:67]
s_add_u32 s79, s13, 1
s_mov_b32 s64, s13
s_mov_b32 s0, s1
v_mfma_f32_16x16x32_bf16 v[68:71], v[196:199], v[32:35], v[68:71]
v_mfma_f32_16x16x32_bf16 v[68:71], v[212:215], v[36:39], v[68:71]
v_mfma_f32_16x16x32_bf16 v[68:71], v[228:231], v[40:43], v[68:71]
v_mfma_f32_16x16x32_bf16 v[68:71], v[244:247], v[44:47], v[68:71]
v_mfma_f32_16x16x32_bf16 v[72:75], v[200:203], v[32:35], v[72:75]
v_mfma_f32_16x16x32_bf16 v[72:75], v[216:219], v[36:39], v[72:75]
v_mfma_f32_16x16x32_bf16 v[72:75], v[232:235], v[40:43], v[72:75]
v_mfma_f32_16x16x32_bf16 v[72:75], v[248:251], v[44:47], v[72:75]
v_mfma_f32_16x16x32_bf16 v[76:79], v[204:207], v[32:35], v[76:79]
v_mfma_f32_16x16x32_bf16 v[76:79], v[220:223], v[36:39], v[76:79]
v_mfma_f32_16x16x32_bf16 v[76:79], v[236:239], v[40:43], v[76:79]
v_mfma_f32_16x16x32_bf16 v[76:79], v[252:255], v[44:47], v[76:79]
s_waitcnt vmcnt(0)
s_mov_b32 s68, 2
s_cmp_gt_u32 s64, 33
s_cbranch_scc1 K2_EP1f
v_cmp_le_u32 vcc, s65, v6
s_nop 0
s_cmp_eq_u64 vcc, -1
s_cselect_b32 s68, 1, 0
s_cselect_b32 s42, 0x4000000, 0
s_mul_i32 s71, s1, 24576
s_add_u32 s71, s71, s12
buffer_load_dwordx4 v[108:111], v105, s[40:43], s71 offen sc1
buffer_load_dwordx4 v[112:115], v106, s[40:43], s71 offen sc1
s_add_u32 s69, s66, 4096
s_add_u32 m0, s72, 4096
s_nop 0
buffer_load_dwordx4 v1, s[40:43], s69 offen offset:0 sc1 lds
s_add_u32 m0, s72, 0
s_nop 0
buffer_load_dwordx4 v1, s[40:43], s66 offen offset:0 sc1 lds
buffer_load_dwordx4 v1, s[40:43], s66 offen offset:1024 sc1 lds
buffer_load_dwordx4 v1, s[40:43], s66 offen offset:2048 sc1 lds
buffer_load_dwordx4 v1, s[40:43], s66 offen offset:3072 sc1 lds
buffer_load_dword v6, v5, s[36:39], 0 offen sc1
K2_EP1f:
v_add_f32 v132, v64, v65
v_mul_f32 v133, v64, v64
v_fmac_f32 v133, v65, v65
v_fmac_f32 v133, v66, v66
v_add_f32 v132, v132, v66
v_fmac_f32 v133, v67, v67
v_add_f32 v132, v132, v67
v_fmac_f32 v133, v68, v68
v_add_f32 v132, v132, v68
v_fmac_f32 v133, v69, v69
v_add_f32 v132, v132, v69
v_fmac_f32 v133, v70, v70
v_add_f32 v132, v132, v70
v_fmac_f32 v133, v71, v71
v_add_f32 v132, v132, v71
v_cvt_pk_bf16_f32 v96, v64, v65
v_cvt_pk_bf16_f32 v97, v66, v67
v_cvt_pk_bf16_f32 v98, v68, v69
v_cvt_pk_bf16_f32 v99, v70, v71
buffer_store_dwordx4 v[96:99], v105, s[44:47], s67 offen
v_add_f32 v134, v72, v73
v_mul_f32 v135, v72, v72
v_fmac_f32 v135, v73, v73
v_fmac_f32 v135, v74, v74
v_add_f32 v134, v134, v74
v_fmac_f32 v135, v75, v75
v_add_f32 v134, v134, v75
v_fmac_f32 v135, v76, v76
v_add_f32 v134, v134, v76
v_fmac_f32 v135, v77, v77
v_add_f32 v134, v134, v77
v_fmac_f32 v135, v78, v78
v_add_f32 v134, v134, v78
v_fmac_f32 v135, v79, v79
v_add_f32 v134, v134, v79
v_cvt_pk_bf16_f32 v100, v72, v73
v_cvt_pk_bf16_f32 v101, v74, v75
v_cvt_pk_bf16_f32 v102, v76, v77
v_cvt_pk_bf16_f32 v103, v78, v79
buffer_store_dwordx4 v[100:103], v106, s[44:47], s67 offen
v_permlane32_swap_b32 v132, v133
v_permlane32_swap_b32 v134, v135
v_add_f32 v132, v132, v133
v_add_f32 v134, v134, v135
s_nop 1
v_permlane16_swap_b32 v132, v134
v_add_f32 v132, v132, v134
v_fma_f32 v132, v132, s76, v137
buffer_store_dword v132, v136, s[44:47], s67 offen
v_add_u32 v8, s79, v11
s_mov_b32 s46, 0
s_cmp_eq_u32 s68, 0
s_cbranch_scc1 K2_N21f
s_waitcnt vmcnt(0)
buffer_store_dword v8, v7, s[36:39], 0 offen
s_cmp_eq_u32 s68, 2
s_cbranch_scc1 L_FIN
s_branch K2_GO1f
K2_N21f:
s_waitcnt vmcnt(3)
v_cmp_le_u32 vcc, s65, v6
s_nop 0
s_cmp_eq_u64 vcc, -1
s_cselect_b32 s68, 1, 0
s_cselect_b32 s42, 0x4000000, 0
s_mul_i32 s71, s1, 24576
s_add_u32 s71, s71, s12
buffer_load_dwordx4 v[108:111], v105, s[40:43], s71 offen sc1
buffer_load_dwordx4 v[112:115], v106, s[40:43], s71 offen sc1
s_add_u32 s69, s66, 4096
s_add_u32 m0, s72, 4096
s_nop 0
buffer_load_dwordx4 v1, s[40:43], s69 offen offset:0 sc1 lds
s_add_u32 m0, s72, 0
s_nop 0
buffer_load_dwordx4 v1, s[40:43], s66 offen offset:0 sc1 lds
buffer_load_dwordx4 v1, s[40:43], s66 offen offset:1024 sc1 lds
buffer_load_dwordx4 v1, s[40:43], s66 offen offset:2048 sc1 lds
buffer_load_dwordx4 v1, s[40:43], s66 offen offset:3072 sc1 lds
buffer_load_dword v6, v5, s[36:39], 0 offen sc1
s_waitcnt vmcnt(8)
buffer_store_dword v8, v7, s[36:39], 0 offen
s_waitcnt vmcnt(1)
s_cmp_eq_u32 s68, 1
s_cbranch_scc1 K2_GO1f
K2_SW1f:
s_mov_b32 s75, 0
K2_SP1f:
buffer_load_dword v6, v5, s[36:39], 0 offen sc1
s_add_u32 s75, s75, 1
s_cmp_gt_u32 s75, 0x8000
s_cbranch_scc1 L_TIMEOUT
s_waitcnt vmcnt(0)
v_cmp_le_u32 vcc, s65, v6
s_nop 0
s_cmp_eq_u64 vcc, -1
s_cbranch_scc0 K2_SP1f
s_mov_b32 s42, 0x4000000
s_mul_i32 s71, s1, 24576
s_add_u32 s71, s71, s12
buffer_load_dwordx4 v[108:111], v105, s[40:43], s71 offen sc1
buffer_load_dwordx4 v[112:115], v106, s[40:43], s71 offen sc1
s_add_u32 s69, s66, 4096
s_add_u32 m0, s72, 4096
s_nop 0
buffer_load_dwordx4 v1, s[40:43], s69 offen offset:0 sc1 lds
s_add_u32 m0, s72, 0
s_nop 0
buffer_load_dwordx4 v1, s[40:43], s66 offen offset:0 sc1 lds
buffer_load_dwordx4 v1, s[40:43], s66 offen offset:1024 sc1 lds
buffer_load_dwordx4 v1, s[40:43], s66 offen offset:2048 sc1 lds
buffer_load_dwordx4 v1, s[40:43], s66 offen offset:3072 sc1 lds
buffer_load_dword v6, v5, s[36:39], 0 offen sc1
s_waitcnt vmcnt(0)
K2_GO1f:
v_lshlrev_b32 v116, 16, v108
v_and_b32 v117, 0xffff0000, v108
v_lshlrev_b32 v118, 16, v109
v_and_b32 v119, 0xffff0000, v109
v_lshlrev_b32 v120, 16, v110
v_and_b32 v121, 0xffff0000, v110
v_lshlrev_b32 v122, 16, v111
v_and_b32 v123, 0xffff0000, v111
v_lshlrev_b32 v124, 16, v112
v_and_b32 v125, 0xffff0000, v112
v_lshlrev_b32 v126, 16, v113
v_and_b32 v127, 0xffff0000, v113
v_lshlrev_b32 v128, 16, v114
v_and_b32 v129, 0xffff0000, v114
v_lshlrev_b32 v130, 16, v115
v_and_b32 v131, 0xffff0000, v115
s_barrier

ds_read2st64_b64 v[16:19], v104 offset0:0 offset1:1
ds_read2st64_b64 v[20:23], v104 offset0:2 offset1:3
ds_read2st64_b64 v[24:27], v104 offset0:4 offset1:5
s_add_u32 s13, s64, 1
ds_read2st64_b64 v[28:31], v104 offset0:6 offset1:7
s_cmp_eq_u32 s13, 17
s_addc_u32 s13, s13, 0
s_sub_u32 s1, s13, 17
s_cselect_b32 s1, s13, s1
s_and_b32 s66, s13, 7
s_mul_i32 s66, s66, 24576
s_add_u32 s66, s66, s10
s_add_u32 s65, s13, 2
v_add_u32 v8, s79, v11
v_add_f32 v132, v64, v65
v_mul_f32 v133, v64, v64
v_fmac_f32 v133, v65, v65
v_fmac_f32 v133, v66, v66
v_add_f32 v132, v132, v66
s_waitcnt vmcnt(1)
v_cmp_le_u32 vcc, s65, v6
v_fmac_f32 v133, v67, v67
s_cmp_eq_u64 vcc, -1
v_add_f32 v132, v132, v67
v_fmac_f32 v133, v68, v68
s_cbranch_scc0 K2_W0f_c
K2_W0f_cR:
s_cselect_b32 s68, 1, 0
s_waitcnt lgkmcnt(0)
s_cselect_b32 s42, 0x4000000, 0
s_mul_i32 s71, s1, 24576
s_nop 7
s_branch K2_F0f
K2_W1f:
s_mov_b32 s75, 6
s_cmp_lt_u32 s65, 36
s_cbranch_scc0 K2_W1fR
s_cmp_lg_u32 s65, 20
s_cbranch_scc0 K2_W1fR
K2_W1fL:
buffer_load_dword v6, v5, s[36:39], 0 offen sc1
s_waitcnt vmcnt(0)
v_cmp_le_u32 vcc, s65, v6
s_nop 0
s_cmp_eq_u64 vcc, -1
s_cbranch_scc1 K2_W1fR
s_sub_u32 s75, s75, 1
s_cmp_lg_u32 s75, 0
s_cbranch_scc1 K2_W1fL
s_branch K2_W1fR
K2_W0f_c:
s_mov_b32 s75, 6
s_cmp_lt_u32 s65, 36
s_cbranch_scc0 K2_W0f_cR
s_cmp_lg_u32 s65, 20
s_cbranch_scc0 K2_W0f_cR
K2_W0f_cL:
buffer_load_dword v6, v5, s[36:39], 0 offen sc1
s_waitcnt vmcnt(0)
v_cmp_le_u32 vcc, s65, v6
s_nop 0
s_cmp_eq_u64 vcc, -1
s_cbranch_scc1 K2_W0f_cR
s_sub_u32 s75, s75, 1
s_cmp_lg_u32 s75, 0
s_cbranch_scc1 K2_W0f_cL
s_branch K2_W0f_cR
K2_X0f:
K2_NR0f:
buffer_load_dword v6, v5, s[36:39], 0 offen sc1
v_mfma_f32_16x16x32_bf16 v[48:51], v[224:227], v[24:27], v[48:51]
s_mul_i32 s67, s0, s100
s_add_u32 s67, s67, s11
s_mov_b32 s46, s74
v_mfma_f32_16x16x32_bf16 v[48:51], v[240:243], v[28:31], v[48:51]
s_add_u32 s79, s13, 1
s_mov_b32 s64, s13
s_mov_b32 s0, s1
v_mfma_f32_16x16x32_bf16 v[52:55], v[196:199], v[16:19], v[52:55]
v_mfma_f32_16x16x32_bf16 v[52:55], v[212:215], v[20:23], v[52:55]
v_mfma_f32_16x16x32_bf16 v[52:55], v[228:231], v[24:27], v[52:55]
v_mfma_f32_16x16x32_bf16 v[52:55], v[244:247], v[28:31], v[52:55]
v_mfma_f32_16x16x32_bf16 v[56:59], v[200:203], v[16:19], v[56:59]
v_mfma_f32_16x16x32_bf16 v[56:59], v[216:219], v[20:23], v[56:59]
v_mfma_f32_16x16x32_bf16 v[56:59], v[232:235], v[24:27], v[56:59]
v_mfma_f32_16x16x32_bf16 v[56:59], v[248:251], v[28:31], v[56:59]
v_mfma_f32_16x16x32_bf16 v[60:63], v[204:207], v[16:19], v[60:63]
v_mfma_f32_16x16x32_bf16 v[60:63], v[220:223], v[20:23], v[60:63]
v_mfma_f32_16x16x32_bf16 v[60:63], v[236:239], v[24:27], v[60:63]
v_mfma_f32_16x16x32_bf16 v[60:63], v[252:255], v[28:31], v[60:63]
s_waitcnt vmcnt(0)
s_mov_b32 s68, 2
s_cmp_gt_u32 s64, 33
s_cbranch_scc1 K2_EP0f
v_cmp_le_u32 vcc, s65, v6
s_nop 0
s_cmp_eq_u64 vcc, -1
s_cselect_b32 s68, 1, 0
s_cselect_b32 s42, 0x4000000, 0
s_mul_i32 s71, s1, 24576
s_add_u32 s71, s71, s12
buffer_load_dwordx4 v[108:111], v105, s[40:43], s71 offen sc1
buffer_load_dwordx4 v[112:115], v106, s[40:43], s71 offen sc1
s_add_u32 s69, s66, 4096
s_add_u32 m0, s72, 28672
s_nop 0
buffer_load_dwordx4 v1, s[40:43], s69 offen offset:0 sc1 lds
s_add_u32 m0, s72, 24576
s_nop 0
buffer_load_dwordx4 v1, s[40:43], s66 offen offset:0 sc1 lds
buffer_load_dwordx4 v1, s[40:43], s66 offen offset:1024 sc1 lds
buffer_load_dwordx4 v1, s[40:43], s66 offen offset:2048 sc1 lds
buffer_load_dwordx4 v1, s[40:43], s66 offen offset:3072 sc1 lds
buffer_load_dword v6, v5, s[36:39], 0 offen sc1
K2_EP0f:
v_add_f32 v132, v48, v49
v_mul_f32 v133, v48, v48
v_fmac_f32 v133, v49, v49
v_fmac_f32 v133, v50, v50
v_add_f32 v132, v132, v50
v_fmac_f32 v133, v51, v51
v_add_f32 v132, v132, v51
v_fmac_f32 v133, v52, v52
v_add_f32 v132, v132, v52
v_fmac_f32 v133, v53, v53
v_add_f32 v132, v132, v53
v_fmac_f32 v133, v54, v54
v_add_f32 v132, v132, v54
v_fmac_f32 v133, v55, v55
v_add_f32 v132, v132, v55
v_cvt_pk_bf16_f32 v96, v48, v49
v_cvt_pk_bf16_f32 v97, v50, v51
v_cvt_pk_bf16_f32 v98, v52, v53
v_cvt_pk_bf16_f32 v99, v54, v55
buffer_store_dwordx4 v[96:99], v105, s[44:47], s67 offen
v_add_f32 v134, v56, v57
v_mul_f32 v135, v56, v56
v_fmac_f32 v135, v57, v57
v_fmac_f32 v135, v58, v58
v_add_f32 v134, v134, v58
v_fmac_f32 v135, v59, v59
v_add_f32 v134, v134, v59
v_fmac_f32 v135, v60, v60
v_add_f32 v134, v134, v60
v_fmac_f32 v135, v61, v61
v_add_f32 v134, v134, v61
v_fmac_f32 v135, v62, v62
v_add_f32 v134, v134, v62
v_fmac_f32 v135, v63, v63
v_add_f32 v134, v134, v63
v_cvt_pk_bf16_f32 v100, v56, v57
v_cvt_pk_bf16_f32 v101, v58, v59
v_cvt_pk_bf16_f32 v102, v60, v61
v_cvt_pk_bf16_f32 v103, v62, v63
buffer_store_dwordx4 v[100:103], v106, s[44:47], s67 offen
v_permlane32_swap_b32 v132, v133
v_permlane32_swap_b32 v134, v135
v_add_f32 v132, v132, v133
v_add_f32 v134, v134, v135
s_nop 1
v_permlane16_swap_b32 v132, v134
v_add_f32 v132, v132, v134
v_fma_f32 v132, v132, s76, v137
buffer_store_dword v132, v136, s[44:47], s67 offen
v_add_u32 v8, s79, v11
s_mov_b32 s46, 0
s_cmp_eq_u32 s68, 0
s_cbranch_scc1 K2_N20f
s_waitcnt vmcnt(0)
buffer_store_dword v8, v7, s[36:39], 0 offen
s_cmp_eq_u32 s68, 2
s_cbranch_scc1 L_FIN
s_branch K2_GO0f
K2_N20f:
s_waitcnt vmcnt(3)
v_cmp_le_u32 vcc, s65, v6
s_nop 0
s_cmp_eq_u64 vcc, -1
s_cselect_b32 s68, 1, 0
s_cselect_b32 s42, 0x4000000, 0
s_mul_i32 s71, s1, 24576
s_add_u32 s71, s71, s12
buffer_load_dwordx4 v[108:111], v105, s[40:43], s71 offen sc1
buffer_load_dwordx4 v[112:115], v106, s[40:43], s71 offen sc1
s_add_u32 s69, s66, 4096
s_add_u32 m0, s72, 28672
s_nop 0
buffer_load_dwordx4 v1, s[40:43], s69 offen offset:0 sc1 lds
s_add_u32 m0, s72, 24576
s_nop 0
buffer_load_dwordx4 v1, s[40:43], s66 offen offset:0 sc1 lds
buffer_load_dwordx4 v1, s[40:43], s66 offen offset:1024 sc1 lds
buffer_load_dwordx4 v1, s[40:43], s66 offen offset:2048 sc1 lds
buffer_load_dwordx4 v1, s[40:43], s66 offen offset:3072 sc1 lds
buffer_load_dword v6, v5, s[36:39], 0 offen sc1
s_waitcnt vmcnt(8)
buffer_store_dword v8, v7, s[36:39], 0 offen
s_waitcnt vmcnt(1)
s_cmp_eq_u32 s68, 1
s_cbranch_scc1 K2_GO0f
K2_SW0f:
s_mov_b32 s75, 0
K2_SP0f:
buffer_load_dword v6, v5, s[36:39], 0 offen sc1
s_add_u32 s75, s75, 1
s_cmp_gt_u32 s75, 0x8000
s_cbranch_scc1 L_TIMEOUT
s_waitcnt vmcnt(0)
v_cmp_le_u32 vcc, s65, v6
s_nop 0
s_cmp_eq_u64 vcc, -1
s_cbranch_scc0 K2_SP0f
s_mov_b32 s42, 0x4000000
s_mul_i32 s71, s1, 24576
s_add_u32 s71, s71, s12
buffer_load_dwordx4 v[108:111], v105, s[40:43], s71 offen sc1
buffer_load_dwordx4 v[112:115], v106, s[40:43], s71 offen sc1
s_add_u32 s69, s66, 4096
s_add_u32 m0, s72, 28672
s_nop 0
buffer_load_dwordx4 v1, s[40:43], s69 offen offset:0 sc1 lds
s_add_u32 m0, s72, 24576
s_nop 0
buffer_load_dwordx4 v1, s[40:43], s66 offen offset:0 sc1 lds
buffer_load_dwordx4 v1, s[40:43], s66 offen offset:1024 sc1 lds
buffer_load_dwordx4 v1, s[40:43], s66 offen offset:2048 sc1 lds
buffer_load_dwordx4 v1, s[40:43], s66 offen offset:3072 sc1 lds
buffer_load_dword v6, v5, s[36:39], 0 offen sc1
s_waitcnt vmcnt(0)
K2_GO0f:
v_lshlrev_b32 v116, 16, v108
v_and_b32 v117, 0xffff0000, v108
v_lshlrev_b32 v118, 16, v109
v_and_b32 v119, 0xffff0000, v109
v_lshlrev_b32 v120, 16, v110
v_and_b32 v121, 0xffff0000, v110
v_lshlrev_b32 v122, 16, v111
v_and_b32 v123, 0xffff0000, v111
v_lshlrev_b32 v124, 16, v112
v_and_b32 v125, 0xffff0000, v112
v_lshlrev_b32 v126, 16, v113
v_and_b32 v127, 0xffff0000, v113
v_lshlrev_b32 v128, 16, v114
v_and_b32 v129, 0xffff0000, v114
v_lshlrev_b32 v130, 16, v115
v_and_b32 v131, 0xffff0000, v115
s_barrier

ds_read2st64_b64 v[32:35], v104 offset0:48 offset1:49
ds_read2st64_b64 v[36:39], v104 offset0:50 offset1:51
ds_read2st64_b64 v[40:43], v104 offset0:52 offset1:53
s_add_u32 s13, s64, 1
ds_read2st64_b64 v[44:47], v104 offset0:54 offset1:55
s_cmp_eq_u32 s13, 17
s_addc_u32 s13, s13, 0
s_sub_u32 s1, s13, 17
s_cselect_b32 s1, s13, s1
s_and_b32 s66, s13, 7
s_mul_i32 s66, s66, 24576
s_add_u32 s66, s66, s10
s_add_u32 s65, s13, 2
v_add_u32 v8, s79, v11
v_add_f32 v132, v48, v49
v_mul_f32 v133, v48, v48
v_fmac_f32 v133, v49, v49
v_fmac_f32 v133, v50, v50
v_add_f32 v132, v132, v50
s_waitcnt vmcnt(1)
v_cmp_le_u32 vcc, s65, v6
v_fmac_f32 v133, v51, v51
s_cmp_eq_u64 vcc, -1
v_add_f32 v132, v132, v51
v_fmac_f32 v133, v52, v52
s_cbranch_scc0 K2_W1f_c
K2_W1f_cR:
s_cselect_b32 s68, 1, 0
s_waitcnt lgkmcnt(0)
s_cselect_b32 s42, 0x4000000, 0
s_mul_i32 s71, s1, 24576
s_nop 7
s_branch K2_F1f
K2_W0f:
s_mov_b32 s75, 6
s_cmp_lt_u32 s65, 36
s_cbranch_scc0 K2_W0fR
s_cmp_lg_u32 s65, 20
s_cbranch_scc0 K2_W0fR
K2_W0fL:
buffer_load_dword v6, v5, s[36:39], 0 offen sc1
s_waitcnt vmcnt(0)
v_cmp_le_u32 vcc, s65, v6
s_nop 0
s_cmp_eq_u64 vcc, -1
s_cbranch_scc1 K2_W0fR
s_sub_u32 s75, s75, 1
s_cmp_lg_u32 s75, 0
s_cbranch_scc1 K2_W0fL
s_branch K2_W0fR
K2_W1f_c:
s_mov_b32 s75, 6
s_cmp_lt_u32 s65, 36
s_cbranch_scc0 K2_W1f_cR
s_cmp_lg_u32 s65, 20
s_cbranch_scc0 K2_W1f_cR
K2_W1f_cL:
buffer_load_dword v6, v5, s[36:39], 0 offen sc1
s_waitcnt vmcnt(0)
v_cmp_le_u32 vcc, s65, v6
s_nop 0
s_cmp_eq_u64 vcc, -1
s_cbranch_scc1 K2_W1f_cR
s_sub_u32 s75, s75, 1
s_cmp_lg_u32 s75, 0
s_cbranch_scc1 K2_W1f_cL
s_branch K2_W1f_cR
K3_START:
s_sub_u32 s6, s5, 18
s_lshl_b32 s71, s6, 2
s_add_u32 s71, s71, s3
s_mov_b32 s73, s71
s_mul_i32 s7, s4, 7
s_lshr_b32 s7, s7, 2
s_sub_u32 s73, s73, s7
s_cselect_b32 s7, 54, 0
s_add_u32 s73, s73, s7
s_cmp_lt_u32 s71, 54
s_cselect_b32 s73, s73, s71
s_mul_i32 s69, s3, 5
s_lshl_b32 s7, s4, 15
s_lshl_b32 s8, s73, 7
s_add_u32 s8, s8, s7
s_add_u32 s8, s8, 16384
v_mov_b32 v12, s8
v_mov_b32 v13, 0x7ff00000
v_cmp_eq_u32 vcc, 0, v2
s_nop 1
v_cndmask_b32 v7, v13, v12, vcc
s_add_u32 s7, s7, 8192
v_min_u32 v5, 4, v2
buffer_store_dword v8, v7, s[36:39], 0 offen sc1
v_add_u32 v5, s69, v5
v_lshl_add_u32 v5, v5, 7, s7
s_lshl_b32 s7, s4, 15
s_add_u32 s7, s7, 31104
v_min_u32 v12, 11, v2
v_lshl_add_u32 v12, v12, 7, s7
v_cmp_lt_u32 vcc, 4, v2
s_nop 1
v_cndmask_b32 v5, v5, v12, vcc
s_lshl_b32 s7, s71, 13
v_lshl_add_u32 v12, v2, 7, s7
s_mov_b32 s56, s20
s_mov_b32 s57, s21
s_mov_b32 s58, 819200
s_mul_i32 s8, s4, 5
s_lshr_b32 s8, s8, 1
s_mul_i32 s8, s8, 122880
v_add_u32 v14, s8, v12
v_subrev_u32 v13, 2457600, v14
v_min_u32 v13, v13, v14
buffer_load_dword v16, v13, s[48:51], 0 offen
v_add_u32 v14, 458752, v14
v_subrev_u32 v13, 2457600, v14
v_min_u32 v13, v13, v14
buffer_load_dword v16, v13, s[48:51], 0 offen
v_add_u32 v14, 458752, v14
s_waitcnt vmcnt(2)
s_barrier
buffer_atomic_add v254, v255, s[52:55], 0 offen sc1
v_subrev_u32 v13, 2457600, v14
v_min_u32 v13, v13, v14
buffer_load_dword v16, v13, s[48:51], 0 offen
v_add_u32 v14, 458752, v14
v_subrev_u32 v13, 2457600, v14
v_min_u32 v13, v13, v14
buffer_load_dword v16, v13, s[48:51], 0 offen
v_add_u32 v14, 458752, v14
v_subrev_u32 v13, 2457600, v14
v_min_u32 v13, v13, v14
buffer_load_dword v16, v13, s[48:51], 0 offen
v_add_u32 v14, 458752, v14
v_mov_b32 v15, 0x7ff00000
v_cmp_gt_u32 vcc, 163840, v12
s_nop 1
v_cndmask_b32 v14, v15, v14, vcc
v_subrev_u32 v13, 2457600, v14
v_min_u32 v13, v13, v14
buffer_load_dword v16, v13, s[48:51], 0 offen
v_add_u32 v14, 458752, v14
s_mov_b32 s7, 0
buffer_load_dword v16, v12, s[56:59], s7 offen
s_mov_b32 s7, 458752
buffer_load_dword v16, v12, s[56:59], s7 offen
v_lshlrev_b32 v12, 2, v4
v_xor_b32 v12, v12, v3
s_lshr_b32 s7, s3, 1
s_and_b32 s8, s3, 1
v_mov_b32 v15, 0x7ff00000
s_cmp_eq_u32 s7, 0
s_cselect_b32 s48, s24, s26
s_cselect_b32 s49, s25, s27
s_mov_b32 s50, 2211840
s_lshl_b32 s7, s6, 8
v_lshl_add_u32 v14, v12, 4, s7
s_mul_i32 s15, s8, 55296
v_cmp_gt_u32 vcc, 3456, v14
s_nop 1
v_cndmask_b32 v14, v15, v14, vcc
v_mul_u32_u24 v13, 3456, v4
v_add_u32 v88, v13, v14
s_lshl_b32 s70, s3, 12
s_add_u32 s13, s15, 2211840
s_mul_i32 s7, s4, 5
s_lshr_b32 s7, s7, 1
s_mul_i32 s7, s7, 110592
s_add_u32 s15, s15, s7
v_lshrrev_b32 v12, 2, v3
v_and_b32 v13, 3, v3
v_lshl_add_u32 v14, v4, 3, v12
v_lshlrev_b32 v14, 8, v14
v_lshlrev_b32 v12, 2, v12
s_lshl_b32 s7, s3, 6
s_add_u32 s7, s7, 0
v_lshl_add_u32 v15, v13, 4, s7
v_bfe_u32 v84, v15, 4, 4
v_xor_b32 v84, v84, v12
v_lshl_add_u32 v80, v84, 4, v14
v_lshrrev_b32 v84, 8, v15
v_lshl_add_u32 v80, v84, 13, v80
v_and_b32 v84, 8, v15
v_add_u32 v80, v80, v84
s_lshl_b32 s7, s3, 6
s_add_u32 s7, s7, 256
v_lshl_add_u32 v15, v13, 4, s7
v_bfe_u32 v84, v15, 4, 4
v_xor_b32 v84, v84, v12
v_lshl_add_u32 v81, v84, 4, v14
v_lshrrev_b32 v84, 8, v15
v_lshl_add_u32 v81, v84, 13, v81
v_and_b32 v84, 8, v15
v_add_u32 v81, v81, v84
s_lshl_b32 s7, s3, 6
s_add_u32 s7, s7, 8
v_lshl_add_u32 v15, v13, 4, s7
v_bfe_u32 v84, v15, 4, 4
v_xor_b32 v84, v84, v12
v_lshl_add_u32 v82, v84, 4, v14
v_lshrrev_b32 v84, 8, v15
v_lshl_add_u32 v82, v84, 13, v82
v_and_b32 v84, 8, v15
v_add_u32 v82, v82, v84
s_lshl_b32 s7, s3, 6
s_add_u32 s7, s7, 264
v_lshl_add_u32 v15, v13, 4, s7
v_bfe_u32 v84, v15, 4, 4
v_xor_b32 v84, v84, v12
v_lshl_add_u32 v83, v84, 4, v14
v_lshrrev_b32 v84, 8, v15
v_lshl_add_u32 v83, v84, 13, v83
v_and_b32 v84, 8, v15
v_add_u32 v83, v83, v84
v_lshrrev_b32 v15, 2, v3
v_lshl_add_u32 v15, v13, 2, v15
v_lshl_add_u32 v15, v4, 4, v15
v_lshlrev_b32 v89, 2, v15
v_mov_b32 v84, 0x3f803f80
v_mov_b32 v85, 0x3f803f80
v_mov_b32 v86, 0x3f803f80
v_mov_b32 v87, 0x3f803f80
s_mul_i32 s10, s9, 24576
s_add_u32 s12, s10, 327680
s_mul_i32 s7, s3, 6144
s_add_u32 s10, s10, s7
s_add_u32 s10, s10, 327680
s_mov_b32 s66, s10
s_add_u32 s72, s7, 98304
s_mul_i32 s11, s9, 55296
s_add_u32 s11, s11, 10354688
s_mov_b32 s100, 55296
v_mov_b32 v48, 0
v_mov_b32 v49, 0
v_mov_b32 v50, 0
v_mov_b32 v51, 0
v_mov_b32 v52, 0
v_mov_b32 v53, 0
v_mov_b32 v54, 0
v_mov_b32 v55, 0
v_mov_b32 v56, 0
v_mov_b32 v57, 0
v_mov_b32 v58, 0
v_mov_b32 v59, 0
v_mov_b32 v60, 0
v_mov_b32 v61, 0
v_mov_b32 v62, 0
v_mov_b32 v63, 0
v_mov_b32 v64, 0
v_mov_b32 v65, 0
v_mov_b32 v66, 0
v_mov_b32 v67, 0
v_mov_b32 v68, 0
v_mov_b32 v69, 0
v_mov_b32 v70, 0
v_mov_b32 v71, 0
v_mov_b32 v72, 0
v_mov_b32 v73, 0
v_mov_b32 v74, 0
v_mov_b32 v75, 0
v_mov_b32 v76, 0
v_mov_b32 v77, 0
v_mov_b32 v78, 0
v_mov_b32 v79, 0
v_add_u32 v100, 98304, v1
v_mul_u32_u24 v12, 6144, v4
v_lshl_add_u32 v12, v3, 3, v12
v_add_u32 v103, 103424, v12
v_mov_b32 v130, 0
v_mov_b32 v131, 0
v_mov_b32 v132, 0
v_mov_b32 v133, 0
v_mov_b32 v134, 0
v_mov_b32 v135, 0
s_lshl_b32 s7, s73, 10
s_cmp_lt_u32 s71, 54
s_cselect_b32 s7, s7, 0x7ff00000
v_add_u32 v101, s7, v1
s_mov_b32 s60, s11
v_mov_b32 v4, v101
s_waitcnt vmcnt(1)
s_add_u32 m0, s70, 0
s_add_u32 s7, s15, 0
buffer_load_dwordx4 v88, s[48:51], s7 offen lds
s_add_u32 m0, s70, 1024
s_add_u32 s7, s15, 13824
buffer_load_dwordx4 v88, s[48:51], s7 offen lds
s_add_u32 m0, s70, 2048
s_add_u32 s7, s15, 27648
buffer_load_dwordx4 v88, s[48:51], s7 offen lds
s_add_u32 m0, s70, 3072
s_add_u32 s7, s15, 41472
buffer_load_dwordx4 v88, s[48:51], s7 offen lds
s_add_u32 s15, s15, 110592
s_cmp_ge_u32 s15, s13
s_cselect_b32 s7, 2211840, 0
s_sub_u32 s15, s15, s7
s_add_u32 m0, s70, 16384
s_add_u32 s7, s15, 0
buffer_load_dwordx4 v88, s[48:51], s7 offen lds
s_add_u32 m0, s70, 17408
s_add_u32 s7, s15, 13824
buffer_load_dwordx4 v88, s[48:51], s7 offen lds
s_add_u32 m0, s70, 18432
s_add_u32 s7, s15, 27648
buffer_load_dwordx4 v88, s[48:51], s7 offen lds
s_add_u32 m0, s70, 19456
s_add_u32 s7, s15, 41472
buffer_load_dwordx4 v88, s[48:51], s7 offen lds
s_add_u32 s15, s15, 110592
s_cmp_ge_u32 s15, s13
s_cselect_b32 s7, 2211840, 0
s_sub_u32 s15, s15, s7
s_add_u32 m0, s70, 32768
s_add_u32 s7, s15, 0
buffer_load_dwordx4 v88, s[48:51], s7 offen lds
s_add_u32 m0, s70, 33792
s_add_u32 s7, s15, 13824
buffer_load_dwordx4 v88, s[48:51], s7 offen lds
s_add_u32 m0, s70, 34816
s_add_u32 s7, s15, 27648
buffer_load_dwordx4 v88, s[48:51], s7 offen lds
s_add_u32 m0, s70, 35840
s_add_u32 s7, s15, 41472
buffer_load_dwordx4 v88, s[48:51], s7 offen lds
s_add_u32 s15, s15, 110592
s_cmp_ge_u32 s15, s13
s_cselect_b32 s7, 2211840, 0
s_sub_u32 s15, s15, s7
s_add_u32 m0, s70, 49152
s_add_u32 s7, s15, 0
buffer_load_dwordx4 v88, s[48:51], s7 offen lds
s_add_u32 m0, s70, 50176
s_add_u32 s7, s15, 13824
buffer_load_dwordx4 v88, s[48:51], s7 offen lds
s_add_u32 m0, s70, 51200
s_add_u32 s7, s15, 27648
buffer_load_dwordx4 v88, s[48:51], s7 offen lds
s_add_u32 m0, s70, 52224
s_add_u32 s7, s15, 41472
buffer_load_dwordx4 v88, s[48:51], s7 offen lds
s_add_u32 s15, s15, 110592
s_cmp_ge_u32 s15, s13
s_cselect_b32 s7, 2211840, 0
s_sub_u32 s15, s15, s7
s_add_u32 m0, s70, 65536
s_add_u32 s7, s15, 0
buffer_load_dwordx4 v88, s[48:51], s7 offen lds
s_add_u32 m0, s70, 66560
s_add_u32 s7, s15, 13824
buffer_load_dwordx4 v88, s[48:51], s7 offen lds
s_add_u32 m0, s70, 67584
s_add_u32 s7, s15, 27648
buffer_load_dwordx4 v88, s[48:51], s7 offen lds
s_add_u32 m0, s70, 68608
s_add_u32 s7, s15, 41472
buffer_load_dwordx4 v88, s[48:51], s7 offen lds
s_add_u32 s15, s15, 110592
s_cmp_ge_u32 s15, s13
s_cselect_b32 s7, 2211840, 0
s_sub_u32 s15, s15, s7
s_mov_b32 s65, 2
s_waitcnt vmcnt(16)
s_barrier
s_add_u32 m0, s70, 81920
s_add_u32 s7, s15, 0
buffer_load_dwordx4 v88, s[48:51], s7 offen lds
ds_read_b64_tr_b16 a[0:1], v80 offset:0
ds_read_b64_tr_b16 a[2:3], v80 offset:1024
s_add_u32 m0, s70, 82944
s_add_u32 s7, s15, 13824
buffer_load_dwordx4 v88, s[48:51], s7 offen lds
ds_read_b64_tr_b16 a[4:5], v81 offset:0
ds_read_b64_tr_b16 a[6:7], v81 offset:1024
s_add_u32 m0, s70, 83968
s_add_u32 s7, s15, 27648
buffer_load_dwordx4 v88, s[48:51], s7 offen lds
ds_read_b64_tr_b16 a[8:9], v82 offset:0
ds_read_b64_tr_b16 a[10:11], v82 offset:1024
s_add_u32 m0, s70, 84992
s_add_u32 s7, s15, 41472
buffer_load_dwordx4 v88, s[48:51], s7 offen lds
ds_read_b64_tr_b16 a[12:13], v83 offset:0
ds_read_b64_tr_b16 a[14:15], v83 offset:1024
s_add_u32 s15, s15, 110592
s_cmp_ge_u32 s15, s13
s_cselect_b32 s7, 2211840, 0
s_sub_u32 s15, s15, s7
s_waitcnt lgkmcnt(0)
s_waitcnt vmcnt(16)
s_barrier
s_add_u32 m0, s70, 0
s_add_u32 s7, s15, 0
buffer_load_dwordx4 v88, s[48:51], s7 offen lds
ds_read_b64_tr_b16 a[16:17], v80 offset:16384
ds_read_b64_tr_b16 a[18:19], v80 offset:17408
s_add_u32 m0, s70, 1024
s_add_u32 s7, s15, 13824
buffer_load_dwordx4 v88, s[48:51], s7 offen lds
ds_read_b64_tr_b16 a[20:21], v81 offset:16384
ds_read_b64_tr_b16 a[22:23], v81 offset:17408
s_add_u32 m0, s70, 2048
s_add_u32 s7, s15, 27648
buffer_load_dwordx4 v88, s[48:51], s7 offen lds
ds_read_b64_tr_b16 a[24:25], v82 offset:16384
ds_read_b64_tr_b16 a[26:27], v82 offset:17408
s_add_u32 m0, s70, 3072
s_add_u32 s7, s15, 41472
buffer_load_dwordx4 v88, s[48:51], s7 offen lds
ds_read_b64_tr_b16 a[28:29], v83 offset:16384
ds_read_b64_tr_b16 a[30:31], v83 offset:17408
s_add_u32 s15, s15, 110592
s_cmp_ge_u32 s15, s13
s_cselect_b32 s7, 2211840, 0
s_sub_u32 s15, s15, s7
v_mfma_f32_16x16x32_bf16 v[104:107], a[0:3], v[84:87], 0
v_mfma_f32_16x16x32_bf16 v[108:111], a[4:7], v[84:87], 0
v_mfma_f32_16x16x32_bf16 v[112:115], a[8:11], v[84:87], 0
v_mfma_f32_16x16x32_bf16 v[116:119], a[12:15], v[84:87], 0
s_waitcnt lgkmcnt(0)
s_waitcnt vmcnt(16)
s_barrier
s_add_u32 m0, s70, 16384
s_add_u32 s7, s15, 0
buffer_load_dwordx4 v88, s[48:51], s7 offen lds
ds_read_b64_tr_b16 a[32:33], v80 offset:32768
ds_read_b64_tr_b16 a[34:35], v80 offset:33792
s_add_u32 m0, s70, 17408
s_add_u32 s7, s15, 13824
buffer_load_dwordx4 v88, s[48:51], s7 offen lds
ds_read_b64_tr_b16 a[36:37], v81 offset:32768
ds_read_b64_tr_b16 a[38:39], v81 offset:33792
s_add_u32 m0, s70, 18432
s_add_u32 s7, s15, 27648
buffer_load_dwordx4 v88, s[48:51], s7 offen lds
ds_read_b64_tr_b16 a[40:41], v82 offset:32768
ds_read_b64_tr_b16 a[42:43], v82 offset:33792
s_add_u32 m0, s70, 19456
s_add_u32 s7, s15, 41472
buffer_load_dwordx4 v88, s[48:51], s7 offen lds
ds_read_b64_tr_b16 a[44:45], v83 offset:32768
ds_read_b64_tr_b16 a[46:47], v83 offset:33792
s_add_u32 s15, s15, 110592
s_cmp_ge_u32 s15, s13
s_cselect_b32 s7, 2211840, 0
s_sub_u32 s15, s15, s7
v_mfma_f32_16x16x32_bf16 v[104:107], a[16:19], v[84:87], v[104:107]
v_mfma_f32_16x16x32_bf16 v[108:111], a[20:23], v[84:87], v[108:111]
v_mfma_f32_16x16x32_bf16 v[112:115], a[24:27], v[84:87], v[112:115]
v_mfma_f32_16x16x32_bf16 v[116:119], a[28:31], v[84:87], v[116:119]
s_waitcnt lgkmcnt(0)
s_waitcnt vmcnt(16)
s_barrier
s_add_u32 m0, s70, 32768
s_add_u32 s7, s15, 0
buffer_load_dwordx4 v88, s[48:51], s7 offen lds
ds_read_b64_tr_b16 a[48:49], v80 offset:49152
ds_read_b64_tr_b16 a[50:51], v80 offset:50176
s_add_u32 m0, s70, 33792
s_add_u32 s7, s15, 13824
buffer_load_dwordx4 v88, s[48:51], s7 offen lds
ds_read_b64_tr_b16 a[52:53], v81 offset:49152
ds_read_b64_tr_b16 a[54:55], v81 offset:50176
s_add_u32 m0, s70, 34816
s_add_u32 s7, s15, 27648
buffer_load_dwordx4 v88, s[48:51], s7 offen lds
ds_read_b64_tr_b16 a[56:57], v82 offset:49152
ds_read_b64_tr_b16 a[58:59], v82 offset:50176
s_add_u32 m0, s70, 35840
s_add_u32 s7, s15, 41472
buffer_load_dwordx4 v88, s[48:51], s7 offen lds
ds_read_b64_tr_b16 a[60:61], v83 offset:49152
ds_read_b64_tr_b16 a[62:63], v83 offset:50176
s_add_u32 s15, s15, 110592
s_cmp_ge_u32 s15, s13
s_cselect_b32 s7, 2211840, 0
s_sub_u32 s15, s15, s7
v_mfma_f32_16x16x32_bf16 v[104:107], a[32:35], v[84:87], v[104:107]
v_mfma_f32_16x16x32_bf16 v[108:111], a[36:39], v[84:87], v[108:111]
v_mfma_f32_16x16x32_bf16 v[112:115], a[40:43], v[84:87], v[112:115]
v_mfma_f32_16x16x32_bf16 v[116:119], a[44:47], v[84:87], v[116:119]
s_waitcnt lgkmcnt(0)
s_waitcnt vmcnt(16)
s_barrier
v_add_u32 v80, 0x10000, v80
v_add_u32 v81, 0x10000, v81
v_add_u32 v82, 0x10000, v82
v_add_u32 v83, 0x10000, v83
s_add_u32 m0, s70, 49152
s_add_u32 s7, s15, 0
buffer_load_dwordx4 v88, s[48:51], s7 offen lds
ds_read_b64_tr_b16 a[64:65], v80 offset:0
ds_read_b64_tr_b16 a[66:67], v80 offset:1024
s_add_u32 m0, s70, 50176
s_add_u32 s7, s15, 13824
buffer_load_dwordx4 v88, s[48:51], s7 offen lds
ds_read_b64_tr_b16 a[68:69], v81 offset:0
ds_read_b64_tr_b16 a[70:71], v81 offset:1024
s_add_u32 m0, s70, 51200
s_add_u32 s7, s15, 27648
buffer_load_dwordx4 v88, s[48:51], s7 offen lds
ds_read_b64_tr_b16 a[72:73], v82 offset:0
ds_read_b64_tr_b16 a[74:75], v82 offset:1024
s_add_u32 m0, s70, 52224
s_add_u32 s7, s15, 41472
buffer_load_dwordx4 v88, s[48:51], s7 offen lds
ds_read_b64_tr_b16 a[76:77], v83 offset:0
ds_read_b64_tr_b16 a[78:79], v83 offset:1024
s_add_u32 s15, s15, 110592
s_cmp_ge_u32 s15, s13
s_cselect_b32 s7, 2211840, 0
s_sub_u32 s15, s15, s7
v_mfma_f32_16x16x32_bf16 v[104:107], a[48:51], v[84:87], v[104:107]
v_mfma_f32_16x16x32_bf16 v[108:111], a[52:55], v[84:87], v[108:111]
v_mfma_f32_16x16x32_bf16 v[112:115], a[56:59], v[84:87], v[112:115]
v_mfma_f32_16x16x32_bf16 v[116:119], a[60:63], v[84:87], v[116:119]
s_waitcnt lgkmcnt(0)
s_waitcnt vmcnt(16)
s_barrier
s_add_u32 m0, s70, 65536
s_add_u32 s7, s15, 0
buffer_load_dwordx4 v88, s[48:51], s7 offen lds
ds_read_b64_tr_b16 a[80:81], v80 offset:16384
ds_read_b64_tr_b16 a[82:83], v80 offset:17408
s_add_u32 m0, s70, 66560
s_add_u32 s7, s15, 13824
buffer_load_dwordx4 v88, s[48:51], s7 offen lds
ds_read_b64_tr_b16 a[84:85], v81 offset:16384
ds_read_b64_tr_b16 a[86:87], v81 offset:17408
s_add_u32 m0, s70, 67584
s_add_u32 s7, s15, 27648
buffer_load_dwordx4 v88, s[48:51], s7 offen lds
ds_read_b64_tr_b16 a[88:89], v82 offset:16384
ds_read_b64_tr_b16 a[90:91], v82 offset:17408
s_add_u32 m0, s70, 68608
s_add_u32 s7, s15, 41472
buffer_load_dwordx4 v88, s[48:51], s7 offen lds
ds_read_b64_tr_b16 a[92:93], v83 offset:16384
ds_read_b64_tr_b16 a[94:95], v83 offset:17408
s_add_u32 s15, s15, 110592
s_cmp_ge_u32 s15, s13
s_cselect_b32 s7, 2211840, 0
s_sub_u32 s15, s15, s7
v_mfma_f32_16x16x32_bf16 v[104:107], a[64:67], v[84:87], v[104:107]
v_mfma_f32_16x16x32_bf16 v[108:111], a[68:71], v[84:87], v[108:111]
v_mfma_f32_16x16x32_bf16 v[112:115], a[72:75], v[84:87], v[112:115]
v_mfma_f32_16x16x32_bf16 v[116:119], a[76:79], v[84:87], v[116:119]
s_waitcnt lgkmcnt(0)
s_waitcnt vmcnt(16)
s_barrier
v_add_u32 v80, 0xffff0000, v80
v_add_u32 v81, 0xffff0000, v81
v_add_u32 v82, 0xffff0000, v82
v_add_u32 v83, 0xffff0000, v83
s_add_u32 m0, s70, 81920
s_add_u32 s7, s15, 0
buffer_load_dwordx4 v88, s[48:51], s7 offen lds
ds_read_b64_tr_b16 a[96:97], v80 offset:0
ds_read_b64_tr_b16 a[98:99], v80 offset:1024
s_add_u32 m0, s70, 82944
s_add_u32 s7, s15, 13824
buffer_load_dwordx4 v88, s[48:51], s7 offen lds
ds_read_b64_tr_b16 a[100:101], v81 offset:0
ds_read_b64_tr_b16 a[102:103], v81 offset:1024
s_add_u32 m0, s70, 83968
s_add_u32 s7, s15, 27648
buffer_load_dwordx4 v88, s[48:51], s7 offen lds
ds_read_b64_tr_b16 a[104:105], v82 offset:0
ds_read_b64_tr_b16 a[106:107], v82 offset:1024
s_add_u32 m0, s70, 84992
s_add_u32 s7, s15, 41472
buffer_load_dwordx4 v88, s[48:51], s7 offen lds
ds_read_b64_tr_b16 a[108:109], v83 offset:0
ds_read_b64_tr_b16 a[110:111], v83 offset:1024
s_add_u32 s15, s15, 110592
s_cmp_ge_u32 s15, s13
s_cselect_b32 s7, 2211840, 0
s_sub_u32 s15, s15, s7
v_mfma_f32_16x16x32_bf16 v[104:107], a[80:83], v[84:87], v[104:107]
v_mfma_f32_16x16x32_bf16 v[108:111], a[84:87], v[84:87], v[108:111]
v_mfma_f32_16x16x32_bf16 v[112:115], a[88:91], v[84:87], v[112:115]
v_mfma_f32_16x16x32_bf16 v[116:119], a[92:95], v[84:87], v[116:119]
s_waitcnt lgkmcnt(0)
s_waitcnt vmcnt(16)
s_barrier
s_add_u32 m0, s70, 0
s_add_u32 s7, s15, 0
buffer_load_dwordx4 v88, s[48:51], s7 offen lds
ds_read_b64_tr_b16 a[112:113], v80 offset:16384
ds_read_b64_tr_b16 a[114:115], v80 offset:17408
s_add_u32 m0, s70, 1024
s_add_u32 s7, s15, 13824
buffer_load_dwordx4 v88, s[48:51], s7 offen lds
ds_read_b64_tr_b16 a[116:117], v81 offset:16384
ds_read_b64_tr_b16 a[118:119], v81 offset:17408
s_add_u32 m0, s70, 2048
s_add_u32 s7, s15, 27648
buffer_load_dwordx4 v88, s[48:51], s7 offen lds
ds_read_b64_tr_b16 a[120:121], v82 offset:16384
ds_read_b64_tr_b16 a[122:123], v82 offset:17408
s_add_u32 m0, s70, 3072
s_add_u32 s7, s15, 41472
buffer_load_dwordx4 v88, s[48:51], s7 offen lds
ds_read_b64_tr_b16 a[124:125], v83 offset:16384
ds_read_b64_tr_b16 a[126:127], v83 offset:17408
s_add_u32 s15, s15, 110592
s_cmp_ge_u32 s15, s13
s_cselect_b32 s7, 2211840, 0
s_sub_u32 s15, s15, s7
v_mfma_f32_16x16x32_bf16 v[104:107], a[96:99], v[84:87], v[104:107]
v_mfma_f32_16x16x32_bf16 v[108:111], a[100:103], v[84:87], v[108:111]
v_mfma_f32_16x16x32_bf16 v[112:115], a[104:107], v[84:87], v[112:115]
v_mfma_f32_16x16x32_bf16 v[116:119], a[108:111], v[84:87], v[116:119]
s_waitcnt lgkmcnt(0)
s_waitcnt vmcnt(16)
s_barrier
s_add_u32 m0, s70, 16384
s_add_u32 s7, s15, 0
buffer_load_dwordx4 v88, s[48:51], s7 offen lds
ds_read_b64_tr_b16 a[128:129], v80 offset:32768
ds_read_b64_tr_b16 a[130:131], v80 offset:33792
s_add_u32 m0, s70, 17408
s_add_u32 s7, s15, 13824
buffer_load_dwordx4 v88, s[48:51], s7 offen lds
ds_read_b64_tr_b16 a[132:133], v81 offset:32768
ds_read_b64_tr_b16 a[134:135], v81 offset:33792
s_add_u32 m0, s70, 18432
s_add_u32 s7, s15, 27648
buffer_load_dwordx4 v88, s[48:51], s7 offen lds
ds_read_b64_tr_b16 a[136:137], v82 offset:32768
ds_read_b64_tr_b16 a[138:139], v82 offset:33792
s_add_u32 m0, s70, 19456
s_add_u32 s7, s15, 41472
buffer_load_dwordx4 v88, s[48:51], s7 offen lds
ds_read_b64_tr_b16 a[140:141], v83 offset:32768
ds_read_b64_tr_b16 a[142:143], v83 offset:33792
s_add_u32 s15, s15, 110592
s_cmp_ge_u32 s15, s13
s_cselect_b32 s7, 2211840, 0
s_sub_u32 s15, s15, s7
s_lshl_b32 s7, s4, 5
v_mov_b32 v14, s7
buffer_load_dwordx2 v[14:15], v14, s[52:55], 0 offen sc1
v_mfma_f32_16x16x32_bf16 v[104:107], a[112:115], v[84:87], v[104:107]
v_mfma_f32_16x16x32_bf16 v[108:111], a[116:119], v[84:87], v[108:111]
v_mfma_f32_16x16x32_bf16 v[112:115], a[120:123], v[84:87], v[112:115]
v_mfma_f32_16x16x32_bf16 v[116:119], a[124:127], v[84:87], v[116:119]
s_waitcnt lgkmcnt(0)
s_waitcnt vmcnt(17)
s_barrier
s_add_u32 m0, s70, 32768
s_add_u32 s7, s15, 0
buffer_load_dwordx4 v88, s[48:51], s7 offen lds
ds_read_b64_tr_b16 a[144:145], v80 offset:49152
ds_read_b64_tr_b16 a[146:147], v80 offset:50176
s_add_u32 m0, s70, 33792
s_add_u32 s7, s15, 13824
buffer_load_dwordx4 v88, s[48:51], s7 offen lds
ds_read_b64_tr_b16 a[148:149], v81 offset:49152
ds_read_b64_tr_b16 a[150:151], v81 offset:50176
s_add_u32 m0, s70, 34816
s_add_u32 s7, s15, 27648
buffer_load_dwordx4 v88, s[48:51], s7 offen lds
ds_read_b64_tr_b16 a[152:153], v82 offset:49152
ds_read_b64_tr_b16 a[154:155], v82 offset:50176
s_add_u32 m0, s70, 35840
s_add_u32 s7, s15, 41472
buffer_load_dwordx4 v88, s[48:51], s7 offen lds
ds_read_b64_tr_b16 a[156:157], v83 offset:49152
ds_read_b64_tr_b16 a[158:159], v83 offset:50176
s_add_u32 s15, s15, 110592
s_cmp_ge_u32 s15, s13
s_cselect_b32 s7, 2211840, 0
s_sub_u32 s15, s15, s7
v_mfma_f32_16x16x32_bf16 v[104:107], a[128:131], v[84:87], v[104:107]
v_mfma_f32_16x16x32_bf16 v[108:111], a[132:135], v[84:87], v[108:111]
v_mfma_f32_16x16x32_bf16 v[112:115], a[136:139], v[84:87], v[112:115]
v_mfma_f32_16x16x32_bf16 v[116:119], a[140:143], v[84:87], v[116:119]
s_waitcnt lgkmcnt(0)
s_waitcnt vmcnt(17)
s_barrier
v_add_u32 v80, 0x10000, v80
v_add_u32 v81, 0x10000, v81
v_add_u32 v82, 0x10000, v82
v_add_u32 v83, 0x10000, v83
s_add_u32 m0, s70, 49152
s_add_u32 s7, s15, 0
buffer_load_dwordx4 v88, s[48:51], s7 offen lds
ds_read_b64_tr_b16 a[160:161], v80 offset:0
ds_read_b64_tr_b16 a[162:163], v80 offset:1024
s_add_u32 m0, s70, 50176
s_add_u32 s7, s15, 13824
buffer_load_dwordx4 v88, s[48:51], s7 offen lds
ds_read_b64_tr_b16 a[164:165], v81 offset:0
ds_read_b64_tr_b16 a[166:167], v81 offset:1024
s_add_u32 m0, s70, 51200
s_add_u32 s7, s15, 27648
buffer_load_dwordx4 v88, s[48:51], s7 offen lds
ds_read_b64_tr_b16 a[168:169], v82 offset:0
ds_read_b64_tr_b16 a[170:171], v82 offset:1024
s_add_u32 m0, s70, 52224
s_add_u32 s7, s15, 41472
buffer_load_dwordx4 v88, s[48:51], s7 offen lds
ds_read_b64_tr_b16 a[172:173], v83 offset:0
ds_read_b64_tr_b16 a[174:175], v83 offset:1024
s_add_u32 s15, s15, 110592
s_cmp_ge_u32 s15, s13
s_cselect_b32 s7, 2211840, 0
s_sub_u32 s15, s15, s7
v_mfma_f32_16x16x32_bf16 v[104:107], a[144:147], v[84:87], v[104:107]
v_mfma_f32_16x16x32_bf16 v[108:111], a[148:151], v[84:87], v[108:111]
v_mfma_f32_16x16x32_bf16 v[112:115], a[152:155], v[84:87], v[112:115]
v_mfma_f32_16x16x32_bf16 v[116:119], a[156:159], v[84:87], v[116:119]
s_waitcnt lgkmcnt(0)
s_waitcnt vmcnt(17)
s_barrier
s_add_u32 m0, s70, 65536
s_add_u32 s7, s15, 0
buffer_load_dwordx4 v88, s[48:51], s7 offen lds
ds_read_b64_tr_b16 a[176:177], v80 offset:16384
ds_read_b64_tr_b16 a[178:179], v80 offset:17408
s_add_u32 m0, s70, 66560
s_add_u32 s7, s15, 13824
buffer_load_dwordx4 v88, s[48:51], s7 offen lds
ds_read_b64_tr_b16 a[180:181], v81 offset:16384
ds_read_b64_tr_b16 a[182:183], v81 offset:17408
s_add_u32 m0, s70, 67584
s_add_u32 s7, s15, 27648
buffer_load_dwordx4 v88, s[48:51], s7 offen lds
ds_read_b64_tr_b16 a[184:185], v82 offset:16384
ds_read_b64_tr_b16 a[186:187], v82 offset:17408
s_add_u32 m0, s70, 68608
s_add_u32 s7, s15, 41472
buffer_load_dwordx4 v88, s[48:51], s7 offen lds
ds_read_b64_tr_b16 a[188:189], v83 offset:16384
ds_read_b64_tr_b16 a[190:191], v83 offset:17408
s_add_u32 s15, s15, 110592
s_cmp_ge_u32 s15, s13
s_cselect_b32 s7, 2211840, 0
s_sub_u32 s15, s15, s7
v_mfma_f32_16x16x32_bf16 v[104:107], a[160:163], v[84:87], v[104:107]
v_mfma_f32_16x16x32_bf16 v[108:111], a[164:167], v[84:87], v[108:111]
v_mfma_f32_16x16x32_bf16 v[112:115], a[168:171], v[84:87], v[112:115]
v_mfma_f32_16x16x32_bf16 v[116:119], a[172:175], v[84:87], v[116:119]
s_waitcnt lgkmcnt(0)
s_waitcnt vmcnt(17)
s_barrier
v_add_u32 v80, 0xffff0000, v80
v_add_u32 v81, 0xffff0000, v81
v_add_u32 v82, 0xffff0000, v82
v_add_u32 v83, 0xffff0000, v83
s_add_u32 m0, s70, 81920
s_add_u32 s7, s15, 0
buffer_load_dwordx4 v88, s[48:51], s7 offen lds
ds_read_b64_tr_b16 a[192:193], v80 offset:0
ds_read_b64_tr_b16 a[194:195], v80 offset:1024
s_add_u32 m0, s70, 82944
s_add_u32 s7, s15, 13824
buffer_load_dwordx4 v88, s[48:51], s7 offen lds
ds_read_b64_tr_b16 a[196:197], v81 offset:0
ds_read_b64_tr_b16 a[198:199], v81 offset:1024
s_add_u32 m0, s70, 83968
s_add_u32 s7, s15, 27648
buffer_load_dwordx4 v88, s[48:51], s7 offen lds
ds_read_b64_tr_b16 a[200:201], v82 offset:0
ds_read_b64_tr_b16 a[202:203], v82 offset:1024
s_add_u32 m0, s70, 84992
s_add_u32 s7, s15, 41472
buffer_load_dwordx4 v88, s[48:51], s7 offen lds
ds_read_b64_tr_b16 a[204:205], v83 offset:0
ds_read_b64_tr_b16 a[206:207], v83 offset:1024
s_add_u32 s15, s15, 110592
s_cmp_ge_u32 s15, s13
s_cselect_b32 s7, 2211840, 0
s_sub_u32 s15, s15, s7
v_mfma_f32_16x16x32_bf16 v[104:107], a[176:179], v[84:87], v[104:107]
v_mfma_f32_16x16x32_bf16 v[108:111], a[180:183], v[84:87], v[108:111]
v_mfma_f32_16x16x32_bf16 v[112:115], a[184:187], v[84:87], v[112:115]
v_mfma_f32_16x16x32_bf16 v[116:119], a[188:191], v[84:87], v[116:119]
s_waitcnt lgkmcnt(0)
s_waitcnt vmcnt(17)
s_barrier
s_add_u32 m0, s70, 0
s_add_u32 s7, s15, 0
buffer_load_dwordx4 v88, s[48:51], s7 offen lds
ds_read_b64_tr_b16 a[208:209], v80 offset:16384
ds_read_b64_tr_b16 a[210:211], v80 offset:17408
s_add_u32 m0, s70, 1024
s_add_u32 s7, s15, 13824
buffer_load_dwordx4 v88, s[48:51], s7 offen lds
ds_read_b64_tr_b16 a[212:213], v81 offset:16384
ds_read_b64_tr_b16 a[214:215], v81 offset:17408
s_add_u32 m0, s70, 2048
s_add_u32 s7, s15, 27648
buffer_load_dwordx4 v88, s[48:51], s7 offen lds
ds_read_b64_tr_b16 a[216:217], v82 offset:16384
ds_read_b64_tr_b16 a[218:219], v82 offset:17408
s_add_u32 m0, s70, 3072
s_add_u32 s7, s15, 41472
buffer_load_dwordx4 v88, s[48:51], s7 offen lds
ds_read_b64_tr_b16 a[220:221], v83 offset:16384
ds_read_b64_tr_b16 a[222:223], v83 offset:17408
s_add_u32 s15, s15, 110592
s_cmp_ge_u32 s15, s13
s_cselect_b32 s7, 2211840, 0
s_sub_u32 s15, s15, s7
v_mfma_f32_16x16x32_bf16 v[104:107], a[192:195], v[84:87], v[104:107]
v_mfma_f32_16x16x32_bf16 v[108:111], a[196:199], v[84:87], v[108:111]
v_mfma_f32_16x16x32_bf16 v[112:115], a[200:203], v[84:87], v[112:115]
v_mfma_f32_16x16x32_bf16 v[116:119], a[204:207], v[84:87], v[116:119]
s_waitcnt lgkmcnt(0)
s_waitcnt vmcnt(16)
s_barrier
s_add_u32 m0, s70, 16384
s_add_u32 s7, s15, 0
buffer_load_dwordx4 v88, s[48:51], s7 offen lds
ds_read_b64_tr_b16 a[224:225], v80 offset:32768
ds_read_b64_tr_b16 a[226:227], v80 offset:33792
s_add_u32 m0, s70, 17408
s_add_u32 s7, s15, 13824
buffer_load_dwordx4 v88, s[48:51], s7 offen lds
ds_read_b64_tr_b16 a[228:229], v81 offset:32768
ds_read_b64_tr_b16 a[230:231], v81 offset:33792
s_add_u32 m0, s70, 18432
s_add_u32 s7, s15, 27648
buffer_load_dwordx4 v88, s[48:51], s7 offen lds
ds_read_b64_tr_b16 a[232:233], v82 offset:32768
ds_read_b64_tr_b16 a[234:235], v82 offset:33792
s_add_u32 m0, s70, 19456
s_add_u32 s7, s15, 41472
buffer_load_dwordx4 v88, s[48:51], s7 offen lds
ds_read_b64_tr_b16 a[236:237], v83 offset:32768
ds_read_b64_tr_b16 a[238:239], v83 offset:33792
s_add_u32 s15, s15, 110592
s_cmp_ge_u32 s15, s13
s_cselect_b32 s7, 2211840, 0
s_sub_u32 s15, s15, s7
v_mfma_f32_16x16x32_bf16 v[104:107], a[208:211], v[84:87], v[104:107]
v_mfma_f32_16x16x32_bf16 v[108:111], a[212:215], v[84:87], v[108:111]
v_mfma_f32_16x16x32_bf16 v[112:115], a[216:219], v[84:87], v[112:115]
v_mfma_f32_16x16x32_bf16 v[116:119], a[220:223], v[84:87], v[116:119]
s_waitcnt lgkmcnt(0)
s_waitcnt vmcnt(16)
s_barrier
ds_read_b64_tr_b16 a[240:241], v80 offset:49152
ds_read_b64_tr_b16 a[242:243], v80 offset:50176
ds_read_b64_tr_b16 a[244:245], v81 offset:49152
ds_read_b64_tr_b16 a[246:247], v81 offset:50176
ds_read_b64_tr_b16 a[248:249], v82 offset:49152
ds_read_b64_tr_b16 a[250:251], v82 offset:50176
ds_read_b64_tr_b16 a[252:253], v83 offset:49152
ds_read_b64_tr_b16 a[254:255], v83 offset:50176
s_waitcnt vmcnt(24)
v_readfirstlane_b32 s7, v14
v_readfirstlane_b32 s8, v15
s_xor_b32 s101, s7, s22
s_xor_b32 s69, s8, s23
s_or_b32 s69, s69, s101
s_cmp_eq_u32 s69, 0
s_cselect_b32 s101, 1, 0
s_add_u32 s7, s7, s8
s_mul_i32 s7, s7, 0x01010101
s_lshr_b32 s7, s7, 24
s_cmp_eq_u32 s7, 32
s_cselect_b32 s75, 1, 0
buffer_load_dword v6, v5, s[36:39], 0 offen sc1
v_mfma_f32_16x16x32_bf16 v[104:107], a[224:227], v[84:87], v[104:107]
v_mfma_f32_16x16x32_bf16 v[108:111], a[228:231], v[84:87], v[108:111]
v_mfma_f32_16x16x32_bf16 v[112:115], a[232:235], v[84:87], v[112:115]
v_mfma_f32_16x16x32_bf16 v[116:119], a[236:239], v[84:87], v[116:119]
s_waitcnt lgkmcnt(0)
s_waitcnt vmcnt(13)
s_barrier
v_add_u32 v80, 0x10000, v80
v_add_u32 v81, 0x10000, v81
v_add_u32 v82, 0x10000, v82
v_add_u32 v83, 0x10000, v83
ds_read_b64_tr_b16 v[192:193], v80 offset:0
ds_read_b64_tr_b16 v[194:195], v80 offset:1024
ds_read_b64_tr_b16 v[196:197], v81 offset:0
ds_read_b64_tr_b16 v[198:199], v81 offset:1024
ds_read_b64_tr_b16 v[200:201], v82 offset:0
ds_read_b64_tr_b16 v[202:203], v82 offset:1024
ds_read_b64_tr_b16 v[204:205], v83 offset:0
ds_read_b64_tr_b16 v[206:207], v83 offset:1024
v_mfma_f32_16x16x32_bf16 v[104:107], a[240:243], v[84:87], v[104:107]
v_mfma_f32_16x16x32_bf16 v[108:111], a[244:247], v[84:87], v[108:111]
v_mfma_f32_16x16x32_bf16 v[112:115], a[248:251], v[84:87], v[112:115]
v_mfma_f32_16x16x32_bf16 v[116:119], a[252:255], v[84:87], v[116:119]
s_waitcnt lgkmcnt(0)
s_waitcnt vmcnt(9)
s_barrier
ds_read_b64_tr_b16 v[208:209], v80 offset:16384
ds_read_b64_tr_b16 v[210:211], v80 offset:17408
ds_read_b64_tr_b16 v[212:213], v81 offset:16384
ds_read_b64_tr_b16 v[214:215], v81 offset:17408
ds_read_b64_tr_b16 v[216:217], v82 offset:16384
ds_read_b64_tr_b16 v[218:219], v82 offset:17408
ds_read_b64_tr_b16 v[220:221], v83 offset:16384
ds_read_b64_tr_b16 v[222:223], v83 offset:17408
v_mfma_f32_16x16x32_bf16 v[104:107], v[192:195], v[84:87], v[104:107]
v_mfma_f32_16x16x32_bf16 v[108:111], v[196:199], v[84:87], v[108:111]
v_mfma_f32_16x16x32_bf16 v[112:115], v[200:203], v[84:87], v[112:115]
v_mfma_f32_16x16x32_bf16 v[116:119], v[204:207], v[84:87], v[116:119]
s_waitcnt lgkmcnt(0)
s_waitcnt vmcnt(5)
s_barrier
v_add_u32 v80, 0xffff0000, v80
v_add_u32 v81, 0xffff0000, v81
v_add_u32 v82, 0xffff0000, v82
v_add_u32 v83, 0xffff0000, v83
ds_read_b64_tr_b16 v[224:225], v80 offset:0
ds_read_b64_tr_b16 v[226:227], v80 offset:1024
ds_read_b64_tr_b16 v[228:229], v81 offset:0
ds_read_b64_tr_b16 v[230:231], v81 offset:1024
ds_read_b64_tr_b16 v[232:233], v82 offset:0
ds_read_b64_tr_b16 v[234:235], v82 offset:1024
ds_read_b64_tr_b16 v[236:237], v83 offset:0
ds_read_b64_tr_b16 v[238:239], v83 offset:1024
s_waitcnt vmcnt(0)
v_cmp_le_u32 vcc, s65, v6
s_nop 0
s_cmp_eq_u64 vcc, -1
s_cselect_b32 s68, 1, 0
s_and_b32 s68, s68, s75
s_cselect_b32 s42, 0x4000000, 0
s_add_u32 s69, s66, 4096
s_add_u32 m0, s72, 4096
s_nop 0
buffer_load_dwordx4 v11, s[40:43], s69 offen offset:1024 sc1 lds
buffer_load_dwordx4 v1, s[40:43], s69 offen offset:0 sc1 lds
s_add_u32 m0, s72, 0
s_nop 0
buffer_load_dwordx4 v1, s[40:43], s66 offen offset:0 sc1 lds
buffer_load_dwordx4 v1, s[40:43], s66 offen offset:1024 sc1 lds
buffer_load_dwordx4 v1, s[40:43], s66 offen offset:2048 sc1 lds
buffer_load_dwordx4 v1, s[40:43], s66 offen offset:3072 sc1 lds
v_mfma_f32_16x16x32_bf16 v[104:107], v[208:211], v[84:87], v[104:107]
v_mfma_f32_16x16x32_bf16 v[108:111], v[212:215], v[84:87], v[108:111]
v_mfma_f32_16x16x32_bf16 v[112:115], v[216:219], v[84:87], v[112:115]
v_mfma_f32_16x16x32_bf16 v[116:119], v[220:223], v[84:87], v[116:119]
s_waitcnt lgkmcnt(0)
s_waitcnt vmcnt(7)
s_barrier
ds_read_b64_tr_b16 v[240:241], v80 offset:16384
ds_read_b64_tr_b16 v[242:243], v80 offset:17408
ds_read_b64_tr_b16 v[244:245], v81 offset:16384
ds_read_b64_tr_b16 v[246:247], v81 offset:17408
ds_read_b64_tr_b16 v[248:249], v82 offset:16384
ds_read_b64_tr_b16 v[250:251], v82 offset:17408
ds_read_b64_tr_b16 v[252:253], v83 offset:16384
ds_read_b64_tr_b16 v[254:255], v83 offset:17408
v_mfma_f32_16x16x32_bf16 v[104:107], v[224:227], v[84:87], v[104:107]
v_mfma_f32_16x16x32_bf16 v[108:111], v[228:231], v[84:87], v[108:111]
v_mfma_f32_16x16x32_bf16 v[112:115], v[232:235], v[84:87], v[112:115]
v_mfma_f32_16x16x32_bf16 v[116:119], v[236:239], v[84:87], v[116:119]
s_waitcnt lgkmcnt(0)
v_mfma_f32_16x16x32_bf16 v[104:107], v[240:243], v[84:87], v[104:107]
v_mfma_f32_16x16x32_bf16 v[108:111], v[244:247], v[84:87], v[108:111]
v_mfma_f32_16x16x32_bf16 v[112:115], v[248:251], v[84:87], v[112:115]
v_mfma_f32_16x16x32_bf16 v[116:119], v[252:255], v[84:87], v[116:119]
s_cmp_eq_u32 s68, 0
s_cbranch_scc1 K3_LATE
s_waitcnt vmcnt(0)
s_cmp_eq_u32 s101, 1
s_cbranch_scc1 K3_GO1f
s_branch K3_GO1s
K3_LATE:
s_cmp_eq_u32 s75, 1
s_cbranch_scc1 K3_IOK
s_mov_b32 s75, 0
K3_IW:
s_lshl_b32 s7, s4, 5
v_mov_b32 v14, s7
buffer_load_dwordx2 v[14:15], v14, s[52:55], 0 offen sc1
s_add_u32 s75, s75, 1
s_cmp_gt_u32 s75, 0x8000
s_cbranch_scc1 L_TIMEOUT
s_waitcnt vmcnt(0)
v_readfirstlane_b32 s7, v14
v_readfirstlane_b32 s8, v15
s_xor_b32 s101, s7, s22
s_xor_b32 s69, s8, s23
s_or_b32 s69, s69, s101
s_cmp_eq_u32 s69, 0
s_cselect_b32 s101, 1, 0
s_add_u32 s7, s7, s8
s_mul_i32 s7, s7, 0x01010101
s_lshr_b32 s7, s7, 24
s_cmp_eq_u32 s7, 32
s_cbranch_scc0 K3_IW
K3_IOK:
s_cmp_eq_u32 s101, 1
s_cbranch_scc1 K3_SW1f
s_branch K3_SW1s
.p2align 6
K3_U0f:
v_mfma_f32_16x16x32_bf16 v[64:67], v[224:227], v[40:43], v[64:67]
s_barrier

v_mfma_f32_16x16x32_bf16 v[64:67], v[240:243], v[44:47], v[64:67]
s_and_b32 s67, s64, 7
ds_read_b128 v[16:19], v100 offset:0
s_mul_i32 s67, s67, s100
v_mfma_f32_16x16x32_bf16 v[68:71], v[196:199], v[32:35], v[68:71]
s_add_u32 s67, s67, s11
ds_read_b128 v[20:23], v100 offset:1024
s_mov_b32 s46, s74
v_mfma_f32_16x16x32_bf16 v[68:71], v[212:215], v[36:39], v[68:71]
s_add_u32 s79, s64, 2
ds_read_b128 v[24:27], v100 offset:2048
v_fma_f32 v80, -v131, v104, v64
v_mfma_f32_16x16x32_bf16 v[68:71], v[228:231], v[40:43], v[68:71]
s_mov_b32 s64, s13
ds_read_b128 v[28:31], v100 offset:3072
v_fma_f32 v81, -v131, v105, v65
v_mfma_f32_16x16x32_bf16 v[68:71], v[244:247], v[44:47], v[68:71]
buffer_load_dword v6, v5, s[36:39], 0 offen sc1
v_mfma_f32_16x16x32_bf16 v[72:75], v[200:203], v[32:35], v[72:75]
s_mov_b32 s0, s1
v_mov_b32 v8, s79
v_fma_f32 v82, -v131, v106, v66
v_mfma_f32_16x16x32_bf16 v[72:75], v[216:219], v[36:39], v[72:75]
s_add_u32 s13, s64, 1
v_fma_f32 v83, -v131, v107, v67
v_mul_f32 v80, v80, v133
v_mfma_f32_16x16x32_bf16 v[72:75], v[232:235], v[40:43], v[72:75]
s_cmp_eq_u32 s13, 17
v_mul_f32 v81, v81, v133
v_mul_f32 v82, v82, v133
v_mfma_f32_16x16x32_bf16 v[72:75], v[248:251], v[44:47], v[72:75]
s_addc_u32 s13, s13, 0
v_mul_f32 v83, v83, v133
v_fma_f32 v84, -v131, v108, v68
v_mfma_f32_16x16x32_bf16 v[76:79], v[204:207], v[32:35], v[76:79]
s_sub_u32 s1, s13, 17
v_fma_f32 v85, -v131, v109, v69
v_fma_f32 v86, -v131, v110, v70
v_mfma_f32_16x16x32_bf16 v[76:79], v[220:223], v[36:39], v[76:79]
s_cselect_b32 s1, s13, s1
v_fma_f32 v87, -v131, v111, v71
v_mul_f32 v80, v80, v84
v_mfma_f32_16x16x32_bf16 v[76:79], v[236:239], v[40:43], v[76:79]
s_mul_i32 s66, s1, 24576
v_mul_f32 v81, v81, v85
v_mul_f32 v82, v82, v86
v_mfma_f32_16x16x32_bf16 v[76:79], v[252:255], v[44:47], v[76:79]
s_waitcnt lgkmcnt(0)
v_mul_f32 v83, v83, v87
v_cvt_pk_bf16_f32 v96, v80, v81
K3_F0f:
v_mfma_f32_16x16x32_bf16 v[48:51], a[0:3], v[16:19], 0
s_add_u32 s66, s66, s10
ds_read_b128 v[32:35], v100 offset:4096
v_cvt_pk_bf16_f32 v97, v82, v83
v_mfma_f32_16x16x32_bf16 v[48:51], a[16:19], v[20:23], v[48:51]
s_add_u32 s65, s13, 2
v_fma_f32 v88, -v131, v112, v72
v_fma_f32 v89, -v131, v113, v73
v_mfma_f32_16x16x32_bf16 v[48:51], a[32:35], v[24:27], v[48:51]
ds_read_b128 v[36:39], v100 offset:6144
v_fma_f32 v90, -v131, v114, v74
v_mfma_f32_16x16x32_bf16 v[48:51], a[48:51], v[28:31], v[48:51]
v_fma_f32 v91, -v131, v115, v75
v_mul_f32 v88, v88, v133
v_mfma_f32_16x16x32_bf16 v[52:55], a[4:7], v[16:19], 0
ds_read_b128 v[40:43], v100 offset:7168
v_mul_f32 v89, v89, v133
v_mfma_f32_16x16x32_bf16 v[52:55], a[20:23], v[20:23], v[52:55]
v_mul_f32 v90, v90, v133
v_mul_f32 v91, v91, v133
v_mfma_f32_16x16x32_bf16 v[52:55], a[36:39], v[24:27], v[52:55]
ds_read_b128 v[44:47], v100 offset:8192
v_fma_f32 v92, -v131, v116, v76
v_mfma_f32_16x16x32_bf16 v[52:55], a[52:55], v[28:31], v[52:55]
v_fma_f32 v93, -v131, v117, v77
v_fma_f32 v94, -v131, v118, v78
v_mfma_f32_16x16x32_bf16 v[56:59], a[8:11], v[16:19], 0
v_fma_f32 v95, -v131, v119, v79
v_mul_f32 v88, v88, v92
v_mfma_f32_16x16x32_bf16 v[56:59], a[24:27], v[20:23], v[56:59]
v_mul_f32 v89, v89, v93
v_mul_f32 v90, v90, v94
v_mfma_f32_16x16x32_bf16 v[56:59], a[40:43], v[24:27], v[56:59]
v_mul_f32 v91, v91, v95
v_cvt_pk_bf16_f32 v98, v88, v89
v_mfma_f32_16x16x32_bf16 v[56:59], a[56:59], v[28:31], v[56:59]
s_waitcnt vmcnt(0)
v_cmp_le_u32 vcc, s65, v6
v_cvt_pk_bf16_f32 v99, v90, v91
v_mfma_f32_16x16x32_bf16 v[60:63], a[12:15], v[16:19], 0
buffer_store_dwordx4 v[96:99], v101, s[44:47], s67 offen
v_mfma_f32_16x16x32_bf16 v[60:63], a[28:31], v[20:23], v[60:63]
s_cmp_eq_u64 vcc, -1
v_mfma_f32_16x16x32_bf16 v[60:63], a[44:47], v[24:27], v[60:63]
s_cbranch_scc0 K3_W0f
K3_W0fR:
s_cselect_b32 s68, 1, 0
v_mfma_f32_16x16x32_bf16 v[60:63], a[60:63], v[28:31], v[60:63]
s_waitcnt lgkmcnt(0)
s_cselect_b32 s42, 0x4000000, 0
s_add_u32 s69, s66, 4096
v_mfma_f32_16x16x32_bf16 v[48:51], a[64:67], v[32:35], v[48:51]
s_add_u32 m0, s72, 28672
ds_read_b128 v[16:19], v100 offset:9216
v_mfma_f32_16x16x32_bf16 v[48:51], a[80:83], v[36:39], v[48:51]
buffer_load_dwordx4 v11, s[40:43], s69 offen offset:1024 sc1 lds
v_mfma_f32_16x16x32_bf16 v[48:51], a[96:99], v[40:43], v[48:51]
ds_read_b128 v[20:23], v100 offset:10240
v_mfma_f32_16x16x32_bf16 v[48:51], a[112:115], v[44:47], v[48:51]
v_mfma_f32_16x16x32_bf16 v[52:55], a[68:71], v[32:35], v[52:55]
ds_read_b128 v[24:27], v100 offset:12288
v_mfma_f32_16x16x32_bf16 v[52:55], a[84:87], v[36:39], v[52:55]
buffer_load_dwordx4 v1, s[40:43], s69 offen offset:0 sc1 lds
v_mfma_f32_16x16x32_bf16 v[52:55], a[100:103], v[40:43], v[52:55]
s_add_u32 m0, s72, 24576
ds_read_b128 v[28:31], v100 offset:13312
v_mfma_f32_16x16x32_bf16 v[52:55], a[116:119], v[44:47], v[52:55]
v_mfma_f32_16x16x32_bf16 v[56:59], a[72:75], v[32:35], v[56:59]
v_mfma_f32_16x16x32_bf16 v[56:59], a[88:91], v[36:39], v[56:59]
buffer_load_dwordx4 v1, s[40:43], s66 offen offset:0 sc1 lds
v_mfma_f32_16x16x32_bf16 v[56:59], a[104:107], v[40:43], v[56:59]
ds_read_b64 v[120:121], v103 offset:0
v_mfma_f32_16x16x32_bf16 v[56:59], a[120:123], v[44:47], v[56:59]
ds_read_b64 v[122:123], v103 offset:128
v_mfma_f32_16x16x32_bf16 v[60:63], a[76:79], v[32:35], v[60:63]
buffer_load_dwordx4 v1, s[40:43], s66 offen offset:1024 sc1 lds
v_mfma_f32_16x16x32_bf16 v[60:63], a[92:95], v[36:39], v[60:63]
ds_read_b64 v[124:125], v103 offset:256
v_mfma_f32_16x16x32_bf16 v[60:63], a[108:111], v[40:43], v[60:63]
ds_read_b64 v[126:127], v103 offset:384
v_mfma_f32_16x16x32_bf16 v[60:63], a[124:127], v[44:47], v[60:63]
s_waitcnt lgkmcnt(4)
ds_read_b64 v[128:129], v103 offset:512
v_mfma_f32_16x16x32_bf16 v[48:51], a[128:131], v[16:19], v[48:51]
ds_read_b128 v[32:35], v100 offset:14336
v_mfma_f32_16x16x32_bf16 v[48:51], a[144:147], v[20:23], v[48:51]
buffer_load_dwordx4 v1, s[40:43], s66 offen offset:2048 sc1 lds
v_mfma_f32_16x16x32_bf16 v[48:51], a[160:163], v[24:27], v[48:51]
s_waitcnt vmcnt(5)
ds_read_b128 v[36:39], v100 offset:15360
v_mfma_f32_16x16x32_bf16 v[48:51], a[176:179], v[28:31], v[48:51]
buffer_store_dword v8, v7, s[36:39], 0 offen
v_mfma_f32_16x16x32_bf16 v[52:55], a[132:135], v[16:19], v[52:55]
ds_read_b128 v[40:43], v100 offset:16384
v_mfma_f32_16x16x32_bf16 v[52:55], a[148:151], v[20:23], v[52:55]
buffer_load_dwordx4 v1, s[40:43], s66 offen offset:3072 sc1 lds
v_mfma_f32_16x16x32_bf16 v[52:55], a[164:167], v[24:27], v[52:55]
s_cmp_eq_u32 s68, 0
ds_read_b128 v[44:47], v100 offset:18432
s_waitcnt lgkmcnt(4)
v_mfma_f32_16x16x32_bf16 v[52:55], a[180:183], v[28:31], v[52:55]
v_add_f32 v120, v120, v122
v_add_f32 v121, v121, v123
v_mfma_f32_16x16x32_bf16 v[56:59], a[136:139], v[16:19], v[56:59]
v_add_f32 v124, v124, v126
v_add_f32 v125, v125, v127
v_mfma_f32_16x16x32_bf16 v[56:59], a[152:155], v[20:23], v[56:59]
v_add_f32 v120, v120, v128
v_add_f32 v121, v121, v129
v_mfma_f32_16x16x32_bf16 v[56:59], a[168:171], v[24:27], v[56:59]
v_add_f32 v120, v120, v124
v_add_f32 v121, v121, v125
v_mfma_f32_16x16x32_bf16 v[56:59], a[184:187], v[28:31], v[56:59]
v_mfma_f32_16x16x32_bf16 v[60:63], a[140:143], v[16:19], v[60:63]
v_permlane32_swap_b32 v120, v121
v_mfma_f32_16x16x32_bf16 v[60:63], a[156:159], v[20:23], v[60:63]
v_add_f32 v122, v120, v121
v_add_f32 v123, v120, v121
v_mfma_f32_16x16x32_bf16 v[60:63], a[172:175], v[24:27], v[60:63]
v_mfma_f32_16x16x32_bf16 v[60:63], a[188:191], v[28:31], v[60:63]
s_waitcnt lgkmcnt(0)
v_permlane16_swap_b32 v122, v123
v_mfma_f32_16x16x32_bf16 v[48:51], a[192:195], v[32:35], v[48:51]
ds_read_b128 v[16:19], v100 offset:19456
v_add_f32 v130, v122, v123
v_mfma_f32_16x16x32_bf16 v[48:51], a[208:211], v[36:39], v[48:51]
v_add_f32 v121, v122, v123
v_mfma_f32_16x16x32_bf16 v[48:51], a[224:227], v[40:43], v[48:51]
ds_read_b128 v[20:23], v100 offset:20480
v_mfma_f32_16x16x32_bf16 v[48:51], a[240:243], v[44:47], v[48:51]
v_permlane32_swap_b32 v130, v121
v_mfma_f32_16x16x32_bf16 v[52:55], a[196:199], v[32:35], v[52:55]
ds_read_b128 v[24:27], v100 offset:21504
v_fma_f32 v121, -v130, v130, v121
v_mfma_f32_16x16x32_bf16 v[52:55], a[212:215], v[36:39], v[52:55]
v_max_f32 v121, s77, v121
v_mfma_f32_16x16x32_bf16 v[52:55], a[228:231], v[40:43], v[52:55]
ds_read_b128 v[28:31], v100 offset:22528
v_mfma_f32_16x16x32_bf16 v[52:55], a[244:247], v[44:47], v[52:55]
v_rcp_f32 v132, v121
v_mfma_f32_16x16x32_bf16 v[56:59], a[200:203], v[32:35], v[56:59]
v_mfma_f32_16x16x32_bf16 v[56:59], a[216:219], v[36:39], v[56:59]
v_mfma_f32_16x16x32_bf16 v[56:59], a[232:235], v[40:43], v[56:59]
v_mfma_f32_16x16x32_bf16 v[56:59], a[248:251], v[44:47], v[56:59]
v_mfma_f32_16x16x32_bf16 v[60:63], a[204:207], v[32:35], v[60:63]
v_mfma_f32_16x16x32_bf16 v[60:63], a[220:223], v[36:39], v[60:63]
v_mfma_f32_16x16x32_bf16 v[60:63], a[236:239], v[40:43], v[60:63]
v_mfma_f32_16x16x32_bf16 v[60:63], a[252:255], v[44:47], v[60:63]
s_waitcnt lgkmcnt(0)
v_mfma_f32_16x16x32_bf16 v[48:51], v[192:195], v[16:19], v[48:51]
s_waitcnt vmcnt(0) lgkmcnt(0)
v_mfma_f32_16x16x32_bf16 v[48:51], v[208:211], v[20:23], v[48:51]
s_cbranch_scc1 K3_X0f
K3_U1f:
v_mfma_f32_16x16x32_bf16 v[48:51], v[224:227], v[24:27], v[48:51]
s_barrier

v_mfma_f32_16x16x32_bf16 v[48:51], v[240:243], v[28:31], v[48:51]
s_and_b32 s67, s64, 7
ds_read_b128 v[32:35], v100 offset:24576
s_mul_i32 s67, s67, s100
v_mfma_f32_16x16x32_bf16 v[52:55], v[196:199], v[16:19], v[52:55]
s_add_u32 s67, s67, s11
ds_read_b128 v[36:39], v100 offset:25600
s_mov_b32 s46, s74
v_mfma_f32_16x16x32_bf16 v[52:55], v[212:215], v[20:23], v[52:55]
s_add_u32 s79, s64, 2
ds_read_b128 v[40:43], v100 offset:26624
v_fma_f32 v80, -v130, v104, v48
v_mfma_f32_16x16x32_bf16 v[52:55], v[228:231], v[24:27], v[52:55]
s_mov_b32 s64, s13
ds_read_b128 v[44:47], v100 offset:27648
v_fma_f32 v81, -v130, v105, v49
v_mfma_f32_16x16x32_bf16 v[52:55], v[244:247], v[28:31], v[52:55]
buffer_load_dword v6, v5, s[36:39], 0 offen sc1
v_mfma_f32_16x16x32_bf16 v[56:59], v[200:203], v[16:19], v[56:59]
s_mov_b32 s0, s1
v_mov_b32 v8, s79
v_fma_f32 v82, -v130, v106, v50
v_mfma_f32_16x16x32_bf16 v[56:59], v[216:219], v[20:23], v[56:59]
s_add_u32 s13, s64, 1
v_fma_f32 v83, -v130, v107, v51
v_mul_f32 v80, v80, v132
v_mfma_f32_16x16x32_bf16 v[56:59], v[232:235], v[24:27], v[56:59]
s_cmp_eq_u32 s13, 17
v_mul_f32 v81, v81, v132
v_mul_f32 v82, v82, v132
v_mfma_f32_16x16x32_bf16 v[56:59], v[248:251], v[28:31], v[56:59]
s_addc_u32 s13, s13, 0
v_mul_f32 v83, v83, v132
v_fma_f32 v84, -v130, v108, v52
v_mfma_f32_16x16x32_bf16 v[60:63], v[204:207], v[16:19], v[60:63]
s_sub_u32 s1, s13, 17
v_fma_f32 v85, -v130, v109, v53
v_fma_f32 v86, -v130, v110, v54
v_mfma_f32_16x16x32_bf16 v[60:63], v[220:223], v[20:23], v[60:63]
s_cselect_b32 s1, s13, s1
v_fma_f32 v87, -v130, v111, v55
v_mul_f32 v80, v80, v84
v_mfma_f32_16x16x32_bf16 v[60:63], v[236:239], v[24:27], v[60:63]
s_mul_i32 s66, s1, 24576
v_mul_f32 v81, v81, v85
v_mul_f32 v82, v82, v86
v_mfma_f32_16x16x32_bf16 v[60:63], v[252:255], v[28:31], v[60:63]
s_waitcnt lgkmcnt(0)
v_mul_f32 v83, v83, v87
v_cvt_pk_bf16_f32 v96, v80, v81
K3_F1f:
v_mfma_f32_16x16x32_bf16 v[64:67], a[0:3], v[32:35], 0
s_add_u32 s66, s66, s10
ds_read_b128 v[16:19], v100 offset:28672
v_cvt_pk_bf16_f32 v97, v82, v83
v_mfma_f32_16x16x32_bf16 v[64:67], a[16:19], v[36:39], v[64:67]
s_add_u32 s65, s13, 2
v_fma_f32 v88, -v130, v112, v56
v_fma_f32 v89, -v130, v113, v57
v_mfma_f32_16x16x32_bf16 v[64:67], a[32:35], v[40:43], v[64:67]
ds_read_b128 v[20:23], v100 offset:30720
v_fma_f32 v90, -v130, v114, v58
v_mfma_f32_16x16x32_bf16 v[64:67], a[48:51], v[44:47], v[64:67]
v_fma_f32 v91, -v130, v115, v59
v_mul_f32 v88, v88, v132
v_mfma_f32_16x16x32_bf16 v[68:71], a[4:7], v[32:35], 0
ds_read_b128 v[24:27], v100 offset:31744
v_mul_f32 v89, v89, v132
v_mfma_f32_16x16x32_bf16 v[68:71], a[20:23], v[36:39], v[68:71]
v_mul_f32 v90, v90, v132
v_mul_f32 v91, v91, v132
v_mfma_f32_16x16x32_bf16 v[68:71], a[36:39], v[40:43], v[68:71]
ds_read_b128 v[28:31], v100 offset:32768
v_fma_f32 v92, -v130, v116, v60
v_mfma_f32_16x16x32_bf16 v[68:71], a[52:55], v[44:47], v[68:71]
v_fma_f32 v93, -v130, v117, v61
v_fma_f32 v94, -v130, v118, v62
v_mfma_f32_16x16x32_bf16 v[72:75], a[8:11], v[32:35], 0
v_fma_f32 v95, -v130, v119, v63
v_mul_f32 v88, v88, v92
v_mfma_f32_16x16x32_bf16 v[72:75], a[24:27], v[36:39], v[72:75]
v_mul_f32 v89, v89, v93
v_mul_f32 v90, v90, v94
v_mfma_f32_16x16x32_bf16 v[72:75], a[40:43], v[40:43], v[72:75]
v_mul_f32 v91, v91, v95
v_cvt_pk_bf16_f32 v98, v88, v89
v_mfma_f32_16x16x32_bf16 v[72:75], a[56:59], v[44:47], v[72:75]
s_waitcnt vmcnt(0)
v_cmp_le_u32 vcc, s65, v6
v_cvt_pk_bf16_f32 v99, v90, v91
v_mfma_f32_16x16x32_bf16 v[76:79], a[12:15], v[32:35], 0
buffer_store_dwordx4 v[96:99], v101, s[44:47], s67 offen
v_mfma_f32_16x16x32_bf16 v[76:79], a[28:31], v[36:39], v[76:79]
s_cmp_eq_u64 vcc, -1
v_mfma_f32_16x16x32_bf16 v[76:79], a[44:47], v[40:43], v[76:79]
s_cbranch_scc0 K3_W1f
K3_W1fR:
s_cselect_b32 s68, 1, 0
v_mfma_f32_16x16x32_bf16 v[76:79], a[60:63], v[44:47], v[76:79]
s_waitcnt lgkmcnt(0)
s_cselect_b32 s42, 0x4000000, 0
s_add_u32 s69, s66, 4096
v_mfma_f32_16x16x32_bf16 v[64:67], a[64:67], v[16:19], v[64:67]
s_add_u32 m0, s72, 4096
ds_read_b128 v[32:35], v100 offset:33792
v_mfma_f32_16x16x32_bf16 v[64:67], a[80:83], v[20:23], v[64:67]
buffer_load_dwordx4 v11, s[40:43], s69 offen offset:1024 sc1 lds
v_mfma_f32_16x16x32_bf16 v[64:67], a[96:99], v[24:27], v[64:67]
ds_read_b128 v[36:39], v100 offset:34816
v_mfma_f32_16x16x32_bf16 v[64:67], a[112:115], v[28:31], v[64:67]
v_mfma_f32_16x16x32_bf16 v[68:71], a[68:71], v[16:19], v[68:71]
ds_read_b128 v[40:43], v100 offset:36864
v_mfma_f32_16x16x32_bf16 v[68:71], a[84:87], v[20:23], v[68:71]
buffer_load_dwordx4 v1, s[40:43], s69 offen offset:0 sc1 lds
v_mfma_f32_16x16x32_bf16 v[68:71], a[100:103], v[24:27], v[68:71]
s_add_u32 m0, s72, 0
ds_read_b128 v[44:47], v100 offset:37888
v_mfma_f32_16x16x32_bf16 v[68:71], a[116:119], v[28:31], v[68:71]
v_mfma_f32_16x16x32_bf16 v[72:75], a[72:75], v[16:19], v[72:75]
v_mfma_f32_16x16x32_bf16 v[72:75], a[88:91], v[20:23], v[72:75]
buffer_load_dwordx4 v1, s[40:43], s66 offen offset:0 sc1 lds
v_mfma_f32_16x16x32_bf16 v[72:75], a[104:107], v[24:27], v[72:75]
ds_read_b64 v[120:121], v103 offset:24576
v_mfma_f32_16x16x32_bf16 v[72:75], a[120:123], v[28:31], v[72:75]
ds_read_b64 v[122:123], v103 offset:24704
v_mfma_f32_16x16x32_bf16 v[76:79], a[76:79], v[16:19], v[76:79]
buffer_load_dwordx4 v1, s[40:43], s66 offen offset:1024 sc1 lds
v_mfma_f32_16x16x32_bf16 v[76:79], a[92:95], v[20:23], v[76:79]
ds_read_b64 v[124:125], v103 offset:24832
v_mfma_f32_16x16x32_bf16 v[76:79], a[108:111], v[24:27], v[76:79]
ds_read_b64 v[126:127], v103 offset:24960
v_mfma_f32_16x16x32_bf16 v[76:79], a[124:127], v[28:31], v[76:79]
s_waitcnt lgkmcnt(4)
ds_read_b64 v[128:129], v103 offset:25088
v_mfma_f32_16x16x32_bf16 v[64:67], a[128:131], v[32:35], v[64:67]
ds_read_b128 v[16:19], v100 offset:38912
v_mfma_f32_16x16x32_bf16 v[64:67], a[144:147], v[36:39], v[64:67]
buffer_load_dwordx4 v1, s[40:43], s66 offen offset:2048 sc1 lds
v_mfma_f32_16x16x32_bf16 v[64:67], a[160:163], v[40:43], v[64:67]
s_waitcnt vmcnt(5)
ds_read_b128 v[20:23], v100 offset:39936
v_mfma_f32_16x16x32_bf16 v[64:67], a[176:179], v[44:47], v[64:67]
buffer_store_dword v8, v7, s[36:39], 0 offen
v_mfma_f32_16x16x32_bf16 v[68:71], a[132:135], v[32:35], v[68:71]
ds_read_b128 v[24:27], v100 offset:40960
v_mfma_f32_16x16x32_bf16 v[68:71], a[148:151], v[36:39], v[68:71]
buffer_load_dwordx4 v1, s[40:43], s66 offen offset:3072 sc1 lds
v_mfma_f32_16x16x32_bf16 v[68:71], a[164:167], v[40:43], v[68:71]
s_cmp_eq_u32 s68, 0
ds_read_b128 v[28:31], v100 offset:43008
s_waitcnt lgkmcnt(4)
v_mfma_f32_16x16x32_bf16 v[68:71], a[180:183], v[44:47], v[68:71]
v_add_f32 v120, v120, v122
v_add_f32 v121, v121, v123
v_mfma_f32_16x16x32_bf16 v[72:75], a[136:139], v[32:35], v[72:75]
v_add_f32 v124, v124, v126
v_add_f32 v125, v125, v127
v_mfma_f32_16x16x32_bf16 v[72:75], a[152:155], v[36:39], v[72:75]
v_add_f32 v120, v120, v128
v_add_f32 v121, v121, v129
v_mfma_f32_16x16x32_bf16 v[72:75], a[168:171], v[40:43], v[72:75]
v_add_f32 v120, v120, v124
v_add_f32 v121, v121, v125
v_mfma_f32_16x16x32_bf16 v[72:75], a[184:187], v[44:47], v[72:75]
v_mfma_f32_16x16x32_bf16 v[76:79], a[140:143], v[32:35], v[76:79]
v_permlane32_swap_b32 v120, v121
v_mfma_f32_16x16x32_bf16 v[76:79], a[156:159], v[36:39], v[76:79]
v_add_f32 v122, v120, v121
v_add_f32 v123, v120, v121
v_mfma_f32_16x16x32_bf16 v[76:79], a[172:175], v[40:43], v[76:79]
v_mfma_f32_16x16x32_bf16 v[76:79], a[188:191], v[44:47], v[76:79]
s_waitcnt lgkmcnt(0)
v_permlane16_swap_b32 v122, v123
v_mfma_f32_16x16x32_bf16 v[64:67], a[192:195], v[16:19], v[64:67]
ds_read_b128 v[32:35], v100 offset:44032
v_add_f32 v131, v122, v123
v_mfma_f32_16x16x32_bf16 v[64:67], a[208:211], v[20:23], v[64:67]
v_add_f32 v121, v122, v123
v_mfma_f32_16x16x32_bf16 v[64:67], a[224:227], v[24:27], v[64:67]
ds_read_b128 v[36:39], v100 offset:45056
v_mfma_f32_16x16x32_bf16 v[64:67], a[240:243], v[28:31], v[64:67]
v_permlane32_swap_b32 v131, v121
v_mfma_f32_16x16x32_bf16 v[68:71], a[196:199], v[16:19], v[68:71]
ds_read_b128 v[40:43], v100 offset:46080
v_fma_f32 v121, -v131, v131, v121
v_mfma_f32_16x16x32_bf16 v[68:71], a[212:215], v[20:23], v[68:71]
v_max_f32 v121, s77, v121
v_mfma_f32_16x16x32_bf16 v[68:71], a[228:231], v[24:27], v[68:71]
ds_read_b128 v[44:47], v100 offset:47104
v_mfma_f32_16x16x32_bf16 v[68:71], a[244:247], v[28:31], v[68:71]
v_rcp_f32 v133, v121
v_mfma_f32_16x16x32_bf16 v[72:75], a[200:203], v[16:19], v[72:75]
v_mfma_f32_16x16x32_bf16 v[72:75], a[216:219], v[20:23], v[72:75]
v_mfma_f32_16x16x32_bf16 v[72:75], a[232:235], v[24:27], v[72:75]
v_mfma_f32_16x16x32_bf16 v[72:75], a[248:251], v[28:31], v[72:75]
v_mfma_f32_16x16x32_bf16 v[76:79], a[204:207], v[16:19], v[76:79]
v_mfma_f32_16x16x32_bf16 v[76:79], a[220:223], v[20:23], v[76:79]
v_mfma_f32_16x16x32_bf16 v[76:79], a[236:239], v[24:27], v[76:79]
v_mfma_f32_16x16x32_bf16 v[76:79], a[252:255], v[28:31], v[76:79]
s_waitcnt lgkmcnt(0)
v_mfma_f32_16x16x32_bf16 v[64:67], v[192:195], v[32:35], v[64:67]
s_waitcnt vmcnt(0) lgkmcnt(0)
v_mfma_f32_16x16x32_bf16 v[64:67], v[208:211], v[36:39], v[64:67]
s_cbranch_scc0 K3_U0f
K3_X1f:
K3_NR1f:
buffer_load_dword v6, v5, s[36:39], 0 offen sc1
v_mfma_f32_16x16x32_bf16 v[64:67], v[224:227], v[40:43], v[64:67]
s_and_b32 s67, s64, 7
s_mul_i32 s67, s67, s100
s_add_u32 s67, s67, s11
v_mfma_f32_16x16x32_bf16 v[64:67], v[240:243], v[44:47], v[64:67]
s_mov_b32 s46, s74
s_add_u32 s79, s64, 2
s_mov_b32 s64, s13
v_mfma_f32_16x16x32_bf16 v[68:71], v[196:199], v[32:35], v[68:71]
s_mov_b32 s0, s1
v_mfma_f32_16x16x32_bf16 v[68:71], v[212:215], v[36:39], v[68:71]
v_mfma_f32_16x16x32_bf16 v[68:71], v[228:231], v[40:43], v[68:71]
v_mfma_f32_16x16x32_bf16 v[68:71], v[244:247], v[44:47], v[68:71]
v_mfma_f32_16x16x32_bf16 v[72:75], v[200:203], v[32:35], v[72:75]
v_mfma_f32_16x16x32_bf16 v[72:75], v[216:219], v[36:39], v[72:75]
v_mfma_f32_16x16x32_bf16 v[72:75], v[232:235], v[40:43], v[72:75]
v_mfma_f32_16x16x32_bf16 v[72:75], v[248:251], v[44:47], v[72:75]
v_mfma_f32_16x16x32_bf16 v[76:79], v[204:207], v[32:35], v[76:79]
v_mfma_f32_16x16x32_bf16 v[76:79], v[220:223], v[36:39], v[76:79]
v_mfma_f32_16x16x32_bf16 v[76:79], v[236:239], v[40:43], v[76:79]
v_mfma_f32_16x16x32_bf16 v[76:79], v[252:255], v[44:47], v[76:79]
s_waitcnt vmcnt(0)
s_mov_b32 s68, 2
s_cmp_gt_u32 s64, 33
s_cbranch_scc1 K3_EP1f
v_cmp_le_u32 vcc, s65, v6
s_nop 0
s_cmp_eq_u64 vcc, -1
s_cselect_b32 s68, 1, 0
s_cselect_b32 s42, 0x4000000, 0
s_add_u32 s69, s66, 4096
s_add_u32 m0, s72, 4096
s_nop 0
buffer_load_dwordx4 v11, s[40:43], s69 offen offset:1024 sc1 lds
buffer_load_dwordx4 v1, s[40:43], s69 offen offset:0 sc1 lds
s_add_u32 m0, s72, 0
s_nop 0
buffer_load_dwordx4 v1, s[40:43], s66 offen offset:0 sc1 lds
buffer_load_dwordx4 v1, s[40:43], s66 offen offset:1024 sc1 lds
buffer_load_dwordx4 v1, s[40:43], s66 offen offset:2048 sc1 lds
buffer_load_dwordx4 v1, s[40:43], s66 offen offset:3072 sc1 lds
buffer_load_dword v6, v5, s[36:39], 0 offen sc1
K3_EP1f:
v_fma_f32 v80, -v131, v104, v64
v_fma_f32 v81, -v131, v105, v65
v_fma_f32 v82, -v131, v106, v66
v_fma_f32 v83, -v131, v107, v67
v_mul_f32 v80, v80, v133
v_mul_f32 v81, v81, v133
v_mul_f32 v82, v82, v133
v_mul_f32 v83, v83, v133
v_fma_f32 v84, -v131, v108, v68
v_fma_f32 v85, -v131, v109, v69
v_fma_f32 v86, -v131, v110, v70
v_fma_f32 v87, -v131, v111, v71
v_mul_f32 v80, v80, v84
v_mul_f32 v81, v81, v85
v_mul_f32 v82, v82, v86
v_mul_f32 v83, v83, v87
v_cvt_pk_bf16_f32 v96, v80, v81
v_cvt_pk_bf16_f32 v97, v82, v83
v_fma_f32 v88, -v131, v112, v72
v_fma_f32 v89, -v131, v113, v73
v_fma_f32 v90, -v131, v114, v74
v_fma_f32 v91, -v131, v115, v75
v_mul_f32 v88, v88, v133
v_mul_f32 v89, v89, v133
v_mul_f32 v90, v90, v133
v_mul_f32 v91, v91, v133
v_fma_f32 v92, -v131, v116, v76
v_fma_f32 v93, -v131, v117, v77
v_fma_f32 v94, -v131, v118, v78
v_fma_f32 v95, -v131, v119, v79
v_mul_f32 v88, v88, v92
v_mul_f32 v89, v89, v93
v_mul_f32 v90, v90, v94
v_mul_f32 v91, v91, v95
v_cvt_pk_bf16_f32 v98, v88, v89
v_cvt_pk_bf16_f32 v99, v90, v91
buffer_store_dwordx4 v[96:99], v101, s[44:47], s67 offen
v_mov_b32 v8, s79
s_mov_b32 s46, 0
s_cmp_eq_u32 s68, 0
s_cbranch_scc1 K3_N21f
s_waitcnt vmcnt(0)
buffer_store_dword v8, v7, s[36:39], 0 offen
s_cmp_eq_u32 s68, 2
s_cbranch_scc1 L_FIN
s_branch K3_GO1f
K3_N21f:
s_waitcnt vmcnt(1)
v_cmp_le_u32 vcc, s65, v6
s_nop 0
s_cmp_eq_u64 vcc, -1
s_cselect_b32 s68, 1, 0
s_cselect_b32 s42, 0x4000000, 0
s_add_u32 s69, s66, 4096
s_add_u32 m0, s72, 4096
s_nop 0
buffer_load_dwordx4 v11, s[40:43], s69 offen offset:1024 sc1 lds
buffer_load_dwordx4 v1, s[40:43], s69 offen offset:0 sc1 lds
s_add_u32 m0, s72, 0
s_nop 0
buffer_load_dwordx4 v1, s[40:43], s66 offen offset:0 sc1 lds
buffer_load_dwordx4 v1, s[40:43], s66 offen offset:1024 sc1 lds
buffer_load_dwordx4 v1, s[40:43], s66 offen offset:2048 sc1 lds
buffer_load_dwordx4 v1, s[40:43], s66 offen offset:3072 sc1 lds
buffer_load_dword v6, v5, s[36:39], 0 offen sc1
s_waitcnt vmcnt(7)
buffer_store_dword v8, v7, s[36:39], 0 offen
s_waitcnt vmcnt(1)
s_cmp_eq_u32 s68, 1
s_cbranch_scc1 K3_GO1f
K3_SW1f:
s_mov_b32 s75, 0
K3_SP1f:
buffer_load_dword v6, v5, s[36:39], 0 offen sc1
s_add_u32 s75, s75, 1
s_cmp_gt_u32 s75, 0x8000
s_cbranch_scc1 L_TIMEOUT
s_waitcnt vmcnt(0)
v_cmp_le_u32 vcc, s65, v6
s_nop 0
s_cmp_eq_u64 vcc, -1
s_cbranch_scc0 K3_SP1f
s_mov_b32 s42, 0x4000000
s_add_u32 s69, s66, 4096
s_add_u32 m0, s72, 4096
s_nop 0
buffer_load_dwordx4 v11, s[40:43], s69 offen offset:1024 sc1 lds
buffer_load_dwordx4 v1, s[40:43], s69 offen offset:0 sc1 lds
s_add_u32 m0, s72, 0
s_nop 0
buffer_load_dwordx4 v1, s[40:43], s66 offen offset:0 sc1 lds
buffer_load_dwordx4 v1, s[40:43], s66 offen offset:1024 sc1 lds
buffer_load_dwordx4 v1, s[40:43], s66 offen offset:2048 sc1 lds
buffer_load_dwordx4 v1, s[40:43], s66 offen offset:3072 sc1 lds
buffer_load_dword v6, v5, s[36:39], 0 offen sc1
s_waitcnt vmcnt(0)
K3_GO1f:
s_barrier

ds_read_b128 v[16:19], v100 offset:0
ds_read_b128 v[20:23], v100 offset:1024
ds_read_b128 v[24:27], v100 offset:2048
v_fma_f32 v80, -v131, v104, v64
ds_read_b128 v[28:31], v100 offset:3072
v_fma_f32 v81, -v131, v105, v65
buffer_load_dword v6, v5, s[36:39], 0 offen sc1
v_mov_b32 v8, s79
v_fma_f32 v82, -v131, v106, v66
s_add_u32 s13, s64, 1
v_fma_f32 v83, -v131, v107, v67
v_mul_f32 v80, v80, v133
s_cmp_eq_u32 s13, 17
v_mul_f32 v81, v81, v133
v_mul_f32 v82, v82, v133
s_addc_u32 s13, s13, 0
v_mul_f32 v83, v83, v133
v_fma_f32 v84, -v131, v108, v68
s_sub_u32 s1, s13, 17
v_fma_f32 v85, -v131, v109, v69
v_fma_f32 v86, -v131, v110, v70
s_cselect_b32 s1, s13, s1
v_fma_f32 v87, -v131, v111, v71
v_mul_f32 v80, v80, v84
s_mul_i32 s66, s1, 24576
v_mul_f32 v81, v81, v85
v_mul_f32 v82, v82, v86
s_waitcnt lgkmcnt(0)
v_mul_f32 v83, v83, v87
v_cvt_pk_bf16_f32 v96, v80, v81
s_nop 7
s_branch K3_F0f
K3_W1f:
s_mov_b32 s75, 6
s_cmp_lt_u32 s65, 36
s_cbranch_scc0 K3_W1fR
K3_W1fL:
buffer_load_dword v6, v5, s[36:39], 0 offen sc1
s_waitcnt vmcnt(0)
v_cmp_le_u32 vcc, s65, v6
s_nop 0
s_cmp_eq_u64 vcc, -1
s_cbranch_scc1 K3_W1fR
s_sub_u32 s75, s75, 1
s_cmp_lg_u32 s75, 0
s_cbranch_scc1 K3_W1fL
s_branch K3_W1fR
K3_X0f:
K3_NR0f:
buffer_load_dword v6, v5, s[36:39], 0 offen sc1
v_mfma_f32_16x16x32_bf16 v[48:51], v[224:227], v[24:27], v[48:51]
s_and_b32 s67, s64, 7
s_mul_i32 s67, s67, s100
s_add_u32 s67, s67, s11
v_mfma_f32_16x16x32_bf16 v[48:51], v[240:243], v[28:31], v[48:51]
s_mov_b32 s46, s74
s_add_u32 s79, s64, 2
s_mov_b32 s64, s13
v_mfma_f32_16x16x32_bf16 v[52:55], v[196:199], v[16:19], v[52:55]
s_mov_b32 s0, s1
v_mfma_f32_16x16x32_bf16 v[52:55], v[212:215], v[20:23], v[52:55]
v_mfma_f32_16x16x32_bf16 v[52:55], v[228:231], v[24:27], v[52:55]
v_mfma_f32_16x16x32_bf16 v[52:55], v[244:247], v[28:31], v[52:55]
v_mfma_f32_16x16x32_bf16 v[56:59], v[200:203], v[16:19], v[56:59]
v_mfma_f32_16x16x32_bf16 v[56:59], v[216:219], v[20:23], v[56:59]
v_mfma_f32_16x16x32_bf16 v[56:59], v[232:235], v[24:27], v[56:59]
v_mfma_f32_16x16x32_bf16 v[56:59], v[248:251], v[28:31], v[56:59]
v_mfma_f32_16x16x32_bf16 v[60:63], v[204:207], v[16:19], v[60:63]
v_mfma_f32_16x16x32_bf16 v[60:63], v[220:223], v[20:23], v[60:63]
v_mfma_f32_16x16x32_bf16 v[60:63], v[236:239], v[24:27], v[60:63]
v_mfma_f32_16x16x32_bf16 v[60:63], v[252:255], v[28:31], v[60:63]
s_waitcnt vmcnt(0)
s_mov_b32 s68, 2
s_cmp_gt_u32 s64, 33
s_cbranch_scc1 K3_EP0f
v_cmp_le_u32 vcc, s65, v6
s_nop 0
s_cmp_eq_u64 vcc, -1
s_cselect_b32 s68, 1, 0
s_cselect_b32 s42, 0x4000000, 0
s_add_u32 s69, s66, 4096
s_add_u32 m0, s72, 28672
s_nop 0
buffer_load_dwordx4 v11, s[40:43], s69 offen offset:1024 sc1 lds
buffer_load_dwordx4 v1, s[40:43], s69 offen offset:0 sc1 lds
s_add_u32 m0, s72, 24576
s_nop 0
buffer_load_dwordx4 v1, s[40:43], s66 offen offset:0 sc1 lds
buffer_load_dwordx4 v1, s[40:43], s66 offen offset:1024 sc1 lds
buffer_load_dwordx4 v1, s[40:43], s66 offen offset:2048 sc1 lds
buffer_load_dwordx4 v1, s[40:43], s66 offen offset:3072 sc1 lds
buffer_load_dword v6, v5, s[36:39], 0 offen sc1
K3_EP0f:
v_fma_f32 v80, -v130, v104, v48
v_fma_f32 v81, -v130, v105, v49
v_fma_f32 v82, -v130, v106, v50
v_fma_f32 v83, -v130, v107, v51
v_mul_f32 v80, v80, v132
v_mul_f32 v81, v81, v132
v_mul_f32 v82, v82, v132
v_mul_f32 v83, v83, v132
v_fma_f32 v84, -v130, v108, v52
v_fma_f32 v85, -v130, v109, v53
v_fma_f32 v86, -v130, v110, v54
v_fma_f32 v87, -v130, v111, v55
v_mul_f32 v80, v80, v84
v_mul_f32 v81, v81, v85
v_mul_f32 v82, v82, v86
v_mul_f32 v83, v83, v87
v_cvt_pk_bf16_f32 v96, v80, v81
v_cvt_pk_bf16_f32 v97, v82, v83
v_fma_f32 v88, -v130, v112, v56
v_fma_f32 v89, -v130, v113, v57
v_fma_f32 v90, -v130, v114, v58
v_fma_f32 v91, -v130, v115, v59
v_mul_f32 v88, v88, v132
v_mul_f32 v89, v89, v132
v_mul_f32 v90, v90, v132
v_mul_f32 v91, v91, v132
v_fma_f32 v92, -v130, v116, v60
v_fma_f32 v93, -v130, v117, v61
v_fma_f32 v94, -v130, v118, v62
v_fma_f32 v95, -v130, v119, v63
v_mul_f32 v88, v88, v92
v_mul_f32 v89, v89, v93
v_mul_f32 v90, v90, v94
v_mul_f32 v91, v91, v95
v_cvt_pk_bf16_f32 v98, v88, v89
v_cvt_pk_bf16_f32 v99, v90, v91
buffer_store_dwordx4 v[96:99], v101, s[44:47], s67 offen
v_mov_b32 v8, s79
s_mov_b32 s46, 0
s_cmp_eq_u32 s68, 0
s_cbranch_scc1 K3_N20f
s_waitcnt vmcnt(0)
buffer_store_dword v8, v7, s[36:39], 0 offen
s_cmp_eq_u32 s68, 2
s_cbranch_scc1 L_FIN
s_branch K3_GO0f
K3_N20f:
s_waitcnt vmcnt(1)
v_cmp_le_u32 vcc, s65, v6
s_nop 0
s_cmp_eq_u64 vcc, -1
s_cselect_b32 s68, 1, 0
s_cselect_b32 s42, 0x4000000, 0
s_add_u32 s69, s66, 4096
s_add_u32 m0, s72, 28672
s_nop 0
buffer_load_dwordx4 v11, s[40:43], s69 offen offset:1024 sc1 lds
buffer_load_dwordx4 v1, s[40:43], s69 offen offset:0 sc1 lds
s_add_u32 m0, s72, 24576
s_nop 0
buffer_load_dwordx4 v1, s[40:43], s66 offen offset:0 sc1 lds
buffer_load_dwordx4 v1, s[40:43], s66 offen offset:1024 sc1 lds
buffer_load_dwordx4 v1, s[40:43], s66 offen offset:2048 sc1 lds
buffer_load_dwordx4 v1, s[40:43], s66 offen offset:3072 sc1 lds
buffer_load_dword v6, v5, s[36:39], 0 offen sc1
s_waitcnt vmcnt(7)
buffer_store_dword v8, v7, s[36:39], 0 offen
s_waitcnt vmcnt(1)
s_cmp_eq_u32 s68, 1
s_cbranch_scc1 K3_GO0f
K3_SW0f:
s_mov_b32 s75, 0
K3_SP0f:
buffer_load_dword v6, v5, s[36:39], 0 offen sc1
s_add_u32 s75, s75, 1
s_cmp_gt_u32 s75, 0x8000
s_cbranch_scc1 L_TIMEOUT
s_waitcnt vmcnt(0)
v_cmp_le_u32 vcc, s65, v6
s_nop 0
s_cmp_eq_u64 vcc, -1
s_cbranch_scc0 K3_SP0f
s_mov_b32 s42, 0x4000000
s_add_u32 s69, s66, 4096
s_add_u32 m0, s72, 28672
s_nop 0
buffer_load_dwordx4 v11, s[40:43], s69 offen offset:1024 sc1 lds
buffer_load_dwordx4 v1, s[40:43], s69 offen offset:0 sc1 lds
s_add_u32 m0, s72, 24576
s_nop 0
buffer_load_dwordx4 v1, s[40:43], s66 offen offset:0 sc1 lds
buffer_load_dwordx4 v1, s[40:43], s66 offen offset:1024 sc1 lds
buffer_load_dwordx4 v1, s[40:43], s66 offen offset:2048 sc1 lds
buffer_load_dwordx4 v1, s[40:43], s66 offen offset:3072 sc1 lds
buffer_load_dword v6, v5, s[36:39], 0 offen sc1
s_waitcnt vmcnt(0)
K3_GO0f:
s_barrier

ds_read_b128 v[32:35], v100 offset:24576
ds_read_b128 v[36:39], v100 offset:25600
ds_read_b128 v[40:43], v100 offset:26624
v_fma_f32 v80, -v130, v104, v48
ds_read_b128 v[44:47], v100 offset:27648
v_fma_f32 v81, -v130, v105, v49
buffer_load_dword v6, v5, s[36:39], 0 offen sc1
v_mov_b32 v8, s79
v_fma_f32 v82, -v130, v106, v50
s_add_u32 s13, s64, 1
v_fma_f32 v83, -v130, v107, v51
v_mul_f32 v80, v80, v132
s_cmp_eq_u32 s13, 17
v_mul_f32 v81, v81, v132
v_mul_f32 v82, v82, v132
s_addc_u32 s13, s13, 0
v_mul_f32 v83, v83, v132
v_fma_f32 v84, -v130, v108, v52
s_sub_u32 s1, s13, 17
v_fma_f32 v85, -v130, v109, v53
v_fma_f32 v86, -v130, v110, v54
s_cselect_b32 s1, s13, s1
v_fma_f32 v87, -v130, v111, v55
v_mul_f32 v80, v80, v84
s_mul_i32 s66, s1, 24576
v_mul_f32 v81, v81, v85
v_mul_f32 v82, v82, v86
s_waitcnt lgkmcnt(0)
v_mul_f32 v83, v83, v87
v_cvt_pk_bf16_f32 v96, v80, v81
s_nop 7
s_branch K3_F1f
K3_W0f:
s_mov_b32 s75, 6
s_cmp_lt_u32 s65, 36
s_cbranch_scc0 K3_W0fR
K3_W0fL:
buffer_load_dword v6, v5, s[36:39], 0 offen sc1
s_waitcnt vmcnt(0)
v_cmp_le_u32 vcc, s65, v6
s_nop 0
s_cmp_eq_u64 vcc, -1
s_cbranch_scc1 K3_W0fR
s_sub_u32 s75, s75, 1
s_cmp_lg_u32 s75, 0
s_cbranch_scc1 K3_W0fL
s_branch K3_W0fR
L_FIN:
L_END:
s_endpgm
L_TIMEOUT:
s_lshl_b32 s7, s2, 4
s_lshl_b32 s8, s3, 2
s_add_u32 s7, s7, s8
s_add_u32 s7, s7, 262144
s_or_b32 s8, s64, 0xdead0000
v_mov_b32 v12, s8
v_mov_b32 v13, 0
buffer_store_dword v12, v13, s[36:39], s7 offen
s_endpgm
L_CODE_END:
.p2align 6
K1_U0s:
v_mfma_f32_16x16x32_bf16 v[64:67], v[224:227], v[40:43], v[64:67]
s_barrier

v_mfma_f32_16x16x32_bf16 v[64:67], v[240:243], v[44:47], v[64:67]
s_and_b32 s67, s64, 7
ds_read_b128 v[16:19], v96 offset:0
s_mul_i32 s67, s67, s100
v_mfma_f32_16x16x32_bf16 v[68:71], v[196:199], v[32:35], v[68:71]
s_add_u32 s67, s67, s11
ds_read_b128 v[20:23], v96 offset:1024
s_mov_b32 s46, s74
v_mfma_f32_16x16x32_bf16 v[68:71], v[212:215], v[36:39], v[68:71]
s_add_u32 s79, s64, 2
ds_read_b128 v[24:27], v96 offset:2048
v_fma_f32 v80, -v127, v100, v64
v_mfma_f32_16x16x32_bf16 v[68:71], v[228:231], v[40:43], v[68:71]
s_mov_b32 s64, s13
ds_read_b128 v[28:31], v96 offset:3072
v_fma_f32 v81, -v127, v101, v65
v_mfma_f32_16x16x32_bf16 v[68:71], v[244:247], v[44:47], v[68:71]
s_mov_b32 s0, s1
ds_read_b64 v[116:117], v99 offset:0
v_fma_f32 v82, -v127, v102, v66
v_mfma_f32_16x16x32_bf16 v[72:75], v[200:203], v[32:35], v[72:75]
s_add_u32 s13, s64, 1
ds_read_b64 v[118:119], v99 offset:128
v_fma_f32 v83, -v127, v103, v67
v_mfma_f32_16x16x32_bf16 v[72:75], v[216:219], v[36:39], v[72:75]
s_sub_u32 s1, s13, 17
ds_read_b64 v[120:121], v99 offset:256
v_fma_f32 v84, -v127, v104, v68
v_mfma_f32_16x16x32_bf16 v[72:75], v[232:235], v[40:43], v[72:75]
s_cselect_b32 s1, s13, s1
ds_read_b64 v[122:123], v99 offset:384
v_fma_f32 v85, -v127, v105, v69
v_mfma_f32_16x16x32_bf16 v[72:75], v[248:251], v[44:47], v[72:75]
s_mul_i32 s66, s1, 24576
ds_read_b64 v[124:125], v99 offset:512
v_fma_f32 v86, -v127, v106, v70
v_mfma_f32_16x16x32_bf16 v[76:79], v[204:207], v[32:35], v[76:79]
s_add_u32 s66, s66, s10
v_fma_f32 v87, -v127, v107, v71
s_add_u32 s65, s13, 2
v_mfma_f32_16x16x32_bf16 v[76:79], v[220:223], v[36:39], v[76:79]
s_waitcnt vmcnt(2)
v_cmp_le_u32 vcc, s65, v6
v_fma_f32 v88, -v127, v108, v72
v_mfma_f32_16x16x32_bf16 v[76:79], v[236:239], v[40:43], v[76:79]
s_cmp_eq_u64 vcc, -1
v_fma_f32 v89, -v127, v109, v73
v_fma_f32 v90, -v127, v110, v74
v_mfma_f32_16x16x32_bf16 v[76:79], v[252:255], v[44:47], v[76:79]
s_waitcnt lgkmcnt(5)
v_fma_f32 v91, -v127, v111, v75
K1_F0s:
v_mfma_f32_16x16x32_bf16 v[48:51], a[0:3], v[16:19], 0
ds_read_b128 v[32:35], v96 offset:4096
v_mfma_f32_16x16x32_bf16 v[48:51], a[16:19], v[20:23], v[48:51]
s_cbranch_scc0 K1_W0s
K1_W0sR:
s_cselect_b32 s68, 1, 0
v_mfma_f32_16x16x32_bf16 v[48:51], a[32:35], v[24:27], v[48:51]
s_cselect_b32 s42, 0x4000000, 0
ds_read_b128 v[36:39], v96 offset:6144
s_add_u32 s69, s66, 4096
v_mfma_f32_16x16x32_bf16 v[48:51], a[48:51], v[28:31], v[48:51]
s_add_u32 m0, s72, 28672
v_fma_f32 v92, -v127, v112, v76
v_fma_f32 v93, -v127, v113, v77
v_mfma_f32_16x16x32_bf16 v[52:55], a[4:7], v[16:19], 0
s_waitcnt lgkmcnt(2)
ds_read_b128 v[40:43], v96 offset:7168
v_fma_f32 v94, -v127, v114, v78
v_mfma_f32_16x16x32_bf16 v[52:55], a[20:23], v[20:23], v[52:55]
buffer_load_dwordx4 v11, s[40:43], s69 offen offset:1024 sc1 lds
v_mfma_f32_16x16x32_bf16 v[52:55], a[36:39], v[24:27], v[52:55]
ds_read_b128 v[44:47], v96 offset:8192
v_fma_f32 v95, -v127, v115, v79
v_mfma_f32_16x16x32_bf16 v[52:55], a[52:55], v[28:31], v[52:55]
v_mul_f32 v84, v84, v129
v_mul_f32 v85, v85, v129
v_mfma_f32_16x16x32_bf16 v[56:59], a[8:11], v[16:19], 0
buffer_load_dwordx4 v1, s[40:43], s69 offen offset:0 sc1 lds
v_mfma_f32_16x16x32_bf16 v[56:59], a[24:27], v[20:23], v[56:59]
s_add_u32 m0, s72, 24576
v_mul_f32 v86, v86, v129
v_mul_f32 v87, v87, v129
v_mfma_f32_16x16x32_bf16 v[56:59], a[40:43], v[24:27], v[56:59]
v_mul_f32 v88, v88, v129
v_mul_f32 v89, v89, v129
v_mfma_f32_16x16x32_bf16 v[56:59], a[56:59], v[28:31], v[56:59]
v_mul_f32 v90, v90, v129
v_mul_f32 v91, v91, v129
v_mfma_f32_16x16x32_bf16 v[60:63], a[12:15], v[16:19], 0
buffer_load_dwordx4 v1, s[40:43], s66 offen offset:0 sc1 lds
v_mfma_f32_16x16x32_bf16 v[60:63], a[28:31], v[20:23], v[60:63]
s_waitcnt vmcnt(3)
v_cvt_pk_bf16_f32 v132, v80, v81
v_cvt_pk_bf16_f32 v133, v82, v83
v_mfma_f32_16x16x32_bf16 v[60:63], a[44:47], v[24:27], v[60:63]
buffer_store_dword v8, v7, s[36:39], 0 offen sc1
v_mfma_f32_16x16x32_bf16 v[60:63], a[60:63], v[28:31], v[60:63]
s_waitcnt lgkmcnt(0)
v_mov_b32 v8, s79
v_cvt_pk_bf16_f32 v134, v92, v93
v_mfma_f32_16x16x32_bf16 v[48:51], a[64:67], v[32:35], v[48:51]
ds_read_b128 v[16:19], v96 offset:9216
v_cvt_pk_bf16_f32 v135, v94, v95
v_mfma_f32_16x16x32_bf16 v[48:51], a[80:83], v[36:39], v[48:51]
buffer_load_dwordx4 v1, s[40:43], s66 offen offset:1024 sc1 lds
v_mfma_f32_16x16x32_bf16 v[48:51], a[96:99], v[40:43], v[48:51]
ds_read_b128 v[20:23], v96 offset:10240
v_cvt_pk_bf16_f32 v136, v88, v89
v_mfma_f32_16x16x32_bf16 v[48:51], a[112:115], v[44:47], v[48:51]
v_cvt_pk_bf16_f32 v137, v90, v91
v_cvt_pk_bf16_f32 v188, v84, v85
v_mfma_f32_16x16x32_bf16 v[52:55], a[68:71], v[32:35], v[52:55]
ds_read_b128 v[24:27], v96 offset:12288
v_cvt_pk_bf16_f32 v189, v86, v87
v_mfma_f32_16x16x32_bf16 v[52:55], a[84:87], v[36:39], v[52:55]
buffer_load_dwordx4 v1, s[40:43], s66 offen offset:2048 sc1 lds
v_mfma_f32_16x16x32_bf16 v[52:55], a[100:103], v[40:43], v[52:55]
ds_read_b128 v[28:31], v96 offset:13312
v_cndmask_b32 v190, 0, v136, s[56:57]
v_mfma_f32_16x16x32_bf16 v[52:55], a[116:119], v[44:47], v[52:55]
v_cndmask_b32 v191, 0, v137, s[56:57]
v_mul_f32 v92, v92, v129
v_mfma_f32_16x16x32_bf16 v[144:147], v[184:187], v[132:135], v[164:167]
v_mul_f32 v93, v93, v129
v_mul_f32 v94, v94, v129
v_mfma_f32_16x16x32_bf16 v[140:143], v[188:191], v[132:135], v[168:171]
v_mul_f32 v95, v95, v129
v_cvt_pk_bf16_f32 v138, v92, v93
v_mfma_f32_16x16x32_bf16 v[56:59], a[72:75], v[32:35], v[56:59]
buffer_load_dwordx4 v1, s[40:43], s66 offen offset:3072 sc1 lds
v_mfma_f32_16x16x32_bf16 v[56:59], a[88:91], v[36:39], v[56:59]
v_cvt_pk_bf16_f32 v139, v94, v95
v_add_f32 v116, v116, v118
v_mfma_f32_16x16x32_bf16 v[56:59], a[104:107], v[40:43], v[56:59]
v_max_f32 v140, v144, v140
v_max_f32 v141, v145, v141
v_mfma_f32_16x16x32_bf16 v[148:151], v[136:139], v[172:175], 0
v_max_f32 v142, v146, v142
v_max_f32 v143, v147, v143
v_mfma_f32_16x16x32_bf16 v[152:155], v[136:139], v[176:179], v[180:183]
v_max3_f32 v144, v140, v141, v142
v_max_f32 v145, v144, v143
v_mfma_f32_16x16x32_bf16 v[56:59], a[120:123], v[44:47], v[56:59]
v_max_f32 v144, v144, v143
v_add_f32 v117, v117, v119
v_mfma_f32_16x16x32_bf16 v[60:63], a[76:79], v[32:35], v[60:63]
v_permlane32_swap_b32 v144, v145
v_mfma_f32_16x16x32_bf16 v[60:63], a[92:95], v[36:39], v[60:63]
v_max_f32 v146, v144, v145
v_max_f32 v147, v144, v145
v_mfma_f32_16x16x32_bf16 v[60:63], a[108:111], v[40:43], v[60:63]
v_cvt_pk_bf16_f32 v158, v148, v149
v_cvt_pk_bf16_f32 v159, v150, v151
v_mfma_f32_16x16x32_bf16 v[60:63], a[124:127], v[44:47], v[60:63]
s_waitcnt lgkmcnt(0)
v_permlane16_swap_b32 v146, v147
v_mfma_f32_16x16x32_bf16 v[48:51], a[128:131], v[16:19], v[48:51]
ds_read_b128 v[32:35], v96 offset:14336
v_max_f32 v144, v146, v147
v_mfma_f32_16x16x32_bf16 v[48:51], a[144:147], v[20:23], v[48:51]
v_mul_f32 v144, v144, v131
v_fma_f32 v140, v140, v131, -v144
v_mfma_f32_16x16x32_bf16 v[48:51], a[160:163], v[24:27], v[48:51]
ds_read_b128 v[36:39], v96 offset:15360
v_fma_f32 v141, v141, v131, -v144
v_mfma_f32_16x16x32_bf16 v[48:51], a[176:179], v[28:31], v[48:51]
v_fma_f32 v142, v142, v131, -v144
v_fma_f32 v143, v143, v131, -v144
v_mfma_f32_16x16x32_bf16 v[52:55], a[132:135], v[16:19], v[52:55]
ds_read_b128 v[40:43], v96 offset:16384
v_cvt_pk_bf16_f32 v162, v152, v153
v_mfma_f32_16x16x32_bf16 v[52:55], a[148:151], v[20:23], v[52:55]
v_exp_f32 v140, v140
v_mfma_f32_16x16x32_bf16 v[52:55], a[164:167], v[24:27], v[52:55]
ds_read_b128 v[44:47], v96 offset:18432
v_cvt_pk_bf16_f32 v163, v154, v155
v_mfma_f32_16x16x32_bf16 v[52:55], a[180:183], v[28:31], v[52:55]
v_exp_f32 v141, v141
v_mfma_f32_16x16x32_bf16 v[56:59], a[136:139], v[16:19], v[56:59]
v_exp_f32 v142, v142
v_mfma_f32_16x16x32_bf16 v[56:59], a[152:155], v[20:23], v[56:59]
v_exp_f32 v143, v143
v_mfma_f32_16x16x32_bf16 v[56:59], a[168:171], v[24:27], v[56:59]
buffer_load_dword v6, v5, s[36:39], 0 offen sc1
v_mfma_f32_16x16x32_bf16 v[56:59], a[184:187], v[28:31], v[56:59]
s_sub_u32 s69, s0, s73
v_cvt_pk_bf16_f32 v144, v140, v141
v_cvt_pk_bf16_f32 v145, v142, v143
v_mfma_f32_16x16x32_bf16 v[60:63], a[140:143], v[16:19], v[60:63]
s_cmp_lt_u32 s69, 2
v_and_b32 v134, v12, v144
v_and_b32 v135, v13, v145
v_mfma_f32_16x16x32_bf16 v[60:63], a[156:159], v[20:23], v[60:63]
s_cselect_b32 s69, 0, s68
v_bfi_b32 v132, v12, 0, v144
v_bfi_b32 v133, v13, 0, v145
v_mfma_f32_16x16x32_bf16 v[60:63], a[172:175], v[24:27], v[60:63]
s_cmp_eq_u32 s69, 0
v_add_f32 v120, v120, v122
v_add_f32 v121, v121, v123
v_mfma_f32_16x16x32_bf16 v[152:155], v[160:163], v[132:135], 0
v_add_f32 v116, v116, v124
v_add_f32 v117, v117, v125
v_mfma_f32_16x16x32_bf16 v[148:151], v[156:159], v[132:135], 0
v_add_f32 v116, v116, v120
v_add_f32 v117, v117, v121
v_mfma_f32_16x16x32_bf16 v[60:63], a[188:191], v[28:31], v[60:63]
s_waitcnt lgkmcnt(0)
v_permlane32_swap_b32 v116, v117
v_mfma_f32_16x16x32_bf16 v[48:51], a[192:195], v[32:35], v[48:51]
ds_read_b128 v[16:19], v96 offset:19456
v_add_f32 v118, v116, v117
v_mfma_f32_16x16x32_bf16 v[48:51], a[208:211], v[36:39], v[48:51]
v_rcp_f32 v144, v153
v_mfma_f32_16x16x32_bf16 v[48:51], a[224:227], v[40:43], v[48:51]
ds_read_b128 v[20:23], v96 offset:20480
v_mul_f32 v148, v148, v144
v_mfma_f32_16x16x32_bf16 v[48:51], a[240:243], v[44:47], v[48:51]
v_mul_f32 v149, v149, v144
v_mul_f32 v150, v150, v144
v_mfma_f32_16x16x32_bf16 v[52:55], a[196:199], v[32:35], v[52:55]
ds_read_b128 v[24:27], v96 offset:21504
v_mul_f32 v151, v151, v144
v_mfma_f32_16x16x32_bf16 v[52:55], a[212:215], v[36:39], v[52:55]
v_mul_f32 v152, v152, v144
v_cvt_pk_bf16_f32 v140, v148, v149
v_mfma_f32_16x16x32_bf16 v[52:55], a[228:231], v[40:43], v[52:55]
ds_read_b128 v[28:31], v96 offset:22528
v_cvt_pk_bf16_f32 v141, v150, v151
v_mfma_f32_16x16x32_bf16 v[52:55], a[244:247], v[44:47], v[52:55]
v_cvt_pk_bf16_f32 v142, v152, v152
v_add_f32 v119, v116, v117
v_mfma_f32_16x16x32_bf16 v[56:59], a[200:203], v[32:35], v[56:59]
buffer_store_dwordx2 v[140:141], v97, s[44:47], s67 offen sc1
v_mfma_f32_16x16x32_bf16 v[56:59], a[216:219], v[36:39], v[56:59]
buffer_store_short v142, v98, s[44:47], s67 offen sc1
v_mfma_f32_16x16x32_bf16 v[56:59], a[232:235], v[40:43], v[56:59]
v_permlane16_swap_b32 v118, v119
v_mfma_f32_16x16x32_bf16 v[56:59], a[248:251], v[44:47], v[56:59]
v_add_f32 v126, v118, v119
v_add_f32 v117, v118, v119
v_mfma_f32_16x16x32_bf16 v[60:63], a[204:207], v[32:35], v[60:63]
v_mfma_f32_16x16x32_bf16 v[60:63], a[220:223], v[36:39], v[60:63]
v_permlane32_swap_b32 v126, v117
v_mfma_f32_16x16x32_bf16 v[60:63], a[236:239], v[40:43], v[60:63]
v_fma_f32 v117, -v126, v126, v117
v_max_f32 v117, s77, v117
v_mfma_f32_16x16x32_bf16 v[60:63], a[252:255], v[44:47], v[60:63]
s_waitcnt lgkmcnt(0)
v_rsq_f32 v128, v117
v_mfma_f32_16x16x32_bf16 v[48:51], v[192:195], v[16:19], v[48:51]
s_waitcnt vmcnt(3) lgkmcnt(0)
v_mul_f32 v130, s78, v128
v_mfma_f32_16x16x32_bf16 v[48:51], v[208:211], v[20:23], v[48:51]
s_cbranch_scc1 K1_X0s
K1_U1s:
v_mfma_f32_16x16x32_bf16 v[48:51], v[224:227], v[24:27], v[48:51]
s_barrier

v_mfma_f32_16x16x32_bf16 v[48:51], v[240:243], v[28:31], v[48:51]
s_and_b32 s67, s64, 7
ds_read_b128 v[32:35], v96 offset:24576
s_mul_i32 s67, s67, s100
v_mfma_f32_16x16x32_bf16 v[52:55], v[196:199], v[16:19], v[52:55]
s_add_u32 s67, s67, s11
ds_read_b128 v[36:39], v96 offset:25600
s_mov_b32 s46, s74
v_mfma_f32_16x16x32_bf16 v[52:55], v[212:215], v[20:23], v[52:55]
s_add_u32 s79, s64, 2
ds_read_b128 v[40:43], v96 offset:26624
v_fma_f32 v80, -v126, v100, v48
v_mfma_f32_16x16x32_bf16 v[52:55], v[228:231], v[24:27], v[52:55]
s_mov_b32 s64, s13
ds_read_b128 v[44:47], v96 offset:27648
v_fma_f32 v81, -v126, v101, v49
v_mfma_f32_16x16x32_bf16 v[52:55], v[244:247], v[28:31], v[52:55]
s_mov_b32 s0, s1
ds_read_b64 v[116:117], v99 offset:24576
v_fma_f32 v82, -v126, v102, v50
v_mfma_f32_16x16x32_bf16 v[56:59], v[200:203], v[16:19], v[56:59]
s_add_u32 s13, s64, 1
ds_read_b64 v[118:119], v99 offset:24704
v_fma_f32 v83, -v126, v103, v51
v_mfma_f32_16x16x32_bf16 v[56:59], v[216:219], v[20:23], v[56:59]
s_sub_u32 s1, s13, 17
ds_read_b64 v[120:121], v99 offset:24832
v_fma_f32 v84, -v126, v104, v52
v_mfma_f32_16x16x32_bf16 v[56:59], v[232:235], v[24:27], v[56:59]
s_cselect_b32 s1, s13, s1
ds_read_b64 v[122:123], v99 offset:24960
v_fma_f32 v85, -v126, v105, v53
v_mfma_f32_16x16x32_bf16 v[56:59], v[248:251], v[28:31], v[56:59]
s_mul_i32 s66, s1, 24576
ds_read_b64 v[124:125], v99 offset:25088
v_fma_f32 v86, -v126, v106, v54
v_mfma_f32_16x16x32_bf16 v[60:63], v[204:207], v[16:19], v[60:63]
s_add_u32 s66, s66, s10
v_fma_f32 v87, -v126, v107, v55
s_add_u32 s65, s13, 2
v_mfma_f32_16x16x32_bf16 v[60:63], v[220:223], v[20:23], v[60:63]
s_waitcnt vmcnt(2)
v_cmp_le_u32 vcc, s65, v6
v_fma_f32 v88, -v126, v108, v56
v_mfma_f32_16x16x32_bf16 v[60:63], v[236:239], v[24:27], v[60:63]
s_cmp_eq_u64 vcc, -1
v_fma_f32 v89, -v126, v109, v57
v_fma_f32 v90, -v126, v110, v58
v_mfma_f32_16x16x32_bf16 v[60:63], v[252:255], v[28:31], v[60:63]
s_waitcnt lgkmcnt(5)
v_fma_f32 v91, -v126, v111, v59
K1_F1s:
v_mfma_f32_16x16x32_bf16 v[64:67], a[0:3], v[32:35], 0
ds_read_b128 v[16:19], v96 offset:28672
v_mfma_f32_16x16x32_bf16 v[64:67], a[16:19], v[36:39], v[64:67]
s_cbranch_scc0 K1_W1s
K1_W1sR:
s_cselect_b32 s68, 1, 0
v_mfma_f32_16x16x32_bf16 v[64:67], a[32:35], v[40:43], v[64:67]
s_cselect_b32 s42, 0x4000000, 0
ds_read_b128 v[20:23], v96 offset:30720
s_add_u32 s69, s66, 4096
v_mfma_f32_16x16x32_bf16 v[64:67], a[48:51], v[44:47], v[64:67]
s_add_u32 m0, s72, 4096
v_fma_f32 v92, -v126, v112, v60
v_fma_f32 v93, -v126, v113, v61
v_mfma_f32_16x16x32_bf16 v[68:71], a[4:7], v[32:35], 0
s_waitcnt lgkmcnt(2)
ds_read_b128 v[24:27], v96 offset:31744
v_fma_f32 v94, -v126, v114, v62
v_mfma_f32_16x16x32_bf16 v[68:71], a[20:23], v[36:39], v[68:71]
buffer_load_dwordx4 v11, s[40:43], s69 offen offset:1024 sc1 lds
v_mfma_f32_16x16x32_bf16 v[68:71], a[36:39], v[40:43], v[68:71]
ds_read_b128 v[28:31], v96 offset:32768
v_fma_f32 v95, -v126, v115, v63
v_mfma_f32_16x16x32_bf16 v[68:71], a[52:55], v[44:47], v[68:71]
v_mul_f32 v84, v84, v128
v_mul_f32 v85, v85, v128
v_mfma_f32_16x16x32_bf16 v[72:75], a[8:11], v[32:35], 0
buffer_load_dwordx4 v1, s[40:43], s69 offen offset:0 sc1 lds
v_mfma_f32_16x16x32_bf16 v[72:75], a[24:27], v[36:39], v[72:75]
s_add_u32 m0, s72, 0
v_mul_f32 v86, v86, v128
v_mul_f32 v87, v87, v128
v_mfma_f32_16x16x32_bf16 v[72:75], a[40:43], v[40:43], v[72:75]
v_mul_f32 v88, v88, v128
v_mul_f32 v89, v89, v128
v_mfma_f32_16x16x32_bf16 v[72:75], a[56:59], v[44:47], v[72:75]
v_mul_f32 v90, v90, v128
v_mul_f32 v91, v91, v128
v_mfma_f32_16x16x32_bf16 v[76:79], a[12:15], v[32:35], 0
buffer_load_dwordx4 v1, s[40:43], s66 offen offset:0 sc1 lds
v_mfma_f32_16x16x32_bf16 v[76:79], a[28:31], v[36:39], v[76:79]
s_waitcnt vmcnt(3)
v_cvt_pk_bf16_f32 v132, v80, v81
v_cvt_pk_bf16_f32 v133, v82, v83
v_mfma_f32_16x16x32_bf16 v[76:79], a[44:47], v[40:43], v[76:79]
buffer_store_dword v8, v7, s[36:39], 0 offen sc1
v_mfma_f32_16x16x32_bf16 v[76:79], a[60:63], v[44:47], v[76:79]
s_waitcnt lgkmcnt(0)
v_mov_b32 v8, s79
v_cvt_pk_bf16_f32 v134, v92, v93
v_mfma_f32_16x16x32_bf16 v[64:67], a[64:67], v[16:19], v[64:67]
ds_read_b128 v[32:35], v96 offset:33792
v_cvt_pk_bf16_f32 v135, v94, v95
v_mfma_f32_16x16x32_bf16 v[64:67], a[80:83], v[20:23], v[64:67]
buffer_load_dwordx4 v1, s[40:43], s66 offen offset:1024 sc1 lds
v_mfma_f32_16x16x32_bf16 v[64:67], a[96:99], v[24:27], v[64:67]
ds_read_b128 v[36:39], v96 offset:34816
v_cvt_pk_bf16_f32 v136, v88, v89
v_mfma_f32_16x16x32_bf16 v[64:67], a[112:115], v[28:31], v[64:67]
v_cvt_pk_bf16_f32 v137, v90, v91
v_cvt_pk_bf16_f32 v184, v84, v85
v_mfma_f32_16x16x32_bf16 v[68:71], a[68:71], v[16:19], v[68:71]
ds_read_b128 v[40:43], v96 offset:36864
v_cvt_pk_bf16_f32 v185, v86, v87
v_mfma_f32_16x16x32_bf16 v[68:71], a[84:87], v[20:23], v[68:71]
buffer_load_dwordx4 v1, s[40:43], s66 offen offset:2048 sc1 lds
v_mfma_f32_16x16x32_bf16 v[68:71], a[100:103], v[24:27], v[68:71]
ds_read_b128 v[44:47], v96 offset:37888
v_cndmask_b32 v186, 0, v136, s[56:57]
v_mfma_f32_16x16x32_bf16 v[68:71], a[116:119], v[28:31], v[68:71]
v_cndmask_b32 v187, 0, v137, s[56:57]
v_mul_f32 v92, v92, v128
v_mfma_f32_16x16x32_bf16 v[144:147], v[188:191], v[132:135], v[164:167]
v_mul_f32 v93, v93, v128
v_mul_f32 v94, v94, v128
v_mfma_f32_16x16x32_bf16 v[140:143], v[184:187], v[132:135], v[168:171]
v_mul_f32 v95, v95, v128
v_cvt_pk_bf16_f32 v138, v92, v93
v_mfma_f32_16x16x32_bf16 v[72:75], a[72:75], v[16:19], v[72:75]
buffer_load_dwordx4 v1, s[40:43], s66 offen offset:3072 sc1 lds
v_mfma_f32_16x16x32_bf16 v[72:75], a[88:91], v[20:23], v[72:75]
v_cvt_pk_bf16_f32 v139, v94, v95
v_add_f32 v116, v116, v118
v_mfma_f32_16x16x32_bf16 v[72:75], a[104:107], v[24:27], v[72:75]
v_max_f32 v140, v144, v140
v_max_f32 v141, v145, v141
v_mfma_f32_16x16x32_bf16 v[148:151], v[136:139], v[172:175], 0
v_max_f32 v142, v146, v142
v_max_f32 v143, v147, v143
v_mfma_f32_16x16x32_bf16 v[152:155], v[136:139], v[176:179], v[180:183]
v_max3_f32 v144, v140, v141, v142
v_max_f32 v145, v144, v143
v_mfma_f32_16x16x32_bf16 v[72:75], a[120:123], v[28:31], v[72:75]
v_max_f32 v144, v144, v143
v_add_f32 v117, v117, v119
v_mfma_f32_16x16x32_bf16 v[76:79], a[76:79], v[16:19], v[76:79]
v_permlane32_swap_b32 v144, v145
v_mfma_f32_16x16x32_bf16 v[76:79], a[92:95], v[20:23], v[76:79]
v_max_f32 v146, v144, v145
v_max_f32 v147, v144, v145
v_mfma_f32_16x16x32_bf16 v[76:79], a[108:111], v[24:27], v[76:79]
v_cvt_pk_bf16_f32 v156, v148, v149
v_cvt_pk_bf16_f32 v157, v150, v151
v_mfma_f32_16x16x32_bf16 v[76:79], a[124:127], v[28:31], v[76:79]
s_waitcnt lgkmcnt(0)
v_permlane16_swap_b32 v146, v147
v_mfma_f32_16x16x32_bf16 v[64:67], a[128:131], v[32:35], v[64:67]
ds_read_b128 v[16:19], v96 offset:38912
v_max_f32 v144, v146, v147
v_mfma_f32_16x16x32_bf16 v[64:67], a[144:147], v[36:39], v[64:67]
v_mul_f32 v144, v144, v130
v_fma_f32 v140, v140, v130, -v144
v_mfma_f32_16x16x32_bf16 v[64:67], a[160:163], v[40:43], v[64:67]
ds_read_b128 v[20:23], v96 offset:39936
v_fma_f32 v141, v141, v130, -v144
v_mfma_f32_16x16x32_bf16 v[64:67], a[176:179], v[44:47], v[64:67]
v_fma_f32 v142, v142, v130, -v144
v_fma_f32 v143, v143, v130, -v144
v_mfma_f32_16x16x32_bf16 v[68:71], a[132:135], v[32:35], v[68:71]
ds_read_b128 v[24:27], v96 offset:40960
v_cvt_pk_bf16_f32 v160, v152, v153
v_mfma_f32_16x16x32_bf16 v[68:71], a[148:151], v[36:39], v[68:71]
v_exp_f32 v140, v140
v_mfma_f32_16x16x32_bf16 v[68:71], a[164:167], v[40:43], v[68:71]
ds_read_b128 v[28:31], v96 offset:43008
v_cvt_pk_bf16_f32 v161, v154, v155
v_mfma_f32_16x16x32_bf16 v[68:71], a[180:183], v[44:47], v[68:71]
v_exp_f32 v141, v141
v_mfma_f32_16x16x32_bf16 v[72:75], a[136:139], v[32:35], v[72:75]
v_exp_f32 v142, v142
v_mfma_f32_16x16x32_bf16 v[72:75], a[152:155], v[36:39], v[72:75]
v_exp_f32 v143, v143
v_mfma_f32_16x16x32_bf16 v[72:75], a[168:171], v[40:43], v[72:75]
buffer_load_dword v6, v5, s[36:39], 0 offen sc1
v_mfma_f32_16x16x32_bf16 v[72:75], a[184:187], v[44:47], v[72:75]
s_sub_u32 s69, s0, s73
v_cvt_pk_bf16_f32 v144, v140, v141
v_cvt_pk_bf16_f32 v145, v142, v143
v_mfma_f32_16x16x32_bf16 v[76:79], a[140:143], v[32:35], v[76:79]
s_cmp_lt_u32 s69, 2
v_and_b32 v132, v12, v144
v_and_b32 v133, v13, v145
v_mfma_f32_16x16x32_bf16 v[76:79], a[156:159], v[36:39], v[76:79]
s_cselect_b32 s69, 0, s68
v_bfi_b32 v134, v12, 0, v144
v_bfi_b32 v135, v13, 0, v145
v_mfma_f32_16x16x32_bf16 v[76:79], a[172:175], v[40:43], v[76:79]
s_cmp_eq_u32 s69, 0
v_add_f32 v120, v120, v122
v_add_f32 v121, v121, v123
v_mfma_f32_16x16x32_bf16 v[152:155], v[160:163], v[132:135], 0
v_add_f32 v116, v116, v124
v_add_f32 v117, v117, v125
v_mfma_f32_16x16x32_bf16 v[148:151], v[156:159], v[132:135], 0
v_add_f32 v116, v116, v120
v_add_f32 v117, v117, v121
v_mfma_f32_16x16x32_bf16 v[76:79], a[188:191], v[44:47], v[76:79]
s_waitcnt lgkmcnt(0)
v_permlane32_swap_b32 v116, v117
v_mfma_f32_16x16x32_bf16 v[64:67], a[192:195], v[16:19], v[64:67]
ds_read_b128 v[32:35], v96 offset:44032
v_add_f32 v118, v116, v117
v_mfma_f32_16x16x32_bf16 v[64:67], a[208:211], v[20:23], v[64:67]
v_rcp_f32 v144, v153
v_mfma_f32_16x16x32_bf16 v[64:67], a[224:227], v[24:27], v[64:67]
ds_read_b128 v[36:39], v96 offset:45056
v_mul_f32 v148, v148, v144
v_mfma_f32_16x16x32_bf16 v[64:67], a[240:243], v[28:31], v[64:67]
v_mul_f32 v149, v149, v144
v_mul_f32 v150, v150, v144
v_mfma_f32_16x16x32_bf16 v[68:71], a[196:199], v[16:19], v[68:71]
ds_read_b128 v[40:43], v96 offset:46080
v_mul_f32 v151, v151, v144
v_mfma_f32_16x16x32_bf16 v[68:71], a[212:215], v[20:23], v[68:71]
v_mul_f32 v152, v152, v144
v_cvt_pk_bf16_f32 v140, v148, v149
v_mfma_f32_16x16x32_bf16 v[68:71], a[228:231], v[24:27], v[68:71]
ds_read_b128 v[44:47], v96 offset:47104
v_cvt_pk_bf16_f32 v141, v150, v151
v_mfma_f32_16x16x32_bf16 v[68:71], a[244:247], v[28:31], v[68:71]
v_cvt_pk_bf16_f32 v142, v152, v152
v_add_f32 v119, v116, v117
v_mfma_f32_16x16x32_bf16 v[72:75], a[200:203], v[16:19], v[72:75]
buffer_store_dwordx2 v[140:141], v97, s[44:47], s67 offen sc1
v_mfma_f32_16x16x32_bf16 v[72:75], a[216:219], v[20:23], v[72:75]
buffer_store_short v142, v98, s[44:47], s67 offen sc1
v_mfma_f32_16x16x32_bf16 v[72:75], a[232:235], v[24:27], v[72:75]
v_permlane16_swap_b32 v118, v119
v_mfma_f32_16x16x32_bf16 v[72:75], a[248:251], v[28:31], v[72:75]
v_add_f32 v127, v118, v119
v_add_f32 v117, v118, v119
v_mfma_f32_16x16x32_bf16 v[76:79], a[204:207], v[16:19], v[76:79]
v_mfma_f32_16x16x32_bf16 v[76:79], a[220:223], v[20:23], v[76:79]
v_permlane32_swap_b32 v127, v117
v_mfma_f32_16x16x32_bf16 v[76:79], a[236:239], v[24:27], v[76:79]
v_fma_f32 v117, -v127, v127, v117
v_max_f32 v117, s77, v117
v_mfma_f32_16x16x32_bf16 v[76:79], a[252:255], v[28:31], v[76:79]
s_waitcnt lgkmcnt(0)
v_rsq_f32 v129, v117
v_mfma_f32_16x16x32_bf16 v[64:67], v[192:195], v[32:35], v[64:67]
s_waitcnt vmcnt(3) lgkmcnt(0)
v_mul_f32 v131, s78, v129
v_mfma_f32_16x16x32_bf16 v[64:67], v[208:211], v[36:39], v[64:67]
s_cbranch_scc0 K1_U0s
K1_X1s:
s_sub_u32 s69, s0, s73
s_cmp_lt_u32 s69, 2
s_cbranch_scc0 K1_XB1s
s_cmp_eq_u32 s69, 0
s_cselect_b64 s[96:97], 0, -1
v_mov_b32 v14, 0xf149f2ca
s_and_b64 vcc, s[88:89], s[96:97]
v_cndmask_b32 v164, v14, 0, vcc
s_and_b64 vcc, s[90:91], s[96:97]
v_cndmask_b32 v165, v14, 0, vcc
s_and_b64 vcc, s[92:93], s[96:97]
v_cndmask_b32 v166, v14, 0, vcc
s_and_b64 vcc, s[94:95], s[96:97]
v_cndmask_b32 v167, v14, 0, vcc
K1_XB1s:
s_cmp_eq_u32 s68, 0
s_cbranch_scc1 K1_NR1s
s_branch K1_U0s
K1_NR1s:
buffer_load_dword v6, v5, s[36:39], 0 offen sc1
v_mfma_f32_16x16x32_bf16 v[64:67], v[224:227], v[40:43], v[64:67]
s_and_b32 s67, s64, 7
s_mul_i32 s67, s67, s100
s_add_u32 s67, s67, s11
v_mfma_f32_16x16x32_bf16 v[64:67], v[240:243], v[44:47], v[64:67]
s_mov_b32 s46, s74
s_add_u32 s79, s64, 2
s_mov_b32 s64, s13
v_mfma_f32_16x16x32_bf16 v[68:71], v[196:199], v[32:35], v[68:71]
s_mov_b32 s0, s1
v_mfma_f32_16x16x32_bf16 v[68:71], v[212:215], v[36:39], v[68:71]
v_mfma_f32_16x16x32_bf16 v[68:71], v[228:231], v[40:43], v[68:71]
v_mfma_f32_16x16x32_bf16 v[68:71], v[244:247], v[44:47], v[68:71]
v_mfma_f32_16x16x32_bf16 v[72:75], v[200:203], v[32:35], v[72:75]
v_mfma_f32_16x16x32_bf16 v[72:75], v[216:219], v[36:39], v[72:75]
v_mfma_f32_16x16x32_bf16 v[72:75], v[232:235], v[40:43], v[72:75]
v_mfma_f32_16x16x32_bf16 v[72:75], v[248:251], v[44:47], v[72:75]
v_mfma_f32_16x16x32_bf16 v[76:79], v[204:207], v[32:35], v[76:79]
v_mfma_f32_16x16x32_bf16 v[76:79], v[220:223], v[36:39], v[76:79]
v_mfma_f32_16x16x32_bf16 v[76:79], v[236:239], v[40:43], v[76:79]
v_mfma_f32_16x16x32_bf16 v[76:79], v[252:255], v[44:47], v[76:79]
s_waitcnt vmcnt(0)
buffer_store_dword v8, v7, s[36:39], 0 offen sc1
s_mov_b32 s68, 2
s_cmp_gt_u32 s64, 33
s_cbranch_scc1 K1_EP1s
v_cmp_le_u32 vcc, s65, v6
s_nop 0
s_cmp_eq_u64 vcc, -1
s_cselect_b32 s68, 1, 0
s_cselect_b32 s42, 0x4000000, 0
s_add_u32 s69, s66, 4096
s_add_u32 m0, s72, 4096
s_nop 0
buffer_load_dwordx4 v11, s[40:43], s69 offen offset:1024 sc1 lds
buffer_load_dwordx4 v1, s[40:43], s69 offen offset:0 sc1 lds
s_add_u32 m0, s72, 0
s_nop 0
buffer_load_dwordx4 v1, s[40:43], s66 offen offset:0 sc1 lds
buffer_load_dwordx4 v1, s[40:43], s66 offen offset:1024 sc1 lds
buffer_load_dwordx4 v1, s[40:43], s66 offen offset:2048 sc1 lds
buffer_load_dwordx4 v1, s[40:43], s66 offen offset:3072 sc1 lds
buffer_load_dword v6, v5, s[36:39], 0 offen sc1
K1_EP1s:
v_fma_f32 v80, -v127, v100, v64
v_fma_f32 v81, -v127, v101, v65
v_fma_f32 v82, -v127, v102, v66
v_fma_f32 v83, -v127, v103, v67
v_fma_f32 v84, -v127, v104, v68
v_fma_f32 v85, -v127, v105, v69
v_fma_f32 v86, -v127, v106, v70
v_fma_f32 v87, -v127, v107, v71
v_fma_f32 v88, -v127, v108, v72
v_fma_f32 v89, -v127, v109, v73
v_fma_f32 v90, -v127, v110, v74
v_fma_f32 v91, -v127, v111, v75
v_fma_f32 v92, -v127, v112, v76
v_fma_f32 v93, -v127, v113, v77
v_fma_f32 v94, -v127, v114, v78
v_fma_f32 v95, -v127, v115, v79
v_mul_f32 v84, v84, v129
v_mul_f32 v85, v85, v129
v_mul_f32 v86, v86, v129
v_mul_f32 v87, v87, v129
v_mul_f32 v88, v88, v129
v_mul_f32 v89, v89, v129
v_mul_f32 v90, v90, v129
v_mul_f32 v91, v91, v129
v_cvt_pk_bf16_f32 v132, v80, v81
v_cvt_pk_bf16_f32 v133, v82, v83
v_cvt_pk_bf16_f32 v134, v92, v93
v_cvt_pk_bf16_f32 v135, v94, v95
v_cvt_pk_bf16_f32 v136, v88, v89
v_cvt_pk_bf16_f32 v137, v90, v91
v_cvt_pk_bf16_f32 v188, v84, v85
v_cvt_pk_bf16_f32 v189, v86, v87
v_cndmask_b32 v190, 0, v136, s[56:57]
v_cndmask_b32 v191, 0, v137, s[56:57]
v_mfma_f32_16x16x32_bf16 v[144:147], v[184:187], v[132:135], v[164:167]
v_mul_f32 v92, v92, v129
v_mfma_f32_16x16x32_bf16 v[140:143], v[188:191], v[132:135], v[168:171]
v_mul_f32 v93, v93, v129
v_mul_f32 v94, v94, v129
v_mul_f32 v95, v95, v129
v_cvt_pk_bf16_f32 v138, v92, v93
v_cvt_pk_bf16_f32 v139, v94, v95
s_nop 1
v_mfma_f32_16x16x32_bf16 v[148:151], v[136:139], v[172:175], 0
v_max_f32 v140, v144, v140
v_max_f32 v141, v145, v141
v_max_f32 v142, v146, v142
v_max_f32 v143, v147, v143
v_max3_f32 v144, v140, v141, v142
v_max_f32 v145, v144, v143
v_max_f32 v144, v144, v143
v_mfma_f32_16x16x32_bf16 v[152:155], v[136:139], v[176:179], v[180:183]
v_cvt_pk_bf16_f32 v158, v148, v149
v_permlane32_swap_b32 v144, v145
v_max_f32 v146, v144, v145
v_max_f32 v147, v144, v145
v_cvt_pk_bf16_f32 v159, v150, v151
s_nop 0
v_permlane16_swap_b32 v146, v147
v_max_f32 v144, v146, v147
v_mul_f32 v144, v144, v131
v_fma_f32 v140, v140, v131, -v144
v_fma_f32 v141, v141, v131, -v144
v_fma_f32 v142, v142, v131, -v144
v_fma_f32 v143, v143, v131, -v144
v_exp_f32 v140, v140
v_exp_f32 v141, v141
v_exp_f32 v142, v142
v_exp_f32 v143, v143
v_cvt_pk_bf16_f32 v144, v140, v141
v_cvt_pk_bf16_f32 v145, v142, v143
v_and_b32 v134, v12, v144
v_and_b32 v135, v13, v145
v_bfi_b32 v132, v12, 0, v144
v_bfi_b32 v133, v13, 0, v145
v_cvt_pk_bf16_f32 v162, v152, v153
v_cvt_pk_bf16_f32 v163, v154, v155
s_nop 1
v_mfma_f32_16x16x32_bf16 v[152:155], v[160:163], v[132:135], 0
v_mfma_f32_16x16x32_bf16 v[148:151], v[156:159], v[132:135], 0
s_nop 6
v_rcp_f32 v144, v153
s_nop 0
v_mul_f32 v148, v148, v144
v_mul_f32 v149, v149, v144
v_mul_f32 v150, v150, v144
v_mul_f32 v151, v151, v144
v_mul_f32 v152, v152, v144
v_cvt_pk_bf16_f32 v140, v148, v149
v_cvt_pk_bf16_f32 v141, v150, v151
v_cvt_pk_bf16_f32 v142, v152, v152
buffer_store_dwordx2 v[140:141], v97, s[44:47], s67 offen sc1
buffer_store_short v142, v98, s[44:47], s67 offen sc1
v_mov_b32 v8, s79
s_mov_b32 s46, 0
s_cmp_eq_u32 s68, 0
s_cbranch_scc1 K1_N21s
s_waitcnt vmcnt(0)
buffer_store_dword v8, v7, s[36:39], 0 offen sc1
s_cmp_eq_u32 s68, 2
s_cbranch_scc1 L_FIN
s_branch K1_GO1s
K1_N21s:
s_waitcnt vmcnt(2)
v_cmp_le_u32 vcc, s65, v6
s_nop 0
s_cmp_eq_u64 vcc, -1
s_cselect_b32 s68, 1, 0
s_cselect_b32 s42, 0x4000000, 0
s_add_u32 s69, s66, 4096
s_add_u32 m0, s72, 4096
s_nop 0
buffer_load_dwordx4 v11, s[40:43], s69 offen offset:1024 sc1 lds
buffer_load_dwordx4 v1, s[40:43], s69 offen offset:0 sc1 lds
s_add_u32 m0, s72, 0
s_nop 0
buffer_load_dwordx4 v1, s[40:43], s66 offen offset:0 sc1 lds
buffer_load_dwordx4 v1, s[40:43], s66 offen offset:1024 sc1 lds
buffer_load_dwordx4 v1, s[40:43], s66 offen offset:2048 sc1 lds
buffer_load_dwordx4 v1, s[40:43], s66 offen offset:3072 sc1 lds
buffer_load_dword v6, v5, s[36:39], 0 offen sc1
s_waitcnt vmcnt(7)
buffer_store_dword v8, v7, s[36:39], 0 offen sc1
s_waitcnt vmcnt(1)
s_cmp_eq_u32 s68, 1
s_cbranch_scc1 K1_GO1s
K1_SW1s:
s_mov_b32 s75, 0
K1_SP1s:
buffer_load_dword v6, v5, s[36:39], 0 offen sc1
s_add_u32 s75, s75, 1
s_cmp_gt_u32 s75, 0x8000
s_cbranch_scc1 L_TIMEOUT
s_waitcnt vmcnt(0)
v_cmp_le_u32 vcc, s65, v6
s_nop 0
s_cmp_eq_u64 vcc, -1
s_cbranch_scc0 K1_SP1s
s_mov_b32 s42, 0x4000000
s_add_u32 s69, s66, 4096
s_add_u32 m0, s72, 4096
s_nop 0
buffer_load_dwordx4 v11, s[40:43], s69 offen offset:1024 sc1 lds
buffer_load_dwordx4 v1, s[40:43], s69 offen offset:0 sc1 lds
s_add_u32 m0, s72, 0
s_nop 0
buffer_load_dwordx4 v1, s[40:43], s66 offen offset:0 sc1 lds
buffer_load_dwordx4 v1, s[40:43], s66 offen offset:1024 sc1 lds
buffer_load_dwordx4 v1, s[40:43], s66 offen offset:2048 sc1 lds
buffer_load_dwordx4 v1, s[40:43], s66 offen offset:3072 sc1 lds
buffer_load_dword v6, v5, s[36:39], 0 offen sc1
s_waitcnt vmcnt(0)
K1_GO1s:
s_barrier

ds_read_b128 v[16:19], v96 offset:0
ds_read_b128 v[20:23], v96 offset:1024
ds_read_b128 v[24:27], v96 offset:2048
v_fma_f32 v80, -v127, v100, v64
ds_read_b128 v[28:31], v96 offset:3072
v_fma_f32 v81, -v127, v101, v65
ds_read_b64 v[116:117], v99 offset:0
v_fma_f32 v82, -v127, v102, v66
s_add_u32 s13, s64, 1
ds_read_b64 v[118:119], v99 offset:128
v_fma_f32 v83, -v127, v103, v67
s_sub_u32 s1, s13, 17
ds_read_b64 v[120:121], v99 offset:256
v_fma_f32 v84, -v127, v104, v68
s_cselect_b32 s1, s13, s1
ds_read_b64 v[122:123], v99 offset:384
v_fma_f32 v85, -v127, v105, v69
s_mul_i32 s66, s1, 24576
ds_read_b64 v[124:125], v99 offset:512
v_fma_f32 v86, -v127, v106, v70
s_add_u32 s66, s66, s10
v_fma_f32 v87, -v127, v107, v71
s_add_u32 s65, s13, 2
s_waitcnt vmcnt(2)
v_cmp_le_u32 vcc, s65, v6
v_fma_f32 v88, -v127, v108, v72
s_cmp_eq_u64 vcc, -1
v_fma_f32 v89, -v127, v109, v73
v_fma_f32 v90, -v127, v110, v74
s_waitcnt lgkmcnt(5)
v_fma_f32 v91, -v127, v111, v75
s_nop 7
s_branch K1_F0s
K1_W1s:
s_mov_b32 s75, 6
s_cmp_lt_u32 s65, 36
s_cbranch_scc0 K1_W1sR
K1_W1sL:
buffer_load_dword v6, v5, s[36:39], 0 offen sc1
s_waitcnt vmcnt(0)
v_cmp_le_u32 vcc, s65, v6
s_nop 0
s_cmp_eq_u64 vcc, -1
s_cbranch_scc1 K1_W1sR
s_sub_u32 s75, s75, 1
s_cmp_lg_u32 s75, 0
s_cbranch_scc1 K1_W1sL
s_branch K1_W1sR
K1_X0s:
s_sub_u32 s69, s0, s73
s_cmp_lt_u32 s69, 2
s_cbranch_scc0 K1_XB0s
s_cmp_eq_u32 s69, 0
s_cselect_b64 s[96:97], 0, -1
v_mov_b32 v14, 0xf149f2ca
s_and_b64 vcc, s[88:89], s[96:97]
v_cndmask_b32 v164, v14, 0, vcc
s_and_b64 vcc, s[90:91], s[96:97]
v_cndmask_b32 v165, v14, 0, vcc
s_and_b64 vcc, s[92:93], s[96:97]
v_cndmask_b32 v166, v14, 0, vcc
s_and_b64 vcc, s[94:95], s[96:97]
v_cndmask_b32 v167, v14, 0, vcc
K1_XB0s:
s_cmp_eq_u32 s68, 0
s_cbranch_scc1 K1_NR0s
s_branch K1_U1s
K1_NR0s:
buffer_load_dword v6, v5, s[36:39], 0 offen sc1
v_mfma_f32_16x16x32_bf16 v[48:51], v[224:227], v[24:27], v[48:51]
s_and_b32 s67, s64, 7
s_mul_i32 s67, s67, s100
s_add_u32 s67, s67, s11
v_mfma_f32_16x16x32_bf16 v[48:51], v[240:243], v[28:31], v[48:51]
s_mov_b32 s46, s74
s_add_u32 s79, s64, 2
s_mov_b32 s64, s13
v_mfma_f32_16x16x32_bf16 v[52:55], v[196:199], v[16:19], v[52:55]
s_mov_b32 s0, s1
v_mfma_f32_16x16x32_bf16 v[52:55], v[212:215], v[20:23], v[52:55]
v_mfma_f32_16x16x32_bf16 v[52:55], v[228:231], v[24:27], v[52:55]
v_mfma_f32_16x16x32_bf16 v[52:55], v[244:247], v[28:31], v[52:55]
v_mfma_f32_16x16x32_bf16 v[56:59], v[200:203], v[16:19], v[56:59]
v_mfma_f32_16x16x32_bf16 v[56:59], v[216:219], v[20:23], v[56:59]
v_mfma_f32_16x16x32_bf16 v[56:59], v[232:235], v[24:27], v[56:59]
v_mfma_f32_16x16x32_bf16 v[56:59], v[248:251], v[28:31], v[56:59]
v_mfma_f32_16x16x32_bf16 v[60:63], v[204:207], v[16:19], v[60:63]
v_mfma_f32_16x16x32_bf16 v[60:63], v[220:223], v[20:23], v[60:63]
v_mfma_f32_16x16x32_bf16 v[60:63], v[236:239], v[24:27], v[60:63]
v_mfma_f32_16x16x32_bf16 v[60:63], v[252:255], v[28:31], v[60:63]
s_waitcnt vmcnt(0)
buffer_store_dword v8, v7, s[36:39], 0 offen sc1
s_mov_b32 s68, 2
s_cmp_gt_u32 s64, 33
s_cbranch_scc1 K1_EP0s
v_cmp_le_u32 vcc, s65, v6
s_nop 0
s_cmp_eq_u64 vcc, -1
s_cselect_b32 s68, 1, 0
s_cselect_b32 s42, 0x4000000, 0
s_add_u32 s69, s66, 4096
s_add_u32 m0, s72, 28672
s_nop 0
buffer_load_dwordx4 v11, s[40:43], s69 offen offset:1024 sc1 lds
buffer_load_dwordx4 v1, s[40:43], s69 offen offset:0 sc1 lds
s_add_u32 m0, s72, 24576
s_nop 0
buffer_load_dwordx4 v1, s[40:43], s66 offen offset:0 sc1 lds
buffer_load_dwordx4 v1, s[40:43], s66 offen offset:1024 sc1 lds
buffer_load_dwordx4 v1, s[40:43], s66 offen offset:2048 sc1 lds
buffer_load_dwordx4 v1, s[40:43], s66 offen offset:3072 sc1 lds
buffer_load_dword v6, v5, s[36:39], 0 offen sc1
K1_EP0s:
v_fma_f32 v80, -v126, v100, v48
v_fma_f32 v81, -v126, v101, v49
v_fma_f32 v82, -v126, v102, v50
v_fma_f32 v83, -v126, v103, v51
v_fma_f32 v84, -v126, v104, v52
v_fma_f32 v85, -v126, v105, v53
v_fma_f32 v86, -v126, v106, v54
v_fma_f32 v87, -v126, v107, v55
v_fma_f32 v88, -v126, v108, v56
v_fma_f32 v89, -v126, v109, v57
v_fma_f32 v90, -v126, v110, v58
v_fma_f32 v91, -v126, v111, v59
v_fma_f32 v92, -v126, v112, v60
v_fma_f32 v93, -v126, v113, v61
v_fma_f32 v94, -v126, v114, v62
v_fma_f32 v95, -v126, v115, v63
v_mul_f32 v84, v84, v128
v_mul_f32 v85, v85, v128
v_mul_f32 v86, v86, v128
v_mul_f32 v87, v87, v128
v_mul_f32 v88, v88, v128
v_mul_f32 v89, v89, v128
v_mul_f32 v90, v90, v128
v_mul_f32 v91, v91, v128
v_cvt_pk_bf16_f32 v132, v80, v81
v_cvt_pk_bf16_f32 v133, v82, v83
v_cvt_pk_bf16_f32 v134, v92, v93
v_cvt_pk_bf16_f32 v135, v94, v95
v_cvt_pk_bf16_f32 v136, v88, v89
v_cvt_pk_bf16_f32 v137, v90, v91
v_cvt_pk_bf16_f32 v184, v84, v85
v_cvt_pk_bf16_f32 v185, v86, v87
v_cndmask_b32 v186, 0, v136, s[56:57]
v_cndmask_b32 v187, 0, v137, s[56:57]
v_mfma_f32_16x16x32_bf16 v[144:147], v[188:191], v[132:135], v[164:167]
v_mul_f32 v92, v92, v128
v_mfma_f32_16x16x32_bf16 v[140:143], v[184:187], v[132:135], v[168:171]
v_mul_f32 v93, v93, v128
v_mul_f32 v94, v94, v128
v_mul_f32 v95, v95, v128
v_cvt_pk_bf16_f32 v138, v92, v93
v_cvt_pk_bf16_f32 v139, v94, v95
s_nop 1
v_mfma_f32_16x16x32_bf16 v[148:151], v[136:139], v[172:175], 0
v_max_f32 v140, v144, v140
v_max_f32 v141, v145, v141
v_max_f32 v142, v146, v142
v_max_f32 v143, v147, v143
v_max3_f32 v144, v140, v141, v142
v_max_f32 v145, v144, v143
v_max_f32 v144, v144, v143
v_mfma_f32_16x16x32_bf16 v[152:155], v[136:139], v[176:179], v[180:183]
v_cvt_pk_bf16_f32 v156, v148, v149
v_permlane32_swap_b32 v144, v145
v_max_f32 v146, v144, v145
v_max_f32 v147, v144, v145
v_cvt_pk_bf16_f32 v157, v150, v151
s_nop 0
v_permlane16_swap_b32 v146, v147
v_max_f32 v144, v146, v147
v_mul_f32 v144, v144, v130
v_fma_f32 v140, v140, v130, -v144
v_fma_f32 v141, v141, v130, -v144
v_fma_f32 v142, v142, v130, -v144
v_fma_f32 v143, v143, v130, -v144
v_exp_f32 v140, v140
v_exp_f32 v141, v141
v_exp_f32 v142, v142
v_exp_f32 v143, v143
v_cvt_pk_bf16_f32 v144, v140, v141
v_cvt_pk_bf16_f32 v145, v142, v143
v_and_b32 v132, v12, v144
v_and_b32 v133, v13, v145
v_bfi_b32 v134, v12, 0, v144
v_bfi_b32 v135, v13, 0, v145
v_cvt_pk_bf16_f32 v160, v152, v153
v_cvt_pk_bf16_f32 v161, v154, v155
s_nop 1
v_mfma_f32_16x16x32_bf16 v[152:155], v[160:163], v[132:135], 0
v_mfma_f32_16x16x32_bf16 v[148:151], v[156:159], v[132:135], 0
s_nop 6
v_rcp_f32 v144, v153
s_nop 0
v_mul_f32 v148, v148, v144
v_mul_f32 v149, v149, v144
v_mul_f32 v150, v150, v144
v_mul_f32 v151, v151, v144
v_mul_f32 v152, v152, v144
v_cvt_pk_bf16_f32 v140, v148, v149
v_cvt_pk_bf16_f32 v141, v150, v151
v_cvt_pk_bf16_f32 v142, v152, v152
buffer_store_dwordx2 v[140:141], v97, s[44:47], s67 offen sc1
buffer_store_short v142, v98, s[44:47], s67 offen sc1
v_mov_b32 v8, s79
s_mov_b32 s46, 0
s_cmp_eq_u32 s68, 0
s_cbranch_scc1 K1_N20s
s_waitcnt vmcnt(0)
buffer_store_dword v8, v7, s[36:39], 0 offen sc1
s_cmp_eq_u32 s68, 2
s_cbranch_scc1 L_FIN
s_branch K1_GO0s
K1_N20s:
s_waitcnt vmcnt(2)
v_cmp_le_u32 vcc, s65, v6
s_nop 0
s_cmp_eq_u64 vcc, -1
s_cselect_b32 s68, 1, 0
s_cselect_b32 s42, 0x4000000, 0
s_add_u32 s69, s66, 4096
s_add_u32 m0, s72, 28672
s_nop 0
buffer_load_dwordx4 v11, s[40:43], s69 offen offset:1024 sc1 lds
buffer_load_dwordx4 v1, s[40:43], s69 offen offset:0 sc1 lds
s_add_u32 m0, s72, 24576
s_nop 0
buffer_load_dwordx4 v1, s[40:43], s66 offen offset:0 sc1 lds
buffer_load_dwordx4 v1, s[40:43], s66 offen offset:1024 sc1 lds
buffer_load_dwordx4 v1, s[40:43], s66 offen offset:2048 sc1 lds
buffer_load_dwordx4 v1, s[40:43], s66 offen offset:3072 sc1 lds
buffer_load_dword v6, v5, s[36:39], 0 offen sc1
s_waitcnt vmcnt(7)
buffer_store_dword v8, v7, s[36:39], 0 offen sc1
s_waitcnt vmcnt(1)
s_cmp_eq_u32 s68, 1
s_cbranch_scc1 K1_GO0s
K1_SW0s:
s_mov_b32 s75, 0
K1_SP0s:
buffer_load_dword v6, v5, s[36:39], 0 offen sc1
s_add_u32 s75, s75, 1
s_cmp_gt_u32 s75, 0x8000
s_cbranch_scc1 L_TIMEOUT
s_waitcnt vmcnt(0)
v_cmp_le_u32 vcc, s65, v6
s_nop 0
s_cmp_eq_u64 vcc, -1
s_cbranch_scc0 K1_SP0s
s_mov_b32 s42, 0x4000000
s_add_u32 s69, s66, 4096
s_add_u32 m0, s72, 28672
s_nop 0
buffer_load_dwordx4 v11, s[40:43], s69 offen offset:1024 sc1 lds
buffer_load_dwordx4 v1, s[40:43], s69 offen offset:0 sc1 lds
s_add_u32 m0, s72, 24576
s_nop 0
buffer_load_dwordx4 v1, s[40:43], s66 offen offset:0 sc1 lds
buffer_load_dwordx4 v1, s[40:43], s66 offen offset:1024 sc1 lds
buffer_load_dwordx4 v1, s[40:43], s66 offen offset:2048 sc1 lds
buffer_load_dwordx4 v1, s[40:43], s66 offen offset:3072 sc1 lds
buffer_load_dword v6, v5, s[36:39], 0 offen sc1
s_waitcnt vmcnt(0)
K1_GO0s:
s_barrier

ds_read_b128 v[32:35], v96 offset:24576
ds_read_b128 v[36:39], v96 offset:25600
ds_read_b128 v[40:43], v96 offset:26624
v_fma_f32 v80, -v126, v100, v48
ds_read_b128 v[44:47], v96 offset:27648
v_fma_f32 v81, -v126, v101, v49
ds_read_b64 v[116:117], v99 offset:24576
v_fma_f32 v82, -v126, v102, v50
s_add_u32 s13, s64, 1
ds_read_b64 v[118:119], v99 offset:24704
v_fma_f32 v83, -v126, v103, v51
s_sub_u32 s1, s13, 17
ds_read_b64 v[120:121], v99 offset:24832
v_fma_f32 v84, -v126, v104, v52
s_cselect_b32 s1, s13, s1
ds_read_b64 v[122:123], v99 offset:24960
v_fma_f32 v85, -v126, v105, v53
s_mul_i32 s66, s1, 24576
ds_read_b64 v[124:125], v99 offset:25088
v_fma_f32 v86, -v126, v106, v54
s_add_u32 s66, s66, s10
v_fma_f32 v87, -v126, v107, v55
s_add_u32 s65, s13, 2
s_waitcnt vmcnt(2)
v_cmp_le_u32 vcc, s65, v6
v_fma_f32 v88, -v126, v108, v56
s_cmp_eq_u64 vcc, -1
v_fma_f32 v89, -v126, v109, v57
v_fma_f32 v90, -v126, v110, v58
s_waitcnt lgkmcnt(5)
v_fma_f32 v91, -v126, v111, v59
s_nop 7
s_branch K1_F1s
K1_W0s:
s_mov_b32 s75, 6
s_cmp_lt_u32 s65, 36
s_cbranch_scc0 K1_W0sR
K1_W0sL:
buffer_load_dword v6, v5, s[36:39], 0 offen sc1
s_waitcnt vmcnt(0)
v_cmp_le_u32 vcc, s65, v6
s_nop 0
s_cmp_eq_u64 vcc, -1
s_cbranch_scc1 K1_W0sR
s_sub_u32 s75, s75, 1
s_cmp_lg_u32 s75, 0
s_cbranch_scc1 K1_W0sL
s_branch K1_W0sR
.p2align 6
K4_F0s:
v_mfma_f32_16x16x32_bf16 v[72:75], a[0:3], v[16:19], 0
ds_write_b32 v151, v84 offset:27648
v_mfma_f32_16x16x32_bf16 v[72:75], a[24:27], v[20:23], v[72:75]
ds_write_b32 v151, v85 offset:27652
v_mfma_f32_16x16x32_bf16 v[72:75], a[48:51], v[24:27], v[72:75]
buffer_load_dwordx4 v[56:59], v1, s[36:39], s80 offen offset:0 sc1
v_mfma_f32_16x16x32_bf16 v[72:75], a[72:75], v[28:31], v[72:75]
ds_write_b32 v151, v86 offset:28160
v_mfma_f32_16x16x32_bf16 v[76:79], a[4:7], v[16:19], 0
ds_write_b32 v151, v87 offset:28164
v_mfma_f32_16x16x32_bf16 v[76:79], a[28:31], v[20:23], v[76:79]
v_mfma_f32_16x16x32_bf16 v[76:79], a[52:55], v[24:27], v[76:79]
v_mfma_f32_16x16x32_bf16 v[76:79], a[76:79], v[28:31], v[76:79]
buffer_load_dwordx4 v[60:63], v1, s[36:39], s80 offen offset:1024 sc1
v_mfma_f32_16x16x32_bf16 v[80:83], a[8:11], v[16:19], 0
s_waitcnt lgkmcnt(0)
v_mfma_f32_16x16x32_bf16 v[80:83], a[32:35], v[20:23], v[80:83]
s_barrier
K4_B0s:
v_mfma_f32_16x16x32_bf16 v[80:83], a[56:59], v[24:27], v[80:83]
s_add_u32 s13, s64, 1
ds_read2st64_b64 v[104:107], v152 offset0:48 offset1:49
s_cmp_eq_u32 s13, 17
v_mfma_f32_16x16x32_bf16 v[80:83], a[80:83], v[28:31], v[80:83]
s_addc_u32 s13, s13, 0
ds_read2st64_b64 v[108:111], v153 offset0:48 offset1:49
s_sub_u32 s1, s13, 17
v_mfma_f32_16x16x32_bf16 v[84:87], a[12:15], v[16:19], 0
buffer_load_dwordx4 v[64:67], v1, s[36:39], s80 offen offset:2048 sc1
v_mfma_f32_16x16x32_bf16 v[84:87], a[36:39], v[20:23], v[84:87]
s_cselect_b32 s1, s13, s1
ds_read2st64_b64 v[112:115], v154 offset0:48 offset1:49
s_and_b32 s66, s13, 7
v_mfma_f32_16x16x32_bf16 v[84:87], a[60:63], v[24:27], v[84:87]
s_mul_i32 s66, s66, 55296
ds_read2st64_b64 v[116:119], v155 offset0:48 offset1:49
s_add_u32 s66, s66, s10
v_mfma_f32_16x16x32_bf16 v[84:87], a[84:87], v[28:31], v[84:87]
s_add_u32 s65, s13, 2
ds_read2st64_b64 v[120:123], v156 offset0:48 offset1:49
v_mfma_f32_16x16x32_bf16 v[88:91], a[16:19], v[16:19], v[132:135]
ds_read2st64_b64 v[124:127], v157 offset0:48 offset1:49
v_mfma_f32_16x16x32_bf16 v[88:91], a[40:43], v[20:23], v[88:91]
buffer_load_dwordx4 v[68:71], v1, s[36:39], s86 offen offset:3072 sc1
v_mfma_f32_16x16x32_bf16 v[88:91], a[64:67], v[24:27], v[88:91]
s_waitcnt lgkmcnt(4)
v_add_f32 v104, v104, v96
v_add_f32 v105, v105, v97
v_mfma_f32_16x16x32_bf16 v[88:91], a[88:91], v[28:31], v[88:91]
v_add_f32 v106, v106, v98
v_add_f32 v107, v107, v99
v_mfma_f32_16x16x32_bf16 v[92:95], a[20:23], v[16:19], v[136:139]
s_waitcnt vmcnt(7)
v_cmp_le_u32 vcc, s65, v6
v_add_f32 v108, v108, v100
v_mfma_f32_16x16x32_bf16 v[92:95], a[44:47], v[20:23], v[92:95]
s_cmp_eq_u64 vcc, -1
v_add_f32 v109, v109, v101
v_add_f32 v110, v110, v102
v_mfma_f32_16x16x32_bf16 v[92:95], a[68:71], v[24:27], v[92:95]
s_cbranch_scc0 K4_W0s
K4_W0sR:
s_cselect_b32 s68, 1, 0
v_mfma_f32_16x16x32_bf16 v[92:95], a[92:95], v[28:31], v[92:95]
s_waitcnt vmcnt(9)
s_cselect_b32 s42, 0x4000000, 0
v_add_f32 v111, v111, v103
v_mfma_f32_16x16x32_bf16 v[72:75], a[96:99], v[32:35], v[72:75]
buffer_load_dwordx4 v[16:19], v1, s[40:43], s66 offen offset:0 sc1
v_mfma_f32_16x16x32_bf16 v[72:75], a[120:123], v[36:39], v[72:75]
s_mul_i32 s71, s1, 24576
s_add_u32 s71, s71, s12
s_waitcnt vmcnt(9)
v_mfma_f32_16x16x32_bf16 v[72:75], a[144:147], v[40:43], v[72:75]
buffer_store_dword v8, v7, s[36:39], 0 offen sc1
v_mfma_f32_16x16x32_bf16 v[76:79], a[100:103], v[32:35], v[76:79]
buffer_load_dwordx4 v[128:131], v150, s[40:43], s71 offen sc1
v_mfma_f32_16x16x32_bf16 v[76:79], a[124:127], v[36:39], v[76:79]
s_add_u32 s80, s66, 10240
s_add_u32 s86, s80, s84
v_add_u32 v8, s79, v11
v_mfma_f32_16x16x32_bf16 v[76:79], a[148:151], v[40:43], v[76:79]
s_waitcnt lgkmcnt(0)
v_add_f32 v112, v112, v120
v_add_f32 v113, v113, v121
v_mfma_f32_16x16x32_bf16 v[80:83], a[104:107], v[32:35], v[80:83]
buffer_load_dwordx4 v[20:23], v1, s[40:43], s66 offen offset:1024 sc1
v_mfma_f32_16x16x32_bf16 v[80:83], a[128:131], v[36:39], v[80:83]
v_add_f32 v114, v114, v122
v_add_f32 v115, v115, v123
v_mfma_f32_16x16x32_bf16 v[80:83], a[152:155], v[40:43], v[80:83]
v_add_f32 v116, v116, v124
v_add_f32 v117, v117, v125
v_mfma_f32_16x16x32_bf16 v[84:87], a[108:111], v[32:35], v[84:87]
v_add_f32 v118, v118, v126
v_add_f32 v119, v119, v127
v_mfma_f32_16x16x32_bf16 v[84:87], a[132:135], v[36:39], v[84:87]
v_add_f32 v104, v104, v112
v_add_f32 v105, v105, v113
v_mfma_f32_16x16x32_bf16 v[84:87], a[156:159], v[40:43], v[84:87]
v_add_f32 v106, v106, v114
v_add_f32 v107, v107, v115
v_mfma_f32_16x16x32_bf16 v[88:91], a[112:115], v[32:35], v[88:91]
buffer_load_dwordx4 v[24:27], v1, s[40:43], s66 offen offset:2048 sc1
v_mfma_f32_16x16x32_bf16 v[88:91], a[136:139], v[36:39], v[88:91]
v_add_f32 v108, v108, v116
v_add_f32 v109, v109, v117
v_mfma_f32_16x16x32_bf16 v[88:91], a[160:163], v[40:43], v[88:91]
v_add_f32 v110, v110, v118
v_add_f32 v111, v111, v119
v_mfma_f32_16x16x32_bf16 v[92:95], a[116:119], v[32:35], v[92:95]
v_cvt_pk_bf16_f32 v140, v104, v105
v_cvt_pk_bf16_f32 v141, v106, v107
v_mfma_f32_16x16x32_bf16 v[92:95], a[140:143], v[36:39], v[92:95]
v_cvt_pk_bf16_f32 v142, v108, v109
v_cvt_pk_bf16_f32 v143, v110, v111
v_mfma_f32_16x16x32_bf16 v[92:95], a[164:167], v[40:43], v[92:95]
s_waitcnt vmcnt(9)
v_mfma_f32_16x16x32_bf16 v[72:75], a[168:171], v[44:47], v[72:75]
buffer_load_dwordx4 v[28:31], v1, s[40:43], s66 offen offset:3072 sc1
v_mfma_f32_16x16x32_bf16 v[72:75], a[192:195], v[48:51], v[72:75]
buffer_store_dwordx4 v[140:143], v148, s[44:47], s67 offen sc1
v_mfma_f32_16x16x32_bf16 v[72:75], a[216:219], v[52:55], v[72:75]
s_add_u32 s69, s66, 4096
v_add_f32 v144, v104, v105
v_mul_f32 v145, v104, v104
v_mfma_f32_16x16x32_bf16 v[76:79], a[172:175], v[44:47], v[76:79]
v_fmac_f32 v145, v105, v105
v_fmac_f32 v145, v106, v106
v_mfma_f32_16x16x32_bf16 v[76:79], a[196:199], v[48:51], v[76:79]
buffer_load_dwordx4 v[32:35], v1, s[40:43], s69 offen offset:0 sc1
v_mfma_f32_16x16x32_bf16 v[76:79], a[220:223], v[52:55], v[76:79]
v_add_f32 v144, v144, v106
v_fmac_f32 v145, v107, v107
v_mfma_f32_16x16x32_bf16 v[80:83], a[176:179], v[44:47], v[80:83]
v_add_f32 v144, v144, v107
v_fmac_f32 v145, v108, v108
v_mfma_f32_16x16x32_bf16 v[80:83], a[200:203], v[48:51], v[80:83]
v_add_f32 v144, v144, v108
v_fmac_f32 v145, v109, v109
v_mfma_f32_16x16x32_bf16 v[80:83], a[224:227], v[52:55], v[80:83]
v_add_f32 v144, v144, v109
v_fmac_f32 v145, v110, v110
v_mfma_f32_16x16x32_bf16 v[84:87], a[180:183], v[44:47], v[84:87]
buffer_load_dwordx4 v[36:39], v1, s[40:43], s69 offen offset:1024 sc1
v_mfma_f32_16x16x32_bf16 v[84:87], a[204:207], v[48:51], v[84:87]
s_waitcnt vmcnt(6)
v_add_f32 v144, v144, v110
v_fmac_f32 v145, v111, v111
v_mfma_f32_16x16x32_bf16 v[84:87], a[228:231], v[52:55], v[84:87]
v_add_f32 v144, v144, v111
v_lshlrev_b32 v132, 16, v128
v_mfma_f32_16x16x32_bf16 v[88:91], a[184:187], v[44:47], v[88:91]
v_permlane32_swap_b32 v144, v145
v_mfma_f32_16x16x32_bf16 v[88:91], a[208:211], v[48:51], v[88:91]
v_add_f32 v146, v144, v145
v_add_f32 v147, v144, v145
v_mfma_f32_16x16x32_bf16 v[88:91], a[232:235], v[52:55], v[88:91]
buffer_load_dwordx4 v[40:43], v1, s[40:43], s69 offen offset:2048 sc1
v_mfma_f32_16x16x32_bf16 v[92:95], a[188:191], v[44:47], v[92:95]
v_permlane16_swap_b32 v146, v147
v_mfma_f32_16x16x32_bf16 v[92:95], a[212:215], v[48:51], v[92:95]
v_add_f32 v144, v146, v147
v_fma_f32 v144, v144, s76, v168
v_mfma_f32_16x16x32_bf16 v[92:95], a[236:239], v[52:55], v[92:95]
s_waitcnt vmcnt(10)
v_and_b32 v133, 0xffff0000, v128
v_lshlrev_b32 v134, 16, v129
v_mfma_f32_16x16x32_bf16 v[72:75], a[240:243], v[56:59], v[72:75]
buffer_store_dword v144, v149, s[60:63], s67 offen sc1
v_mfma_f32_16x16x32_bf16 v[72:75], v[196:199], v[60:63], v[72:75]
buffer_load_dword v6, v5, s[36:39], 0 offen sc1
v_mfma_f32_16x16x32_bf16 v[72:75], v[220:223], v[64:67], v[72:75]
buffer_load_dwordx4 v[44:47], v1, s[40:43], s69 offen offset:3072 sc1
v_mfma_f32_16x16x32_bf16 v[72:75], v[244:247], v[68:71], v[72:75]
s_add_u32 s69, s66, 8192
v_and_b32 v135, 0xffff0000, v129
v_lshlrev_b32 v136, 16, v130
v_mfma_f32_16x16x32_bf16 v[76:79], a[244:247], v[56:59], v[76:79]
buffer_load_dwordx4 v[48:51], v1, s[40:43], s69 offen offset:0 sc1
v_mfma_f32_16x16x32_bf16 v[76:79], v[200:203], v[60:63], v[76:79]
s_mul_i32 s67, s0, s100
v_and_b32 v137, 0xffff0000, v130
v_lshlrev_b32 v138, 16, v131
v_mfma_f32_16x16x32_bf16 v[76:79], v[224:227], v[64:67], v[76:79]
s_add_u32 s67, s67, s11
ds_write_b32 v151, v72 offset:0
v_mfma_f32_16x16x32_bf16 v[76:79], v[248:251], v[68:71], v[76:79]
s_mov_b32 s46, s74
ds_write_b32 v151, v73 offset:4
v_mfma_f32_16x16x32_bf16 v[80:83], a[248:251], v[56:59], v[80:83]
s_add_u32 s79, s64, 19
ds_write_b32 v151, v74 offset:512
v_mfma_f32_16x16x32_bf16 v[80:83], v[204:207], v[60:63], v[80:83]
s_mov_b32 s62, s81
ds_write_b32 v151, v75 offset:516
v_mfma_f32_16x16x32_bf16 v[80:83], v[228:231], v[64:67], v[80:83]
s_mov_b32 s64, s13
ds_write_b32 v151, v76 offset:1024
v_mfma_f32_16x16x32_bf16 v[80:83], v[252:255], v[68:71], v[80:83]
s_mov_b32 s0, s1
ds_write_b32 v151, v77 offset:1028
v_mfma_f32_16x16x32_bf16 v[84:87], a[252:255], v[56:59], v[84:87]
buffer_load_dwordx4 v[52:55], v1, s[40:43], s69 offen offset:1024 sc1
v_mfma_f32_16x16x32_bf16 v[84:87], v[208:211], v[60:63], v[84:87]
s_cmp_eq_u32 s64, 19
ds_write_b32 v151, v78 offset:1536
v_mfma_f32_16x16x32_bf16 v[84:87], v[232:235], v[64:67], v[84:87]
s_cselect_b32 s69, 0, s68
ds_write_b32 v151, v79 offset:1540
v_mfma_f32_16x16x32_bf16 v[88:91], v[188:191], v[56:59], v[88:91]
s_cmp_eq_u32 s69, 0
ds_write_b32 v151, v80 offset:2048
v_mfma_f32_16x16x32_bf16 v[88:91], v[212:215], v[60:63], v[88:91]
ds_write_b32 v151, v81 offset:2052
v_mfma_f32_16x16x32_bf16 v[88:91], v[236:239], v[64:67], v[88:91]
ds_write_b32 v151, v82 offset:2560
v_mfma_f32_16x16x32_bf16 v[92:95], v[192:195], v[56:59], v[92:95]
ds_write_b32 v151, v83 offset:2564
v_mfma_f32_16x16x32_bf16 v[92:95], v[216:219], v[60:63], v[92:95]
s_waitcnt vmcnt(9)
v_and_b32 v139, 0xffff0000, v131
v_mfma_f32_16x16x32_bf16 v[92:95], v[240:243], v[64:67], v[92:95]
s_cbranch_scc1 K4_X0s
K4_F1s:
v_mfma_f32_16x16x32_bf16 v[72:75], a[0:3], v[16:19], 0
ds_write_b32 v151, v84 offset:3072
v_mfma_f32_16x16x32_bf16 v[72:75], a[24:27], v[20:23], v[72:75]
ds_write_b32 v151, v85 offset:3076
v_mfma_f32_16x16x32_bf16 v[72:75], a[48:51], v[24:27], v[72:75]
buffer_load_dwordx4 v[56:59], v1, s[36:39], s80 offen offset:0 sc1
v_mfma_f32_16x16x32_bf16 v[72:75], a[72:75], v[28:31], v[72:75]
ds_write_b32 v151, v86 offset:3584
v_mfma_f32_16x16x32_bf16 v[76:79], a[4:7], v[16:19], 0
ds_write_b32 v151, v87 offset:3588
v_mfma_f32_16x16x32_bf16 v[76:79], a[28:31], v[20:23], v[76:79]
v_mfma_f32_16x16x32_bf16 v[76:79], a[52:55], v[24:27], v[76:79]
v_mfma_f32_16x16x32_bf16 v[76:79], a[76:79], v[28:31], v[76:79]
buffer_load_dwordx4 v[60:63], v1, s[36:39], s80 offen offset:1024 sc1
v_mfma_f32_16x16x32_bf16 v[80:83], a[8:11], v[16:19], 0
s_waitcnt lgkmcnt(0)
v_mfma_f32_16x16x32_bf16 v[80:83], a[32:35], v[20:23], v[80:83]
s_barrier
K4_B1s:
v_mfma_f32_16x16x32_bf16 v[80:83], a[56:59], v[24:27], v[80:83]
s_add_u32 s13, s64, 1
ds_read2st64_b64 v[104:107], v152 offset0:0 offset1:1
s_cmp_eq_u32 s13, 17
v_mfma_f32_16x16x32_bf16 v[80:83], a[80:83], v[28:31], v[80:83]
s_addc_u32 s13, s13, 0
ds_read2st64_b64 v[108:111], v153 offset0:0 offset1:1
s_sub_u32 s1, s13, 17
v_mfma_f32_16x16x32_bf16 v[84:87], a[12:15], v[16:19], 0
buffer_load_dwordx4 v[64:67], v1, s[36:39], s80 offen offset:2048 sc1
v_mfma_f32_16x16x32_bf16 v[84:87], a[36:39], v[20:23], v[84:87]
s_cselect_b32 s1, s13, s1
ds_read2st64_b64 v[112:115], v154 offset0:0 offset1:1
s_and_b32 s66, s13, 7
v_mfma_f32_16x16x32_bf16 v[84:87], a[60:63], v[24:27], v[84:87]
s_mul_i32 s66, s66, 55296
ds_read2st64_b64 v[116:119], v155 offset0:0 offset1:1
s_add_u32 s66, s66, s10
v_mfma_f32_16x16x32_bf16 v[84:87], a[84:87], v[28:31], v[84:87]
s_add_u32 s65, s13, 2
ds_read2st64_b64 v[120:123], v156 offset0:0 offset1:1
v_mfma_f32_16x16x32_bf16 v[96:99], a[16:19], v[16:19], v[132:135]
ds_read2st64_b64 v[124:127], v157 offset0:0 offset1:1
v_mfma_f32_16x16x32_bf16 v[96:99], a[40:43], v[20:23], v[96:99]
buffer_load_dwordx4 v[68:71], v1, s[36:39], s86 offen offset:3072 sc1
v_mfma_f32_16x16x32_bf16 v[96:99], a[64:67], v[24:27], v[96:99]
s_waitcnt lgkmcnt(4)
v_add_f32 v104, v104, v88
v_add_f32 v105, v105, v89
v_mfma_f32_16x16x32_bf16 v[96:99], a[88:91], v[28:31], v[96:99]
v_add_f32 v106, v106, v90
v_add_f32 v107, v107, v91
v_mfma_f32_16x16x32_bf16 v[100:103], a[20:23], v[16:19], v[136:139]
s_waitcnt vmcnt(7)
v_cmp_le_u32 vcc, s65, v6
v_add_f32 v108, v108, v92
v_mfma_f32_16x16x32_bf16 v[100:103], a[44:47], v[20:23], v[100:103]
s_cmp_eq_u64 vcc, -1
v_add_f32 v109, v109, v93
v_add_f32 v110, v110, v94
v_mfma_f32_16x16x32_bf16 v[100:103], a[68:71], v[24:27], v[100:103]
s_cbranch_scc0 K4_W1s
K4_W1sR:
s_cselect_b32 s68, 1, 0
v_mfma_f32_16x16x32_bf16 v[100:103], a[92:95], v[28:31], v[100:103]
s_waitcnt vmcnt(9)
s_cselect_b32 s42, 0x4000000, 0
v_add_f32 v111, v111, v95
v_mfma_f32_16x16x32_bf16 v[72:75], a[96:99], v[32:35], v[72:75]
buffer_load_dwordx4 v[16:19], v1, s[40:43], s66 offen offset:0 sc1
v_mfma_f32_16x16x32_bf16 v[72:75], a[120:123], v[36:39], v[72:75]
s_mul_i32 s71, s1, 24576
s_add_u32 s71, s71, s12
s_waitcnt vmcnt(9)
v_mfma_f32_16x16x32_bf16 v[72:75], a[144:147], v[40:43], v[72:75]
buffer_store_dword v8, v7, s[36:39], 0 offen sc1
v_mfma_f32_16x16x32_bf16 v[76:79], a[100:103], v[32:35], v[76:79]
buffer_load_dwordx4 v[128:131], v150, s[40:43], s71 offen sc1
v_mfma_f32_16x16x32_bf16 v[76:79], a[124:127], v[36:39], v[76:79]
s_add_u32 s80, s66, 10240
s_add_u32 s86, s80, s84
v_add_u32 v8, s79, v11
v_mfma_f32_16x16x32_bf16 v[76:79], a[148:151], v[40:43], v[76:79]
s_waitcnt lgkmcnt(0)
v_add_f32 v112, v112, v120
v_add_f32 v113, v113, v121
v_mfma_f32_16x16x32_bf16 v[80:83], a[104:107], v[32:35], v[80:83]
buffer_load_dwordx4 v[20:23], v1, s[40:43], s66 offen offset:1024 sc1
v_mfma_f32_16x16x32_bf16 v[80:83], a[128:131], v[36:39], v[80:83]
v_add_f32 v114, v114, v122
v_add_f32 v115, v115, v123
v_mfma_f32_16x16x32_bf16 v[80:83], a[152:155], v[40:43], v[80:83]
v_add_f32 v116, v116, v124
v_add_f32 v117, v117, v125
v_mfma_f32_16x16x32_bf16 v[84:87], a[108:111], v[32:35], v[84:87]
v_add_f32 v118, v118, v126
v_add_f32 v119, v119, v127
v_mfma_f32_16x16x32_bf16 v[84:87], a[132:135], v[36:39], v[84:87]
v_add_f32 v104, v104, v112
v_add_f32 v105, v105, v113
v_mfma_f32_16x16x32_bf16 v[84:87], a[156:159], v[40:43], v[84:87]
v_add_f32 v106, v106, v114
v_add_f32 v107, v107, v115
v_mfma_f32_16x16x32_bf16 v[96:99], a[112:115], v[32:35], v[96:99]
buffer_load_dwordx4 v[24:27], v1, s[40:43], s66 offen offset:2048 sc1
v_mfma_f32_16x16x32_bf16 v[96:99], a[136:139], v[36:39], v[96:99]
v_add_f32 v108, v108, v116
v_add_f32 v109, v109, v117
v_mfma_f32_16x16x32_bf16 v[96:99], a[160:163], v[40:43], v[96:99]
v_add_f32 v110, v110, v118
v_add_f32 v111, v111, v119
v_mfma_f32_16x16x32_bf16 v[100:103], a[116:119], v[32:35], v[100:103]
v_cvt_pk_bf16_f32 v140, v104, v105
v_cvt_pk_bf16_f32 v141, v106, v107
v_mfma_f32_16x16x32_bf16 v[100:103], a[140:143], v[36:39], v[100:103]
v_cvt_pk_bf16_f32 v142, v108, v109
v_cvt_pk_bf16_f32 v143, v110, v111
v_mfma_f32_16x16x32_bf16 v[100:103], a[164:167], v[40:43], v[100:103]
s_waitcnt vmcnt(9)
v_mfma_f32_16x16x32_bf16 v[72:75], a[168:171], v[44:47], v[72:75]
buffer_load_dwordx4 v[28:31], v1, s[40:43], s66 offen offset:3072 sc1
v_mfma_f32_16x16x32_bf16 v[72:75], a[192:195], v[48:51], v[72:75]
buffer_store_dwordx4 v[140:143], v148, s[44:47], s67 offen sc1
v_mfma_f32_16x16x32_bf16 v[72:75], a[216:219], v[52:55], v[72:75]
s_add_u32 s69, s66, 4096
v_add_f32 v144, v104, v105
v_mul_f32 v145, v104, v104
v_mfma_f32_16x16x32_bf16 v[76:79], a[172:175], v[44:47], v[76:79]
v_fmac_f32 v145, v105, v105
v_fmac_f32 v145, v106, v106
v_mfma_f32_16x16x32_bf16 v[76:79], a[196:199], v[48:51], v[76:79]
buffer_load_dwordx4 v[32:35], v1, s[40:43], s69 offen offset:0 sc1
v_mfma_f32_16x16x32_bf16 v[76:79], a[220:223], v[52:55], v[76:79]
v_add_f32 v144, v144, v106
v_fmac_f32 v145, v107, v107
v_mfma_f32_16x16x32_bf16 v[80:83], a[176:179], v[44:47], v[80:83]
v_add_f32 v144, v144, v107
v_fmac_f32 v145, v108, v108
v_mfma_f32_16x16x32_bf16 v[80:83], a[200:203], v[48:51], v[80:83]
v_add_f32 v144, v144, v108
v_fmac_f32 v145, v109, v109
v_mfma_f32_16x16x32_bf16 v[80:83], a[224:227], v[52:55], v[80:83]
v_add_f32 v144, v144, v109
v_fmac_f32 v145, v110, v110
v_mfma_f32_16x16x32_bf16 v[84:87], a[180:183], v[44:47], v[84:87]
buffer_load_dwordx4 v[36:39], v1, s[40:43], s69 offen offset:1024 sc1
v_mfma_f32_16x16x32_bf16 v[84:87], a[204:207], v[48:51], v[84:87]
s_waitcnt vmcnt(6)
v_add_f32 v144, v144, v110
v_fmac_f32 v145, v111, v111
v_mfma_f32_16x16x32_bf16 v[84:87], a[228:231], v[52:55], v[84:87]
v_add_f32 v144, v144, v111
v_lshlrev_b32 v132, 16, v128
v_mfma_f32_16x16x32_bf16 v[96:99], a[184:187], v[44:47], v[96:99]
v_permlane32_swap_b32 v144, v145
v_mfma_f32_16x16x32_bf16 v[96:99], a[208:211], v[48:51], v[96:99]
v_add_f32 v146, v144, v145
v_add_f32 v147, v144, v145
v_mfma_f32_16x16x32_bf16 v[96:99], a[232:235], v[52:55], v[96:99]
buffer_load_dwordx4 v[40:43], v1, s[40:43], s69 offen offset:2048 sc1
v_mfma_f32_16x16x32_bf16 v[100:103], a[188:191], v[44:47], v[100:103]
v_permlane16_swap_b32 v146, v147
v_mfma_f32_16x16x32_bf16 v[100:103], a[212:215], v[48:51], v[100:103]
v_add_f32 v144, v146, v147
v_fma_f32 v144, v144, s76, v168
v_mfma_f32_16x16x32_bf16 v[100:103], a[236:239], v[52:55], v[100:103]
s_waitcnt vmcnt(10)
v_and_b32 v133, 0xffff0000, v128
v_lshlrev_b32 v134, 16, v129
v_mfma_f32_16x16x32_bf16 v[72:75], a[240:243], v[56:59], v[72:75]
buffer_store_dword v144, v149, s[60:63], s67 offen sc1
v_mfma_f32_16x16x32_bf16 v[72:75], v[196:199], v[60:63], v[72:75]
buffer_load_dword v6, v5, s[36:39], 0 offen sc1
v_mfma_f32_16x16x32_bf16 v[72:75], v[220:223], v[64:67], v[72:75]
buffer_load_dwordx4 v[44:47], v1, s[40:43], s69 offen offset:3072 sc1
v_mfma_f32_16x16x32_bf16 v[72:75], v[244:247], v[68:71], v[72:75]
s_add_u32 s69, s66, 8192
v_and_b32 v135, 0xffff0000, v129
v_lshlrev_b32 v136, 16, v130
v_mfma_f32_16x16x32_bf16 v[76:79], a[244:247], v[56:59], v[76:79]
buffer_load_dwordx4 v[48:51], v1, s[40:43], s69 offen offset:0 sc1
v_mfma_f32_16x16x32_bf16 v[76:79], v[200:203], v[60:63], v[76:79]
s_mul_i32 s67, s0, s100
v_and_b32 v137, 0xffff0000, v130
v_lshlrev_b32 v138, 16, v131
v_mfma_f32_16x16x32_bf16 v[76:79], v[224:227], v[64:67], v[76:79]
s_add_u32 s67, s67, s11
ds_write_b32 v151, v72 offset:24576
v_mfma_f32_16x16x32_bf16 v[76:79], v[248:251], v[68:71], v[76:79]
s_mov_b32 s46, s74
ds_write_b32 v151, v73 offset:24580
v_mfma_f32_16x16x32_bf16 v[80:83], a[248:251], v[56:59], v[80:83]
s_add_u32 s79, s64, 19
ds_write_b32 v151, v74 offset:25088
v_mfma_f32_16x16x32_bf16 v[80:83], v[204:207], v[60:63], v[80:83]
s_mov_b32 s62, s81
ds_write_b32 v151, v75 offset:25092
v_mfma_f32_16x16x32_bf16 v[80:83], v[228:231], v[64:67], v[80:83]
s_mov_b32 s64, s13
ds_write_b32 v151, v76 offset:25600
v_mfma_f32_16x16x32_bf16 v[80:83], v[252:255], v[68:71], v[80:83]
s_mov_b32 s0, s1
ds_write_b32 v151, v77 offset:25604
v_mfma_f32_16x16x32_bf16 v[84:87], a[252:255], v[56:59], v[84:87]
buffer_load_dwordx4 v[52:55], v1, s[40:43], s69 offen offset:1024 sc1
v_mfma_f32_16x16x32_bf16 v[84:87], v[208:211], v[60:63], v[84:87]
s_cmp_eq_u32 s64, 19
ds_write_b32 v151, v78 offset:26112
v_mfma_f32_16x16x32_bf16 v[84:87], v[232:235], v[64:67], v[84:87]
s_cselect_b32 s69, 0, s68
ds_write_b32 v151, v79 offset:26116
v_mfma_f32_16x16x32_bf16 v[96:99], v[188:191], v[56:59], v[96:99]
s_cmp_eq_u32 s69, 0
ds_write_b32 v151, v80 offset:26624
v_mfma_f32_16x16x32_bf16 v[96:99], v[212:215], v[60:63], v[96:99]
ds_write_b32 v151, v81 offset:26628
v_mfma_f32_16x16x32_bf16 v[96:99], v[236:239], v[64:67], v[96:99]
ds_write_b32 v151, v82 offset:27136
v_mfma_f32_16x16x32_bf16 v[100:103], v[192:195], v[56:59], v[100:103]
ds_write_b32 v151, v83 offset:27140
v_mfma_f32_16x16x32_bf16 v[100:103], v[216:219], v[60:63], v[100:103]
s_waitcnt vmcnt(9)
v_and_b32 v139, 0xffff0000, v131
v_mfma_f32_16x16x32_bf16 v[100:103], v[240:243], v[64:67], v[100:103]
s_cbranch_scc1 K4_X1s
s_branch K4_F0s
K4_X0s:
s_cmp_lg_u32 s64, 19
s_cbranch_scc1 K4_NR0s
s_mov_b32 s44, s30
s_mov_b32 s45, s31
s_mov_b32 s74, 2621440
s_mov_b32 s46, s74
s_mov_b32 s81, 0
s_mov_b32 s62, 0
s_mov_b32 s100, 40960
s_mov_b32 s11, 4294926336
s_mov_b32 s67, 0
v_mov_b32 v148, v158
s_waitcnt vmcnt(0)
buffer_store_dword v8, v7, s[36:39], 0 offen sc1
s_mov_b32 s7, 0x7ff00000
s_nop 1
v_writelane_b32 v7, s7, 0
s_cmp_eq_u32 s68, 1
s_cbranch_scc1 K4_F1s
s_branch K4_NR0s
K4_NR0s:
s_cmp_gt_u32 s64, 33
s_cbranch_scc1 K4_E0s
buffer_load_dword v6, v5, s[36:39], 0 offen sc1
ds_write_b32 v151, v84 offset:3072
ds_write_b32 v151, v85 offset:3076
ds_write_b32 v151, v86 offset:3584
ds_write_b32 v151, v87 offset:3588
s_waitcnt lgkmcnt(0)
s_barrier
ds_read2st64_b64 v[104:107], v152 offset0:0 offset1:1
ds_read2st64_b64 v[108:111], v153 offset0:0 offset1:1
ds_read2st64_b64 v[112:115], v154 offset0:0 offset1:1
ds_read2st64_b64 v[116:119], v155 offset0:0 offset1:1
ds_read2st64_b64 v[120:123], v156 offset0:0 offset1:1
ds_read2st64_b64 v[124:127], v157 offset0:0 offset1:1
s_waitcnt vmcnt(0)
buffer_store_dword v8, v7, s[36:39], 0 offen sc1
v_cmp_le_u32 vcc, s65, v6
s_nop 0
s_cmp_eq_u64 vcc, -1
s_cselect_b32 s68, 1, 0
s_cselect_b32 s42, 0x4000000, 0
buffer_load_dwordx4 v[16:19], v1, s[40:43], s66 offen offset:0 sc1
s_mul_i32 s71, s1, 24576
s_add_u32 s71, s71, s12
buffer_load_dwordx4 v[128:131], v150, s[40:43], s71 offen sc1
s_add_u32 s80, s66, 10240
s_add_u32 s86, s80, s84
buffer_load_dwordx4 v[20:23], v1, s[40:43], s66 offen offset:1024 sc1
buffer_load_dwordx4 v[24:27], v1, s[40:43], s66 offen offset:2048 sc1
buffer_load_dwordx4 v[28:31], v1, s[40:43], s66 offen offset:3072 sc1
s_add_u32 s69, s66, 4096
buffer_load_dwordx4 v[32:35], v1, s[40:43], s69 offen offset:0 sc1
buffer_load_dwordx4 v[36:39], v1, s[40:43], s69 offen offset:1024 sc1
buffer_load_dwordx4 v[40:43], v1, s[40:43], s69 offen offset:2048 sc1
buffer_load_dwordx4 v[44:47], v1, s[40:43], s69 offen offset:3072 sc1
s_add_u32 s69, s66, 8192
buffer_load_dwordx4 v[48:51], v1, s[40:43], s69 offen offset:0 sc1
buffer_load_dwordx4 v[52:55], v1, s[40:43], s69 offen offset:1024 sc1
buffer_load_dword v6, v5, s[36:39], 0 offen sc1
s_waitcnt lgkmcnt(4)
v_add_f32 v104, v104, v88
v_add_f32 v105, v105, v89
v_add_f32 v106, v106, v90
v_add_f32 v107, v107, v91
v_add_f32 v108, v108, v92
v_add_f32 v109, v109, v93
v_add_f32 v110, v110, v94
v_add_f32 v111, v111, v95
s_waitcnt lgkmcnt(0)
v_add_f32 v112, v112, v120
v_add_f32 v113, v113, v121
v_add_f32 v114, v114, v122
v_add_f32 v115, v115, v123
v_add_f32 v116, v116, v124
v_add_f32 v117, v117, v125
v_add_f32 v118, v118, v126
v_add_f32 v119, v119, v127
v_add_f32 v104, v104, v112
v_add_f32 v105, v105, v113
v_add_f32 v106, v106, v114
v_add_f32 v107, v107, v115
v_add_f32 v108, v108, v116
v_add_f32 v109, v109, v117
v_add_f32 v110, v110, v118
v_add_f32 v111, v111, v119
v_cvt_pk_bf16_f32 v140, v104, v105
v_cvt_pk_bf16_f32 v141, v106, v107
v_cvt_pk_bf16_f32 v142, v108, v109
v_cvt_pk_bf16_f32 v143, v110, v111
buffer_store_dwordx4 v[140:143], v148, s[44:47], s67 offen sc1
v_add_f32 v144, v104, v105
v_mul_f32 v145, v104, v104
v_fmac_f32 v145, v105, v105
v_fmac_f32 v145, v106, v106
v_add_f32 v144, v144, v106
v_fmac_f32 v145, v107, v107
v_add_f32 v144, v144, v107
v_fmac_f32 v145, v108, v108
v_add_f32 v144, v144, v108
v_fmac_f32 v145, v109, v109
v_add_f32 v144, v144, v109
v_fmac_f32 v145, v110, v110
v_add_f32 v144, v144, v110
v_fmac_f32 v145, v111, v111
v_add_f32 v144, v144, v111
s_nop 1
v_permlane32_swap_b32 v144, v145
v_add_f32 v146, v144, v145
v_add_f32 v147, v144, v145
s_nop 1
v_permlane16_swap_b32 v146, v147
v_add_f32 v144, v146, v147
v_fma_f32 v144, v144, s76, v168
buffer_store_dword v144, v149, s[60:63], s67 offen sc1
v_add_u32 v8, s79, v11
s_mov_b32 s46, 0
s_mov_b32 s62, 0
s_cmp_eq_u32 s68, 0
s_cbranch_scc1 K4_N20s
s_waitcnt vmcnt(0)
buffer_store_dword v8, v7, s[36:39], 0 offen sc1
s_branch K4_G1s
K4_N20s:
s_waitcnt vmcnt(2)
v_cmp_le_u32 vcc, s65, v6
s_nop 0
s_cmp_eq_u64 vcc, -1
s_cselect_b32 s68, 1, 0
s_cselect_b32 s42, 0x4000000, 0
buffer_load_dwordx4 v[16:19], v1, s[40:43], s66 offen offset:0 sc1
s_mul_i32 s71, s1, 24576
s_add_u32 s71, s71, s12
buffer_load_dwordx4 v[128:131], v150, s[40:43], s71 offen sc1
s_add_u32 s80, s66, 10240
s_add_u32 s86, s80, s84
buffer_load_dwordx4 v[20:23], v1, s[40:43], s66 offen offset:1024 sc1
buffer_load_dwordx4 v[24:27], v1, s[40:43], s66 offen offset:2048 sc1
buffer_load_dwordx4 v[28:31], v1, s[40:43], s66 offen offset:3072 sc1
s_add_u32 s69, s66, 4096
buffer_load_dwordx4 v[32:35], v1, s[40:43], s69 offen offset:0 sc1
buffer_load_dwordx4 v[36:39], v1, s[40:43], s69 offen offset:1024 sc1
buffer_load_dwordx4 v[40:43], v1, s[40:43], s69 offen offset:2048 sc1
buffer_load_dwordx4 v[44:47], v1, s[40:43], s69 offen offset:3072 sc1
s_add_u32 s69, s66, 8192
buffer_load_dwordx4 v[48:51], v1, s[40:43], s69 offen offset:0 sc1
buffer_load_dwordx4 v[52:55], v1, s[40:43], s69 offen offset:1024 sc1
buffer_load_dword v6, v5, s[36:39], 0 offen sc1
s_waitcnt vmcnt(12)
buffer_store_dword v8, v7, s[36:39], 0 offen sc1
s_waitcnt vmcnt(1)
s_cmp_eq_u32 s68, 1
s_cbranch_scc1 K4_G1s
s_cmp_gt_u32 s64, 33
s_cbranch_scc1 L_FIN
K4_SW0s:
s_mov_b32 s75, 0
K4_SP0s:
buffer_load_dword v6, v5, s[36:39], 0 offen sc1
s_add_u32 s75, s75, 1
s_cmp_gt_u32 s75, 0x8000
s_cbranch_scc1 L_TIMEOUT
s_waitcnt vmcnt(0)
v_cmp_le_u32 vcc, s65, v6
s_nop 0
s_cmp_eq_u64 vcc, -1
s_cbranch_scc0 K4_SP0s
K4_LC0s:
s_mov_b32 s42, 0x4000000
buffer_load_dwordx4 v[16:19], v1, s[40:43], s66 offen offset:0 sc1
s_mul_i32 s71, s1, 24576
s_add_u32 s71, s71, s12
buffer_load_dwordx4 v[128:131], v150, s[40:43], s71 offen sc1
s_add_u32 s80, s66, 10240
s_add_u32 s86, s80, s84
buffer_load_dwordx4 v[20:23], v1, s[40:43], s66 offen offset:1024 sc1
buffer_load_dwordx4 v[24:27], v1, s[40:43], s66 offen offset:2048 sc1
buffer_load_dwordx4 v[28:31], v1, s[40:43], s66 offen offset:3072 sc1
s_add_u32 s69, s66, 4096
buffer_load_dwordx4 v[32:35], v1, s[40:43], s69 offen offset:0 sc1
buffer_load_dwordx4 v[36:39], v1, s[40:43], s69 offen offset:1024 sc1
buffer_load_dwordx4 v[40:43], v1, s[40:43], s69 offen offset:2048 sc1
buffer_load_dwordx4 v[44:47], v1, s[40:43], s69 offen offset:3072 sc1
s_add_u32 s69, s66, 8192
buffer_load_dwordx4 v[48:51], v1, s[40:43], s69 offen offset:0 sc1
buffer_load_dwordx4 v[52:55], v1, s[40:43], s69 offen offset:1024 sc1
buffer_load_dword v6, v5, s[36:39], 0 offen sc1
s_waitcnt vmcnt(0)
s_branch K4_G1s
K4_W0s:
s_mov_b32 s75, 6
s_cmp_lt_u32 s65, 36
s_cbranch_scc0 K4_W0sR
K4_W0sL:
buffer_load_dword v6, v5, s[36:39], 0 offen sc1
s_waitcnt vmcnt(0)
v_cmp_le_u32 vcc, s65, v6
s_nop 0
s_cmp_eq_u64 vcc, -1
s_cbranch_scc1 K4_W0sR
s_sub_u32 s75, s75, 1
s_cmp_lg_u32 s75, 0
s_cbranch_scc1 K4_W0sL
s_branch K4_W0sR
K4_E0s:
ds_write_b32 v151, v84 offset:3072
ds_write_b32 v151, v85 offset:3076
ds_write_b32 v151, v86 offset:3584
ds_write_b32 v151, v87 offset:3588
s_waitcnt lgkmcnt(0)
s_barrier
ds_read2st64_b64 v[104:107], v152 offset0:0 offset1:1
ds_read2st64_b64 v[108:111], v153 offset0:0 offset1:1
ds_read2st64_b64 v[112:115], v154 offset0:0 offset1:1
ds_read2st64_b64 v[116:119], v155 offset0:0 offset1:1
ds_read2st64_b64 v[120:123], v156 offset0:0 offset1:1
ds_read2st64_b64 v[124:127], v157 offset0:0 offset1:1
s_waitcnt lgkmcnt(4)
v_add_f32 v104, v104, v88
v_add_f32 v105, v105, v89
v_add_f32 v106, v106, v90
v_add_f32 v107, v107, v91
v_add_f32 v108, v108, v92
v_add_f32 v109, v109, v93
v_add_f32 v110, v110, v94
v_add_f32 v111, v111, v95
s_waitcnt lgkmcnt(0)
v_add_f32 v112, v112, v120
v_add_f32 v113, v113, v121
v_add_f32 v114, v114, v122
v_add_f32 v115, v115, v123
v_add_f32 v116, v116, v124
v_add_f32 v117, v117, v125
v_add_f32 v118, v118, v126
v_add_f32 v119, v119, v127
v_add_f32 v104, v104, v112
v_add_f32 v105, v105, v113
v_add_f32 v106, v106, v114
v_add_f32 v107, v107, v115
v_add_f32 v108, v108, v116
v_add_f32 v109, v109, v117
v_add_f32 v110, v110, v118
v_add_f32 v111, v111, v119
v_cvt_pk_bf16_f32 v140, v104, v105
v_cvt_pk_bf16_f32 v141, v106, v107
v_cvt_pk_bf16_f32 v142, v108, v109
v_cvt_pk_bf16_f32 v143, v110, v111
buffer_store_dwordx4 v[140:143], v148, s[44:47], s67 offen sc1
s_branch L_FIN
K4_X1s:
s_cmp_lg_u32 s64, 19
s_cbranch_scc1 K4_NR1s
s_mov_b32 s44, s30
s_mov_b32 s45, s31
s_mov_b32 s74, 2621440
s_mov_b32 s46, s74
s_mov_b32 s81, 0
s_mov_b32 s62, 0
s_mov_b32 s100, 40960
s_mov_b32 s11, 4294926336
s_mov_b32 s67, 0
v_mov_b32 v148, v158
s_waitcnt vmcnt(0)
buffer_store_dword v8, v7, s[36:39], 0 offen sc1
s_mov_b32 s7, 0x7ff00000
s_nop 1
v_writelane_b32 v7, s7, 0
s_cmp_eq_u32 s68, 1
s_cbranch_scc1 K4_F0s
s_branch K4_NR1s
K4_NR1s:
s_cmp_gt_u32 s64, 33
s_cbranch_scc1 K4_E1s
buffer_load_dword v6, v5, s[36:39], 0 offen sc1
ds_write_b32 v151, v84 offset:27648
ds_write_b32 v151, v85 offset:27652
ds_write_b32 v151, v86 offset:28160
ds_write_b32 v151, v87 offset:28164
s_waitcnt lgkmcnt(0)
s_barrier
ds_read2st64_b64 v[104:107], v152 offset0:48 offset1:49
ds_read2st64_b64 v[108:111], v153 offset0:48 offset1:49
ds_read2st64_b64 v[112:115], v154 offset0:48 offset1:49
ds_read2st64_b64 v[116:119], v155 offset0:48 offset1:49
ds_read2st64_b64 v[120:123], v156 offset0:48 offset1:49
ds_read2st64_b64 v[124:127], v157 offset0:48 offset1:49
s_waitcnt vmcnt(0)
buffer_store_dword v8, v7, s[36:39], 0 offen sc1
v_cmp_le_u32 vcc, s65, v6
s_nop 0
s_cmp_eq_u64 vcc, -1
s_cselect_b32 s68, 1, 0
s_cselect_b32 s42, 0x4000000, 0
buffer_load_dwordx4 v[16:19], v1, s[40:43], s66 offen offset:0 sc1
s_mul_i32 s71, s1, 24576
s_add_u32 s71, s71, s12
buffer_load_dwordx4 v[128:131], v150, s[40:43], s71 offen sc1
s_add_u32 s80, s66, 10240
s_add_u32 s86, s80, s84
buffer_load_dwordx4 v[20:23], v1, s[40:43], s66 offen offset:1024 sc1
buffer_load_dwordx4 v[24:27], v1, s[40:43], s66 offen offset:2048 sc1
buffer_load_dwordx4 v[28:31], v1, s[40:43], s66 offen offset:3072 sc1
s_add_u32 s69, s66, 4096
buffer_load_dwordx4 v[32:35], v1, s[40:43], s69 offen offset:0 sc1
buffer_load_dwordx4 v[36:39], v1, s[40:43], s69 offen offset:1024 sc1
buffer_load_dwordx4 v[40:43], v1, s[40:43], s69 offen offset:2048 sc1
buffer_load_dwordx4 v[44:47], v1, s[40:43], s69 offen offset:3072 sc1
s_add_u32 s69, s66, 8192
buffer_load_dwordx4 v[48:51], v1, s[40:43], s69 offen offset:0 sc1
buffer_load_dwordx4 v[52:55], v1, s[40:43], s69 offen offset:1024 sc1
buffer_load_dword v6, v5, s[36:39], 0 offen sc1
s_waitcnt lgkmcnt(4)
v_add_f32 v104, v104, v96
v_add_f32 v105, v105, v97
v_add_f32 v106, v106, v98
v_add_f32 v107, v107, v99
v_add_f32 v108, v108, v100
v_add_f32 v109, v109, v101
v_add_f32 v110, v110, v102
v_add_f32 v111, v111, v103
s_waitcnt lgkmcnt(0)
v_add_f32 v112, v112, v120
v_add_f32 v113, v113, v121
v_add_f32 v114, v114, v122
v_add_f32 v115, v115, v123
v_add_f32 v116, v116, v124
v_add_f32 v117, v117, v125
v_add_f32 v118, v118, v126
v_add_f32 v119, v119, v127
v_add_f32 v104, v104, v112
v_add_f32 v105, v105, v113
v_add_f32 v106, v106, v114
v_add_f32 v107, v107, v115
v_add_f32 v108, v108, v116
v_add_f32 v109, v109, v117
v_add_f32 v110, v110, v118
v_add_f32 v111, v111, v119
v_cvt_pk_bf16_f32 v140, v104, v105
v_cvt_pk_bf16_f32 v141, v106, v107
v_cvt_pk_bf16_f32 v142, v108, v109
v_cvt_pk_bf16_f32 v143, v110, v111
buffer_store_dwordx4 v[140:143], v148, s[44:47], s67 offen sc1
v_add_f32 v144, v104, v105
v_mul_f32 v145, v104, v104
v_fmac_f32 v145, v105, v105
v_fmac_f32 v145, v106, v106
v_add_f32 v144, v144, v106
v_fmac_f32 v145, v107, v107
v_add_f32 v144, v144, v107
v_fmac_f32 v145, v108, v108
v_add_f32 v144, v144, v108
v_fmac_f32 v145, v109, v109
v_add_f32 v144, v144, v109
v_fmac_f32 v145, v110, v110
v_add_f32 v144, v144, v110
v_fmac_f32 v145, v111, v111
v_add_f32 v144, v144, v111
s_nop 1
v_permlane32_swap_b32 v144, v145
v_add_f32 v146, v144, v145
v_add_f32 v147, v144, v145
s_nop 1
v_permlane16_swap_b32 v146, v147
v_add_f32 v144, v146, v147
v_fma_f32 v144, v144, s76, v168
buffer_store_dword v144, v149, s[60:63], s67 offen sc1
v_add_u32 v8, s79, v11
s_mov_b32 s46, 0
s_mov_b32 s62, 0
s_cmp_eq_u32 s68, 0
s_cbranch_scc1 K4_N21s
s_waitcnt vmcnt(0)
buffer_store_dword v8, v7, s[36:39], 0 offen sc1
s_branch K4_G0s
K4_N21s:
s_waitcnt vmcnt(2)
v_cmp_le_u32 vcc, s65, v6
s_nop 0
s_cmp_eq_u64 vcc, -1
s_cselect_b32 s68, 1, 0
s_cselect_b32 s42, 0x4000000, 0
buffer_load_dwordx4 v[16:19], v1, s[40:43], s66 offen offset:0 sc1
s_mul_i32 s71, s1, 24576
s_add_u32 s71, s71, s12
buffer_load_dwordx4 v[128:131], v150, s[40:43], s71 offen sc1
s_add_u32 s80, s66, 10240
s_add_u32 s86, s80, s84
buffer_load_dwordx4 v[20:23], v1, s[40:43], s66 offen offset:1024 sc1
buffer_load_dwordx4 v[24:27], v1, s[40:43], s66 offen offset:2048 sc1
buffer_load_dwordx4 v[28:31], v1, s[40:43], s66 offen offset:3072 sc1
s_add_u32 s69, s66, 4096
buffer_load_dwordx4 v[32:35], v1, s[40:43], s69 offen offset:0 sc1
buffer_load_dwordx4 v[36:39], v1, s[40:43], s69 offen offset:1024 sc1
buffer_load_dwordx4 v[40:43], v1, s[40:43], s69 offen offset:2048 sc1
buffer_load_dwordx4 v[44:47], v1, s[40:43], s69 offen offset:3072 sc1
s_add_u32 s69, s66, 8192
buffer_load_dwordx4 v[48:51], v1, s[40:43], s69 offen offset:0 sc1
buffer_load_dwordx4 v[52:55], v1, s[40:43], s69 offen offset:1024 sc1
buffer_load_dword v6, v5, s[36:39], 0 offen sc1
s_waitcnt vmcnt(12)
buffer_store_dword v8, v7, s[36:39], 0 offen sc1
s_waitcnt vmcnt(1)
s_cmp_eq_u32 s68, 1
s_cbranch_scc1 K4_G0s
s_cmp_gt_u32 s64, 33
s_cbranch_scc1 L_FIN
K4_SW1s:
s_mov_b32 s75, 0
K4_SP1s:
buffer_load_dword v6, v5, s[36:39], 0 offen sc1
s_add_u32 s75, s75, 1
s_cmp_gt_u32 s75, 0x8000
s_cbranch_scc1 L_TIMEOUT
s_waitcnt vmcnt(0)
v_cmp_le_u32 vcc, s65, v6
s_nop 0
s_cmp_eq_u64 vcc, -1
s_cbranch_scc0 K4_SP1s
K4_LC1s:
s_mov_b32 s42, 0x4000000
buffer_load_dwordx4 v[16:19], v1, s[40:43], s66 offen offset:0 sc1
s_mul_i32 s71, s1, 24576
s_add_u32 s71, s71, s12
buffer_load_dwordx4 v[128:131], v150, s[40:43], s71 offen sc1
s_add_u32 s80, s66, 10240
s_add_u32 s86, s80, s84
buffer_load_dwordx4 v[20:23], v1, s[40:43], s66 offen offset:1024 sc1
buffer_load_dwordx4 v[24:27], v1, s[40:43], s66 offen offset:2048 sc1
buffer_load_dwordx4 v[28:31], v1, s[40:43], s66 offen offset:3072 sc1
s_add_u32 s69, s66, 4096
buffer_load_dwordx4 v[32:35], v1, s[40:43], s69 offen offset:0 sc1
buffer_load_dwordx4 v[36:39], v1, s[40:43], s69 offen offset:1024 sc1
buffer_load_dwordx4 v[40:43], v1, s[40:43], s69 offen offset:2048 sc1
buffer_load_dwordx4 v[44:47], v1, s[40:43], s69 offen offset:3072 sc1
s_add_u32 s69, s66, 8192
buffer_load_dwordx4 v[48:51], v1, s[40:43], s69 offen offset:0 sc1
buffer_load_dwordx4 v[52:55], v1, s[40:43], s69 offen offset:1024 sc1
buffer_load_dword v6, v5, s[36:39], 0 offen sc1
s_waitcnt vmcnt(0)
s_branch K4_G0s
K4_W1s:
s_mov_b32 s75, 6
s_cmp_lt_u32 s65, 36
s_cbranch_scc0 K4_W1sR
K4_W1sL:
buffer_load_dword v6, v5, s[36:39], 0 offen sc1
s_waitcnt vmcnt(0)
v_cmp_le_u32 vcc, s65, v6
s_nop 0
s_cmp_eq_u64 vcc, -1
s_cbranch_scc1 K4_W1sR
s_sub_u32 s75, s75, 1
s_cmp_lg_u32 s75, 0
s_cbranch_scc1 K4_W1sL
s_branch K4_W1sR
K4_E1s:
ds_write_b32 v151, v84 offset:27648
ds_write_b32 v151, v85 offset:27652
ds_write_b32 v151, v86 offset:28160
ds_write_b32 v151, v87 offset:28164
s_waitcnt lgkmcnt(0)
s_barrier
ds_read2st64_b64 v[104:107], v152 offset0:48 offset1:49
ds_read2st64_b64 v[108:111], v153 offset0:48 offset1:49
ds_read2st64_b64 v[112:115], v154 offset0:48 offset1:49
ds_read2st64_b64 v[116:119], v155 offset0:48 offset1:49
ds_read2st64_b64 v[120:123], v156 offset0:48 offset1:49
ds_read2st64_b64 v[124:127], v157 offset0:48 offset1:49
s_waitcnt lgkmcnt(4)
v_add_f32 v104, v104, v96
v_add_f32 v105, v105, v97
v_add_f32 v106, v106, v98
v_add_f32 v107, v107, v99
v_add_f32 v108, v108, v100
v_add_f32 v109, v109, v101
v_add_f32 v110, v110, v102
v_add_f32 v111, v111, v103
s_waitcnt lgkmcnt(0)
v_add_f32 v112, v112, v120
v_add_f32 v113, v113, v121
v_add_f32 v114, v114, v122
v_add_f32 v115, v115, v123
v_add_f32 v116, v116, v124
v_add_f32 v117, v117, v125
v_add_f32 v118, v118, v126
v_add_f32 v119, v119, v127
v_add_f32 v104, v104, v112
v_add_f32 v105, v105, v113
v_add_f32 v106, v106, v114
v_add_f32 v107, v107, v115
v_add_f32 v108, v108, v116
v_add_f32 v109, v109, v117
v_add_f32 v110, v110, v118
v_add_f32 v111, v111, v119
v_cvt_pk_bf16_f32 v140, v104, v105
v_cvt_pk_bf16_f32 v141, v106, v107
v_cvt_pk_bf16_f32 v142, v108, v109
v_cvt_pk_bf16_f32 v143, v110, v111
buffer_store_dwordx4 v[140:143], v148, s[44:47], s67 offen sc1
s_branch L_FIN
K4_G0s:
v_lshlrev_b32 v132, 16, v128
v_and_b32 v133, 0xffff0000, v128
v_lshlrev_b32 v134, 16, v129
v_and_b32 v135, 0xffff0000, v129
v_lshlrev_b32 v136, 16, v130
v_and_b32 v137, 0xffff0000, v130
v_lshlrev_b32 v138, 16, v131
v_and_b32 v139, 0xffff0000, v131
v_mfma_f32_16x16x32_bf16 v[72:75], a[0:3], v[16:19], 0
ds_write_b32 v151, v84 offset:27648
v_mfma_f32_16x16x32_bf16 v[72:75], a[24:27], v[20:23], v[72:75]
ds_write_b32 v151, v85 offset:27652
v_mfma_f32_16x16x32_bf16 v[72:75], a[48:51], v[24:27], v[72:75]
buffer_load_dwordx4 v[56:59], v1, s[36:39], s80 offen offset:0 sc1
v_mfma_f32_16x16x32_bf16 v[72:75], a[72:75], v[28:31], v[72:75]
ds_write_b32 v151, v86 offset:28160
v_mfma_f32_16x16x32_bf16 v[76:79], a[4:7], v[16:19], 0
ds_write_b32 v151, v87 offset:28164
v_mfma_f32_16x16x32_bf16 v[76:79], a[28:31], v[20:23], v[76:79]
v_mfma_f32_16x16x32_bf16 v[76:79], a[52:55], v[24:27], v[76:79]
v_mfma_f32_16x16x32_bf16 v[76:79], a[76:79], v[28:31], v[76:79]
buffer_load_dwordx4 v[60:63], v1, s[36:39], s80 offen offset:1024 sc1
v_mfma_f32_16x16x32_bf16 v[80:83], a[8:11], v[16:19], 0
s_waitcnt lgkmcnt(0)
v_mfma_f32_16x16x32_bf16 v[80:83], a[32:35], v[20:23], v[80:83]
s_branch K4_B0s
K4_G1s:
v_lshlrev_b32 v132, 16, v128
v_and_b32 v133, 0xffff0000, v128
v_lshlrev_b32 v134, 16, v129
v_and_b32 v135, 0xffff0000, v129
v_lshlrev_b32 v136, 16, v130
v_and_b32 v137, 0xffff0000, v130
v_lshlrev_b32 v138, 16, v131
v_and_b32 v139, 0xffff0000, v131
v_mfma_f32_16x16x32_bf16 v[72:75], a[0:3], v[16:19], 0
ds_write_b32 v151, v84 offset:3072
v_mfma_f32_16x16x32_bf16 v[72:75], a[24:27], v[20:23], v[72:75]
ds_write_b32 v151, v85 offset:3076
v_mfma_f32_16x16x32_bf16 v[72:75], a[48:51], v[24:27], v[72:75]
buffer_load_dwordx4 v[56:59], v1, s[36:39], s80 offen offset:0 sc1
v_mfma_f32_16x16x32_bf16 v[72:75], a[72:75], v[28:31], v[72:75]
ds_write_b32 v151, v86 offset:3584
v_mfma_f32_16x16x32_bf16 v[76:79], a[4:7], v[16:19], 0
ds_write_b32 v151, v87 offset:3588
v_mfma_f32_16x16x32_bf16 v[76:79], a[28:31], v[20:23], v[76:79]
v_mfma_f32_16x16x32_bf16 v[76:79], a[52:55], v[24:27], v[76:79]
v_mfma_f32_16x16x32_bf16 v[76:79], a[76:79], v[28:31], v[76:79]
buffer_load_dwordx4 v[60:63], v1, s[36:39], s80 offen offset:1024 sc1
v_mfma_f32_16x16x32_bf16 v[80:83], a[8:11], v[16:19], 0
s_waitcnt lgkmcnt(0)
v_mfma_f32_16x16x32_bf16 v[80:83], a[32:35], v[20:23], v[80:83]
s_branch K4_B1s
.p2align 6
K5_F0s:
v_mfma_f32_16x16x32_bf16 v[72:75], a[0:3], v[16:19], 0
ds_write_b32 v151, v84 offset:27648
v_mfma_f32_16x16x32_bf16 v[72:75], a[24:27], v[20:23], v[72:75]
ds_write_b32 v151, v85 offset:27652
v_mfma_f32_16x16x32_bf16 v[72:75], a[48:51], v[24:27], v[72:75]
buffer_load_dwordx4 v[56:59], v1, s[36:39], s80 offen offset:0 sc1
v_mfma_f32_16x16x32_bf16 v[72:75], a[72:75], v[28:31], v[72:75]
ds_write_b32 v151, v86 offset:28160
v_mfma_f32_16x16x32_bf16 v[76:79], a[4:7], v[16:19], 0
ds_write_b32 v151, v87 offset:28164
v_mfma_f32_16x16x32_bf16 v[76:79], a[28:31], v[20:23], v[76:79]
ds_write_b32 v151, v96 offset:28672
v_mfma_f32_16x16x32_bf16 v[76:79], a[52:55], v[24:27], v[76:79]
ds_write_b32 v151, v97 offset:28676
v_mfma_f32_16x16x32_bf16 v[76:79], a[76:79], v[28:31], v[76:79]
buffer_load_dwordx4 v[60:63], v1, s[36:39], s80 offen offset:1024 sc1
v_mfma_f32_16x16x32_bf16 v[80:83], a[8:11], v[16:19], 0
ds_write_b32 v151, v98 offset:29184
v_mfma_f32_16x16x32_bf16 v[80:83], a[32:35], v[20:23], v[80:83]
ds_write_b32 v151, v99 offset:29188
v_mfma_f32_16x16x32_bf16 v[80:83], a[56:59], v[24:27], v[80:83]
ds_write_b32 v151, v100 offset:29696
v_mfma_f32_16x16x32_bf16 v[80:83], a[80:83], v[28:31], v[80:83]
ds_write_b32 v151, v101 offset:29700
v_mfma_f32_16x16x32_bf16 v[84:87], a[12:15], v[16:19], 0
buffer_load_dwordx4 v[64:67], v1, s[36:39], s80 offen offset:2048 sc1
v_mfma_f32_16x16x32_bf16 v[84:87], a[36:39], v[20:23], v[84:87]
ds_write_b32 v151, v102 offset:30208
v_mfma_f32_16x16x32_bf16 v[84:87], a[60:63], v[24:27], v[84:87]
ds_write_b32 v151, v103 offset:30212
v_mfma_f32_16x16x32_bf16 v[84:87], a[84:87], v[28:31], v[84:87]
v_mfma_f32_16x16x32_bf16 v[88:91], a[16:19], v[16:19], 0
v_mfma_f32_16x16x32_bf16 v[88:91], a[40:43], v[20:23], v[88:91]
buffer_load_dwordx4 v[68:71], v1, s[36:39], s86 offen offset:3072 sc1
v_mfma_f32_16x16x32_bf16 v[88:91], a[64:67], v[24:27], v[88:91]
s_waitcnt lgkmcnt(0)
v_mfma_f32_16x16x32_bf16 v[88:91], a[88:91], v[28:31], v[88:91]
s_barrier
K5_B0s:
v_mfma_f32_16x16x32_bf16 v[92:95], a[20:23], v[16:19], 0
s_add_u32 s13, s64, 1
s_cmp_eq_u32 s13, 17
s_addc_u32 s13, s13, 0
v_mfma_f32_16x16x32_bf16 v[92:95], a[44:47], v[20:23], v[92:95]
s_sub_u32 s1, s13, 17
s_cselect_b32 s1, s13, s1
s_and_b32 s66, s13, 7
v_mfma_f32_16x16x32_bf16 v[92:95], a[68:71], v[24:27], v[92:95]
s_mul_i32 s66, s66, 55296
s_add_u32 s66, s66, s10
s_add_u32 s65, s13, 2
v_mfma_f32_16x16x32_bf16 v[92:95], a[92:95], v[28:31], v[92:95]
s_waitcnt vmcnt(8)
s_waitcnt vmcnt(7)
v_cmp_le_u32 vcc, s65, v6
v_mfma_f32_16x16x32_bf16 v[72:75], a[96:99], v[32:35], v[72:75]
s_cmp_eq_u64 vcc, -1
v_mfma_f32_16x16x32_bf16 v[72:75], a[120:123], v[36:39], v[72:75]
s_cbranch_scc0 K5_W0s
K5_W0sR:
s_cselect_b32 s68, 1, 0
v_mfma_f32_16x16x32_bf16 v[72:75], a[144:147], v[40:43], v[72:75]
s_cselect_b32 s42, 0x4000000, 0
v_mfma_f32_16x16x32_bf16 v[76:79], a[100:103], v[32:35], v[76:79]
buffer_load_dwordx4 v[16:19], v1, s[40:43], s66 offen offset:0 sc1
v_mfma_f32_16x16x32_bf16 v[76:79], a[124:127], v[36:39], v[76:79]
s_add_u32 s80, s66, 10240
s_add_u32 s86, s80, s84
v_mfma_f32_16x16x32_bf16 v[76:79], a[148:151], v[40:43], v[76:79]
v_mfma_f32_16x16x32_bf16 v[80:83], a[104:107], v[32:35], v[80:83]
buffer_load_dwordx4 v[20:23], v1, s[40:43], s66 offen offset:1024 sc1
v_mfma_f32_16x16x32_bf16 v[80:83], a[128:131], v[36:39], v[80:83]
v_mfma_f32_16x16x32_bf16 v[80:83], a[152:155], v[40:43], v[80:83]
v_mfma_f32_16x16x32_bf16 v[84:87], a[108:111], v[32:35], v[84:87]
v_mfma_f32_16x16x32_bf16 v[84:87], a[132:135], v[36:39], v[84:87]
v_mfma_f32_16x16x32_bf16 v[84:87], a[156:159], v[40:43], v[84:87]
v_mfma_f32_16x16x32_bf16 v[88:91], a[112:115], v[32:35], v[88:91]
buffer_load_dwordx4 v[24:27], v1, s[40:43], s66 offen offset:2048 sc1
v_mfma_f32_16x16x32_bf16 v[88:91], a[136:139], v[36:39], v[88:91]
v_mfma_f32_16x16x32_bf16 v[88:91], a[160:163], v[40:43], v[88:91]
v_mfma_f32_16x16x32_bf16 v[92:95], a[116:119], v[32:35], v[92:95]
v_mfma_f32_16x16x32_bf16 v[92:95], a[140:143], v[36:39], v[92:95]
v_mfma_f32_16x16x32_bf16 v[92:95], a[164:167], v[40:43], v[92:95]
s_waitcnt vmcnt(7)
v_mfma_f32_16x16x32_bf16 v[72:75], a[168:171], v[44:47], v[72:75]
buffer_load_dwordx4 v[28:31], v1, s[40:43], s66 offen offset:3072 sc1
v_mfma_f32_16x16x32_bf16 v[72:75], a[192:195], v[48:51], v[72:75]
s_add_u32 s69, s66, 4096
v_mfma_f32_16x16x32_bf16 v[72:75], a[216:219], v[52:55], v[72:75]
v_mfma_f32_16x16x32_bf16 v[76:79], a[172:175], v[44:47], v[76:79]
v_mfma_f32_16x16x32_bf16 v[76:79], a[196:199], v[48:51], v[76:79]
buffer_load_dwordx4 v[32:35], v1, s[40:43], s69 offen offset:0 sc1
v_mfma_f32_16x16x32_bf16 v[76:79], a[220:223], v[52:55], v[76:79]
v_mfma_f32_16x16x32_bf16 v[80:83], a[176:179], v[44:47], v[80:83]
v_mfma_f32_16x16x32_bf16 v[80:83], a[200:203], v[48:51], v[80:83]
v_mfma_f32_16x16x32_bf16 v[80:83], a[224:227], v[52:55], v[80:83]
v_mfma_f32_16x16x32_bf16 v[84:87], a[180:183], v[44:47], v[84:87]
buffer_load_dwordx4 v[36:39], v1, s[40:43], s69 offen offset:1024 sc1
v_mfma_f32_16x16x32_bf16 v[84:87], a[204:207], v[48:51], v[84:87]
v_mfma_f32_16x16x32_bf16 v[84:87], a[228:231], v[52:55], v[84:87]
v_mfma_f32_16x16x32_bf16 v[88:91], a[184:187], v[44:47], v[88:91]
v_mfma_f32_16x16x32_bf16 v[88:91], a[208:211], v[48:51], v[88:91]
v_mfma_f32_16x16x32_bf16 v[88:91], a[232:235], v[52:55], v[88:91]
buffer_load_dwordx4 v[40:43], v1, s[40:43], s69 offen offset:2048 sc1
v_mfma_f32_16x16x32_bf16 v[92:95], a[188:191], v[44:47], v[92:95]
v_mfma_f32_16x16x32_bf16 v[92:95], a[212:215], v[48:51], v[92:95]
v_mfma_f32_16x16x32_bf16 v[92:95], a[236:239], v[52:55], v[92:95]
s_waitcnt vmcnt(7)
v_mfma_f32_16x16x32_bf16 v[72:75], a[240:243], v[56:59], v[72:75]
v_mfma_f32_16x16x32_bf16 v[72:75], v[196:199], v[60:63], v[72:75]
buffer_load_dword v6, v5, s[36:39], 0 offen sc1
v_mfma_f32_16x16x32_bf16 v[72:75], v[220:223], v[64:67], v[72:75]
buffer_load_dwordx4 v[44:47], v1, s[40:43], s69 offen offset:3072 sc1
v_mfma_f32_16x16x32_bf16 v[72:75], v[244:247], v[68:71], v[72:75]
s_add_u32 s69, s66, 8192
v_mfma_f32_16x16x32_bf16 v[76:79], a[244:247], v[56:59], v[76:79]
buffer_load_dwordx4 v[48:51], v1, s[40:43], s69 offen offset:0 sc1
v_mfma_f32_16x16x32_bf16 v[76:79], v[200:203], v[60:63], v[76:79]
s_mul_i32 s67, s0, s100
s_add_u32 s67, s67, s11
s_mov_b32 s46, s74
v_mfma_f32_16x16x32_bf16 v[76:79], v[224:227], v[64:67], v[76:79]
s_add_u32 s79, s64, 19
ds_write_b32 v151, v72 offset:0
v_mfma_f32_16x16x32_bf16 v[76:79], v[248:251], v[68:71], v[76:79]
s_mov_b32 s62, s81
ds_write_b32 v151, v73 offset:4
v_mfma_f32_16x16x32_bf16 v[80:83], a[248:251], v[56:59], v[80:83]
s_mov_b32 s64, s13
ds_write_b32 v151, v74 offset:512
v_mfma_f32_16x16x32_bf16 v[80:83], v[204:207], v[60:63], v[80:83]
s_mov_b32 s0, s1
ds_write_b32 v151, v75 offset:516
v_mfma_f32_16x16x32_bf16 v[80:83], v[228:231], v[64:67], v[80:83]
buffer_load_dwordx4 v[52:55], v1, s[40:43], s69 offen offset:1024 sc1
v_mfma_f32_16x16x32_bf16 v[80:83], v[252:255], v[68:71], v[80:83]
s_cmp_eq_u32 s64, 19
ds_write_b32 v151, v76 offset:1024
v_mfma_f32_16x16x32_bf16 v[84:87], a[252:255], v[56:59], v[84:87]
s_cselect_b32 s69, 0, s68
ds_write_b32 v151, v77 offset:1028
v_mfma_f32_16x16x32_bf16 v[84:87], v[208:211], v[60:63], v[84:87]
s_cmp_eq_u32 s69, 0
ds_write_b32 v151, v78 offset:1536
v_mfma_f32_16x16x32_bf16 v[84:87], v[232:235], v[64:67], v[84:87]
ds_write_b32 v151, v79 offset:1540
v_mfma_f32_16x16x32_bf16 v[88:91], v[188:191], v[56:59], v[88:91]
ds_write_b32 v151, v80 offset:2048
v_mfma_f32_16x16x32_bf16 v[88:91], v[212:215], v[60:63], v[88:91]
ds_write_b32 v151, v81 offset:2052
v_mfma_f32_16x16x32_bf16 v[88:91], v[236:239], v[64:67], v[88:91]
ds_write_b32 v151, v82 offset:2560
v_mfma_f32_16x16x32_bf16 v[92:95], v[192:195], v[56:59], v[92:95]
ds_write_b32 v151, v83 offset:2564
v_mfma_f32_16x16x32_bf16 v[92:95], v[216:219], v[60:63], v[92:95]
s_waitcnt vmcnt(7)
v_mfma_f32_16x16x32_bf16 v[92:95], v[240:243], v[64:67], v[92:95]
s_cbranch_scc1 K5_X0s
K5_F1s:
v_mfma_f32_16x16x32_bf16 v[72:75], a[0:3], v[16:19], 0
ds_write_b32 v151, v84 offset:3072
v_mfma_f32_16x16x32_bf16 v[72:75], a[24:27], v[20:23], v[72:75]
ds_write_b32 v151, v85 offset:3076
v_mfma_f32_16x16x32_bf16 v[72:75], a[48:51], v[24:27], v[72:75]
buffer_load_dwordx4 v[56:59], v1, s[36:39], s80 offen offset:0 sc1
v_mfma_f32_16x16x32_bf16 v[72:75], a[72:75], v[28:31], v[72:75]
ds_write_b32 v151, v86 offset:3584
v_mfma_f32_16x16x32_bf16 v[76:79], a[4:7], v[16:19], 0
ds_write_b32 v151, v87 offset:3588
v_mfma_f32_16x16x32_bf16 v[76:79], a[28:31], v[20:23], v[76:79]
ds_write_b32 v151, v88 offset:4096
v_mfma_f32_16x16x32_bf16 v[76:79], a[52:55], v[24:27], v[76:79]
ds_write_b32 v151, v89 offset:4100
v_mfma_f32_16x16x32_bf16 v[76:79], a[76:79], v[28:31], v[76:79]
buffer_load_dwordx4 v[60:63], v1, s[36:39], s80 offen offset:1024 sc1
v_mfma_f32_16x16x32_bf16 v[80:83], a[8:11], v[16:19], 0
ds_write_b32 v151, v90 offset:4608
v_mfma_f32_16x16x32_bf16 v[80:83], a[32:35], v[20:23], v[80:83]
ds_write_b32 v151, v91 offset:4612
v_mfma_f32_16x16x32_bf16 v[80:83], a[56:59], v[24:27], v[80:83]
ds_write_b32 v151, v92 offset:5120
v_mfma_f32_16x16x32_bf16 v[80:83], a[80:83], v[28:31], v[80:83]
ds_write_b32 v151, v93 offset:5124
v_mfma_f32_16x16x32_bf16 v[84:87], a[12:15], v[16:19], 0
buffer_load_dwordx4 v[64:67], v1, s[36:39], s80 offen offset:2048 sc1
v_mfma_f32_16x16x32_bf16 v[84:87], a[36:39], v[20:23], v[84:87]
ds_write_b32 v151, v94 offset:5632
v_mfma_f32_16x16x32_bf16 v[84:87], a[60:63], v[24:27], v[84:87]
ds_write_b32 v151, v95 offset:5636
v_mfma_f32_16x16x32_bf16 v[84:87], a[84:87], v[28:31], v[84:87]
v_mfma_f32_16x16x32_bf16 v[96:99], a[16:19], v[16:19], 0
v_mfma_f32_16x16x32_bf16 v[96:99], a[40:43], v[20:23], v[96:99]
buffer_load_dwordx4 v[68:71], v1, s[36:39], s86 offen offset:3072 sc1
v_mfma_f32_16x16x32_bf16 v[96:99], a[64:67], v[24:27], v[96:99]
s_waitcnt lgkmcnt(0)
v_mfma_f32_16x16x32_bf16 v[96:99], a[88:91], v[28:31], v[96:99]
s_barrier
K5_B1s:
v_mfma_f32_16x16x32_bf16 v[100:103], a[20:23], v[16:19], 0
s_add_u32 s13, s64, 1
s_cmp_eq_u32 s13, 17
s_addc_u32 s13, s13, 0
v_mfma_f32_16x16x32_bf16 v[100:103], a[44:47], v[20:23], v[100:103]
s_sub_u32 s1, s13, 17
s_cselect_b32 s1, s13, s1
s_and_b32 s66, s13, 7
v_mfma_f32_16x16x32_bf16 v[100:103], a[68:71], v[24:27], v[100:103]
s_mul_i32 s66, s66, 55296
s_add_u32 s66, s66, s10
s_add_u32 s65, s13, 2
v_mfma_f32_16x16x32_bf16 v[100:103], a[92:95], v[28:31], v[100:103]
s_waitcnt vmcnt(8)
s_waitcnt vmcnt(7)
v_cmp_le_u32 vcc, s65, v6
v_mfma_f32_16x16x32_bf16 v[72:75], a[96:99], v[32:35], v[72:75]
s_cmp_eq_u64 vcc, -1
v_mfma_f32_16x16x32_bf16 v[72:75], a[120:123], v[36:39], v[72:75]
s_cbranch_scc0 K5_W1s
K5_W1sR:
s_cselect_b32 s68, 1, 0
v_mfma_f32_16x16x32_bf16 v[72:75], a[144:147], v[40:43], v[72:75]
s_cselect_b32 s42, 0x4000000, 0
v_mfma_f32_16x16x32_bf16 v[76:79], a[100:103], v[32:35], v[76:79]
buffer_load_dwordx4 v[16:19], v1, s[40:43], s66 offen offset:0 sc1
v_mfma_f32_16x16x32_bf16 v[76:79], a[124:127], v[36:39], v[76:79]
s_add_u32 s80, s66, 10240
s_add_u32 s86, s80, s84
v_mfma_f32_16x16x32_bf16 v[76:79], a[148:151], v[40:43], v[76:79]
v_mfma_f32_16x16x32_bf16 v[80:83], a[104:107], v[32:35], v[80:83]
buffer_load_dwordx4 v[20:23], v1, s[40:43], s66 offen offset:1024 sc1
v_mfma_f32_16x16x32_bf16 v[80:83], a[128:131], v[36:39], v[80:83]
v_mfma_f32_16x16x32_bf16 v[80:83], a[152:155], v[40:43], v[80:83]
v_mfma_f32_16x16x32_bf16 v[84:87], a[108:111], v[32:35], v[84:87]
v_mfma_f32_16x16x32_bf16 v[84:87], a[132:135], v[36:39], v[84:87]
v_mfma_f32_16x16x32_bf16 v[84:87], a[156:159], v[40:43], v[84:87]
v_mfma_f32_16x16x32_bf16 v[96:99], a[112:115], v[32:35], v[96:99]
buffer_load_dwordx4 v[24:27], v1, s[40:43], s66 offen offset:2048 sc1
v_mfma_f32_16x16x32_bf16 v[96:99], a[136:139], v[36:39], v[96:99]
v_mfma_f32_16x16x32_bf16 v[96:99], a[160:163], v[40:43], v[96:99]
v_mfma_f32_16x16x32_bf16 v[100:103], a[116:119], v[32:35], v[100:103]
v_mfma_f32_16x16x32_bf16 v[100:103], a[140:143], v[36:39], v[100:103]
v_mfma_f32_16x16x32_bf16 v[100:103], a[164:167], v[40:43], v[100:103]
s_waitcnt vmcnt(7)
v_mfma_f32_16x16x32_bf16 v[72:75], a[168:171], v[44:47], v[72:75]
buffer_load_dwordx4 v[28:31], v1, s[40:43], s66 offen offset:3072 sc1
v_mfma_f32_16x16x32_bf16 v[72:75], a[192:195], v[48:51], v[72:75]
s_add_u32 s69, s66, 4096
v_mfma_f32_16x16x32_bf16 v[72:75], a[216:219], v[52:55], v[72:75]
v_mfma_f32_16x16x32_bf16 v[76:79], a[172:175], v[44:47], v[76:79]
v_mfma_f32_16x16x32_bf16 v[76:79], a[196:199], v[48:51], v[76:79]
buffer_load_dwordx4 v[32:35], v1, s[40:43], s69 offen offset:0 sc1
v_mfma_f32_16x16x32_bf16 v[76:79], a[220:223], v[52:55], v[76:79]
v_mfma_f32_16x16x32_bf16 v[80:83], a[176:179], v[44:47], v[80:83]
v_mfma_f32_16x16x32_bf16 v[80:83], a[200:203], v[48:51], v[80:83]
v_mfma_f32_16x16x32_bf16 v[80:83], a[224:227], v[52:55], v[80:83]
v_mfma_f32_16x16x32_bf16 v[84:87], a[180:183], v[44:47], v[84:87]
buffer_load_dwordx4 v[36:39], v1, s[40:43], s69 offen offset:1024 sc1
v_mfma_f32_16x16x32_bf16 v[84:87], a[204:207], v[48:51], v[84:87]
v_mfma_f32_16x16x32_bf16 v[84:87], a[228:231], v[52:55], v[84:87]
v_mfma_f32_16x16x32_bf16 v[96:99], a[184:187], v[44:47], v[96:99]
v_mfma_f32_16x16x32_bf16 v[96:99], a[208:211], v[48:51], v[96:99]
v_mfma_f32_16x16x32_bf16 v[96:99], a[232:235], v[52:55], v[96:99]
buffer_load_dwordx4 v[40:43], v1, s[40:43], s69 offen offset:2048 sc1
v_mfma_f32_16x16x32_bf16 v[100:103], a[188:191], v[44:47], v[100:103]
v_mfma_f32_16x16x32_bf16 v[100:103], a[212:215], v[48:51], v[100:103]
v_mfma_f32_16x16x32_bf16 v[100:103], a[236:239], v[52:55], v[100:103]
s_waitcnt vmcnt(7)
v_mfma_f32_16x16x32_bf16 v[72:75], a[240:243], v[56:59], v[72:75]
v_mfma_f32_16x16x32_bf16 v[72:75], v[196:199], v[60:63], v[72:75]
buffer_load_dword v6, v5, s[36:39], 0 offen sc1
v_mfma_f32_16x16x32_bf16 v[72:75], v[220:223], v[64:67], v[72:75]
buffer_load_dwordx4 v[44:47], v1, s[40:43], s69 offen offset:3072 sc1
v_mfma_f32_16x16x32_bf16 v[72:75], v[244:247], v[68:71], v[72:75]
s_add_u32 s69, s66, 8192
v_mfma_f32_16x16x32_bf16 v[76:79], a[244:247], v[56:59], v[76:79]
buffer_load_dwordx4 v[48:51], v1, s[40:43], s69 offen offset:0 sc1
v_mfma_f32_16x16x32_bf16 v[76:79], v[200:203], v[60:63], v[76:79]
s_mul_i32 s67, s0, s100
s_add_u32 s67, s67, s11
s_mov_b32 s46, s74
v_mfma_f32_16x16x32_bf16 v[76:79], v[224:227], v[64:67], v[76:79]
s_add_u32 s79, s64, 19
ds_write_b32 v151, v72 offset:24576
v_mfma_f32_16x16x32_bf16 v[76:79], v[248:251], v[68:71], v[76:79]
s_mov_b32 s62, s81
ds_write_b32 v151, v73 offset:24580
v_mfma_f32_16x16x32_bf16 v[80:83], a[248:251], v[56:59], v[80:83]
s_mov_b32 s64, s13
ds_write_b32 v151, v74 offset:25088
v_mfma_f32_16x16x32_bf16 v[80:83], v[204:207], v[60:63], v[80:83]
s_mov_b32 s0, s1
ds_write_b32 v151, v75 offset:25092
v_mfma_f32_16x16x32_bf16 v[80:83], v[228:231], v[64:67], v[80:83]
buffer_load_dwordx4 v[52:55], v1, s[40:43], s69 offen offset:1024 sc1
v_mfma_f32_16x16x32_bf16 v[80:83], v[252:255], v[68:71], v[80:83]
s_cmp_eq_u32 s64, 19
ds_write_b32 v151, v76 offset:25600
v_mfma_f32_16x16x32_bf16 v[84:87], a[252:255], v[56:59], v[84:87]
s_cselect_b32 s69, 0, s68
ds_write_b32 v151, v77 offset:25604
v_mfma_f32_16x16x32_bf16 v[84:87], v[208:211], v[60:63], v[84:87]
s_cmp_eq_u32 s69, 0
ds_write_b32 v151, v78 offset:26112
v_mfma_f32_16x16x32_bf16 v[84:87], v[232:235], v[64:67], v[84:87]
ds_write_b32 v151, v79 offset:26116
v_mfma_f32_16x16x32_bf16 v[96:99], v[188:191], v[56:59], v[96:99]
ds_write_b32 v151, v80 offset:26624
v_mfma_f32_16x16x32_bf16 v[96:99], v[212:215], v[60:63], v[96:99]
ds_write_b32 v151, v81 offset:26628
v_mfma_f32_16x16x32_bf16 v[96:99], v[236:239], v[64:67], v[96:99]
ds_write_b32 v151, v82 offset:27136
v_mfma_f32_16x16x32_bf16 v[100:103], v[192:195], v[56:59], v[100:103]
ds_write_b32 v151, v83 offset:27140
v_mfma_f32_16x16x32_bf16 v[100:103], v[216:219], v[60:63], v[100:103]
s_waitcnt vmcnt(7)
v_mfma_f32_16x16x32_bf16 v[100:103], v[240:243], v[64:67], v[100:103]
s_cbranch_scc1 K5_X1s
s_branch K5_F0s
K5_X0s:
s_cmp_lg_u32 s64, 19
s_cbranch_scc1 K5_NR0s
s_mov_b32 s44, s30
s_mov_b32 s45, s31
s_mov_b32 s74, 2621440
s_mov_b32 s46, s74
s_mov_b32 s81, 0
s_mov_b32 s62, 0
s_mov_b32 s100, 40960
s_mov_b32 s11, 4294926336
s_mov_b32 s67, 0
v_mov_b32 v148, v158
s_waitcnt vmcnt(0)
buffer_store_dword v8, v7, s[36:39], 0 offen sc1
s_mov_b32 s7, 0x7ff00000
s_nop 1
v_writelane_b32 v7, s7, 0
s_cmp_eq_u32 s68, 1
s_cbranch_scc1 K5_F1s
s_branch K5_NR0s
K5_NR0s:
s_cmp_gt_u32 s64, 33
s_cbranch_scc1 K5_E0s
buffer_load_dword v6, v5, s[36:39], 0 offen sc1
ds_write_b32 v151, v84 offset:3072
ds_write_b32 v151, v85 offset:3076
ds_write_b32 v151, v86 offset:3584
ds_write_b32 v151, v87 offset:3588
ds_write_b32 v151, v88 offset:4096
ds_write_b32 v151, v89 offset:4100
ds_write_b32 v151, v90 offset:4608
ds_write_b32 v151, v91 offset:4612
ds_write_b32 v151, v92 offset:5120
ds_write_b32 v151, v93 offset:5124
ds_write_b32 v151, v94 offset:5632
ds_write_b32 v151, v95 offset:5636
s_waitcnt lgkmcnt(0)
s_barrier
s_waitcnt vmcnt(0)
buffer_store_dword v8, v7, s[36:39], 0 offen sc1
v_cmp_le_u32 vcc, s65, v6
s_nop 0
s_cmp_eq_u64 vcc, -1
s_cselect_b32 s68, 1, 0
s_cselect_b32 s42, 0x4000000, 0
buffer_load_dwordx4 v[16:19], v1, s[40:43], s66 offen offset:0 sc1
s_add_u32 s80, s66, 10240
s_add_u32 s86, s80, s84
buffer_load_dwordx4 v[20:23], v1, s[40:43], s66 offen offset:1024 sc1
buffer_load_dwordx4 v[24:27], v1, s[40:43], s66 offen offset:2048 sc1
buffer_load_dwordx4 v[28:31], v1, s[40:43], s66 offen offset:3072 sc1
s_add_u32 s69, s66, 4096
buffer_load_dwordx4 v[32:35], v1, s[40:43], s69 offen offset:0 sc1
buffer_load_dwordx4 v[36:39], v1, s[40:43], s69 offen offset:1024 sc1
buffer_load_dwordx4 v[40:43], v1, s[40:43], s69 offen offset:2048 sc1
buffer_load_dwordx4 v[44:47], v1, s[40:43], s69 offen offset:3072 sc1
s_add_u32 s69, s66, 8192
buffer_load_dwordx4 v[48:51], v1, s[40:43], s69 offen offset:0 sc1
buffer_load_dwordx4 v[52:55], v1, s[40:43], s69 offen offset:1024 sc1
buffer_load_dword v6, v5, s[36:39], 0 offen sc1
v_add_u32 v8, s79, v11
s_mov_b32 s46, 0
s_mov_b32 s62, 0
s_cmp_eq_u32 s68, 0
s_cbranch_scc1 K5_N20s
s_waitcnt vmcnt(0)
buffer_store_dword v8, v7, s[36:39], 0 offen sc1
s_branch K5_G1s
K5_N20s:
s_waitcnt vmcnt(0)
v_cmp_le_u32 vcc, s65, v6
s_nop 0
s_cmp_eq_u64 vcc, -1
s_cselect_b32 s68, 1, 0
s_cselect_b32 s42, 0x4000000, 0
buffer_load_dwordx4 v[16:19], v1, s[40:43], s66 offen offset:0 sc1
s_add_u32 s80, s66, 10240
s_add_u32 s86, s80, s84
buffer_load_dwordx4 v[20:23], v1, s[40:43], s66 offen offset:1024 sc1
buffer_load_dwordx4 v[24:27], v1, s[40:43], s66 offen offset:2048 sc1
buffer_load_dwordx4 v[28:31], v1, s[40:43], s66 offen offset:3072 sc1
s_add_u32 s69, s66, 4096
buffer_load_dwordx4 v[32:35], v1, s[40:43], s69 offen offset:0 sc1
buffer_load_dwordx4 v[36:39], v1, s[40:43], s69 offen offset:1024 sc1
buffer_load_dwordx4 v[40:43], v1, s[40:43], s69 offen offset:2048 sc1
buffer_load_dwordx4 v[44:47], v1, s[40:43], s69 offen offset:3072 sc1
s_add_u32 s69, s66, 8192
buffer_load_dwordx4 v[48:51], v1, s[40:43], s69 offen offset:0 sc1
buffer_load_dwordx4 v[52:55], v1, s[40:43], s69 offen offset:1024 sc1
buffer_load_dword v6, v5, s[36:39], 0 offen sc1
buffer_store_dword v8, v7, s[36:39], 0 offen sc1
s_waitcnt vmcnt(1)
s_cmp_eq_u32 s68, 1
s_cbranch_scc1 K5_G1s
s_cmp_gt_u32 s64, 33
s_cbranch_scc1 L_FIN
K5_SW0s:
s_mov_b32 s75, 0
K5_SP0s:
buffer_load_dword v6, v5, s[36:39], 0 offen sc1
s_add_u32 s75, s75, 1
s_cmp_gt_u32 s75, 0x8000
s_cbranch_scc1 L_TIMEOUT
s_waitcnt vmcnt(0)
v_cmp_le_u32 vcc, s65, v6
s_nop 0
s_cmp_eq_u64 vcc, -1
s_cbranch_scc0 K5_SP0s
K5_LC0s:
s_mov_b32 s42, 0x4000000
buffer_load_dwordx4 v[16:19], v1, s[40:43], s66 offen offset:0 sc1
s_add_u32 s80, s66, 10240
s_add_u32 s86, s80, s84
buffer_load_dwordx4 v[20:23], v1, s[40:43], s66 offen offset:1024 sc1
buffer_load_dwordx4 v[24:27], v1, s[40:43], s66 offen offset:2048 sc1
buffer_load_dwordx4 v[28:31], v1, s[40:43], s66 offen offset:3072 sc1
s_add_u32 s69, s66, 4096
buffer_load_dwordx4 v[32:35], v1, s[40:43], s69 offen offset:0 sc1
buffer_load_dwordx4 v[36:39], v1, s[40:43], s69 offen offset:1024 sc1
buffer_load_dwordx4 v[40:43], v1, s[40:43], s69 offen offset:2048 sc1
buffer_load_dwordx4 v[44:47], v1, s[40:43], s69 offen offset:3072 sc1
s_add_u32 s69, s66, 8192
buffer_load_dwordx4 v[48:51], v1, s[40:43], s69 offen offset:0 sc1
buffer_load_dwordx4 v[52:55], v1, s[40:43], s69 offen offset:1024 sc1
buffer_load_dword v6, v5, s[36:39], 0 offen sc1
s_waitcnt vmcnt(0)
s_branch K5_G1s
K5_W0s:
s_mov_b32 s75, 6
s_cmp_lt_u32 s65, 36
s_cbranch_scc0 K5_W0sR
K5_W0sL:
buffer_load_dword v6, v5, s[36:39], 0 offen sc1
s_waitcnt vmcnt(0)
v_cmp_le_u32 vcc, s65, v6
s_nop 0
s_cmp_eq_u64 vcc, -1
s_cbranch_scc1 K5_W0sR
s_sub_u32 s75, s75, 1
s_cmp_lg_u32 s75, 0
s_cbranch_scc1 K5_W0sL
s_branch K5_W0sR
K5_E0s:
ds_write_b32 v151, v84 offset:3072
ds_write_b32 v151, v85 offset:3076
ds_write_b32 v151, v86 offset:3584
ds_write_b32 v151, v87 offset:3588
ds_write_b32 v151, v88 offset:4096
ds_write_b32 v151, v89 offset:4100
ds_write_b32 v151, v90 offset:4608
ds_write_b32 v151, v91 offset:4612
ds_write_b32 v151, v92 offset:5120
ds_write_b32 v151, v93 offset:5124
ds_write_b32 v151, v94 offset:5632
ds_write_b32 v151, v95 offset:5636
s_waitcnt lgkmcnt(0)
s_barrier
s_branch L_FIN
K5_X1s:
s_cmp_lg_u32 s64, 19
s_cbranch_scc1 K5_NR1s
s_mov_b32 s44, s30
s_mov_b32 s45, s31
s_mov_b32 s74, 2621440
s_mov_b32 s46, s74
s_mov_b32 s81, 0
s_mov_b32 s62, 0
s_mov_b32 s100, 40960
s_mov_b32 s11, 4294926336
s_mov_b32 s67, 0
v_mov_b32 v148, v158
s_waitcnt vmcnt(0)
buffer_store_dword v8, v7, s[36:39], 0 offen sc1
s_mov_b32 s7, 0x7ff00000
s_nop 1
v_writelane_b32 v7, s7, 0
s_cmp_eq_u32 s68, 1
s_cbranch_scc1 K5_F0s
s_branch K5_NR1s
K5_NR1s:
s_cmp_gt_u32 s64, 33
s_cbranch_scc1 K5_E1s
buffer_load_dword v6, v5, s[36:39], 0 offen sc1
ds_write_b32 v151, v84 offset:27648
ds_write_b32 v151, v85 offset:27652
ds_write_b32 v151, v86 offset:28160
ds_write_b32 v151, v87 offset:28164
ds_write_b32 v151, v96 offset:28672
ds_write_b32 v151, v97 offset:28676
ds_write_b32 v151, v98 offset:29184
ds_write_b32 v151, v99 offset:29188
ds_write_b32 v151, v100 offset:29696
ds_write_b32 v151, v101 offset:29700
ds_write_b32 v151, v102 offset:30208
ds_write_b32 v151, v103 offset:30212
s_waitcnt lgkmcnt(0)
s_barrier
s_waitcnt vmcnt(0)
buffer_store_dword v8, v7, s[36:39], 0 offen sc1
v_cmp_le_u32 vcc, s65, v6
s_nop 0
s_cmp_eq_u64 vcc, -1
s_cselect_b32 s68, 1, 0
s_cselect_b32 s42, 0x4000000, 0
buffer_load_dwordx4 v[16:19], v1, s[40:43], s66 offen offset:0 sc1
s_add_u32 s80, s66, 10240
s_add_u32 s86, s80, s84
buffer_load_dwordx4 v[20:23], v1, s[40:43], s66 offen offset:1024 sc1
buffer_load_dwordx4 v[24:27], v1, s[40:43], s66 offen offset:2048 sc1
buffer_load_dwordx4 v[28:31], v1, s[40:43], s66 offen offset:3072 sc1
s_add_u32 s69, s66, 4096
buffer_load_dwordx4 v[32:35], v1, s[40:43], s69 offen offset:0 sc1
buffer_load_dwordx4 v[36:39], v1, s[40:43], s69 offen offset:1024 sc1
buffer_load_dwordx4 v[40:43], v1, s[40:43], s69 offen offset:2048 sc1
buffer_load_dwordx4 v[44:47], v1, s[40:43], s69 offen offset:3072 sc1
s_add_u32 s69, s66, 8192
buffer_load_dwordx4 v[48:51], v1, s[40:43], s69 offen offset:0 sc1
buffer_load_dwordx4 v[52:55], v1, s[40:43], s69 offen offset:1024 sc1
buffer_load_dword v6, v5, s[36:39], 0 offen sc1
v_add_u32 v8, s79, v11
s_mov_b32 s46, 0
s_mov_b32 s62, 0
s_cmp_eq_u32 s68, 0
s_cbranch_scc1 K5_N21s
s_waitcnt vmcnt(0)
buffer_store_dword v8, v7, s[36:39], 0 offen sc1
s_branch K5_G0s
K5_N21s:
s_waitcnt vmcnt(0)
v_cmp_le_u32 vcc, s65, v6
s_nop 0
s_cmp_eq_u64 vcc, -1
s_cselect_b32 s68, 1, 0
s_cselect_b32 s42, 0x4000000, 0
buffer_load_dwordx4 v[16:19], v1, s[40:43], s66 offen offset:0 sc1
s_add_u32 s80, s66, 10240
s_add_u32 s86, s80, s84
buffer_load_dwordx4 v[20:23], v1, s[40:43], s66 offen offset:1024 sc1
buffer_load_dwordx4 v[24:27], v1, s[40:43], s66 offen offset:2048 sc1
buffer_load_dwordx4 v[28:31], v1, s[40:43], s66 offen offset:3072 sc1
s_add_u32 s69, s66, 4096
buffer_load_dwordx4 v[32:35], v1, s[40:43], s69 offen offset:0 sc1
buffer_load_dwordx4 v[36:39], v1, s[40:43], s69 offen offset:1024 sc1
buffer_load_dwordx4 v[40:43], v1, s[40:43], s69 offen offset:2048 sc1
buffer_load_dwordx4 v[44:47], v1, s[40:43], s69 offen offset:3072 sc1
s_add_u32 s69, s66, 8192
buffer_load_dwordx4 v[48:51], v1, s[40:43], s69 offen offset:0 sc1
buffer_load_dwordx4 v[52:55], v1, s[40:43], s69 offen offset:1024 sc1
buffer_load_dword v6, v5, s[36:39], 0 offen sc1
buffer_store_dword v8, v7, s[36:39], 0 offen sc1
s_waitcnt vmcnt(1)
s_cmp_eq_u32 s68, 1
s_cbranch_scc1 K5_G0s
s_cmp_gt_u32 s64, 33
s_cbranch_scc1 L_FIN
K5_SW1s:
s_mov_b32 s75, 0
K5_SP1s:
buffer_load_dword v6, v5, s[36:39], 0 offen sc1
s_add_u32 s75, s75, 1
s_cmp_gt_u32 s75, 0x8000
s_cbranch_scc1 L_TIMEOUT
s_waitcnt vmcnt(0)
v_cmp_le_u32 vcc, s65, v6
s_nop 0
s_cmp_eq_u64 vcc, -1
s_cbranch_scc0 K5_SP1s
K5_LC1s:
s_mov_b32 s42, 0x4000000
buffer_load_dwordx4 v[16:19], v1, s[40:43], s66 offen offset:0 sc1
s_add_u32 s80, s66, 10240
s_add_u32 s86, s80, s84
buffer_load_dwordx4 v[20:23], v1, s[40:43], s66 offen offset:1024 sc1
buffer_load_dwordx4 v[24:27], v1, s[40:43], s66 offen offset:2048 sc1
buffer_load_dwordx4 v[28:31], v1, s[40:43], s66 offen offset:3072 sc1
s_add_u32 s69, s66, 4096
buffer_load_dwordx4 v[32:35], v1, s[40:43], s69 offen offset:0 sc1
buffer_load_dwordx4 v[36:39], v1, s[40:43], s69 offen offset:1024 sc1
buffer_load_dwordx4 v[40:43], v1, s[40:43], s69 offen offset:2048 sc1
buffer_load_dwordx4 v[44:47], v1, s[40:43], s69 offen offset:3072 sc1
s_add_u32 s69, s66, 8192
buffer_load_dwordx4 v[48:51], v1, s[40:43], s69 offen offset:0 sc1
buffer_load_dwordx4 v[52:55], v1, s[40:43], s69 offen offset:1024 sc1
buffer_load_dword v6, v5, s[36:39], 0 offen sc1
s_waitcnt vmcnt(0)
s_branch K5_G0s
K5_W1s:
s_mov_b32 s75, 6
s_cmp_lt_u32 s65, 36
s_cbranch_scc0 K5_W1sR
K5_W1sL:
buffer_load_dword v6, v5, s[36:39], 0 offen sc1
s_waitcnt vmcnt(0)
v_cmp_le_u32 vcc, s65, v6
s_nop 0
s_cmp_eq_u64 vcc, -1
s_cbranch_scc1 K5_W1sR
s_sub_u32 s75, s75, 1
s_cmp_lg_u32 s75, 0
s_cbranch_scc1 K5_W1sL
s_branch K5_W1sR
K5_E1s:
ds_write_b32 v151, v84 offset:27648
ds_write_b32 v151, v85 offset:27652
ds_write_b32 v151, v86 offset:28160
ds_write_b32 v151, v87 offset:28164
ds_write_b32 v151, v96 offset:28672
ds_write_b32 v151, v97 offset:28676
ds_write_b32 v151, v98 offset:29184
ds_write_b32 v151, v99 offset:29188
ds_write_b32 v151, v100 offset:29696
ds_write_b32 v151, v101 offset:29700
ds_write_b32 v151, v102 offset:30208
ds_write_b32 v151, v103 offset:30212
s_waitcnt lgkmcnt(0)
s_barrier
s_branch L_FIN
K5_G0s:
v_mfma_f32_16x16x32_bf16 v[72:75], a[0:3], v[16:19], 0
ds_write_b32 v151, v84 offset:27648
v_mfma_f32_16x16x32_bf16 v[72:75], a[24:27], v[20:23], v[72:75]
ds_write_b32 v151, v85 offset:27652
v_mfma_f32_16x16x32_bf16 v[72:75], a[48:51], v[24:27], v[72:75]
buffer_load_dwordx4 v[56:59], v1, s[36:39], s80 offen offset:0 sc1
v_mfma_f32_16x16x32_bf16 v[72:75], a[72:75], v[28:31], v[72:75]
ds_write_b32 v151, v86 offset:28160
v_mfma_f32_16x16x32_bf16 v[76:79], a[4:7], v[16:19], 0
ds_write_b32 v151, v87 offset:28164
v_mfma_f32_16x16x32_bf16 v[76:79], a[28:31], v[20:23], v[76:79]
ds_write_b32 v151, v96 offset:28672
v_mfma_f32_16x16x32_bf16 v[76:79], a[52:55], v[24:27], v[76:79]
ds_write_b32 v151, v97 offset:28676
v_mfma_f32_16x16x32_bf16 v[76:79], a[76:79], v[28:31], v[76:79]
buffer_load_dwordx4 v[60:63], v1, s[36:39], s80 offen offset:1024 sc1
v_mfma_f32_16x16x32_bf16 v[80:83], a[8:11], v[16:19], 0
ds_write_b32 v151, v98 offset:29184
v_mfma_f32_16x16x32_bf16 v[80:83], a[32:35], v[20:23], v[80:83]
ds_write_b32 v151, v99 offset:29188
v_mfma_f32_16x16x32_bf16 v[80:83], a[56:59], v[24:27], v[80:83]
ds_write_b32 v151, v100 offset:29696
v_mfma_f32_16x16x32_bf16 v[80:83], a[80:83], v[28:31], v[80:83]
ds_write_b32 v151, v101 offset:29700
v_mfma_f32_16x16x32_bf16 v[84:87], a[12:15], v[16:19], 0
buffer_load_dwordx4 v[64:67], v1, s[36:39], s80 offen offset:2048 sc1
v_mfma_f32_16x16x32_bf16 v[84:87], a[36:39], v[20:23], v[84:87]
ds_write_b32 v151, v102 offset:30208
v_mfma_f32_16x16x32_bf16 v[84:87], a[60:63], v[24:27], v[84:87]
ds_write_b32 v151, v103 offset:30212
v_mfma_f32_16x16x32_bf16 v[84:87], a[84:87], v[28:31], v[84:87]
v_mfma_f32_16x16x32_bf16 v[88:91], a[16:19], v[16:19], 0
v_mfma_f32_16x16x32_bf16 v[88:91], a[40:43], v[20:23], v[88:91]
buffer_load_dwordx4 v[68:71], v1, s[36:39], s86 offen offset:3072 sc1
v_mfma_f32_16x16x32_bf16 v[88:91], a[64:67], v[24:27], v[88:91]
s_waitcnt lgkmcnt(0)
v_mfma_f32_16x16x32_bf16 v[88:91], a[88:91], v[28:31], v[88:91]
s_branch K5_B0s
K5_G1s:
v_mfma_f32_16x16x32_bf16 v[72:75], a[0:3], v[16:19], 0
ds_write_b32 v151, v84 offset:3072
v_mfma_f32_16x16x32_bf16 v[72:75], a[24:27], v[20:23], v[72:75]
ds_write_b32 v151, v85 offset:3076
v_mfma_f32_16x16x32_bf16 v[72:75], a[48:51], v[24:27], v[72:75]
buffer_load_dwordx4 v[56:59], v1, s[36:39], s80 offen offset:0 sc1
v_mfma_f32_16x16x32_bf16 v[72:75], a[72:75], v[28:31], v[72:75]
ds_write_b32 v151, v86 offset:3584
v_mfma_f32_16x16x32_bf16 v[76:79], a[4:7], v[16:19], 0
ds_write_b32 v151, v87 offset:3588
v_mfma_f32_16x16x32_bf16 v[76:79], a[28:31], v[20:23], v[76:79]
ds_write_b32 v151, v88 offset:4096
v_mfma_f32_16x16x32_bf16 v[76:79], a[52:55], v[24:27], v[76:79]
ds_write_b32 v151, v89 offset:4100
v_mfma_f32_16x16x32_bf16 v[76:79], a[76:79], v[28:31], v[76:79]
buffer_load_dwordx4 v[60:63], v1, s[36:39], s80 offen offset:1024 sc1
v_mfma_f32_16x16x32_bf16 v[80:83], a[8:11], v[16:19], 0
ds_write_b32 v151, v90 offset:4608
v_mfma_f32_16x16x32_bf16 v[80:83], a[32:35], v[20:23], v[80:83]
ds_write_b32 v151, v91 offset:4612
v_mfma_f32_16x16x32_bf16 v[80:83], a[56:59], v[24:27], v[80:83]
ds_write_b32 v151, v92 offset:5120
v_mfma_f32_16x16x32_bf16 v[80:83], a[80:83], v[28:31], v[80:83]
ds_write_b32 v151, v93 offset:5124
v_mfma_f32_16x16x32_bf16 v[84:87], a[12:15], v[16:19], 0
buffer_load_dwordx4 v[64:67], v1, s[36:39], s80 offen offset:2048 sc1
v_mfma_f32_16x16x32_bf16 v[84:87], a[36:39], v[20:23], v[84:87]
ds_write_b32 v151, v94 offset:5632
v_mfma_f32_16x16x32_bf16 v[84:87], a[60:63], v[24:27], v[84:87]
ds_write_b32 v151, v95 offset:5636
v_mfma_f32_16x16x32_bf16 v[84:87], a[84:87], v[28:31], v[84:87]
v_mfma_f32_16x16x32_bf16 v[96:99], a[16:19], v[16:19], 0
v_mfma_f32_16x16x32_bf16 v[96:99], a[40:43], v[20:23], v[96:99]
buffer_load_dwordx4 v[68:71], v1, s[36:39], s86 offen offset:3072 sc1
v_mfma_f32_16x16x32_bf16 v[96:99], a[64:67], v[24:27], v[96:99]
s_waitcnt lgkmcnt(0)
v_mfma_f32_16x16x32_bf16 v[96:99], a[88:91], v[28:31], v[96:99]
s_branch K5_B1s
.p2align 6
K2_U0s:
v_mfma_f32_16x16x32_bf16 v[64:67], v[224:227], v[40:43], v[64:67]
s_barrier

v_mfma_f32_16x16x32_bf16 v[64:67], v[240:243], v[44:47], v[64:67]
s_mul_i32 s67, s0, s100
ds_read2st64_b64 v[16:19], v104 offset0:0 offset1:1
s_add_u32 s67, s67, s11
v_mfma_f32_16x16x32_bf16 v[68:71], v[196:199], v[32:35], v[68:71]
s_mov_b32 s46, s74
ds_read2st64_b64 v[20:23], v104 offset0:2 offset1:3
s_add_u32 s79, s13, 1
v_mfma_f32_16x16x32_bf16 v[68:71], v[212:215], v[36:39], v[68:71]
s_mov_b32 s64, s13
ds_read2st64_b64 v[24:27], v104 offset0:4 offset1:5
s_mov_b32 s0, s1
v_mfma_f32_16x16x32_bf16 v[68:71], v[228:231], v[40:43], v[68:71]
s_add_u32 s13, s64, 1
ds_read2st64_b64 v[28:31], v104 offset0:6 offset1:7
s_cmp_eq_u32 s13, 17
v_mfma_f32_16x16x32_bf16 v[68:71], v[244:247], v[44:47], v[68:71]
s_addc_u32 s13, s13, 0
s_sub_u32 s1, s13, 17
s_cselect_b32 s1, s13, s1
v_mfma_f32_16x16x32_bf16 v[72:75], v[200:203], v[32:35], v[72:75]
s_and_b32 s66, s13, 7
s_mul_i32 s66, s66, 24576
s_add_u32 s66, s66, s10
v_mfma_f32_16x16x32_bf16 v[72:75], v[216:219], v[36:39], v[72:75]
s_add_u32 s65, s13, 2
v_add_f32 v132, v64, v65
v_mul_f32 v133, v64, v64
v_mfma_f32_16x16x32_bf16 v[72:75], v[232:235], v[40:43], v[72:75]
s_waitcnt vmcnt(0)
v_cmp_le_u32 vcc, s65, v6
v_fmac_f32 v133, v65, v65
v_mfma_f32_16x16x32_bf16 v[72:75], v[248:251], v[44:47], v[72:75]
s_cmp_eq_u64 vcc, -1
v_fmac_f32 v133, v66, v66
v_add_f32 v132, v132, v66
v_mfma_f32_16x16x32_bf16 v[76:79], v[204:207], v[32:35], v[76:79]
s_cbranch_scc0 K2_W0s
K2_W0sR:
s_cselect_b32 s68, 1, 0
v_mfma_f32_16x16x32_bf16 v[76:79], v[220:223], v[36:39], v[76:79]
s_cselect_b32 s42, 0x4000000, 0
s_mul_i32 s71, s1, 24576
s_add_u32 s71, s71, s12
v_mfma_f32_16x16x32_bf16 v[76:79], v[236:239], v[40:43], v[76:79]
buffer_load_dwordx4 v[108:111], v105, s[40:43], s71 offen sc1
v_mfma_f32_16x16x32_bf16 v[76:79], v[252:255], v[44:47], v[76:79]
s_waitcnt lgkmcnt(0)
v_fmac_f32 v133, v67, v67
v_add_f32 v132, v132, v67
K2_F0s:
v_mfma_f32_16x16x32_bf16 v[48:51], a[0:3], v[16:19], v[116:119]
ds_read2st64_b64 v[32:35], v104 offset0:8 offset1:9
v_fmac_f32 v133, v68, v68
v_mfma_f32_16x16x32_bf16 v[48:51], a[16:19], v[20:23], v[48:51]
buffer_load_dwordx4 v[112:115], v106, s[40:43], s71 offen sc1
v_mfma_f32_16x16x32_bf16 v[48:51], a[32:35], v[24:27], v[48:51]
s_add_u32 s69, s66, 4096
ds_read2st64_b64 v[36:39], v104 offset0:10 offset1:11
s_add_u32 m0, s72, 28672
v_mfma_f32_16x16x32_bf16 v[48:51], a[48:51], v[28:31], v[48:51]
s_waitcnt vmcnt(3)
v_add_f32 v132, v132, v68
v_fmac_f32 v133, v69, v69
v_mfma_f32_16x16x32_bf16 v[52:55], a[4:7], v[16:19], v[120:123]
ds_read2st64_b64 v[40:43], v104 offset0:12 offset1:13
v_add_f32 v132, v132, v69
v_mfma_f32_16x16x32_bf16 v[52:55], a[20:23], v[20:23], v[52:55]
buffer_load_dwordx4 v1, s[40:43], s69 offen offset:0 sc1 lds
v_mfma_f32_16x16x32_bf16 v[52:55], a[36:39], v[24:27], v[52:55]
s_add_u32 m0, s72, 24576
ds_read2st64_b64 v[44:47], v104 offset0:14 offset1:15
v_fmac_f32 v133, v70, v70
v_mfma_f32_16x16x32_bf16 v[52:55], a[52:55], v[28:31], v[52:55]
buffer_store_dword v8, v7, s[36:39], 0 offen sc1
v_mfma_f32_16x16x32_bf16 v[56:59], a[8:11], v[16:19], v[124:127]
v_add_u32 v8, s79, v11
v_add_f32 v132, v132, v70
v_mfma_f32_16x16x32_bf16 v[56:59], a[24:27], v[20:23], v[56:59]
buffer_load_dwordx4 v1, s[40:43], s66 offen offset:0 sc1 lds
v_mfma_f32_16x16x32_bf16 v[56:59], a[40:43], v[24:27], v[56:59]
v_fmac_f32 v133, v71, v71
v_add_f32 v132, v132, v71
v_mfma_f32_16x16x32_bf16 v[56:59], a[56:59], v[28:31], v[56:59]
v_cvt_pk_bf16_f32 v96, v64, v65
v_cvt_pk_bf16_f32 v97, v66, v67
v_mfma_f32_16x16x32_bf16 v[60:63], a[12:15], v[16:19], v[128:131]
buffer_load_dwordx4 v1, s[40:43], s66 offen offset:1024 sc1 lds
v_mfma_f32_16x16x32_bf16 v[60:63], a[28:31], v[20:23], v[60:63]
v_cvt_pk_bf16_f32 v98, v68, v69
v_cvt_pk_bf16_f32 v99, v70, v71
v_mfma_f32_16x16x32_bf16 v[60:63], a[44:47], v[24:27], v[60:63]
buffer_store_dwordx4 v[96:99], v105, s[44:47], s67 offen sc1
v_mfma_f32_16x16x32_bf16 v[60:63], a[60:63], v[28:31], v[60:63]
s_waitcnt lgkmcnt(0)
v_add_f32 v134, v72, v73
v_mul_f32 v135, v72, v72
v_mfma_f32_16x16x32_bf16 v[48:51], a[64:67], v[32:35], v[48:51]
ds_read2st64_b64 v[16:19], v104 offset0:16 offset1:17
v_fmac_f32 v135, v73, v73
v_mfma_f32_16x16x32_bf16 v[48:51], a[80:83], v[36:39], v[48:51]
buffer_load_dwordx4 v1, s[40:43], s66 offen offset:2048 sc1 lds
v_mfma_f32_16x16x32_bf16 v[48:51], a[96:99], v[40:43], v[48:51]
ds_read2st64_b64 v[20:23], v104 offset0:18 offset1:19
v_fmac_f32 v135, v74, v74
v_mfma_f32_16x16x32_bf16 v[48:51], a[112:115], v[44:47], v[48:51]
v_add_f32 v134, v134, v74
v_fmac_f32 v135, v75, v75
v_mfma_f32_16x16x32_bf16 v[52:55], a[68:71], v[32:35], v[52:55]
ds_read2st64_b64 v[24:27], v104 offset0:20 offset1:21
v_add_f32 v134, v134, v75
v_mfma_f32_16x16x32_bf16 v[52:55], a[84:87], v[36:39], v[52:55]
buffer_load_dwordx4 v1, s[40:43], s66 offen offset:3072 sc1 lds
v_mfma_f32_16x16x32_bf16 v[52:55], a[100:103], v[40:43], v[52:55]
ds_read2st64_b64 v[28:31], v104 offset0:22 offset1:23
v_fmac_f32 v135, v76, v76
v_mfma_f32_16x16x32_bf16 v[52:55], a[116:119], v[44:47], v[52:55]
v_add_f32 v134, v134, v76
v_fmac_f32 v135, v77, v77
v_mfma_f32_16x16x32_bf16 v[56:59], a[72:75], v[32:35], v[56:59]
v_add_f32 v134, v134, v77
v_fmac_f32 v135, v78, v78
v_mfma_f32_16x16x32_bf16 v[56:59], a[88:91], v[36:39], v[56:59]
v_add_f32 v134, v134, v78
v_fmac_f32 v135, v79, v79
v_mfma_f32_16x16x32_bf16 v[56:59], a[104:107], v[40:43], v[56:59]
v_add_f32 v134, v134, v79
v_cvt_pk_bf16_f32 v100, v72, v73
v_mfma_f32_16x16x32_bf16 v[56:59], a[120:123], v[44:47], v[56:59]
v_cvt_pk_bf16_f32 v101, v74, v75
v_cvt_pk_bf16_f32 v102, v76, v77
v_mfma_f32_16x16x32_bf16 v[60:63], a[76:79], v[32:35], v[60:63]
v_cvt_pk_bf16_f32 v103, v78, v79
v_mfma_f32_16x16x32_bf16 v[60:63], a[92:95], v[36:39], v[60:63]
buffer_store_dwordx4 v[100:103], v106, s[44:47], s67 offen sc1
v_mfma_f32_16x16x32_bf16 v[60:63], a[108:111], v[40:43], v[60:63]
v_permlane32_swap_b32 v132, v133
v_mfma_f32_16x16x32_bf16 v[60:63], a[124:127], v[44:47], v[60:63]
s_waitcnt lgkmcnt(0)
v_permlane32_swap_b32 v134, v135
v_mfma_f32_16x16x32_bf16 v[48:51], a[128:131], v[16:19], v[48:51]
ds_read2st64_b64 v[32:35], v104 offset0:24 offset1:25
v_add_f32 v132, v132, v133
v_mfma_f32_16x16x32_bf16 v[48:51], a[144:147], v[20:23], v[48:51]
v_add_f32 v134, v134, v135
v_mfma_f32_16x16x32_bf16 v[48:51], a[160:163], v[24:27], v[48:51]
ds_read2st64_b64 v[36:39], v104 offset0:26 offset1:27
v_mfma_f32_16x16x32_bf16 v[48:51], a[176:179], v[28:31], v[48:51]
v_permlane16_swap_b32 v132, v134
v_mfma_f32_16x16x32_bf16 v[52:55], a[132:135], v[16:19], v[52:55]
ds_read2st64_b64 v[40:43], v104 offset0:28 offset1:29
v_add_f32 v132, v132, v134
v_mfma_f32_16x16x32_bf16 v[52:55], a[148:151], v[20:23], v[52:55]
v_fma_f32 v132, v132, s76, v137
v_mfma_f32_16x16x32_bf16 v[52:55], a[164:167], v[24:27], v[52:55]
ds_read2st64_b64 v[44:47], v104 offset0:30 offset1:31
v_mfma_f32_16x16x32_bf16 v[52:55], a[180:183], v[28:31], v[52:55]
buffer_store_dword v132, v136, s[44:47], s67 offen sc1
v_mfma_f32_16x16x32_bf16 v[56:59], a[136:139], v[16:19], v[56:59]
v_mfma_f32_16x16x32_bf16 v[56:59], a[152:155], v[20:23], v[56:59]
v_mfma_f32_16x16x32_bf16 v[56:59], a[168:171], v[24:27], v[56:59]
buffer_load_dword v6, v5, s[36:39], 0 offen sc1
v_mfma_f32_16x16x32_bf16 v[56:59], a[184:187], v[28:31], v[56:59]
s_cmp_eq_u32 s68, 0
v_mfma_f32_16x16x32_bf16 v[60:63], a[140:143], v[16:19], v[60:63]
v_mfma_f32_16x16x32_bf16 v[60:63], a[156:159], v[20:23], v[60:63]
v_mfma_f32_16x16x32_bf16 v[60:63], a[172:175], v[24:27], v[60:63]
v_mfma_f32_16x16x32_bf16 v[60:63], a[188:191], v[28:31], v[60:63]
s_waitcnt lgkmcnt(0)
v_mfma_f32_16x16x32_bf16 v[48:51], a[192:195], v[32:35], v[48:51]
ds_read2st64_b64 v[16:19], v104 offset0:32 offset1:33
v_mfma_f32_16x16x32_bf16 v[48:51], a[208:211], v[36:39], v[48:51]
v_mfma_f32_16x16x32_bf16 v[48:51], a[224:227], v[40:43], v[48:51]
ds_read2st64_b64 v[20:23], v104 offset0:34 offset1:35
v_mfma_f32_16x16x32_bf16 v[48:51], a[240:243], v[44:47], v[48:51]
v_mfma_f32_16x16x32_bf16 v[52:55], a[196:199], v[32:35], v[52:55]
s_waitcnt vmcnt(10)
ds_read2st64_b64 v[24:27], v104 offset0:36 offset1:37
v_lshlrev_b32 v116, 16, v108
v_mfma_f32_16x16x32_bf16 v[52:55], a[212:215], v[36:39], v[52:55]
v_and_b32 v117, 0xffff0000, v108
v_lshlrev_b32 v118, 16, v109
v_mfma_f32_16x16x32_bf16 v[52:55], a[228:231], v[40:43], v[52:55]
ds_read2st64_b64 v[28:31], v104 offset0:38 offset1:39
v_and_b32 v119, 0xffff0000, v109
v_mfma_f32_16x16x32_bf16 v[52:55], a[244:247], v[44:47], v[52:55]
v_lshlrev_b32 v120, 16, v110
v_and_b32 v121, 0xffff0000, v110
v_mfma_f32_16x16x32_bf16 v[56:59], a[200:203], v[32:35], v[56:59]
v_lshlrev_b32 v122, 16, v111
v_and_b32 v123, 0xffff0000, v111
v_mfma_f32_16x16x32_bf16 v[56:59], a[216:219], v[36:39], v[56:59]
v_lshlrev_b32 v124, 16, v112
v_and_b32 v125, 0xffff0000, v112
v_mfma_f32_16x16x32_bf16 v[56:59], a[232:235], v[40:43], v[56:59]
v_lshlrev_b32 v126, 16, v113
v_and_b32 v127, 0xffff0000, v113
v_mfma_f32_16x16x32_bf16 v[56:59], a[248:251], v[44:47], v[56:59]
v_lshlrev_b32 v128, 16, v114
v_and_b32 v129, 0xffff0000, v114
v_mfma_f32_16x16x32_bf16 v[60:63], a[204:207], v[32:35], v[60:63]
v_lshlrev_b32 v130, 16, v115
v_and_b32 v131, 0xffff0000, v115
v_mfma_f32_16x16x32_bf16 v[60:63], a[220:223], v[36:39], v[60:63]
v_mfma_f32_16x16x32_bf16 v[60:63], a[236:239], v[40:43], v[60:63]
v_mfma_f32_16x16x32_bf16 v[60:63], a[252:255], v[44:47], v[60:63]
s_waitcnt lgkmcnt(0)
v_mfma_f32_16x16x32_bf16 v[48:51], v[192:195], v[16:19], v[48:51]
s_waitcnt vmcnt(3) lgkmcnt(0)
v_mfma_f32_16x16x32_bf16 v[48:51], v[208:211], v[20:23], v[48:51]
s_cbranch_scc1 K2_X0s
K2_U1s:
v_mfma_f32_16x16x32_bf16 v[48:51], v[224:227], v[24:27], v[48:51]
s_barrier

v_mfma_f32_16x16x32_bf16 v[48:51], v[240:243], v[28:31], v[48:51]
s_mul_i32 s67, s0, s100
ds_read2st64_b64 v[32:35], v104 offset0:48 offset1:49
s_add_u32 s67, s67, s11
v_mfma_f32_16x16x32_bf16 v[52:55], v[196:199], v[16:19], v[52:55]
s_mov_b32 s46, s74
ds_read2st64_b64 v[36:39], v104 offset0:50 offset1:51
s_add_u32 s79, s13, 1
v_mfma_f32_16x16x32_bf16 v[52:55], v[212:215], v[20:23], v[52:55]
s_mov_b32 s64, s13
ds_read2st64_b64 v[40:43], v104 offset0:52 offset1:53
s_mov_b32 s0, s1
v_mfma_f32_16x16x32_bf16 v[52:55], v[228:231], v[24:27], v[52:55]
s_add_u32 s13, s64, 1
ds_read2st64_b64 v[44:47], v104 offset0:54 offset1:55
s_cmp_eq_u32 s13, 17
v_mfma_f32_16x16x32_bf16 v[52:55], v[244:247], v[28:31], v[52:55]
s_addc_u32 s13, s13, 0
s_sub_u32 s1, s13, 17
s_cselect_b32 s1, s13, s1
v_mfma_f32_16x16x32_bf16 v[56:59], v[200:203], v[16:19], v[56:59]
s_and_b32 s66, s13, 7
s_mul_i32 s66, s66, 24576
s_add_u32 s66, s66, s10
v_mfma_f32_16x16x32_bf16 v[56:59], v[216:219], v[20:23], v[56:59]
s_add_u32 s65, s13, 2
v_add_f32 v132, v48, v49
v_mul_f32 v133, v48, v48
v_mfma_f32_16x16x32_bf16 v[56:59], v[232:235], v[24:27], v[56:59]
s_waitcnt vmcnt(0)
v_cmp_le_u32 vcc, s65, v6
v_fmac_f32 v133, v49, v49
v_mfma_f32_16x16x32_bf16 v[56:59], v[248:251], v[28:31], v[56:59]
s_cmp_eq_u64 vcc, -1
v_fmac_f32 v133, v50, v50
v_add_f32 v132, v132, v50
v_mfma_f32_16x16x32_bf16 v[60:63], v[204:207], v[16:19], v[60:63]
s_cbranch_scc0 K2_W1s
K2_W1sR:
s_cselect_b32 s68, 1, 0
v_mfma_f32_16x16x32_bf16 v[60:63], v[220:223], v[20:23], v[60:63]
s_cselect_b32 s42, 0x4000000, 0
s_mul_i32 s71, s1, 24576
s_add_u32 s71, s71, s12
v_mfma_f32_16x16x32_bf16 v[60:63], v[236:239], v[24:27], v[60:63]
buffer_load_dwordx4 v[108:111], v105, s[40:43], s71 offen sc1
v_mfma_f32_16x16x32_bf16 v[60:63], v[252:255], v[28:31], v[60:63]
s_waitcnt lgkmcnt(0)
v_fmac_f32 v133, v51, v51
v_add_f32 v132, v132, v51
K2_F1s:
v_mfma_f32_16x16x32_bf16 v[64:67], a[0:3], v[32:35], v[116:119]
ds_read2st64_b64 v[16:19], v104 offset0:56 offset1:57
v_fmac_f32 v133, v52, v52
v_mfma_f32_16x16x32_bf16 v[64:67], a[16:19], v[36:39], v[64:67]
buffer_load_dwordx4 v[112:115], v106, s[40:43], s71 offen sc1
v_mfma_f32_16x16x32_bf16 v[64:67], a[32:35], v[40:43], v[64:67]
s_add_u32 s69, s66, 4096
ds_read2st64_b64 v[20:23], v104 offset0:58 offset1:59
s_add_u32 m0, s72, 4096
v_mfma_f32_16x16x32_bf16 v[64:67], a[48:51], v[44:47], v[64:67]
s_waitcnt vmcnt(3)
v_add_f32 v132, v132, v52
v_fmac_f32 v133, v53, v53
v_mfma_f32_16x16x32_bf16 v[68:71], a[4:7], v[32:35], v[120:123]
ds_read2st64_b64 v[24:27], v104 offset0:60 offset1:61
v_add_f32 v132, v132, v53
v_mfma_f32_16x16x32_bf16 v[68:71], a[20:23], v[36:39], v[68:71]
buffer_load_dwordx4 v1, s[40:43], s69 offen offset:0 sc1 lds
v_mfma_f32_16x16x32_bf16 v[68:71], a[36:39], v[40:43], v[68:71]
s_add_u32 m0, s72, 0
ds_read2st64_b64 v[28:31], v104 offset0:62 offset1:63
v_fmac_f32 v133, v54, v54
v_mfma_f32_16x16x32_bf16 v[68:71], a[52:55], v[44:47], v[68:71]
buffer_store_dword v8, v7, s[36:39], 0 offen sc1
v_mfma_f32_16x16x32_bf16 v[72:75], a[8:11], v[32:35], v[124:127]
v_add_u32 v8, s79, v11
v_add_f32 v132, v132, v54
v_mfma_f32_16x16x32_bf16 v[72:75], a[24:27], v[36:39], v[72:75]
buffer_load_dwordx4 v1, s[40:43], s66 offen offset:0 sc1 lds
v_mfma_f32_16x16x32_bf16 v[72:75], a[40:43], v[40:43], v[72:75]
v_fmac_f32 v133, v55, v55
v_add_f32 v132, v132, v55
v_mfma_f32_16x16x32_bf16 v[72:75], a[56:59], v[44:47], v[72:75]
v_cvt_pk_bf16_f32 v96, v48, v49
v_cvt_pk_bf16_f32 v97, v50, v51
v_mfma_f32_16x16x32_bf16 v[76:79], a[12:15], v[32:35], v[128:131]
buffer_load_dwordx4 v1, s[40:43], s66 offen offset:1024 sc1 lds
v_mfma_f32_16x16x32_bf16 v[76:79], a[28:31], v[36:39], v[76:79]
v_cvt_pk_bf16_f32 v98, v52, v53
v_cvt_pk_bf16_f32 v99, v54, v55
v_mfma_f32_16x16x32_bf16 v[76:79], a[44:47], v[40:43], v[76:79]
buffer_store_dwordx4 v[96:99], v105, s[44:47], s67 offen sc1
v_mfma_f32_16x16x32_bf16 v[76:79], a[60:63], v[44:47], v[76:79]
s_waitcnt lgkmcnt(0)
v_add_f32 v134, v56, v57
v_mul_f32 v135, v56, v56
v_mfma_f32_16x16x32_bf16 v[64:67], a[64:67], v[16:19], v[64:67]
ds_read2st64_b64 v[32:35], v104 offset0:64 offset1:65
v_fmac_f32 v135, v57, v57
v_mfma_f32_16x16x32_bf16 v[64:67], a[80:83], v[20:23], v[64:67]
buffer_load_dwordx4 v1, s[40:43], s66 offen offset:2048 sc1 lds
v_mfma_f32_16x16x32_bf16 v[64:67], a[96:99], v[24:27], v[64:67]
ds_read2st64_b64 v[36:39], v104 offset0:66 offset1:67
v_fmac_f32 v135, v58, v58
v_mfma_f32_16x16x32_bf16 v[64:67], a[112:115], v[28:31], v[64:67]
v_add_f32 v134, v134, v58
v_fmac_f32 v135, v59, v59
v_mfma_f32_16x16x32_bf16 v[68:71], a[68:71], v[16:19], v[68:71]
ds_read2st64_b64 v[40:43], v104 offset0:68 offset1:69
v_add_f32 v134, v134, v59
v_mfma_f32_16x16x32_bf16 v[68:71], a[84:87], v[20:23], v[68:71]
buffer_load_dwordx4 v1, s[40:43], s66 offen offset:3072 sc1 lds
v_mfma_f32_16x16x32_bf16 v[68:71], a[100:103], v[24:27], v[68:71]
ds_read2st64_b64 v[44:47], v104 offset0:70 offset1:71
v_fmac_f32 v135, v60, v60
v_mfma_f32_16x16x32_bf16 v[68:71], a[116:119], v[28:31], v[68:71]
v_add_f32 v134, v134, v60
v_fmac_f32 v135, v61, v61
v_mfma_f32_16x16x32_bf16 v[72:75], a[72:75], v[16:19], v[72:75]
v_add_f32 v134, v134, v61
v_fmac_f32 v135, v62, v62
v_mfma_f32_16x16x32_bf16 v[72:75], a[88:91], v[20:23], v[72:75]
v_add_f32 v134, v134, v62
v_fmac_f32 v135, v63, v63
v_mfma_f32_16x16x32_bf16 v[72:75], a[104:107], v[24:27], v[72:75]
v_add_f32 v134, v134, v63
v_cvt_pk_bf16_f32 v100, v56, v57
v_mfma_f32_16x16x32_bf16 v[72:75], a[120:123], v[28:31], v[72:75]
v_cvt_pk_bf16_f32 v101, v58, v59
v_cvt_pk_bf16_f32 v102, v60, v61
v_mfma_f32_16x16x32_bf16 v[76:79], a[76:79], v[16:19], v[76:79]
v_cvt_pk_bf16_f32 v103, v62, v63
v_mfma_f32_16x16x32_bf16 v[76:79], a[92:95], v[20:23], v[76:79]
buffer_store_dwordx4 v[100:103], v106, s[44:47], s67 offen sc1
v_mfma_f32_16x16x32_bf16 v[76:79], a[108:111], v[24:27], v[76:79]
v_permlane32_swap_b32 v132, v133
v_mfma_f32_16x16x32_bf16 v[76:79], a[124:127], v[28:31], v[76:79]
s_waitcnt lgkmcnt(0)
v_permlane32_swap_b32 v134, v135
v_mfma_f32_16x16x32_bf16 v[64:67], a[128:131], v[32:35], v[64:67]
ds_read2st64_b64 v[16:19], v104 offset0:72 offset1:73
v_add_f32 v132, v132, v133
v_mfma_f32_16x16x32_bf16 v[64:67], a[144:147], v[36:39], v[64:67]
v_add_f32 v134, v134, v135
v_mfma_f32_16x16x32_bf16 v[64:67], a[160:163], v[40:43], v[64:67]
ds_read2st64_b64 v[20:23], v104 offset0:74 offset1:75
v_mfma_f32_16x16x32_bf16 v[64:67], a[176:179], v[44:47], v[64:67]
v_permlane16_swap_b32 v132, v134
v_mfma_f32_16x16x32_bf16 v[68:71], a[132:135], v[32:35], v[68:71]
ds_read2st64_b64 v[24:27], v104 offset0:76 offset1:77
v_add_f32 v132, v132, v134
v_mfma_f32_16x16x32_bf16 v[68:71], a[148:151], v[36:39], v[68:71]
v_fma_f32 v132, v132, s76, v137
v_mfma_f32_16x16x32_bf16 v[68:71], a[164:167], v[40:43], v[68:71]
ds_read2st64_b64 v[28:31], v104 offset0:78 offset1:79
v_mfma_f32_16x16x32_bf16 v[68:71], a[180:183], v[44:47], v[68:71]
buffer_store_dword v132, v136, s[44:47], s67 offen sc1
v_mfma_f32_16x16x32_bf16 v[72:75], a[136:139], v[32:35], v[72:75]
v_mfma_f32_16x16x32_bf16 v[72:75], a[152:155], v[36:39], v[72:75]
v_mfma_f32_16x16x32_bf16 v[72:75], a[168:171], v[40:43], v[72:75]
buffer_load_dword v6, v5, s[36:39], 0 offen sc1
v_mfma_f32_16x16x32_bf16 v[72:75], a[184:187], v[44:47], v[72:75]
s_cmp_eq_u32 s68, 0
v_mfma_f32_16x16x32_bf16 v[76:79], a[140:143], v[32:35], v[76:79]
v_mfma_f32_16x16x32_bf16 v[76:79], a[156:159], v[36:39], v[76:79]
v_mfma_f32_16x16x32_bf16 v[76:79], a[172:175], v[40:43], v[76:79]
v_mfma_f32_16x16x32_bf16 v[76:79], a[188:191], v[44:47], v[76:79]
s_waitcnt lgkmcnt(0)
v_mfma_f32_16x16x32_bf16 v[64:67], a[192:195], v[16:19], v[64:67]
ds_read2st64_b64 v[32:35], v104 offset0:80 offset1:81
v_mfma_f32_16x16x32_bf16 v[64:67], a[208:211], v[20:23], v[64:67]
v_mfma_f32_16x16x32_bf16 v[64:67], a[224:227], v[24:27], v[64:67]
ds_read2st64_b64 v[36:39], v104 offset0:82 offset1:83
v_mfma_f32_16x16x32_bf16 v[64:67], a[240:243], v[28:31], v[64:67]
v_mfma_f32_16x16x32_bf16 v[68:71], a[196:199], v[16:19], v[68:71]
s_waitcnt vmcnt(10)
ds_read2st64_b64 v[40:43], v104 offset0:84 offset1:85
v_lshlrev_b32 v116, 16, v108
v_mfma_f32_16x16x32_bf16 v[68:71], a[212:215], v[20:23], v[68:71]
v_and_b32 v117, 0xffff0000, v108
v_lshlrev_b32 v118, 16, v109
v_mfma_f32_16x16x32_bf16 v[68:71], a[228:231], v[24:27], v[68:71]
ds_read2st64_b64 v[44:47], v104 offset0:86 offset1:87
v_and_b32 v119, 0xffff0000, v109
v_mfma_f32_16x16x32_bf16 v[68:71], a[244:247], v[28:31], v[68:71]
v_lshlrev_b32 v120, 16, v110
v_and_b32 v121, 0xffff0000, v110
v_mfma_f32_16x16x32_bf16 v[72:75], a[200:203], v[16:19], v[72:75]
v_lshlrev_b32 v122, 16, v111
v_and_b32 v123, 0xffff0000, v111
v_mfma_f32_16x16x32_bf16 v[72:75], a[216:219], v[20:23], v[72:75]
v_lshlrev_b32 v124, 16, v112
v_and_b32 v125, 0xffff0000, v112
v_mfma_f32_16x16x32_bf16 v[72:75], a[232:235], v[24:27], v[72:75]
v_lshlrev_b32 v126, 16, v113
v_and_b32 v127, 0xffff0000, v113
v_mfma_f32_16x16x32_bf16 v[72:75], a[248:251], v[28:31], v[72:75]
v_lshlrev_b32 v128, 16, v114
v_and_b32 v129, 0xffff0000, v114
v_mfma_f32_16x16x32_bf16 v[76:79], a[204:207], v[16:19], v[76:79]
v_lshlrev_b32 v130, 16, v115
v_and_b32 v131, 0xffff0000, v115
v_mfma_f32_16x16x32_bf16 v[76:79], a[220:223], v[20:23], v[76:79]
v_mfma_f32_16x16x32_bf16 v[76:79], a[236:239], v[24:27], v[76:79]
v_mfma_f32_16x16x32_bf16 v[76:79], a[252:255], v[28:31], v[76:79]
s_waitcnt lgkmcnt(0)
v_mfma_f32_16x16x32_bf16 v[64:67], v[192:195], v[32:35], v[64:67]
s_waitcnt vmcnt(3) lgkmcnt(0)
v_mfma_f32_16x16x32_bf16 v[64:67], v[208:211], v[36:39], v[64:67]
s_cbranch_scc0 K2_U0s
K2_X1s:
K2_NR1s:
buffer_load_dword v6, v5, s[36:39], 0 offen sc1
v_mfma_f32_16x16x32_bf16 v[64:67], v[224:227], v[40:43], v[64:67]
s_mul_i32 s67, s0, s100
s_add_u32 s67, s67, s11
s_mov_b32 s46, s74
v_mfma_f32_16x16x32_bf16 v[64:67], v[240:243], v[44:47], v[64:67]
s_add_u32 s79, s13, 1
s_mov_b32 s64, s13
s_mov_b32 s0, s1
v_mfma_f32_16x16x32_bf16 v[68:71], v[196:199], v[32:35], v[68:71]
v_mfma_f32_16x16x32_bf16 v[68:71], v[212:215], v[36:39], v[68:71]
v_mfma_f32_16x16x32_bf16 v[68:71], v[228:231], v[40:43], v[68:71]
v_mfma_f32_16x16x32_bf16 v[68:71], v[244:247], v[44:47], v[68:71]
v_mfma_f32_16x16x32_bf16 v[72:75], v[200:203], v[32:35], v[72:75]
v_mfma_f32_16x16x32_bf16 v[72:75], v[216:219], v[36:39], v[72:75]
v_mfma_f32_16x16x32_bf16 v[72:75], v[232:235], v[40:43], v[72:75]
v_mfma_f32_16x16x32_bf16 v[72:75], v[248:251], v[44:47], v[72:75]
v_mfma_f32_16x16x32_bf16 v[76:79], v[204:207], v[32:35], v[76:79]
v_mfma_f32_16x16x32_bf16 v[76:79], v[220:223], v[36:39], v[76:79]
v_mfma_f32_16x16x32_bf16 v[76:79], v[236:239], v[40:43], v[76:79]
v_mfma_f32_16x16x32_bf16 v[76:79], v[252:255], v[44:47], v[76:79]
s_waitcnt vmcnt(0)
buffer_store_dword v8, v7, s[36:39], 0 offen sc1
s_mov_b32 s68, 2
s_cmp_gt_u32 s64, 33
s_cbranch_scc1 K2_EP1s
v_cmp_le_u32 vcc, s65, v6
s_nop 0
s_cmp_eq_u64 vcc, -1
s_cselect_b32 s68, 1, 0
s_cselect_b32 s42, 0x4000000, 0
s_mul_i32 s71, s1, 24576
s_add_u32 s71, s71, s12
buffer_load_dwordx4 v[108:111], v105, s[40:43], s71 offen sc1
buffer_load_dwordx4 v[112:115], v106, s[40:43], s71 offen sc1
s_add_u32 s69, s66, 4096
s_add_u32 m0, s72, 4096
s_nop 0
buffer_load_dwordx4 v1, s[40:43], s69 offen offset:0 sc1 lds
s_add_u32 m0, s72, 0
s_nop 0
buffer_load_dwordx4 v1, s[40:43], s66 offen offset:0 sc1 lds
buffer_load_dwordx4 v1, s[40:43], s66 offen offset:1024 sc1 lds
buffer_load_dwordx4 v1, s[40:43], s66 offen offset:2048 sc1 lds
buffer_load_dwordx4 v1, s[40:43], s66 offen offset:3072 sc1 lds
buffer_load_dword v6, v5, s[36:39], 0 offen sc1
K2_EP1s:
v_add_f32 v132, v64, v65
v_mul_f32 v133, v64, v64
v_fmac_f32 v133, v65, v65
v_fmac_f32 v133, v66, v66
v_add_f32 v132, v132, v66
v_fmac_f32 v133, v67, v67
v_add_f32 v132, v132, v67
v_fmac_f32 v133, v68, v68
v_add_f32 v132, v132, v68
v_fmac_f32 v133, v69, v69
v_add_f32 v132, v132, v69
v_fmac_f32 v133, v70, v70
v_add_f32 v132, v132, v70
v_fmac_f32 v133, v71, v71
v_add_f32 v132, v132, v71
v_cvt_pk_bf16_f32 v96, v64, v65
v_cvt_pk_bf16_f32 v97, v66, v67
v_cvt_pk_bf16_f32 v98, v68, v69
v_cvt_pk_bf16_f32 v99, v70, v71
buffer_store_dwordx4 v[96:99], v105, s[44:47], s67 offen sc1
v_add_f32 v134, v72, v73
v_mul_f32 v135, v72, v72
v_fmac_f32 v135, v73, v73
v_fmac_f32 v135, v74, v74
v_add_f32 v134, v134, v74
v_fmac_f32 v135, v75, v75
v_add_f32 v134, v134, v75
v_fmac_f32 v135, v76, v76
v_add_f32 v134, v134, v76
v_fmac_f32 v135, v77, v77
v_add_f32 v134, v134, v77
v_fmac_f32 v135, v78, v78
v_add_f32 v134, v134, v78
v_fmac_f32 v135, v79, v79
v_add_f32 v134, v134, v79
v_cvt_pk_bf16_f32 v100, v72, v73
v_cvt_pk_bf16_f32 v101, v74, v75
v_cvt_pk_bf16_f32 v102, v76, v77
v_cvt_pk_bf16_f32 v103, v78, v79
buffer_store_dwordx4 v[100:103], v106, s[44:47], s67 offen sc1
v_permlane32_swap_b32 v132, v133
v_permlane32_swap_b32 v134, v135
v_add_f32 v132, v132, v133
v_add_f32 v134, v134, v135
s_nop 1
v_permlane16_swap_b32 v132, v134
v_add_f32 v132, v132, v134
v_fma_f32 v132, v132, s76, v137
buffer_store_dword v132, v136, s[44:47], s67 offen sc1
v_add_u32 v8, s79, v11
s_mov_b32 s46, 0
s_cmp_eq_u32 s68, 0
s_cbranch_scc1 K2_N21s
s_waitcnt vmcnt(0)
buffer_store_dword v8, v7, s[36:39], 0 offen sc1
s_cmp_eq_u32 s68, 2
s_cbranch_scc1 L_FIN
s_branch K2_GO1s
K2_N21s:
s_waitcnt vmcnt(3)
v_cmp_le_u32 vcc, s65, v6
s_nop 0
s_cmp_eq_u64 vcc, -1
s_cselect_b32 s68, 1, 0
s_cselect_b32 s42, 0x4000000, 0
s_mul_i32 s71, s1, 24576
s_add_u32 s71, s71, s12
buffer_load_dwordx4 v[108:111], v105, s[40:43], s71 offen sc1
buffer_load_dwordx4 v[112:115], v106, s[40:43], s71 offen sc1
s_add_u32 s69, s66, 4096
s_add_u32 m0, s72, 4096
s_nop 0
buffer_load_dwordx4 v1, s[40:43], s69 offen offset:0 sc1 lds
s_add_u32 m0, s72, 0
s_nop 0
buffer_load_dwordx4 v1, s[40:43], s66 offen offset:0 sc1 lds
buffer_load_dwordx4 v1, s[40:43], s66 offen offset:1024 sc1 lds
buffer_load_dwordx4 v1, s[40:43], s66 offen offset:2048 sc1 lds
buffer_load_dwordx4 v1, s[40:43], s66 offen offset:3072 sc1 lds
buffer_load_dword v6, v5, s[36:39], 0 offen sc1
s_waitcnt vmcnt(8)
buffer_store_dword v8, v7, s[36:39], 0 offen sc1
s_waitcnt vmcnt(1)
s_cmp_eq_u32 s68, 1
s_cbranch_scc1 K2_GO1s
K2_SW1s:
s_mov_b32 s75, 0
K2_SP1s:
buffer_load_dword v6, v5, s[36:39], 0 offen sc1
s_add_u32 s75, s75, 1
s_cmp_gt_u32 s75, 0x8000
s_cbranch_scc1 L_TIMEOUT
s_waitcnt vmcnt(0)
v_cmp_le_u32 vcc, s65, v6
s_nop 0
s_cmp_eq_u64 vcc, -1
s_cbranch_scc0 K2_SP1s
s_mov_b32 s42, 0x4000000
s_mul_i32 s71, s1, 24576
s_add_u32 s71, s71, s12
buffer_load_dwordx4 v[108:111], v105, s[40:43], s71 offen sc1
buffer_load_dwordx4 v[112:115], v106, s[40:43], s71 offen sc1
s_add_u32 s69, s66, 4096
s_add_u32 m0, s72, 4096
s_nop 0
buffer_load_dwordx4 v1, s[40:43], s69 offen offset:0 sc1 lds
s_add_u32 m0, s72, 0
s_nop 0
buffer_load_dwordx4 v1, s[40:43], s66 offen offset:0 sc1 lds
buffer_load_dwordx4 v1, s[40:43], s66 offen offset:1024 sc1 lds
buffer_load_dwordx4 v1, s[40:43], s66 offen offset:2048 sc1 lds
buffer_load_dwordx4 v1, s[40:43], s66 offen offset:3072 sc1 lds
buffer_load_dword v6, v5, s[36:39], 0 offen sc1
s_waitcnt vmcnt(0)
K2_GO1s:
v_lshlrev_b32 v116, 16, v108
v_and_b32 v117, 0xffff0000, v108
v_lshlrev_b32 v118, 16, v109
v_and_b32 v119, 0xffff0000, v109
v_lshlrev_b32 v120, 16, v110
v_and_b32 v121, 0xffff0000, v110
v_lshlrev_b32 v122, 16, v111
v_and_b32 v123, 0xffff0000, v111
v_lshlrev_b32 v124, 16, v112
v_and_b32 v125, 0xffff0000, v112
v_lshlrev_b32 v126, 16, v113
v_and_b32 v127, 0xffff0000, v113
v_lshlrev_b32 v128, 16, v114
v_and_b32 v129, 0xffff0000, v114
v_lshlrev_b32 v130, 16, v115
v_and_b32 v131, 0xffff0000, v115
s_barrier

ds_read2st64_b64 v[16:19], v104 offset0:0 offset1:1
ds_read2st64_b64 v[20:23], v104 offset0:2 offset1:3
ds_read2st64_b64 v[24:27], v104 offset0:4 offset1:5
s_add_u32 s13, s64, 1
ds_read2st64_b64 v[28:31], v104 offset0:6 offset1:7
s_cmp_eq_u32 s13, 17
s_addc_u32 s13, s13, 0
s_sub_u32 s1, s13, 17
s_cselect_b32 s1, s13, s1
s_and_b32 s66, s13, 7
s_mul_i32 s66, s66, 24576
s_add_u32 s66, s66, s10
s_add_u32 s65, s13, 2
v_add_f32 v132, v64, v65
v_mul_f32 v133, v64, v64
s_waitcnt vmcnt(0)
v_cmp_le_u32 vcc, s65, v6
v_fmac_f32 v133, v65, v65
s_cmp_eq_u64 vcc, -1
v_fmac_f32 v133, v66, v66
v_add_f32 v132, v132, v66
s_cbranch_scc0 K2_W0s_c
K2_W0s_cR:
s_cselect_b32 s68, 1, 0
s_cselect_b32 s42, 0x4000000, 0
s_mul_i32 s71, s1, 24576
s_add_u32 s71, s71, s12
buffer_load_dwordx4 v[108:111], v105, s[40:43], s71 offen sc1
s_waitcnt lgkmcnt(0)
v_fmac_f32 v133, v67, v67
v_add_f32 v132, v132, v67
s_nop 7
s_branch K2_F0s
K2_W1s:
s_mov_b32 s75, 6
s_cmp_lt_u32 s65, 36
s_cbranch_scc0 K2_W1sR
s_cmp_lg_u32 s65, 20
s_cbranch_scc0 K2_W1sR
K2_W1sL:
buffer_load_dword v6, v5, s[36:39], 0 offen sc1
s_waitcnt vmcnt(0)
v_cmp_le_u32 vcc, s65, v6
s_nop 0
s_cmp_eq_u64 vcc, -1
s_cbranch_scc1 K2_W1sR
s_sub_u32 s75, s75, 1
s_cmp_lg_u32 s75, 0
s_cbranch_scc1 K2_W1sL
s_branch K2_W1sR
K2_W0s_c:
s_mov_b32 s75, 6
s_cmp_lt_u32 s65, 36
s_cbranch_scc0 K2_W0s_cR
s_cmp_lg_u32 s65, 20
s_cbranch_scc0 K2_W0s_cR
K2_W0s_cL:
buffer_load_dword v6, v5, s[36:39], 0 offen sc1
s_waitcnt vmcnt(0)
v_cmp_le_u32 vcc, s65, v6
s_nop 0
s_cmp_eq_u64 vcc, -1
s_cbranch_scc1 K2_W0s_cR
s_sub_u32 s75, s75, 1
s_cmp_lg_u32 s75, 0
s_cbranch_scc1 K2_W0s_cL
s_branch K2_W0s_cR
K2_X0s:
K2_NR0s:
buffer_load_dword v6, v5, s[36:39], 0 offen sc1
v_mfma_f32_16x16x32_bf16 v[48:51], v[224:227], v[24:27], v[48:51]
s_mul_i32 s67, s0, s100
s_add_u32 s67, s67, s11
s_mov_b32 s46, s74
v_mfma_f32_16x16x32_bf16 v[48:51], v[240:243], v[28:31], v[48:51]
s_add_u32 s79, s13, 1
s_mov_b32 s64, s13
s_mov_b32 s0, s1
v_mfma_f32_16x16x32_bf16 v[52:55], v[196:199], v[16:19], v[52:55]
v_mfma_f32_16x16x32_bf16 v[52:55], v[212:215], v[20:23], v[52:55]
v_mfma_f32_16x16x32_bf16 v[52:55], v[228:231], v[24:27], v[52:55]
v_mfma_f32_16x16x32_bf16 v[52:55], v[244:247], v[28:31], v[52:55]
v_mfma_f32_16x16x32_bf16 v[56:59], v[200:203], v[16:19], v[56:59]
v_mfma_f32_16x16x32_bf16 v[56:59], v[216:219], v[20:23], v[56:59]
v_mfma_f32_16x16x32_bf16 v[56:59], v[232:235], v[24:27], v[56:59]
v_mfma_f32_16x16x32_bf16 v[56:59], v[248:251], v[28:31], v[56:59]
v_mfma_f32_16x16x32_bf16 v[60:63], v[204:207], v[16:19], v[60:63]
v_mfma_f32_16x16x32_bf16 v[60:63], v[220:223], v[20:23], v[60:63]
v_mfma_f32_16x16x32_bf16 v[60:63], v[236:239], v[24:27], v[60:63]
v_mfma_f32_16x16x32_bf16 v[60:63], v[252:255], v[28:31], v[60:63]
s_waitcnt vmcnt(0)
buffer_store_dword v8, v7, s[36:39], 0 offen sc1
s_mov_b32 s68, 2
s_cmp_gt_u32 s64, 33
s_cbranch_scc1 K2_EP0s
v_cmp_le_u32 vcc, s65, v6
s_nop 0
s_cmp_eq_u64 vcc, -1
s_cselect_b32 s68, 1, 0
s_cselect_b32 s42, 0x4000000, 0
s_mul_i32 s71, s1, 24576
s_add_u32 s71, s71, s12
buffer_load_dwordx4 v[108:111], v105, s[40:43], s71 offen sc1
buffer_load_dwordx4 v[112:115], v106, s[40:43], s71 offen sc1
s_add_u32 s69, s66, 4096
s_add_u32 m0, s72, 28672
s_nop 0
buffer_load_dwordx4 v1, s[40:43], s69 offen offset:0 sc1 lds
s_add_u32 m0, s72, 24576
s_nop 0
buffer_load_dwordx4 v1, s[40:43], s66 offen offset:0 sc1 lds
buffer_load_dwordx4 v1, s[40:43], s66 offen offset:1024 sc1 lds
buffer_load_dwordx4 v1, s[40:43], s66 offen offset:2048 sc1 lds
buffer_load_dwordx4 v1, s[40:43], s66 offen offset:3072 sc1 lds
buffer_load_dword v6, v5, s[36:39], 0 offen sc1
K2_EP0s:
v_add_f32 v132, v48, v49
v_mul_f32 v133, v48, v48
v_fmac_f32 v133, v49, v49
v_fmac_f32 v133, v50, v50
v_add_f32 v132, v132, v50
v_fmac_f32 v133, v51, v51
v_add_f32 v132, v132, v51
v_fmac_f32 v133, v52, v52
v_add_f32 v132, v132, v52
v_fmac_f32 v133, v53, v53
v_add_f32 v132, v132, v53
v_fmac_f32 v133, v54, v54
v_add_f32 v132, v132, v54
v_fmac_f32 v133, v55, v55
v_add_f32 v132, v132, v55
v_cvt_pk_bf16_f32 v96, v48, v49
v_cvt_pk_bf16_f32 v97, v50, v51
v_cvt_pk_bf16_f32 v98, v52, v53
v_cvt_pk_bf16_f32 v99, v54, v55
buffer_store_dwordx4 v[96:99], v105, s[44:47], s67 offen sc1
v_add_f32 v134, v56, v57
v_mul_f32 v135, v56, v56
v_fmac_f32 v135, v57, v57
v_fmac_f32 v135, v58, v58
v_add_f32 v134, v134, v58
v_fmac_f32 v135, v59, v59
v_add_f32 v134, v134, v59
v_fmac_f32 v135, v60, v60
v_add_f32 v134, v134, v60
v_fmac_f32 v135, v61, v61
v_add_f32 v134, v134, v61
v_fmac_f32 v135, v62, v62
v_add_f32 v134, v134, v62
v_fmac_f32 v135, v63, v63
v_add_f32 v134, v134, v63
v_cvt_pk_bf16_f32 v100, v56, v57
v_cvt_pk_bf16_f32 v101, v58, v59
v_cvt_pk_bf16_f32 v102, v60, v61
v_cvt_pk_bf16_f32 v103, v62, v63
buffer_store_dwordx4 v[100:103], v106, s[44:47], s67 offen sc1
v_permlane32_swap_b32 v132, v133
v_permlane32_swap_b32 v134, v135
v_add_f32 v132, v132, v133
v_add_f32 v134, v134, v135
s_nop 1
v_permlane16_swap_b32 v132, v134
v_add_f32 v132, v132, v134
v_fma_f32 v132, v132, s76, v137
buffer_store_dword v132, v136, s[44:47], s67 offen sc1
v_add_u32 v8, s79, v11
s_mov_b32 s46, 0
s_cmp_eq_u32 s68, 0
s_cbranch_scc1 K2_N20s
s_waitcnt vmcnt(0)
buffer_store_dword v8, v7, s[36:39], 0 offen sc1
s_cmp_eq_u32 s68, 2
s_cbranch_scc1 L_FIN
s_branch K2_GO0s
K2_N20s:
s_waitcnt vmcnt(3)
v_cmp_le_u32 vcc, s65, v6
s_nop 0
s_cmp_eq_u64 vcc, -1
s_cselect_b32 s68, 1, 0
s_cselect_b32 s42, 0x4000000, 0
s_mul_i32 s71, s1, 24576
s_add_u32 s71, s71, s12
buffer_load_dwordx4 v[108:111], v105, s[40:43], s71 offen sc1
buffer_load_dwordx4 v[112:115], v106, s[40:43], s71 offen sc1
s_add_u32 s69, s66, 4096
s_add_u32 m0, s72, 28672
s_nop 0
buffer_load_dwordx4 v1, s[40:43], s69 offen offset:0 sc1 lds
s_add_u32 m0, s72, 24576
s_nop 0
buffer_load_dwordx4 v1, s[40:43], s66 offen offset:0 sc1 lds
buffer_load_dwordx4 v1, s[40:43], s66 offen offset:1024 sc1 lds
buffer_load_dwordx4 v1, s[40:43], s66 offen offset:2048 sc1 lds
buffer_load_dwordx4 v1, s[40:43], s66 offen offset:3072 sc1 lds
buffer_load_dword v6, v5, s[36:39], 0 offen sc1
s_waitcnt vmcnt(8)
buffer_store_dword v8, v7, s[36:39], 0 offen sc1
s_waitcnt vmcnt(1)
s_cmp_eq_u32 s68, 1
s_cbranch_scc1 K2_GO0s
K2_SW0s:
s_mov_b32 s75, 0
K2_SP0s:
buffer_load_dword v6, v5, s[36:39], 0 offen sc1
s_add_u32 s75, s75, 1
s_cmp_gt_u32 s75, 0x8000
s_cbranch_scc1 L_TIMEOUT
s_waitcnt vmcnt(0)
v_cmp_le_u32 vcc, s65, v6
s_nop 0
s_cmp_eq_u64 vcc, -1
s_cbranch_scc0 K2_SP0s
s_mov_b32 s42, 0x4000000
s_mul_i32 s71, s1, 24576
s_add_u32 s71, s71, s12
buffer_load_dwordx4 v[108:111], v105, s[40:43], s71 offen sc1
buffer_load_dwordx4 v[112:115], v106, s[40:43], s71 offen sc1
s_add_u32 s69, s66, 4096
s_add_u32 m0, s72, 28672
s_nop 0
buffer_load_dwordx4 v1, s[40:43], s69 offen offset:0 sc1 lds
s_add_u32 m0, s72, 24576
s_nop 0
buffer_load_dwordx4 v1, s[40:43], s66 offen offset:0 sc1 lds
buffer_load_dwordx4 v1, s[40:43], s66 offen offset:1024 sc1 lds
buffer_load_dwordx4 v1, s[40:43], s66 offen offset:2048 sc1 lds
buffer_load_dwordx4 v1, s[40:43], s66 offen offset:3072 sc1 lds
buffer_load_dword v6, v5, s[36:39], 0 offen sc1
s_waitcnt vmcnt(0)
K2_GO0s:
v_lshlrev_b32 v116, 16, v108
v_and_b32 v117, 0xffff0000, v108
v_lshlrev_b32 v118, 16, v109
v_and_b32 v119, 0xffff0000, v109
v_lshlrev_b32 v120, 16, v110
v_and_b32 v121, 0xffff0000, v110
v_lshlrev_b32 v122, 16, v111
v_and_b32 v123, 0xffff0000, v111
v_lshlrev_b32 v124, 16, v112
v_and_b32 v125, 0xffff0000, v112
v_lshlrev_b32 v126, 16, v113
v_and_b32 v127, 0xffff0000, v113
v_lshlrev_b32 v128, 16, v114
v_and_b32 v129, 0xffff0000, v114
v_lshlrev_b32 v130, 16, v115
v_and_b32 v131, 0xffff0000, v115
s_barrier

ds_read2st64_b64 v[32:35], v104 offset0:48 offset1:49
ds_read2st64_b64 v[36:39], v104 offset0:50 offset1:51
ds_read2st64_b64 v[40:43], v104 offset0:52 offset1:53
s_add_u32 s13, s64, 1
ds_read2st64_b64 v[44:47], v104 offset0:54 offset1:55
s_cmp_eq_u32 s13, 17
s_addc_u32 s13, s13, 0
s_sub_u32 s1, s13, 17
s_cselect_b32 s1, s13, s1
s_and_b32 s66, s13, 7
s_mul_i32 s66, s66, 24576
s_add_u32 s66, s66, s10
s_add_u32 s65, s13, 2
v_add_f32 v132, v48, v49
v_mul_f32 v133, v48, v48
s_waitcnt vmcnt(0)
v_cmp_le_u32 vcc, s65, v6
v_fmac_f32 v133, v49, v49
s_cmp_eq_u64 vcc, -1
v_fmac_f32 v133, v50, v50
v_add_f32 v132, v132, v50
s_cbranch_scc0 K2_W1s_c
K2_W1s_cR:
s_cselect_b32 s68, 1, 0
s_cselect_b32 s42, 0x4000000, 0
s_mul_i32 s71, s1, 24576
s_add_u32 s71, s71, s12
buffer_load_dwordx4 v[108:111], v105, s[40:43], s71 offen sc1
s_waitcnt lgkmcnt(0)
v_fmac_f32 v133, v51, v51
v_add_f32 v132, v132, v51
s_nop 7
s_branch K2_F1s
K2_W0s:
s_mov_b32 s75, 6
s_cmp_lt_u32 s65, 36
s_cbranch_scc0 K2_W0sR
s_cmp_lg_u32 s65, 20
s_cbranch_scc0 K2_W0sR
K2_W0sL:
buffer_load_dword v6, v5, s[36:39], 0 offen sc1
s_waitcnt vmcnt(0)
v_cmp_le_u32 vcc, s65, v6
s_nop 0
s_cmp_eq_u64 vcc, -1
s_cbranch_scc1 K2_W0sR
s_sub_u32 s75, s75, 1
s_cmp_lg_u32 s75, 0
s_cbranch_scc1 K2_W0sL
s_branch K2_W0sR
K2_W1s_c:
s_mov_b32 s75, 6
s_cmp_lt_u32 s65, 36
s_cbranch_scc0 K2_W1s_cR
s_cmp_lg_u32 s65, 20
s_cbranch_scc0 K2_W1s_cR
K2_W1s_cL:
buffer_load_dword v6, v5, s[36:39], 0 offen sc1
s_waitcnt vmcnt(0)
v_cmp_le_u32 vcc, s65, v6
s_nop 0
s_cmp_eq_u64 vcc, -1
s_cbranch_scc1 K2_W1s_cR
s_sub_u32 s75, s75, 1
s_cmp_lg_u32 s75, 0
s_cbranch_scc1 K2_W1s_cL
s_branch K2_W1s_cR
.p2align 6
K3_U0s:
v_mfma_f32_16x16x32_bf16 v[64:67], v[224:227], v[40:43], v[64:67]
s_barrier

v_mfma_f32_16x16x32_bf16 v[64:67], v[240:243], v[44:47], v[64:67]
s_and_b32 s67, s64, 7
ds_read_b128 v[16:19], v100 offset:0
s_mul_i32 s67, s67, s100
v_mfma_f32_16x16x32_bf16 v[68:71], v[196:199], v[32:35], v[68:71]
s_add_u32 s67, s67, s11
ds_read_b128 v[20:23], v100 offset:1024
s_mov_b32 s46, s74
v_mfma_f32_16x16x32_bf16 v[68:71], v[212:215], v[36:39], v[68:71]
s_add_u32 s79, s64, 2
ds_read_b128 v[24:27], v100 offset:2048
v_fma_f32 v80, -v131, v104, v64
v_mfma_f32_16x16x32_bf16 v[68:71], v[228:231], v[40:43], v[68:71]
s_mov_b32 s64, s13
ds_read_b128 v[28:31], v100 offset:3072
v_fma_f32 v81, -v131, v105, v65
v_mfma_f32_16x16x32_bf16 v[68:71], v[244:247], v[44:47], v[68:71]
s_mov_b32 s0, s1
v_mov_b32 v8, s79
v_fma_f32 v82, -v131, v106, v66
v_mfma_f32_16x16x32_bf16 v[72:75], v[200:203], v[32:35], v[72:75]
s_add_u32 s13, s64, 1
v_fma_f32 v83, -v131, v107, v67
v_mul_f32 v80, v80, v133
v_mfma_f32_16x16x32_bf16 v[72:75], v[216:219], v[36:39], v[72:75]
s_cmp_eq_u32 s13, 17
v_mul_f32 v81, v81, v133
v_mul_f32 v82, v82, v133
v_mfma_f32_16x16x32_bf16 v[72:75], v[232:235], v[40:43], v[72:75]
s_addc_u32 s13, s13, 0
v_mul_f32 v83, v83, v133
v_fma_f32 v84, -v131, v108, v68
v_mfma_f32_16x16x32_bf16 v[72:75], v[248:251], v[44:47], v[72:75]
s_sub_u32 s1, s13, 17
v_fma_f32 v85, -v131, v109, v69
v_fma_f32 v86, -v131, v110, v70
v_mfma_f32_16x16x32_bf16 v[76:79], v[204:207], v[32:35], v[76:79]
s_cselect_b32 s1, s13, s1
v_fma_f32 v87, -v131, v111, v71
v_mul_f32 v80, v80, v84
v_mfma_f32_16x16x32_bf16 v[76:79], v[220:223], v[36:39], v[76:79]
s_mul_i32 s66, s1, 24576
v_mul_f32 v81, v81, v85
v_mul_f32 v82, v82, v86
v_mfma_f32_16x16x32_bf16 v[76:79], v[236:239], v[40:43], v[76:79]
s_add_u32 s66, s66, s10
v_mul_f32 v83, v83, v87
v_cvt_pk_bf16_f32 v96, v80, v81
v_mfma_f32_16x16x32_bf16 v[76:79], v[252:255], v[44:47], v[76:79]
s_waitcnt lgkmcnt(0)
v_cvt_pk_bf16_f32 v97, v82, v83
v_fma_f32 v88, -v131, v112, v72
K3_F0s:
v_mfma_f32_16x16x32_bf16 v[48:51], a[0:3], v[16:19], 0
s_add_u32 s65, s13, 2
ds_read_b128 v[32:35], v100 offset:4096
v_fma_f32 v89, -v131, v113, v73
v_mfma_f32_16x16x32_bf16 v[48:51], a[16:19], v[20:23], v[48:51]
s_waitcnt vmcnt(1)
v_cmp_le_u32 vcc, s65, v6
v_fma_f32 v90, -v131, v114, v74
v_mfma_f32_16x16x32_bf16 v[48:51], a[32:35], v[24:27], v[48:51]
s_cmp_eq_u64 vcc, -1
ds_read_b128 v[36:39], v100 offset:6144
v_fma_f32 v91, -v131, v115, v75
v_mfma_f32_16x16x32_bf16 v[48:51], a[48:51], v[28:31], v[48:51]
s_cbranch_scc0 K3_W0s
K3_W0sR:
s_cselect_b32 s68, 1, 0
v_mfma_f32_16x16x32_bf16 v[52:55], a[4:7], v[16:19], 0
s_cselect_b32 s42, 0x4000000, 0
ds_read_b128 v[40:43], v100 offset:7168
s_add_u32 s69, s66, 4096
v_mfma_f32_16x16x32_bf16 v[52:55], a[20:23], v[20:23], v[52:55]
s_add_u32 m0, s72, 28672
v_mul_f32 v88, v88, v133
v_mul_f32 v89, v89, v133
v_mfma_f32_16x16x32_bf16 v[52:55], a[36:39], v[24:27], v[52:55]
ds_read_b128 v[44:47], v100 offset:8192
v_mul_f32 v90, v90, v133
v_mfma_f32_16x16x32_bf16 v[52:55], a[52:55], v[28:31], v[52:55]
buffer_load_dwordx4 v11, s[40:43], s69 offen offset:1024 sc1 lds
v_mfma_f32_16x16x32_bf16 v[56:59], a[8:11], v[16:19], 0
v_mul_f32 v91, v91, v133
v_fma_f32 v92, -v131, v116, v76
v_mfma_f32_16x16x32_bf16 v[56:59], a[24:27], v[20:23], v[56:59]
v_fma_f32 v93, -v131, v117, v77
v_fma_f32 v94, -v131, v118, v78
v_mfma_f32_16x16x32_bf16 v[56:59], a[40:43], v[24:27], v[56:59]
buffer_load_dwordx4 v1, s[40:43], s69 offen offset:0 sc1 lds
v_mfma_f32_16x16x32_bf16 v[56:59], a[56:59], v[28:31], v[56:59]
s_add_u32 m0, s72, 24576
v_fma_f32 v95, -v131, v119, v79
v_mul_f32 v88, v88, v92
v_mfma_f32_16x16x32_bf16 v[60:63], a[12:15], v[16:19], 0
v_mul_f32 v89, v89, v93
v_mul_f32 v90, v90, v94
v_mfma_f32_16x16x32_bf16 v[60:63], a[28:31], v[20:23], v[60:63]
v_mul_f32 v91, v91, v95
v_cvt_pk_bf16_f32 v98, v88, v89
v_mfma_f32_16x16x32_bf16 v[60:63], a[44:47], v[24:27], v[60:63]
buffer_load_dwordx4 v1, s[40:43], s66 offen offset:0 sc1 lds
v_mfma_f32_16x16x32_bf16 v[60:63], a[60:63], v[28:31], v[60:63]
s_waitcnt lgkmcnt(0)
v_cvt_pk_bf16_f32 v99, v90, v91
v_mfma_f32_16x16x32_bf16 v[48:51], a[64:67], v[32:35], v[48:51]
ds_read_b128 v[16:19], v100 offset:9216
v_mfma_f32_16x16x32_bf16 v[48:51], a[80:83], v[36:39], v[48:51]
buffer_load_dwordx4 v1, s[40:43], s66 offen offset:1024 sc1 lds
v_mfma_f32_16x16x32_bf16 v[48:51], a[96:99], v[40:43], v[48:51]
ds_read_b128 v[20:23], v100 offset:10240
v_mfma_f32_16x16x32_bf16 v[48:51], a[112:115], v[44:47], v[48:51]
buffer_store_dwordx4 v[96:99], v101, s[44:47], s67 offen sc1
v_mfma_f32_16x16x32_bf16 v[52:55], a[68:71], v[32:35], v[52:55]
ds_read_b128 v[24:27], v100 offset:12288
v_mfma_f32_16x16x32_bf16 v[52:55], a[84:87], v[36:39], v[52:55]
buffer_load_dwordx4 v1, s[40:43], s66 offen offset:2048 sc1 lds
v_mfma_f32_16x16x32_bf16 v[52:55], a[100:103], v[40:43], v[52:55]
ds_read_b128 v[28:31], v100 offset:13312
v_mfma_f32_16x16x32_bf16 v[52:55], a[116:119], v[44:47], v[52:55]
v_mfma_f32_16x16x32_bf16 v[56:59], a[72:75], v[32:35], v[56:59]
buffer_load_dwordx4 v1, s[40:43], s66 offen offset:3072 sc1 lds
v_mfma_f32_16x16x32_bf16 v[56:59], a[88:91], v[36:39], v[56:59]
v_mfma_f32_16x16x32_bf16 v[56:59], a[104:107], v[40:43], v[56:59]
ds_read_b64 v[120:121], v103 offset:0
v_mfma_f32_16x16x32_bf16 v[56:59], a[120:123], v[44:47], v[56:59]
ds_read_b64 v[122:123], v103 offset:128
v_mfma_f32_16x16x32_bf16 v[60:63], a[76:79], v[32:35], v[60:63]
ds_read_b64 v[124:125], v103 offset:256
v_mfma_f32_16x16x32_bf16 v[60:63], a[92:95], v[36:39], v[60:63]
ds_read_b64 v[126:127], v103 offset:384
v_mfma_f32_16x16x32_bf16 v[60:63], a[108:111], v[40:43], v[60:63]
ds_read_b64 v[128:129], v103 offset:512
v_mfma_f32_16x16x32_bf16 v[60:63], a[124:127], v[44:47], v[60:63]
s_waitcnt lgkmcnt(5)
v_mfma_f32_16x16x32_bf16 v[48:51], a[128:131], v[16:19], v[48:51]
ds_read_b128 v[32:35], v100 offset:14336
v_mfma_f32_16x16x32_bf16 v[48:51], a[144:147], v[20:23], v[48:51]
v_mfma_f32_16x16x32_bf16 v[48:51], a[160:163], v[24:27], v[48:51]
ds_read_b128 v[36:39], v100 offset:15360
v_mfma_f32_16x16x32_bf16 v[48:51], a[176:179], v[28:31], v[48:51]
v_mfma_f32_16x16x32_bf16 v[52:55], a[132:135], v[16:19], v[52:55]
s_waitcnt lgkmcnt(2)
ds_read_b128 v[40:43], v100 offset:16384
v_add_f32 v120, v120, v122
v_mfma_f32_16x16x32_bf16 v[52:55], a[148:151], v[20:23], v[52:55]
v_add_f32 v121, v121, v123
v_add_f32 v124, v124, v126
v_mfma_f32_16x16x32_bf16 v[52:55], a[164:167], v[24:27], v[52:55]
ds_read_b128 v[44:47], v100 offset:18432
v_add_f32 v125, v125, v127
v_mfma_f32_16x16x32_bf16 v[52:55], a[180:183], v[28:31], v[52:55]
v_add_f32 v120, v120, v128
v_add_f32 v121, v121, v129
v_mfma_f32_16x16x32_bf16 v[56:59], a[136:139], v[16:19], v[56:59]
v_add_f32 v120, v120, v124
v_add_f32 v121, v121, v125
v_mfma_f32_16x16x32_bf16 v[56:59], a[152:155], v[20:23], v[56:59]
v_mfma_f32_16x16x32_bf16 v[56:59], a[168:171], v[24:27], v[56:59]
v_permlane32_swap_b32 v120, v121
v_mfma_f32_16x16x32_bf16 v[56:59], a[184:187], v[28:31], v[56:59]
v_add_f32 v122, v120, v121
v_add_f32 v123, v120, v121
v_mfma_f32_16x16x32_bf16 v[60:63], a[140:143], v[16:19], v[60:63]
v_mfma_f32_16x16x32_bf16 v[60:63], a[156:159], v[20:23], v[60:63]
v_permlane16_swap_b32 v122, v123
v_mfma_f32_16x16x32_bf16 v[60:63], a[172:175], v[24:27], v[60:63]
v_add_f32 v130, v122, v123
v_add_f32 v121, v122, v123
v_mfma_f32_16x16x32_bf16 v[60:63], a[188:191], v[28:31], v[60:63]
s_waitcnt lgkmcnt(0)
v_permlane32_swap_b32 v130, v121
v_mfma_f32_16x16x32_bf16 v[48:51], a[192:195], v[32:35], v[48:51]
ds_read_b128 v[16:19], v100 offset:19456
v_fma_f32 v121, -v130, v130, v121
v_mfma_f32_16x16x32_bf16 v[48:51], a[208:211], v[36:39], v[48:51]
v_max_f32 v121, s77, v121
v_mfma_f32_16x16x32_bf16 v[48:51], a[224:227], v[40:43], v[48:51]
ds_read_b128 v[20:23], v100 offset:20480
v_mfma_f32_16x16x32_bf16 v[48:51], a[240:243], v[44:47], v[48:51]
v_rcp_f32 v132, v121
v_mfma_f32_16x16x32_bf16 v[52:55], a[196:199], v[32:35], v[52:55]
ds_read_b128 v[24:27], v100 offset:21504
v_mfma_f32_16x16x32_bf16 v[52:55], a[212:215], v[36:39], v[52:55]
v_mfma_f32_16x16x32_bf16 v[52:55], a[228:231], v[40:43], v[52:55]
ds_read_b128 v[28:31], v100 offset:22528
v_mfma_f32_16x16x32_bf16 v[52:55], a[244:247], v[44:47], v[52:55]
s_waitcnt vmcnt(2)
v_mfma_f32_16x16x32_bf16 v[56:59], a[200:203], v[32:35], v[56:59]
buffer_load_dword v6, v5, s[36:39], 0 offen sc1
v_mfma_f32_16x16x32_bf16 v[56:59], a[216:219], v[36:39], v[56:59]
buffer_store_dword v8, v7, s[36:39], 0 offen sc1
v_mfma_f32_16x16x32_bf16 v[56:59], a[232:235], v[40:43], v[56:59]
s_cmp_eq_u32 s68, 0
v_mfma_f32_16x16x32_bf16 v[56:59], a[248:251], v[44:47], v[56:59]
v_mfma_f32_16x16x32_bf16 v[60:63], a[204:207], v[32:35], v[60:63]
v_mfma_f32_16x16x32_bf16 v[60:63], a[220:223], v[36:39], v[60:63]
v_mfma_f32_16x16x32_bf16 v[60:63], a[236:239], v[40:43], v[60:63]
v_mfma_f32_16x16x32_bf16 v[60:63], a[252:255], v[44:47], v[60:63]
s_waitcnt lgkmcnt(0)
v_mfma_f32_16x16x32_bf16 v[48:51], v[192:195], v[16:19], v[48:51]
s_waitcnt vmcnt(2) lgkmcnt(0)
v_mfma_f32_16x16x32_bf16 v[48:51], v[208:211], v[20:23], v[48:51]
s_cbranch_scc1 K3_X0s
K3_U1s:
v_mfma_f32_16x16x32_bf16 v[48:51], v[224:227], v[24:27], v[48:51]
s_barrier

v_mfma_f32_16x16x32_bf16 v[48:51], v[240:243], v[28:31], v[48:51]
s_and_b32 s67, s64, 7
ds_read_b128 v[32:35], v100 offset:24576
s_mul_i32 s67, s67, s100
v_mfma_f32_16x16x32_bf16 v[52:55], v[196:199], v[16:19], v[52:55]
s_add_u32 s67, s67, s11
ds_read_b128 v[36:39], v100 offset:25600
s_mov_b32 s46, s74
v_mfma_f32_16x16x32_bf16 v[52:55], v[212:215], v[20:23], v[52:55]
s_add_u32 s79, s64, 2
ds_read_b128 v[40:43], v100 offset:26624
v_fma_f32 v80, -v130, v104, v48
v_mfma_f32_16x16x32_bf16 v[52:55], v[228:231], v[24:27], v[52:55]
s_mov_b32 s64, s13
ds_read_b128 v[44:47], v100 offset:27648
v_fma_f32 v81, -v130, v105, v49
v_mfma_f32_16x16x32_bf16 v[52:55], v[244:247], v[28:31], v[52:55]
s_mov_b32 s0, s1
v_mov_b32 v8, s79
v_fma_f32 v82, -v130, v106, v50
v_mfma_f32_16x16x32_bf16 v[56:59], v[200:203], v[16:19], v[56:59]
s_add_u32 s13, s64, 1
v_fma_f32 v83, -v130, v107, v51
v_mul_f32 v80, v80, v132
v_mfma_f32_16x16x32_bf16 v[56:59], v[216:219], v[20:23], v[56:59]
s_cmp_eq_u32 s13, 17
v_mul_f32 v81, v81, v132
v_mul_f32 v82, v82, v132
v_mfma_f32_16x16x32_bf16 v[56:59], v[232:235], v[24:27], v[56:59]
s_addc_u32 s13, s13, 0
v_mul_f32 v83, v83, v132
v_fma_f32 v84, -v130, v108, v52
v_mfma_f32_16x16x32_bf16 v[56:59], v[248:251], v[28:31], v[56:59]
s_sub_u32 s1, s13, 17
v_fma_f32 v85, -v130, v109, v53
v_fma_f32 v86, -v130, v110, v54
v_mfma_f32_16x16x32_bf16 v[60:63], v[204:207], v[16:19], v[60:63]
s_cselect_b32 s1, s13, s1
v_fma_f32 v87, -v130, v111, v55
v_mul_f32 v80, v80, v84
v_mfma_f32_16x16x32_bf16 v[60:63], v[220:223], v[20:23], v[60:63]
s_mul_i32 s66, s1, 24576
v_mul_f32 v81, v81, v85
v_mul_f32 v82, v82, v86
v_mfma_f32_16x16x32_bf16 v[60:63], v[236:239], v[24:27], v[60:63]
s_add_u32 s66, s66, s10
v_mul_f32 v83, v83, v87
v_cvt_pk_bf16_f32 v96, v80, v81
v_mfma_f32_16x16x32_bf16 v[60:63], v[252:255], v[28:31], v[60:63]
s_waitcnt lgkmcnt(0)
v_cvt_pk_bf16_f32 v97, v82, v83
v_fma_f32 v88, -v130, v112, v56
K3_F1s:
v_mfma_f32_16x16x32_bf16 v[64:67], a[0:3], v[32:35], 0
s_add_u32 s65, s13, 2
ds_read_b128 v[16:19], v100 offset:28672
v_fma_f32 v89, -v130, v113, v57
v_mfma_f32_16x16x32_bf16 v[64:67], a[16:19], v[36:39], v[64:67]
s_waitcnt vmcnt(1)
v_cmp_le_u32 vcc, s65, v6
v_fma_f32 v90, -v130, v114, v58
v_mfma_f32_16x16x32_bf16 v[64:67], a[32:35], v[40:43], v[64:67]
s_cmp_eq_u64 vcc, -1
ds_read_b128 v[20:23], v100 offset:30720
v_fma_f32 v91, -v130, v115, v59
v_mfma_f32_16x16x32_bf16 v[64:67], a[48:51], v[44:47], v[64:67]
s_cbranch_scc0 K3_W1s
K3_W1sR:
s_cselect_b32 s68, 1, 0
v_mfma_f32_16x16x32_bf16 v[68:71], a[4:7], v[32:35], 0
s_cselect_b32 s42, 0x4000000, 0
ds_read_b128 v[24:27], v100 offset:31744
s_add_u32 s69, s66, 4096
v_mfma_f32_16x16x32_bf16 v[68:71], a[20:23], v[36:39], v[68:71]
s_add_u32 m0, s72, 4096
v_mul_f32 v88, v88, v132
v_mul_f32 v89, v89, v132
v_mfma_f32_16x16x32_bf16 v[68:71], a[36:39], v[40:43], v[68:71]
ds_read_b128 v[28:31], v100 offset:32768
v_mul_f32 v90, v90, v132
v_mfma_f32_16x16x32_bf16 v[68:71], a[52:55], v[44:47], v[68:71]
buffer_load_dwordx4 v11, s[40:43], s69 offen offset:1024 sc1 lds
v_mfma_f32_16x16x32_bf16 v[72:75], a[8:11], v[32:35], 0
v_mul_f32 v91, v91, v132
v_fma_f32 v92, -v130, v116, v60
v_mfma_f32_16x16x32_bf16 v[72:75], a[24:27], v[36:39], v[72:75]
v_fma_f32 v93, -v130, v117, v61
v_fma_f32 v94, -v130, v118, v62
v_mfma_f32_16x16x32_bf16 v[72:75], a[40:43], v[40:43], v[72:75]
buffer_load_dwordx4 v1, s[40:43], s69 offen offset:0 sc1 lds
v_mfma_f32_16x16x32_bf16 v[72:75], a[56:59], v[44:47], v[72:75]
s_add_u32 m0, s72, 0
v_fma_f32 v95, -v130, v119, v63
v_mul_f32 v88, v88, v92
v_mfma_f32_16x16x32_bf16 v[76:79], a[12:15], v[32:35], 0
v_mul_f32 v89, v89, v93
v_mul_f32 v90, v90, v94
v_mfma_f32_16x16x32_bf16 v[76:79], a[28:31], v[36:39], v[76:79]
v_mul_f32 v91, v91, v95
v_cvt_pk_bf16_f32 v98, v88, v89
v_mfma_f32_16x16x32_bf16 v[76:79], a[44:47], v[40:43], v[76:79]
buffer_load_dwordx4 v1, s[40:43], s66 offen offset:0 sc1 lds
v_mfma_f32_16x16x32_bf16 v[76:79], a[60:63], v[44:47], v[76:79]
s_waitcnt lgkmcnt(0)
v_cvt_pk_bf16_f32 v99, v90, v91
v_mfma_f32_16x16x32_bf16 v[64:67], a[64:67], v[16:19], v[64:67]
ds_read_b128 v[32:35], v100 offset:33792
v_mfma_f32_16x16x32_bf16 v[64:67], a[80:83], v[20:23], v[64:67]
buffer_load_dwordx4 v1, s[40:43], s66 offen offset:1024 sc1 lds
v_mfma_f32_16x16x32_bf16 v[64:67], a[96:99], v[24:27], v[64:67]
ds_read_b128 v[36:39], v100 offset:34816
v_mfma_f32_16x16x32_bf16 v[64:67], a[112:115], v[28:31], v[64:67]
buffer_store_dwordx4 v[96:99], v101, s[44:47], s67 offen sc1
v_mfma_f32_16x16x32_bf16 v[68:71], a[68:71], v[16:19], v[68:71]
ds_read_b128 v[40:43], v100 offset:36864
v_mfma_f32_16x16x32_bf16 v[68:71], a[84:87], v[20:23], v[68:71]
buffer_load_dwordx4 v1, s[40:43], s66 offen offset:2048 sc1 lds
v_mfma_f32_16x16x32_bf16 v[68:71], a[100:103], v[24:27], v[68:71]
ds_read_b128 v[44:47], v100 offset:37888
v_mfma_f32_16x16x32_bf16 v[68:71], a[116:119], v[28:31], v[68:71]
v_mfma_f32_16x16x32_bf16 v[72:75], a[72:75], v[16:19], v[72:75]
buffer_load_dwordx4 v1, s[40:43], s66 offen offset:3072 sc1 lds
v_mfma_f32_16x16x32_bf16 v[72:75], a[88:91], v[20:23], v[72:75]
v_mfma_f32_16x16x32_bf16 v[72:75], a[104:107], v[24:27], v[72:75]
ds_read_b64 v[120:121], v103 offset:24576
v_mfma_f32_16x16x32_bf16 v[72:75], a[120:123], v[28:31], v[72:75]
ds_read_b64 v[122:123], v103 offset:24704
v_mfma_f32_16x16x32_bf16 v[76:79], a[76:79], v[16:19], v[76:79]
ds_read_b64 v[124:125], v103 offset:24832
v_mfma_f32_16x16x32_bf16 v[76:79], a[92:95], v[20:23], v[76:79]
ds_read_b64 v[126:127], v103 offset:24960
v_mfma_f32_16x16x32_bf16 v[76:79], a[108:111], v[24:27], v[76:79]
ds_read_b64 v[128:129], v103 offset:25088
v_mfma_f32_16x16x32_bf16 v[76:79], a[124:127], v[28:31], v[76:79]
s_waitcnt lgkmcnt(5)
v_mfma_f32_16x16x32_bf16 v[64:67], a[128:131], v[32:35], v[64:67]
ds_read_b128 v[16:19], v100 offset:38912
v_mfma_f32_16x16x32_bf16 v[64:67], a[144:147], v[36:39], v[64:67]
v_mfma_f32_16x16x32_bf16 v[64:67], a[160:163], v[40:43], v[64:67]
ds_read_b128 v[20:23], v100 offset:39936
v_mfma_f32_16x16x32_bf16 v[64:67], a[176:179], v[44:47], v[64:67]
v_mfma_f32_16x16x32_bf16 v[68:71], a[132:135], v[32:35], v[68:71]
s_waitcnt lgkmcnt(2)
ds_read_b128 v[24:27], v100 offset:40960
v_add_f32 v120, v120, v122
v_mfma_f32_16x16x32_bf16 v[68:71], a[148:151], v[36:39], v[68:71]
v_add_f32 v121, v121, v123
v_add_f32 v124, v124, v126
v_mfma_f32_16x16x32_bf16 v[68:71], a[164:167], v[40:43], v[68:71]
ds_read_b128 v[28:31], v100 offset:43008
v_add_f32 v125, v125, v127
v_mfma_f32_16x16x32_bf16 v[68:71], a[180:183], v[44:47], v[68:71]
v_add_f32 v120, v120, v128
v_add_f32 v121, v121, v129
v_mfma_f32_16x16x32_bf16 v[72:75], a[136:139], v[32:35], v[72:75]
v_add_f32 v120, v120, v124
v_add_f32 v121, v121, v125
v_mfma_f32_16x16x32_bf16 v[72:75], a[152:155], v[36:39], v[72:75]
v_mfma_f32_16x16x32_bf16 v[72:75], a[168:171], v[40:43], v[72:75]
v_permlane32_swap_b32 v120, v121
v_mfma_f32_16x16x32_bf16 v[72:75], a[184:187], v[44:47], v[72:75]
v_add_f32 v122, v120, v121
v_add_f32 v123, v120, v121
v_mfma_f32_16x16x32_bf16 v[76:79], a[140:143], v[32:35], v[76:79]
v_mfma_f32_16x16x32_bf16 v[76:79], a[156:159], v[36:39], v[76:79]
v_permlane16_swap_b32 v122, v123
v_mfma_f32_16x16x32_bf16 v[76:79], a[172:175], v[40:43], v[76:79]
v_add_f32 v131, v122, v123
v_add_f32 v121, v122, v123
v_mfma_f32_16x16x32_bf16 v[76:79], a[188:191], v[44:47], v[76:79]
s_waitcnt lgkmcnt(0)
v_permlane32_swap_b32 v131, v121
v_mfma_f32_16x16x32_bf16 v[64:67], a[192:195], v[16:19], v[64:67]
ds_read_b128 v[32:35], v100 offset:44032
v_fma_f32 v121, -v131, v131, v121
v_mfma_f32_16x16x32_bf16 v[64:67], a[208:211], v[20:23], v[64:67]
v_max_f32 v121, s77, v121
v_mfma_f32_16x16x32_bf16 v[64:67], a[224:227], v[24:27], v[64:67]
ds_read_b128 v[36:39], v100 offset:45056
v_mfma_f32_16x16x32_bf16 v[64:67], a[240:243], v[28:31], v[64:67]
v_rcp_f32 v133, v121
v_mfma_f32_16x16x32_bf16 v[68:71], a[196:199], v[16:19], v[68:71]
ds_read_b128 v[40:43], v100 offset:46080
v_mfma_f32_16x16x32_bf16 v[68:71], a[212:215], v[20:23], v[68:71]
v_mfma_f32_16x16x32_bf16 v[68:71], a[228:231], v[24:27], v[68:71]
ds_read_b128 v[44:47], v100 offset:47104
v_mfma_f32_16x16x32_bf16 v[68:71], a[244:247], v[28:31], v[68:71]
s_waitcnt vmcnt(2)
v_mfma_f32_16x16x32_bf16 v[72:75], a[200:203], v[16:19], v[72:75]
buffer_load_dword v6, v5, s[36:39], 0 offen sc1
v_mfma_f32_16x16x32_bf16 v[72:75], a[216:219], v[20:23], v[72:75]
buffer_store_dword v8, v7, s[36:39], 0 offen sc1
v_mfma_f32_16x16x32_bf16 v[72:75], a[232:235], v[24:27], v[72:75]
s_cmp_eq_u32 s68, 0
v_mfma_f32_16x16x32_bf16 v[72:75], a[248:251], v[28:31], v[72:75]
v_mfma_f32_16x16x32_bf16 v[76:79], a[204:207], v[16:19], v[76:79]
v_mfma_f32_16x16x32_bf16 v[76:79], a[220:223], v[20:23], v[76:79]
v_mfma_f32_16x16x32_bf16 v[76:79], a[236:239], v[24:27], v[76:79]
v_mfma_f32_16x16x32_bf16 v[76:79], a[252:255], v[28:31], v[76:79]
s_waitcnt lgkmcnt(0)
v_mfma_f32_16x16x32_bf16 v[64:67], v[192:195], v[32:35], v[64:67]
s_waitcnt vmcnt(2) lgkmcnt(0)
v_mfma_f32_16x16x32_bf16 v[64:67], v[208:211], v[36:39], v[64:67]
s_cbranch_scc0 K3_U0s
K3_X1s:
K3_NR1s:
buffer_load_dword v6, v5, s[36:39], 0 offen sc1
v_mfma_f32_16x16x32_bf16 v[64:67], v[224:227], v[40:43], v[64:67]
s_and_b32 s67, s64, 7
s_mul_i32 s67, s67, s100
s_add_u32 s67, s67, s11
v_mfma_f32_16x16x32_bf16 v[64:67], v[240:243], v[44:47], v[64:67]
s_mov_b32 s46, s74
s_add_u32 s79, s64, 2
s_mov_b32 s64, s13
v_mfma_f32_16x16x32_bf16 v[68:71], v[196:199], v[32:35], v[68:71]
s_mov_b32 s0, s1
v_mfma_f32_16x16x32_bf16 v[68:71], v[212:215], v[36:39], v[68:71]
v_mfma_f32_16x16x32_bf16 v[68:71], v[228:231], v[40:43], v[68:71]
v_mfma_f32_16x16x32_bf16 v[68:71], v[244:247], v[44:47], v[68:71]
v_mfma_f32_16x16x32_bf16 v[72:75], v[200:203], v[32:35], v[72:75]
v_mfma_f32_16x16x32_bf16 v[72:75], v[216:219], v[36:39], v[72:75]
v_mfma_f32_16x16x32_bf16 v[72:75], v[232:235], v[40:43], v[72:75]
v_mfma_f32_16x16x32_bf16 v[72:75], v[248:251], v[44:47], v[72:75]
v_mfma_f32_16x16x32_bf16 v[76:79], v[204:207], v[32:35], v[76:79]
v_mfma_f32_16x16x32_bf16 v[76:79], v[220:223], v[36:39], v[76:79]
v_mfma_f32_16x16x32_bf16 v[76:79], v[236:239], v[40:43], v[76:79]
v_mfma_f32_16x16x32_bf16 v[76:79], v[252:255], v[44:47], v[76:79]
s_waitcnt vmcnt(0)
s_mov_b32 s68, 2
s_cmp_gt_u32 s64, 33
s_cbranch_scc1 K3_EP1s
v_cmp_le_u32 vcc, s65, v6
s_nop 0
s_cmp_eq_u64 vcc, -1
s_cselect_b32 s68, 1, 0
s_cselect_b32 s42, 0x4000000, 0
s_add_u32 s69, s66, 4096
s_add_u32 m0, s72, 4096
s_nop 0
buffer_load_dwordx4 v11, s[40:43], s69 offen offset:1024 sc1 lds
buffer_load_dwordx4 v1, s[40:43], s69 offen offset:0 sc1 lds
s_add_u32 m0, s72, 0
s_nop 0
buffer_load_dwordx4 v1, s[40:43], s66 offen offset:0 sc1 lds
buffer_load_dwordx4 v1, s[40:43], s66 offen offset:1024 sc1 lds
buffer_load_dwordx4 v1, s[40:43], s66 offen offset:2048 sc1 lds
buffer_load_dwordx4 v1, s[40:43], s66 offen offset:3072 sc1 lds
buffer_load_dword v6, v5, s[36:39], 0 offen sc1
K3_EP1s:
v_fma_f32 v80, -v131, v104, v64
v_fma_f32 v81, -v131, v105, v65
v_fma_f32 v82, -v131, v106, v66
v_fma_f32 v83, -v131, v107, v67
v_mul_f32 v80, v80, v133
v_mul_f32 v81, v81, v133
v_mul_f32 v82, v82, v133
v_mul_f32 v83, v83, v133
v_fma_f32 v84, -v131, v108, v68
v_fma_f32 v85, -v131, v109, v69
v_fma_f32 v86, -v131, v110, v70
v_fma_f32 v87, -v131, v111, v71
v_mul_f32 v80, v80, v84
v_mul_f32 v81, v81, v85
v_mul_f32 v82, v82, v86
v_mul_f32 v83, v83, v87
v_cvt_pk_bf16_f32 v96, v80, v81
v_cvt_pk_bf16_f32 v97, v82, v83
v_fma_f32 v88, -v131, v112, v72
v_fma_f32 v89, -v131, v113, v73
v_fma_f32 v90, -v131, v114, v74
v_fma_f32 v91, -v131, v115, v75
v_mul_f32 v88, v88, v133
v_mul_f32 v89, v89, v133
v_mul_f32 v90, v90, v133
v_mul_f32 v91, v91, v133
v_fma_f32 v92, -v131, v116, v76
v_fma_f32 v93, -v131, v117, v77
v_fma_f32 v94, -v131, v118, v78
v_fma_f32 v95, -v131, v119, v79
v_mul_f32 v88, v88, v92
v_mul_f32 v89, v89, v93
v_mul_f32 v90, v90, v94
v_mul_f32 v91, v91, v95
v_cvt_pk_bf16_f32 v98, v88, v89
v_cvt_pk_bf16_f32 v99, v90, v91
buffer_store_dwordx4 v[96:99], v101, s[44:47], s67 offen sc1
v_mov_b32 v8, s79
s_mov_b32 s46, 0
s_cmp_eq_u32 s68, 0
s_cbranch_scc1 K3_N21s
s_waitcnt vmcnt(0)
buffer_store_dword v8, v7, s[36:39], 0 offen sc1
s_cmp_eq_u32 s68, 2
s_cbranch_scc1 L_FIN
s_branch K3_GO1s
K3_N21s:
s_waitcnt vmcnt(1)
v_cmp_le_u32 vcc, s65, v6
s_nop 0
s_cmp_eq_u64 vcc, -1
s_cselect_b32 s68, 1, 0
s_cselect_b32 s42, 0x4000000, 0
s_add_u32 s69, s66, 4096
s_add_u32 m0, s72, 4096
s_nop 0
buffer_load_dwordx4 v11, s[40:43], s69 offen offset:1024 sc1 lds
buffer_load_dwordx4 v1, s[40:43], s69 offen offset:0 sc1 lds
s_add_u32 m0, s72, 0
s_nop 0
buffer_load_dwordx4 v1, s[40:43], s66 offen offset:0 sc1 lds
buffer_load_dwordx4 v1, s[40:43], s66 offen offset:1024 sc1 lds
buffer_load_dwordx4 v1, s[40:43], s66 offen offset:2048 sc1 lds
buffer_load_dwordx4 v1, s[40:43], s66 offen offset:3072 sc1 lds
buffer_load_dword v6, v5, s[36:39], 0 offen sc1
s_waitcnt vmcnt(7)
buffer_store_dword v8, v7, s[36:39], 0 offen sc1
s_waitcnt vmcnt(1)
s_cmp_eq_u32 s68, 1
s_cbranch_scc1 K3_GO1s
K3_SW1s:
s_mov_b32 s75, 0
K3_SP1s:
buffer_load_dword v6, v5, s[36:39], 0 offen sc1
s_add_u32 s75, s75, 1
s_cmp_gt_u32 s75, 0x8000
s_cbranch_scc1 L_TIMEOUT
s_waitcnt vmcnt(0)
v_cmp_le_u32 vcc, s65, v6
s_nop 0
s_cmp_eq_u64 vcc, -1
s_cbranch_scc0 K3_SP1s
s_mov_b32 s42, 0x4000000
s_add_u32 s69, s66, 4096
s_add_u32 m0, s72, 4096
s_nop 0
buffer_load_dwordx4 v11, s[40:43], s69 offen offset:1024 sc1 lds
buffer_load_dwordx4 v1, s[40:43], s69 offen offset:0 sc1 lds
s_add_u32 m0, s72, 0
s_nop 0
buffer_load_dwordx4 v1, s[40:43], s66 offen offset:0 sc1 lds
buffer_load_dwordx4 v1, s[40:43], s66 offen offset:1024 sc1 lds
buffer_load_dwordx4 v1, s[40:43], s66 offen offset:2048 sc1 lds
buffer_load_dwordx4 v1, s[40:43], s66 offen offset:3072 sc1 lds
buffer_load_dword v6, v5, s[36:39], 0 offen sc1
s_waitcnt vmcnt(0)
K3_GO1s:
s_barrier

ds_read_b128 v[16:19], v100 offset:0
ds_read_b128 v[20:23], v100 offset:1024
ds_read_b128 v[24:27], v100 offset:2048
v_fma_f32 v80, -v131, v104, v64
ds_read_b128 v[28:31], v100 offset:3072
v_fma_f32 v81, -v131, v105, v65
v_mov_b32 v8, s79
v_fma_f32 v82, -v131, v106, v66
s_add_u32 s13, s64, 1
v_fma_f32 v83, -v131, v107, v67
v_mul_f32 v80, v80, v133
s_cmp_eq_u32 s13, 17
v_mul_f32 v81, v81, v133
v_mul_f32 v82, v82, v133
s_addc_u32 s13, s13, 0
v_mul_f32 v83, v83, v133
v_fma_f32 v84, -v131, v108, v68
s_sub_u32 s1, s13, 17
v_fma_f32 v85, -v131, v109, v69
v_fma_f32 v86, -v131, v110, v70
s_cselect_b32 s1, s13, s1
v_fma_f32 v87, -v131, v111, v71
v_mul_f32 v80, v80, v84
s_mul_i32 s66, s1, 24576
v_mul_f32 v81, v81, v85
v_mul_f32 v82, v82, v86
s_add_u32 s66, s66, s10
v_mul_f32 v83, v83, v87
v_cvt_pk_bf16_f32 v96, v80, v81
s_waitcnt lgkmcnt(0)
v_cvt_pk_bf16_f32 v97, v82, v83
v_fma_f32 v88, -v131, v112, v72
s_nop 7
s_branch K3_F0s
K3_W1s:
s_mov_b32 s75, 6
s_cmp_lt_u32 s65, 36
s_cbranch_scc0 K3_W1sR
K3_W1sL:
buffer_load_dword v6, v5, s[36:39], 0 offen sc1
s_waitcnt vmcnt(0)
v_cmp_le_u32 vcc, s65, v6
s_nop 0
s_cmp_eq_u64 vcc, -1
s_cbranch_scc1 K3_W1sR
s_sub_u32 s75, s75, 1
s_cmp_lg_u32 s75, 0
s_cbranch_scc1 K3_W1sL
s_branch K3_W1sR
K3_X0s:
K3_NR0s:
buffer_load_dword v6, v5, s[36:39], 0 offen sc1
v_mfma_f32_16x16x32_bf16 v[48:51], v[224:227], v[24:27], v[48:51]
s_and_b32 s67, s64, 7
s_mul_i32 s67, s67, s100
s_add_u32 s67, s67, s11
v_mfma_f32_16x16x32_bf16 v[48:51], v[240:243], v[28:31], v[48:51]
s_mov_b32 s46, s74
s_add_u32 s79, s64, 2
s_mov_b32 s64, s13
v_mfma_f32_16x16x32_bf16 v[52:55], v[196:199], v[16:19], v[52:55]
s_mov_b32 s0, s1
v_mfma_f32_16x16x32_bf16 v[52:55], v[212:215], v[20:23], v[52:55]
v_mfma_f32_16x16x32_bf16 v[52:55], v[228:231], v[24:27], v[52:55]
v_mfma_f32_16x16x32_bf16 v[52:55], v[244:247], v[28:31], v[52:55]
v_mfma_f32_16x16x32_bf16 v[56:59], v[200:203], v[16:19], v[56:59]
v_mfma_f32_16x16x32_bf16 v[56:59], v[216:219], v[20:23], v[56:59]
v_mfma_f32_16x16x32_bf16 v[56:59], v[232:235], v[24:27], v[56:59]
v_mfma_f32_16x16x32_bf16 v[56:59], v[248:251], v[28:31], v[56:59]
v_mfma_f32_16x16x32_bf16 v[60:63], v[204:207], v[16:19], v[60:63]
v_mfma_f32_16x16x32_bf16 v[60:63], v[220:223], v[20:23], v[60:63]
v_mfma_f32_16x16x32_bf16 v[60:63], v[236:239], v[24:27], v[60:63]
v_mfma_f32_16x16x32_bf16 v[60:63], v[252:255], v[28:31], v[60:63]
s_waitcnt vmcnt(0)
s_mov_b32 s68, 2
s_cmp_gt_u32 s64, 33
s_cbranch_scc1 K3_EP0s
v_cmp_le_u32 vcc, s65, v6
s_nop 0
s_cmp_eq_u64 vcc, -1
s_cselect_b32 s68, 1, 0
s_cselect_b32 s42, 0x4000000, 0
s_add_u32 s69, s66, 4096
s_add_u32 m0, s72, 28672
s_nop 0
buffer_load_dwordx4 v11, s[40:43], s69 offen offset:1024 sc1 lds
buffer_load_dwordx4 v1, s[40:43], s69 offen offset:0 sc1 lds
s_add_u32 m0, s72, 24576
s_nop 0
buffer_load_dwordx4 v1, s[40:43], s66 offen offset:0 sc1 lds
buffer_load_dwordx4 v1, s[40:43], s66 offen offset:1024 sc1 lds
buffer_load_dwordx4 v1, s[40:43], s66 offen offset:2048 sc1 lds
buffer_load_dwordx4 v1, s[40:43], s66 offen offset:3072 sc1 lds
buffer_load_dword v6, v5, s[36:39], 0 offen sc1
K3_EP0s:
v_fma_f32 v80, -v130, v104, v48
v_fma_f32 v81, -v130, v105, v49
v_fma_f32 v82, -v130, v106, v50
v_fma_f32 v83, -v130, v107, v51
v_mul_f32 v80, v80, v132
v_mul_f32 v81, v81, v132
v_mul_f32 v82, v82, v132
v_mul_f32 v83, v83, v132
v_fma_f32 v84, -v130, v108, v52
v_fma_f32 v85, -v130, v109, v53
v_fma_f32 v86, -v130, v110, v54
v_fma_f32 v87, -v130, v111, v55
v_mul_f32 v80, v80, v84
v_mul_f32 v81, v81, v85
v_mul_f32 v82, v82, v86
v_mul_f32 v83, v83, v87
v_cvt_pk_bf16_f32 v96, v80, v81
v_cvt_pk_bf16_f32 v97, v82, v83
v_fma_f32 v88, -v130, v112, v56
v_fma_f32 v89, -v130, v113, v57
v_fma_f32 v90, -v130, v114, v58
v_fma_f32 v91, -v130, v115, v59
v_mul_f32 v88, v88, v132
v_mul_f32 v89, v89, v132
v_mul_f32 v90, v90, v132
v_mul_f32 v91, v91, v132
v_fma_f32 v92, -v130, v116, v60
v_fma_f32 v93, -v130, v117, v61
v_fma_f32 v94, -v130, v118, v62
v_fma_f32 v95, -v130, v119, v63
v_mul_f32 v88, v88, v92
v_mul_f32 v89, v89, v93
v_mul_f32 v90, v90, v94
v_mul_f32 v91, v91, v95
v_cvt_pk_bf16_f32 v98, v88, v89
v_cvt_pk_bf16_f32 v99, v90, v91
buffer_store_dwordx4 v[96:99], v101, s[44:47], s67 offen sc1
v_mov_b32 v8, s79
s_mov_b32 s46, 0
s_cmp_eq_u32 s68, 0
s_cbranch_scc1 K3_N20s
s_waitcnt vmcnt(0)
buffer_store_dword v8, v7, s[36:39], 0 offen sc1
s_cmp_eq_u32 s68, 2
s_cbranch_scc1 L_FIN
s_branch K3_GO0s
K3_N20s:
s_waitcnt vmcnt(1)
v_cmp_le_u32 vcc, s65, v6
s_nop 0
s_cmp_eq_u64 vcc, -1
s_cselect_b32 s68, 1, 0
s_cselect_b32 s42, 0x4000000, 0
s_add_u32 s69, s66, 4096
s_add_u32 m0, s72, 28672
s_nop 0
buffer_load_dwordx4 v11, s[40:43], s69 offen offset:1024 sc1 lds
buffer_load_dwordx4 v1, s[40:43], s69 offen offset:0 sc1 lds
s_add_u32 m0, s72, 24576
s_nop 0
buffer_load_dwordx4 v1, s[40:43], s66 offen offset:0 sc1 lds
buffer_load_dwordx4 v1, s[40:43], s66 offen offset:1024 sc1 lds
buffer_load_dwordx4 v1, s[40:43], s66 offen offset:2048 sc1 lds
buffer_load_dwordx4 v1, s[40:43], s66 offen offset:3072 sc1 lds
buffer_load_dword v6, v5, s[36:39], 0 offen sc1
s_waitcnt vmcnt(7)
buffer_store_dword v8, v7, s[36:39], 0 offen sc1
s_waitcnt vmcnt(1)
s_cmp_eq_u32 s68, 1
s_cbranch_scc1 K3_GO0s
K3_SW0s:
s_mov_b32 s75, 0
K3_SP0s:
buffer_load_dword v6, v5, s[36:39], 0 offen sc1
s_add_u32 s75, s75, 1
s_cmp_gt_u32 s75, 0x8000
s_cbranch_scc1 L_TIMEOUT
s_waitcnt vmcnt(0)
v_cmp_le_u32 vcc, s65, v6
s_nop 0
s_cmp_eq_u64 vcc, -1
s_cbranch_scc0 K3_SP0s
s_mov_b32 s42, 0x4000000
s_add_u32 s69, s66, 4096
s_add_u32 m0, s72, 28672
s_nop 0
buffer_load_dwordx4 v11, s[40:43], s69 offen offset:1024 sc1 lds
buffer_load_dwordx4 v1, s[40:43], s69 offen offset:0 sc1 lds
s_add_u32 m0, s72, 24576
s_nop 0
buffer_load_dwordx4 v1, s[40:43], s66 offen offset:0 sc1 lds
buffer_load_dwordx4 v1, s[40:43], s66 offen offset:1024 sc1 lds
buffer_load_dwordx4 v1, s[40:43], s66 offen offset:2048 sc1 lds
buffer_load_dwordx4 v1, s[40:43], s66 offen offset:3072 sc1 lds
buffer_load_dword v6, v5, s[36:39], 0 offen sc1
s_waitcnt vmcnt(0)
K3_GO0s:
s_barrier

ds_read_b128 v[32:35], v100 offset:24576
ds_read_b128 v[36:39], v100 offset:25600
ds_read_b128 v[40:43], v100 offset:26624
v_fma_f32 v80, -v130, v104, v48
ds_read_b128 v[44:47], v100 offset:27648
v_fma_f32 v81, -v130, v105, v49
v_mov_b32 v8, s79
v_fma_f32 v82, -v130, v106, v50
s_add_u32 s13, s64, 1
v_fma_f32 v83, -v130, v107, v51
v_mul_f32 v80, v80, v132
s_cmp_eq_u32 s13, 17
v_mul_f32 v81, v81, v132
v_mul_f32 v82, v82, v132
s_addc_u32 s13, s13, 0
v_mul_f32 v83, v83, v132
v_fma_f32 v84, -v130, v108, v52
s_sub_u32 s1, s13, 17
v_fma_f32 v85, -v130, v109, v53
v_fma_f32 v86, -v130, v110, v54
s_cselect_b32 s1, s13, s1
v_fma_f32 v87, -v130, v111, v55
v_mul_f32 v80, v80, v84
s_mul_i32 s66, s1, 24576
v_mul_f32 v81, v81, v85
v_mul_f32 v82, v82, v86
s_add_u32 s66, s66, s10
v_mul_f32 v83, v83, v87
v_cvt_pk_bf16_f32 v96, v80, v81
s_waitcnt lgkmcnt(0)
v_cvt_pk_bf16_f32 v97, v82, v83
v_fma_f32 v88, -v130, v112, v56
s_nop 7
s_branch K3_F1s
K3_W0s:
s_mov_b32 s75, 6
s_cmp_lt_u32 s65, 36
s_cbranch_scc0 K3_W0sR
K3_W0sL:
buffer_load_dword v6, v5, s[36:39], 0 offen sc1
s_waitcnt vmcnt(0)
v_cmp_le_u32 vcc, s65, v6
s_nop 0
s_cmp_eq_u64 vcc, -1
s_cbranch_scc1 K3_W0sR
s_sub_u32 s75, s75, 1
s_cmp_lg_u32 s75, 0
s_cbranch_scc1 K3_W0sL
s_branch K3_W0sR
.section .rodata,"a"
.p2align 6
.amdhsa_kernel interleave_layers__sliding_local_dilated__glu_gated_bilinear__prompt_kernel
  .amdhsa_next_free_vgpr 512
  .amdhsa_next_free_sgpr 102
  .amdhsa_accum_offset 256
  .amdhsa_group_segment_fixed_size 0
  .amdhsa_kernarg_size 80
  .amdhsa_user_sgpr_count 2
  .amdhsa_user_sgpr_kernarg_segment_ptr 1
  .amdhsa_system_sgpr_workgroup_id_x 1
.end_amdhsa_kernel
```
